```python
import torch

def _softmax(x, axis=-1):
    return torch.softmax(x, dim=axis)

def _gelu(x):
    return torch.nn.functional.gelu(x, approximate='tanh')

def _silu(x):
    return torch.nn.functional.silu(x)

def _sigmoid(x):
    return torch.sigmoid(x)

def _layernorm(x, axis=-1, eps=1e-05):
    m = x.mean(dim=axis, keepdim=True)
    v = x.var(dim=axis, keepdim=True, unbiased=False)
    return (x - m) / torch.sqrt(v + eps)

def _scatter_add(tgt, idx, src, axis=0):
    return tgt.clone().index_add_(axis, idx, src)

def _segment_sum(src, seg, n):
    out = torch.zeros((n,) + src.shape[1:], dtype=src.dtype)
    return out.index_add_(0, seg, src)

def _pad(x, pw):
    flat = tuple((v for pair in reversed(pw) for v in pair))
    return torch.nn.functional.pad(x, flat)
kernel_name = 'gated_mix__linear_kernel_hedgehog__memory_aug_recurrent_mem_tr__prompt'

def setup_inputs():

    _w = lambda a: (lambda t: t.to(torch.bfloat16) if t.is_floating_point() else t)(torch.as_tensor(a))

    def _A_setup():
        B, S, D, H = (1, 2048, 640, 32)
        Dh = D // H
        return {'x': _w((lambda *s: torch.randn(*s, dtype=torch.bfloat16) * 0.05)(B, S, D)), 'wqkv': _w((lambda *s: torch.randn(*s, dtype=torch.bfloat16) * 1.6)(D, 3 * D)), 'w_phi': _w((lambda *s: torch.randn(*s, dtype=torch.bfloat16) * 1.6)(H, Dh, Dh) * Dh ** (-0.5)), 'wo': _w((lambda *s: torch.randn(*s, dtype=torch.bfloat16) * 0.05)(D, D))}
    _A_in = _A_setup()

    def _B_setup():
        B, S, Dm = (1, 2048, 640)
        H, Dh = (32, 128)
        M, seg = (8, 32)
        seg = min(seg, S)
        S = S // seg * seg
        return {'x': _w((lambda *s: torch.randn(*s, dtype=torch.bfloat16) * 0.05)(B, S, Dm)), 'mem0': _w((lambda *s: torch.randn(*s, dtype=torch.bfloat16) * 0.8)(B, M, Dm)), 'Wq': _w((lambda *s: torch.randn(*s, dtype=torch.bfloat16) * 3.2)(Dm, H, Dh) * Dm ** (-0.5)), 'Wk': _w((lambda *s: torch.randn(*s, dtype=torch.bfloat16) * 3.2)(Dm, H, Dh) * Dm ** (-0.5)), 'Wv': _w((lambda *s: torch.randn(*s, dtype=torch.bfloat16) * 0.8)(Dm, H, Dh) * Dm ** (-0.5)), 'Wo': _w((lambda *s: torch.randn(*s, dtype=torch.bfloat16) * 0.8)(H, Dh, Dm) * (H * Dh) ** (-0.5)), 'seg_len': seg}
    _B_in = _B_setup()
    return {'A_x': _A_in['x'], 'A_wqkv': _A_in['wqkv'], 'A_w_phi': _A_in['w_phi'], 'A_wo': _A_in['wo'], 'B_x': _B_in['x'], 'B_mem0': _B_in['mem0'], 'B_Wq': _B_in['Wq'], 'B_Wk': _B_in['Wk'], 'B_Wv': _B_in['Wv'], 'B_Wo': _B_in['Wo'], 'B_seg_len': _B_in['seg_len'], 'gate_w': _w((lambda *s: torch.randn(*s, dtype=torch.bfloat16) * 0.05)(640) * 16.0)}

def reference(A_x, A_wqkv, A_w_phi, A_wo, B_x, B_mem0, B_Wq, B_Wk, B_Wv, B_Wo, B_seg_len, gate_w):

    def _A_ref(x, wqkv, w_phi, wo):
        B, S, D = x.shape
        H = 32
        Dh = D // H
        qkv = (lambda x, *d: x.permute(*d))((x @ wqkv).reshape(B, S, 3, H, Dh), 2, 0, 3, 1, 4)
        q, k, v = (qkv[0], qkv[1], qkv[2])
        pq = torch.einsum('bhsd,hdf->bhsf', q, w_phi)
        pk = torch.einsum('bhsd,hdf->bhsf', k, w_phi)
        phi_q = torch.concatenate([_softmax(pq, axis=-1), _softmax(-pq, axis=-1)], axis=-1)
        phi_k = torch.concatenate([_softmax(pk, axis=-1), _softmax(-pk, axis=-1)], axis=-1)
        kv = torch.einsum('bhsf,bhsd->bhfd', phi_k, v)
        z = torch.einsum('bhsf->bhf', phi_k)
        num = torch.einsum('bhqf,bhfd->bhqd', phi_q, kv)
        den = torch.einsum('bhqf,bhf->bhq', phi_q, z)[..., None] + 1e-06
        o = num / den
        return (lambda x, *d: x.permute(*d))(o, 0, 2, 1, 3).reshape(B, S, D) @ wo

    def _B_ref(x, mem0, Wq, Wk, Wv, Wo, seg_len):
        B, S, Dm = x.shape
        H, Dh = (Wq.shape[1], Wq.shape[2])
        M = mem0.shape[1]
        scale = Dh ** (-0.5)
        n_seg = S // seg_len
        L = M + seg_len
        idx = torch.arange(L)
        mask = (idx[:, None] < M) | (idx[:, None] >= idx[None, :])
        mem = mem0
        outs = []
        for s in range(n_seg):
            xs = x[:, s * seg_len:(s + 1) * seg_len, :].clone()
            h = torch.concatenate([mem, xs], axis=1)
            q = torch.einsum('btd,dhe->bhte', h, Wq)
            k = torch.einsum('btd,dhe->bhte', h, Wk)
            v = torch.einsum('btd,dhe->bhte', h, Wv)
            scores = torch.einsum('bhqe,bhke->bhqk', q, k) * scale
            scores = torch.where(mask[None, None], scores, -1000000000.0)
            p = _softmax(scores, axis=-1)
            o = torch.einsum('bhqk,bhke->bhqe', p, v)
            o = torch.einsum('bhte,hed->btd', o, Wo)
            mem = o[:, :M, :].clone()
            outs.append(o[:, M:, :])
        return torch.concatenate(outs, axis=1)
    x = A_x
    g = _sigmoid((x * gate_w).sum(-1, keepdims=True))
    a = _A_ref(x, A_wqkv, A_w_phi, A_wo)
    b = _B_ref(x, B_mem0, B_Wq, B_Wk, B_Wv, B_Wo, B_seg_len)
    return g * a + (1 - g) * b
```

```asm
; @launch kernel=main_kernel grid=(256,1,1) block=(256,1,1) lds=163840
.amdgcn_target "amdgcn-amd-amdhsa--gfx950"
.text
.globl main_kernel
.p2align 8
.type main_kernel,@function
main_kernel:

  s_cmp_ge_u32 s2, 256
  s_cbranch_scc1 L_end
  s_load_dwordx2 s[4:5], s[0:1], 112
  s_load_dwordx2 s[6:7], s[0:1], 104
  s_load_dwordx4 s[56:59], s[0:1], 40
  s_load_dwordx4 s[60:63], s[0:1], 56
  s_load_dwordx2 s[64:65], s[0:1], 72
  s_getreg_b32 s20, hwreg(HW_REG_XCC_ID, 0, 4)
  v_lshrrev_b32 v1, 6, v0
  v_and_b32 v0, 63, v0
  s_nop 1
  v_readfirstlane_b32 s22, v1
  s_waitcnt lgkmcnt(0)
  s_mov_b32 s8, s4
  s_and_b32 s9, s5, 0xffff
  s_mov_b32 s10, 268435456
  s_mov_b32 s11, 0x20000
  s_mov_b32 s12, s6
  s_and_b32 s13, s7, 0xffff
  s_mov_b32 s14, 256
  s_mov_b32 s15, 0x20000
  s_cmp_lg_u32 s22, 0
  s_cbranch_scc1 L_tk_done
  v_mov_b32 v2, 1
  s_lshl_b32 s40, s20, 2
  v_mov_b32 v3, s40
  s_mov_b64 exec, 1
  buffer_atomic_add v2, v3, s[12:15], 0 offen sc0
  s_waitcnt vmcnt(0)
  v_mov_b32 v4, 0
  ds_write_b32 v4, v2
  s_waitcnt lgkmcnt(0)
  s_mov_b64 exec, -1
L_tk_done:
  s_barrier
  v_mov_b32 v4, 0
  ds_read_b32 v2, v4
  s_waitcnt lgkmcnt(0)
  v_readfirstlane_b32 s21, v2
  s_barrier
  s_cmp_ge_u32 s20, 2
  s_cbranch_scc1 L_worker
  s_cmp_ge_u32 s21, 32
  s_cbranch_scc1 L_worker
  s_memtime s[54:55]
  v_mov_b32 v24, 0
  s_cmp_lg_u32 s22, 0
  s_cbranch_scc1 L_fi_done
  s_lshl_b32 s40, s20, 5
  s_add_u32 s40, s40, s21
  s_lshl_b32 s40, s40, 10
  s_add_u32 s40, s40, 109068288
  v_mov_b32 v25, 0
  v_mov_b32 v26, 0
  v_mov_b32 v27, 0
  v_lshlrev_b32 v20, 4, v0
  buffer_store_dwordx4 v[24:27], v20, s[8:11], s40 offen sc1
  s_or_b32 s40, s20, s21
  s_cmp_lg_u32 s40, 0
  s_cbranch_scc1 L_fi_done
  v_lshlrev_b32 v20, 7, v0
  s_mov_b32 s40, 109051904
  buffer_store_dword v24, v20, s[8:11], s40 offen sc1
  s_add_u32 s40, s40, 8192
  buffer_store_dword v24, v20, s[8:11], s40 offen sc1
  s_waitcnt vmcnt(0)
  v_mov_b32 v24, 1
  v_mov_b32 v20, 40
  s_mov_b64 exec, 1
  buffer_store_dword v24, v20, s[12:15], 0 offen sc1
  s_mov_b64 exec, -1
L_fi_done:
  v_lshlrev_b32 v1, 4, v0
  v_lshrrev_b32 v20, 4, v0
  v_and_b32 v21, 15, v0
  v_bfe_u32 v22, v0, 1, 1
  v_mov_b32 v2, 0x4444
  v_mov_b32 v23, 0xeeee
  v_cmp_eq_u32 vcc, 1, v22
  s_nop 1
  v_cndmask_b32 v2, v2, v23, vcc
  s_mov_b64 s[2:3], vcc
  v_cmp_gt_u32 vcc, 32, v0
  s_nop 1
  s_mov_b64 s[6:7], vcc
  v_lshrrev_b32 v22, 2, v21
  v_lshl_add_u32 v22, v20, 2, v22
  v_lshlrev_b32 v22, 11, v22
  v_and_b32 v23, 3, v21
  v_lshl_add_u32 v3, v23, 4, v22
  s_lshl_b32 s40, s21, 6
  v_add_u32 v3, s40, v3
  v_lshlrev_b32 v22, 2, v20
  v_add_u32 v22, s22, v22
  v_lshlrev_b32 v22, 11, v22
  v_add_u32 v22, s40, v22
  v_lshl_add_u32 v4, v21, 2, v22
  v_and_b32 v22, 1, v20
  v_lshlrev_b32 v22, 1, v22
  v_lshrrev_b32 v24, 1, v20
  v_add_u32 v22, v22, v24
  v_lshlrev_b32 v22, 4, v22
  v_lshl_add_u32 v5, v23, 2, v22
  v_mul_u32_u24 v22, 576, v20
  s_lshl_b32 s40, s22, 6
  v_and_b32 v24, 3, v21
  v_bfe_u32 v25, v21, 2, 1
  v_lshl_add_u32 v24, v25, 3, v24
  v_bfe_u32 v25, v21, 3, 1
  v_lshl_add_u32 v24, v25, 2, v24
  v_lshl_add_u32 v22, v24, 1, v22
  v_add_u32 v22, s40, v22
  v_add_u32 v6, 18432, v22
  v_lshrrev_b32 v22, 2, v21
  v_lshlrev_b32 v22, 1, v22
  v_and_b32 v24, 1, v21
  v_add_u32 v22, v22, v24
  v_mul_u32_u24 v22, 288, v22
  v_lshl_add_u32 v22, v20, 4, v22
  v_add_u32 v7, 18432, v22
  v_lshrrev_b32 v22, 2, v21
  v_lshlrev_b32 v22, 1, v22
  v_and_b32 v23, 1, v21
  v_add_u32 v22, v22, v23
  v_mul_u32_u24 v22, 288, v22
  v_lshl_add_u32 v22, v20, 4, v22
  v_add_u32 v12, 20736, v22
  s_lshr_b32 s40, s22, 1
  s_lshl_b32 s40, s40, 10
  s_and_b32 s41, s22, 1
  s_lshl_b32 s41, s41, 3
  s_add_u32 s40, s40, s41
  s_add_u32 s40, s40, 18432
  v_add_u32 v13, s40, v1
  s_mul_i32 s40, s22, 34816
  s_add_u32 s40, s40, 24576
  v_add_u32 v14, s40, v1
  v_lshlrev_b32 v22, 4, v21
  v_lshl_add_u32 v17, v20, 2, v22
  v_and_b32 v22, 7, v21
  v_mov_b32 v24, 0x3f80
  v_mov_b32 v25, 0x3f800000
  v_and_b32 v23, 1, v22
  v_cmp_eq_u32 vcc, 1, v23
  s_nop 1
  v_cndmask_b32 v24, v24, v25, vcc
  v_lshrrev_b32 v23, 1, v22
  v_cmp_eq_u32 vcc, 0, v23
  s_nop 1
  v_cndmask_b32 v8, 0, v24, vcc
  v_cmp_eq_u32 vcc, 1, v23
  s_nop 1
  v_cndmask_b32 v9, 0, v24, vcc
  v_cmp_eq_u32 vcc, 2, v23
  s_nop 1
  v_cndmask_b32 v10, 0, v24, vcc
  v_cmp_eq_u32 vcc, 3, v23
  s_nop 1
  v_cndmask_b32 v11, 0, v24, vcc
  s_lshl_b32 s24, s21, 1
  s_add_u32 s24, s24, s22
  s_cmp_lt_u32 s22, 2
  s_cbranch_scc1 L_role_ok
  s_add_u32 s24, s21, 64
  s_cmp_eq_u32 s22, 2
  s_cselect_b32 s40, 1, 0
  s_cmp_lt_u32 s21, 16
  s_cselect_b32 s40, s40, 0
  s_cmp_eq_u32 s40, 1
  s_cselect_b32 s24, s24, -1
L_role_ok:
  s_lshr_b32 s40, s24, 4
  s_lshl_b32 s40, s40, 10
  s_and_b32 s41, s24, 3
  s_lshl_b32 s41, s41, 8
  s_add_u32 s40, s40, s41
  s_lshr_b32 s41, s24, 2
  s_and_b32 s41, s41, 3
  s_lshl_b32 s41, s41, 6
  s_add_u32 s40, s40, s41
  s_mul_i32 s30, s20, 30720
  s_add_u32 s30, s30, 59768832
  s_xor_b32 s41, s20, 1
  s_mul_i32 s41, s41, 30720
  s_add_u32 s41, s41, 59768832
  s_add_u32 s27, s30, s40
  s_add_u32 s28, s41, s40
  s_add_u32 s28, s28, 5120
  s_add_u32 s29, s27, 5120
  s_mul_i32 s25, s20, 327680
  s_add_u32 s25, s25, 58720256
  s_lshl_b32 s40, s24, 11
  s_add_u32 s26, s25, s40
  s_lshl_b32 s33, s22, 15
  s_lshl_b32 s40, s22, 4
  s_mov_b64 s[4:5], 0xffff
  s_lshl_b64 s[4:5], s[4:5], s40
  s_mov_b32 s48, 0x000F000F
  s_mov_b32 s49, 0x000F000F
  s_mov_b32 s38, 0x3e0293ee
  s_mov_b32 s50, 0
  s_mov_b32 s52, 0
  s_lshl_b32 s40, s21, 13
  s_add_u32 s34, s40, 0
  s_add_u32 s35, s40, 16777216
  s_and_b32 s41, s22, 1
  s_cmp_eq_u32 s41, 0
  s_cselect_b32 s53, s34, s35
  s_lshl_b32 s40, s22, 11
  s_add_u32 s35, s35, s40
  s_lshl_b32 s40, s21, 11
  s_lshl_b32 s41, s22, 9
  s_add_u32 s40, s40, s41
  s_mul_i32 s41, s20, 4194304
  s_add_u32 s40, s40, s41
  s_add_u32 s36, s40, 50331648
  v_mov_b32 v24, -1
  v_mov_b32 v25, -1
  v_mov_b32 v26, -1
  v_mov_b32 v27, -1
  s_mul_i32 s40, s21, 10240
  s_add_u32 s40, s40, s25
  s_mul_i32 s41, s22, 2560
  s_add_u32 s40, s40, s41
  buffer_store_dwordx4 v[24:27], v1, s[8:11], s40 offen sc1
  buffer_store_dwordx4 v[24:27], v1, s[8:11], s40 offen offset:1024 sc1
  s_mov_b32 exec_hi, 0
  buffer_store_dwordx4 v[24:27], v1, s[8:11], s40 offen offset:2048 sc1
  s_mov_b64 exec, -1
  s_cmp_lg_u32 s22, 0
  s_cbranch_scc1 L_minit_done
  s_mul_i32 s40, s21, 960
  s_add_u32 s40, s40, s30
  v_cmp_gt_u32 vcc, 60, v0
  s_and_saveexec_b64 s[42:43], vcc
  buffer_store_dwordx4 v[24:27], v1, s[8:11], s40 offen sc1
  s_mov_b64 exec, -1
L_minit_done:
  s_mul_i32 s47, s22, 34816
  s_add_u32 s47, s47, 24576
  v_lshrrev_b32 v28, 2, v0
  v_lshlrev_b32 v28, 13, v28
  v_and_b32 v29, 3, v0
  v_lshl_add_u32 v28, v29, 4, v28
  v_lshrrev_b32 v29, 3, v0
  v_mul_u32_u24 v29, 1280, v29
  v_and_b32 v30, 7, v0
  v_lshl_add_u32 v29, v30, 4, v29
  v_lshrrev_b32 v30, 1, v0
  v_mul_u32_u24 v30, 1280, v30
  v_and_b32 v31, 1, v0
  v_lshl_add_u32 v30, v31, 4, v30
  v_lshrrev_b32 v20, 4, v0
  v_bfe_u32 v21, v0, 2, 2
  v_and_b32 v22, 3, v0
  v_lshlrev_b32 v31, 10, v21
  v_lshl_add_u32 v31, v20, 7, v31
  v_lshl_add_u32 v31, v22, 3, v31
  v_lshlrev_b32 v32, 9, v20
  v_lshl_add_u32 v32, v21, 6, v32
  v_lshl_add_u32 v32, v22, 3, v32
  v_add_u32 v31, s47, v31
  v_add_u32 v32, s47, v32
  v_and_b32 v23, 1, v20
  v_lshlrev_b32 v33, 12, v23
  v_lshrrev_b32 v23, 1, v20
  v_lshl_add_u32 v33, v23, 9, v33
  v_lshl_add_u32 v33, v21, 7, v33
  v_lshl_add_u32 v33, v22, 3, v33
  v_add_u32 v33, s47, v33
  v_and_b32 v23, 1, v20
  v_lshlrev_b32 v34, 10, v23
  v_lshrrev_b32 v23, 1, v20
  v_lshl_add_u32 v34, v23, 7, v34
  v_lshl_add_u32 v34, v21, 5, v34
  v_lshl_add_u32 v34, v22, 3, v34
  v_add_u32 v34, s47, v34
  s_mov_b32 s16, s56
  s_and_b32 s17, s57, 0xffff
  s_mov_b32 s18, 10240
  s_mov_b32 s19, 0x20000
  v_lshrrev_b32 v20, 4, v0
  v_and_b32 v21, 15, v0
  v_lshrrev_b32 v22, 2, v21
  v_lshlrev_b32 v22, 1, v22
  v_and_b32 v23, 1, v21
  v_add_u32 v22, v22, v23
  v_mul_u32_u24 v22, 1280, v22
  v_bfe_u32 v23, v21, 1, 1
  v_lshl_add_u32 v36, v23, 6, v22
  v_lshl_add_u32 v36, v20, 3, v36
  v_lshl_add_u32 v37, v20, 5, v22
  v_lshl_add_u32 v37, v23, 2, v37
  s_mul_i32 s40, s20, 640
  s_xor_b32 s41, s20, 1
  s_mul_i32 s41, s41, 640
  s_cmp_lg_u32 s22, 0
  s_cbranch_scc1 L_m0e_0
  buffer_load_ushort v62, v36, s[16:19], s40 offen offset:0
  buffer_load_ushort v74, v36, s[16:19], s40 offen offset:32
  buffer_load_ushort v63, v36, s[16:19], s40 offen offset:2
  buffer_load_ushort v75, v36, s[16:19], s40 offen offset:34
  buffer_load_ushort v64, v36, s[16:19], s40 offen offset:4
  buffer_load_ushort v76, v36, s[16:19], s40 offen offset:36
  buffer_load_ushort v65, v36, s[16:19], s40 offen offset:6
  buffer_load_ushort v77, v36, s[16:19], s40 offen offset:38
  buffer_load_dword v66, v37, s[16:19], s40 offen offset:512
  buffer_load_dword v67, v37, s[16:19], s40 offen offset:520
  buffer_load_dword v68, v37, s[16:19], s40 offen offset:528
  buffer_load_dword v69, v37, s[16:19], s40 offen offset:536
  buffer_load_ushort v70, v36, s[16:19], s41 offen offset:384
  buffer_load_ushort v82, v36, s[16:19], s41 offen offset:416
  buffer_load_ushort v71, v36, s[16:19], s41 offen offset:386
  buffer_load_ushort v83, v36, s[16:19], s41 offen offset:418
  buffer_load_ushort v72, v36, s[16:19], s41 offen offset:388
  buffer_load_ushort v84, v36, s[16:19], s41 offen offset:420
  buffer_load_ushort v73, v36, s[16:19], s41 offen offset:390
  buffer_load_ushort v85, v36, s[16:19], s41 offen offset:422
L_m0e_0:
  s_cmp_lg_u32 s22, 1
  s_cbranch_scc1 L_m0e_1
  buffer_load_ushort v62, v36, s[16:19], s40 offen offset:128
  buffer_load_ushort v74, v36, s[16:19], s40 offen offset:160
  buffer_load_ushort v63, v36, s[16:19], s40 offen offset:130
  buffer_load_ushort v75, v36, s[16:19], s40 offen offset:162
  buffer_load_ushort v64, v36, s[16:19], s40 offen offset:132
  buffer_load_ushort v76, v36, s[16:19], s40 offen offset:164
  buffer_load_ushort v65, v36, s[16:19], s40 offen offset:134
  buffer_load_ushort v77, v36, s[16:19], s40 offen offset:166
  buffer_load_ushort v66, v36, s[16:19], s41 offen offset:0
  buffer_load_ushort v78, v36, s[16:19], s41 offen offset:32
  buffer_load_ushort v67, v36, s[16:19], s41 offen offset:2
  buffer_load_ushort v79, v36, s[16:19], s41 offen offset:34
  buffer_load_ushort v68, v36, s[16:19], s41 offen offset:4
  buffer_load_ushort v80, v36, s[16:19], s41 offen offset:36
  buffer_load_ushort v69, v36, s[16:19], s41 offen offset:6
  buffer_load_ushort v81, v36, s[16:19], s41 offen offset:38
  buffer_load_dword v70, v37, s[16:19], s41 offen offset:512
  buffer_load_dword v71, v37, s[16:19], s41 offen offset:520
  buffer_load_dword v72, v37, s[16:19], s41 offen offset:528
  buffer_load_dword v73, v37, s[16:19], s41 offen offset:536
L_m0e_1:
  s_cmp_lg_u32 s22, 2
  s_cbranch_scc1 L_m0e_2
  buffer_load_ushort v62, v36, s[16:19], s40 offen offset:256
  buffer_load_ushort v74, v36, s[16:19], s40 offen offset:288
  buffer_load_ushort v63, v36, s[16:19], s40 offen offset:258
  buffer_load_ushort v75, v36, s[16:19], s40 offen offset:290
  buffer_load_ushort v64, v36, s[16:19], s40 offen offset:260
  buffer_load_ushort v76, v36, s[16:19], s40 offen offset:292
  buffer_load_ushort v65, v36, s[16:19], s40 offen offset:262
  buffer_load_ushort v77, v36, s[16:19], s40 offen offset:294
  buffer_load_ushort v66, v36, s[16:19], s41 offen offset:128
  buffer_load_ushort v78, v36, s[16:19], s41 offen offset:160
  buffer_load_ushort v67, v36, s[16:19], s41 offen offset:130
  buffer_load_ushort v79, v36, s[16:19], s41 offen offset:162
  buffer_load_ushort v68, v36, s[16:19], s41 offen offset:132
  buffer_load_ushort v80, v36, s[16:19], s41 offen offset:164
  buffer_load_ushort v69, v36, s[16:19], s41 offen offset:134
  buffer_load_ushort v81, v36, s[16:19], s41 offen offset:166
L_m0e_2:
  s_cmp_lg_u32 s22, 3
  s_cbranch_scc1 L_m0e_3
  buffer_load_ushort v62, v36, s[16:19], s40 offen offset:384
  buffer_load_ushort v74, v36, s[16:19], s40 offen offset:416
  buffer_load_ushort v63, v36, s[16:19], s40 offen offset:386
  buffer_load_ushort v75, v36, s[16:19], s40 offen offset:418
  buffer_load_ushort v64, v36, s[16:19], s40 offen offset:388
  buffer_load_ushort v76, v36, s[16:19], s40 offen offset:420
  buffer_load_ushort v65, v36, s[16:19], s40 offen offset:390
  buffer_load_ushort v77, v36, s[16:19], s40 offen offset:422
  buffer_load_ushort v66, v36, s[16:19], s41 offen offset:256
  buffer_load_ushort v78, v36, s[16:19], s41 offen offset:288
  buffer_load_ushort v67, v36, s[16:19], s41 offen offset:258
  buffer_load_ushort v79, v36, s[16:19], s41 offen offset:290
  buffer_load_ushort v68, v36, s[16:19], s41 offen offset:260
  buffer_load_ushort v80, v36, s[16:19], s41 offen offset:292
  buffer_load_ushort v69, v36, s[16:19], s41 offen offset:262
  buffer_load_ushort v81, v36, s[16:19], s41 offen offset:294
L_m0e_3:
  s_mul_i32 s40, s21, 163840
  s_mul_i32 s41, s20, 640
  s_add_u32 s40, s40, s41
  s_lshl_b32 s41, s22, 7
  s_add_u32 s42, s40, s41
  s_lshl_b32 s41, s22, 5
  s_add_u32 s43, s40, s41
  s_add_u32 s43, s43, 512
  s_mov_b32 s16, s64
  s_and_b32 s17, s65, 0xffff
  s_mov_b32 s18, 5242880
  s_mov_b32 s19, 0x20000
  s_add_u32 s44, s42, 0
  s_add_u32 m0, s47, 0
  buffer_load_dwordx4 v29, s[16:19], s44 offen lds
  s_add_u32 s44, s42, 10240
  s_add_u32 m0, s47, 1024
  buffer_load_dwordx4 v29, s[16:19], s44 offen lds
  s_add_u32 s44, s42, 20480
  s_add_u32 m0, s47, 2048
  buffer_load_dwordx4 v29, s[16:19], s44 offen lds
  s_add_u32 s44, s42, 30720
  s_add_u32 m0, s47, 3072
  buffer_load_dwordx4 v29, s[16:19], s44 offen lds
  s_add_u32 s44, s42, 40960
  s_add_u32 m0, s47, 4096
  buffer_load_dwordx4 v29, s[16:19], s44 offen lds
  s_add_u32 s44, s42, 51200
  s_add_u32 m0, s47, 5120
  buffer_load_dwordx4 v29, s[16:19], s44 offen lds
  s_add_u32 s44, s42, 61440
  s_add_u32 m0, s47, 6144
  buffer_load_dwordx4 v29, s[16:19], s44 offen lds
  s_add_u32 s44, s42, 71680
  s_add_u32 m0, s47, 7168
  buffer_load_dwordx4 v29, s[16:19], s44 offen lds
  s_add_u32 s44, s42, 81920
  s_add_u32 m0, s47, 8192
  buffer_load_dwordx4 v29, s[16:19], s44 offen lds
  s_add_u32 s44, s42, 92160
  s_add_u32 m0, s47, 9216
  buffer_load_dwordx4 v29, s[16:19], s44 offen lds
  s_add_u32 s44, s42, 102400
  s_add_u32 m0, s47, 10240
  buffer_load_dwordx4 v29, s[16:19], s44 offen lds
  s_add_u32 s44, s42, 112640
  s_add_u32 m0, s47, 11264
  buffer_load_dwordx4 v29, s[16:19], s44 offen lds
  s_add_u32 s44, s42, 122880
  s_add_u32 m0, s47, 12288
  buffer_load_dwordx4 v29, s[16:19], s44 offen lds
  s_add_u32 s44, s42, 133120
  s_add_u32 m0, s47, 13312
  buffer_load_dwordx4 v29, s[16:19], s44 offen lds
  s_add_u32 s44, s42, 143360
  s_add_u32 m0, s47, 14336
  buffer_load_dwordx4 v29, s[16:19], s44 offen lds
  s_add_u32 s44, s42, 153600
  s_add_u32 m0, s47, 15360
  buffer_load_dwordx4 v29, s[16:19], s44 offen lds
  s_add_u32 s44, s43, 0
  s_add_u32 m0, s47, 16384
  buffer_load_dwordx4 v30, s[16:19], s44 offen lds
  s_add_u32 s44, s43, 40960
  s_add_u32 m0, s47, 17408
  buffer_load_dwordx4 v30, s[16:19], s44 offen lds
  s_add_u32 s44, s43, 81920
  s_add_u32 m0, s47, 18432
  buffer_load_dwordx4 v30, s[16:19], s44 offen lds
  s_add_u32 s44, s43, 122880
  s_add_u32 m0, s47, 19456
  buffer_load_dwordx4 v30, s[16:19], s44 offen lds
  s_mul_i32 s40, s20, 2621440
  s_xor_b32 s41, s20, 1
  s_mul_i32 s41, s41, 2621440
  s_lshl_b32 s42, s21, 8
  s_lshl_b32 s43, s22, 6
  s_add_u32 s42, s42, s43
  s_add_u32 s40, s40, s42
  s_add_u32 s41, s41, s42
  s_lshl_b32 s46, s22, 12
  s_mov_b32 s16, s58
  s_and_b32 s17, s59, 0xffff
  s_mov_b32 s18, 5242880
  s_mov_b32 s19, 0x20000
  s_add_u32 s44, s40, 0
  s_add_u32 m0, s47, 20480
  buffer_load_dwordx4 v28, s[16:19], s44 offen lds
  s_add_u32 s44, s40, 131072
  s_add_u32 m0, s47, 21504
  buffer_load_dwordx4 v28, s[16:19], s44 offen lds
  s_add_u32 s44, s40, 262144
  s_add_u32 m0, s47, 22528
  buffer_load_dwordx4 v28, s[16:19], s44 offen lds
  s_add_u32 s44, s40, 393216
  s_add_u32 m0, s47, 23552
  buffer_load_dwordx4 v28, s[16:19], s44 offen lds
  s_add_u32 s44, s40, 524288
  s_add_u32 m0, s47, 24576
  buffer_load_dwordx4 v28, s[16:19], s44 offen lds
  s_add_u32 s44, s40, 655360
  s_add_u32 m0, s47, 25600
  buffer_load_dwordx4 v28, s[16:19], s44 offen lds
  s_add_u32 s44, s40, 786432
  s_add_u32 m0, s47, 26624
  buffer_load_dwordx4 v28, s[16:19], s44 offen lds
  s_add_u32 s44, s40, 917504
  s_add_u32 m0, s47, 27648
  buffer_load_dwordx4 v28, s[16:19], s44 offen lds
  s_add_u32 s44, s40, 1048576
  s_add_u32 m0, s47, 28672
  buffer_load_dwordx4 v28, s[16:19], s44 offen lds
  s_add_u32 s44, s40, 1179648
  s_add_u32 m0, s47, 29696
  buffer_load_dwordx4 v28, s[16:19], s44 offen lds
  s_add_u32 s44, s40, 1310720
  s_add_u32 m0, s47, 30720
  buffer_load_dwordx4 v28, s[16:19], s44 offen lds
  s_add_u32 s44, s40, 1441792
  s_add_u32 m0, s47, 31744
  buffer_load_dwordx4 v28, s[16:19], s44 offen lds
  s_waitcnt vmcnt(12)
  ds_read_b64_tr_b16 v[176:177], v33 offset:0
  ds_read_b64_tr_b16 v[178:179], v33 offset:2048
  ds_read_b64_tr_b16 v[180:181], v33 offset:1024
  ds_read_b64_tr_b16 v[182:183], v33 offset:3072
  ds_read_b64_tr_b16 v[184:185], v33 offset:8192
  ds_read_b64_tr_b16 v[186:187], v33 offset:10240
  ds_read_b64_tr_b16 v[188:189], v33 offset:9216
  ds_read_b64_tr_b16 v[190:191], v33 offset:11264
  ds_read_b64_tr_b16 v[192:193], v33 offset:32
  ds_read_b64_tr_b16 v[194:195], v33 offset:2080
  ds_read_b64_tr_b16 v[196:197], v33 offset:1056
  ds_read_b64_tr_b16 v[198:199], v33 offset:3104
  ds_read_b64_tr_b16 v[200:201], v33 offset:8224
  ds_read_b64_tr_b16 v[202:203], v33 offset:10272
  ds_read_b64_tr_b16 v[204:205], v33 offset:9248
  ds_read_b64_tr_b16 v[206:207], v33 offset:11296
  ds_read_b64_tr_b16 v[208:209], v33 offset:64
  ds_read_b64_tr_b16 v[210:211], v33 offset:2112
  ds_read_b64_tr_b16 v[212:213], v33 offset:1088
  ds_read_b64_tr_b16 v[214:215], v33 offset:3136
  ds_read_b64_tr_b16 v[216:217], v33 offset:8256
  ds_read_b64_tr_b16 v[218:219], v33 offset:10304
  ds_read_b64_tr_b16 v[220:221], v33 offset:9280
  ds_read_b64_tr_b16 v[222:223], v33 offset:11328
  ds_read_b64_tr_b16 v[224:225], v33 offset:96
  ds_read_b64_tr_b16 v[226:227], v33 offset:2144
  ds_read_b64_tr_b16 v[228:229], v33 offset:1120
  ds_read_b64_tr_b16 v[230:231], v33 offset:3168
  ds_read_b64_tr_b16 v[232:233], v33 offset:8288
  ds_read_b64_tr_b16 v[234:235], v33 offset:10336
  ds_read_b64_tr_b16 v[236:237], v33 offset:9312
  ds_read_b64_tr_b16 v[238:239], v33 offset:11360
  ds_read_b64_tr_b16 v[240:241], v34 offset:16384
  ds_read_b64_tr_b16 v[242:243], v34 offset:16896
  ds_read_b64_tr_b16 v[244:245], v34 offset:16640
  ds_read_b64_tr_b16 v[246:247], v34 offset:17152
  ds_read_b64_tr_b16 v[248:249], v34 offset:18432
  ds_read_b64_tr_b16 v[250:251], v34 offset:18944
  ds_read_b64_tr_b16 v[252:253], v34 offset:18688
  ds_read_b64_tr_b16 v[254:255], v34 offset:19200
  s_waitcnt lgkmcnt(0)
  s_barrier
  s_cmp_lg_u32 s22, 0
  s_cbranch_scc1 L_arr0
  s_mov_b64 exec, 1
  v_mov_b32 v20, 1
  v_mov_b32 v21, 128
  buffer_atomic_add v20, v21, s[12:15], 0 offen
  s_mov_b64 exec, -1
L_arr0:
  s_add_u32 s44, s40, 1572864
  s_add_u32 m0, s47, 0
  buffer_load_dwordx4 v28, s[16:19], s44 offen lds
  s_add_u32 s44, s40, 1703936
  s_add_u32 m0, s47, 1024
  buffer_load_dwordx4 v28, s[16:19], s44 offen lds
  s_add_u32 s44, s40, 1835008
  s_add_u32 m0, s47, 2048
  buffer_load_dwordx4 v28, s[16:19], s44 offen lds
  s_add_u32 s44, s40, 1966080
  s_add_u32 m0, s47, 3072
  buffer_load_dwordx4 v28, s[16:19], s44 offen lds
  s_add_u32 s44, s40, 2097152
  s_add_u32 m0, s47, 4096
  buffer_load_dwordx4 v28, s[16:19], s44 offen lds
  s_add_u32 s44, s40, 2228224
  s_add_u32 m0, s47, 5120
  buffer_load_dwordx4 v28, s[16:19], s44 offen lds
  s_add_u32 s44, s40, 2359296
  s_add_u32 m0, s47, 6144
  buffer_load_dwordx4 v28, s[16:19], s44 offen lds
  s_add_u32 s44, s40, 2490368
  s_add_u32 m0, s47, 7168
  buffer_load_dwordx4 v28, s[16:19], s44 offen lds
  s_add_u32 s44, s41, 0
  s_add_u32 m0, s47, 8192
  buffer_load_dwordx4 v28, s[16:19], s44 offen lds
  s_add_u32 s44, s41, 131072
  s_add_u32 m0, s47, 9216
  buffer_load_dwordx4 v28, s[16:19], s44 offen lds
  s_add_u32 s44, s41, 262144
  s_add_u32 m0, s47, 10240
  buffer_load_dwordx4 v28, s[16:19], s44 offen lds
  s_add_u32 s44, s41, 393216
  s_add_u32 m0, s47, 11264
  buffer_load_dwordx4 v28, s[16:19], s44 offen lds
  s_add_u32 s44, s41, 524288
  s_add_u32 m0, s47, 12288
  buffer_load_dwordx4 v28, s[16:19], s44 offen lds
  s_add_u32 s44, s41, 655360
  s_add_u32 m0, s47, 13312
  buffer_load_dwordx4 v28, s[16:19], s44 offen lds
  s_add_u32 s44, s41, 786432
  s_add_u32 m0, s47, 14336
  buffer_load_dwordx4 v28, s[16:19], s44 offen lds
  s_add_u32 s44, s41, 917504
  s_add_u32 m0, s47, 15360
  buffer_load_dwordx4 v28, s[16:19], s44 offen lds
  s_add_u32 s44, s41, 1048576
  s_add_u32 m0, s47, 16384
  buffer_load_dwordx4 v28, s[16:19], s44 offen lds
  s_add_u32 s44, s41, 1179648
  s_add_u32 m0, s47, 17408
  buffer_load_dwordx4 v28, s[16:19], s44 offen lds
  s_add_u32 s44, s41, 1310720
  s_add_u32 m0, s47, 18432
  buffer_load_dwordx4 v28, s[16:19], s44 offen lds
  s_add_u32 s44, s41, 1441792
  s_add_u32 m0, s47, 19456
  buffer_load_dwordx4 v28, s[16:19], s44 offen lds
  s_waitcnt vmcnt(28)
  ds_read_b64_tr_b16 a[0:1], v31 offset:20480
  ds_read_b64_tr_b16 a[2:3], v31 offset:20544
  ds_read_b64_tr_b16 a[4:5], v31 offset:20992
  ds_read_b64_tr_b16 a[6:7], v31 offset:21056
  ds_read_b64_tr_b16 a[80:81], v31 offset:20512
  ds_read_b64_tr_b16 a[82:83], v31 offset:20576
  ds_read_b64_tr_b16 a[84:85], v31 offset:21024
  ds_read_b64_tr_b16 a[86:87], v31 offset:21088
  s_waitcnt lgkmcnt(0)
  s_add_u32 s44, s41, 1572864
  s_add_u32 m0, s47, 20480
  buffer_load_dwordx4 v28, s[16:19], s44 offen lds
  s_add_u32 s44, s41, 1703936
  s_add_u32 m0, s47, 21504
  buffer_load_dwordx4 v28, s[16:19], s44 offen lds
  s_add_u32 s44, s41, 1835008
  s_add_u32 m0, s47, 22528
  buffer_load_dwordx4 v28, s[16:19], s44 offen lds
  s_add_u32 s44, s41, 1966080
  s_add_u32 m0, s47, 23552
  buffer_load_dwordx4 v28, s[16:19], s44 offen lds
  s_waitcnt vmcnt(28)
  ds_read_b64_tr_b16 a[8:9], v31 offset:24576
  ds_read_b64_tr_b16 a[10:11], v31 offset:24640
  ds_read_b64_tr_b16 a[12:13], v31 offset:25088
  ds_read_b64_tr_b16 a[14:15], v31 offset:25152
  ds_read_b64_tr_b16 a[88:89], v31 offset:24608
  ds_read_b64_tr_b16 a[90:91], v31 offset:24672
  ds_read_b64_tr_b16 a[92:93], v31 offset:25120
  ds_read_b64_tr_b16 a[94:95], v31 offset:25184
  s_waitcnt lgkmcnt(0)
  s_add_u32 s44, s41, 2097152
  s_add_u32 m0, s47, 24576
  buffer_load_dwordx4 v28, s[16:19], s44 offen lds
  s_add_u32 s44, s41, 2228224
  s_add_u32 m0, s47, 25600
  buffer_load_dwordx4 v28, s[16:19], s44 offen lds
  s_add_u32 s44, s41, 2359296
  s_add_u32 m0, s47, 26624
  buffer_load_dwordx4 v28, s[16:19], s44 offen lds
  s_add_u32 s44, s41, 2490368
  s_add_u32 m0, s47, 27648
  buffer_load_dwordx4 v28, s[16:19], s44 offen lds
  s_waitcnt vmcnt(28)
  ds_read_b64_tr_b16 a[16:17], v31 offset:28672
  ds_read_b64_tr_b16 a[18:19], v31 offset:28736
  ds_read_b64_tr_b16 a[20:21], v31 offset:29184
  ds_read_b64_tr_b16 a[22:23], v31 offset:29248
  ds_read_b64_tr_b16 a[96:97], v31 offset:28704
  ds_read_b64_tr_b16 a[98:99], v31 offset:28768
  ds_read_b64_tr_b16 a[100:101], v31 offset:29216
  ds_read_b64_tr_b16 a[102:103], v31 offset:29280
  s_waitcnt lgkmcnt(0)
  s_mov_b32 s16, s60
  s_and_b32 s17, s61, 0xffff
  s_mov_b32 s18, 5242880
  s_mov_b32 s19, 0x20000
  s_add_u32 s44, s41, 0
  s_add_u32 m0, s47, 28672
  buffer_load_dwordx4 v28, s[16:19], s44 offen lds
  s_add_u32 s44, s41, 131072
  s_add_u32 m0, s47, 29696
  buffer_load_dwordx4 v28, s[16:19], s44 offen lds
  s_add_u32 s44, s41, 262144
  s_add_u32 m0, s47, 30720
  buffer_load_dwordx4 v28, s[16:19], s44 offen lds
  s_add_u32 s44, s41, 393216
  s_add_u32 m0, s47, 31744
  buffer_load_dwordx4 v28, s[16:19], s44 offen lds
  s_waitcnt vmcnt(28)
  ds_read_b64_tr_b16 a[24:25], v31 offset:0
  ds_read_b64_tr_b16 a[26:27], v31 offset:64
  ds_read_b64_tr_b16 a[28:29], v31 offset:512
  ds_read_b64_tr_b16 a[30:31], v31 offset:576
  ds_read_b64_tr_b16 a[104:105], v31 offset:32
  ds_read_b64_tr_b16 a[106:107], v31 offset:96
  ds_read_b64_tr_b16 a[108:109], v31 offset:544
  ds_read_b64_tr_b16 a[110:111], v31 offset:608
  s_waitcnt lgkmcnt(0)
  s_add_u32 s44, s41, 524288
  s_add_u32 m0, s47, 0
  buffer_load_dwordx4 v28, s[16:19], s44 offen lds
  s_add_u32 s44, s41, 655360
  s_add_u32 m0, s47, 1024
  buffer_load_dwordx4 v28, s[16:19], s44 offen lds
  s_add_u32 s44, s41, 786432
  s_add_u32 m0, s47, 2048
  buffer_load_dwordx4 v28, s[16:19], s44 offen lds
  s_add_u32 s44, s41, 917504
  s_add_u32 m0, s47, 3072
  buffer_load_dwordx4 v28, s[16:19], s44 offen lds
  s_waitcnt vmcnt(28)
  ds_read_b64_tr_b16 a[32:33], v32 offset:4096
  ds_read_b64_tr_b16 a[34:35], v32 offset:4352
  ds_read_b64_tr_b16 a[36:37], v32 offset:6144
  ds_read_b64_tr_b16 a[38:39], v32 offset:6400
  ds_read_b64_tr_b16 a[112:113], v32 offset:4128
  ds_read_b64_tr_b16 a[114:115], v32 offset:4384
  ds_read_b64_tr_b16 a[116:117], v32 offset:6176
  ds_read_b64_tr_b16 a[118:119], v32 offset:6432
  s_waitcnt lgkmcnt(0)
  s_add_u32 s44, s41, 1048576
  s_add_u32 m0, s47, 4096
  buffer_load_dwordx4 v28, s[16:19], s44 offen lds
  s_add_u32 s44, s41, 1179648
  s_add_u32 m0, s47, 5120
  buffer_load_dwordx4 v28, s[16:19], s44 offen lds
  s_add_u32 s44, s41, 1310720
  s_add_u32 m0, s47, 6144
  buffer_load_dwordx4 v28, s[16:19], s44 offen lds
  s_add_u32 s44, s41, 1441792
  s_add_u32 m0, s47, 7168
  buffer_load_dwordx4 v28, s[16:19], s44 offen lds
  s_waitcnt vmcnt(28)
  ds_read_b64_tr_b16 a[40:41], v31 offset:8192
  ds_read_b64_tr_b16 a[42:43], v31 offset:8256
  ds_read_b64_tr_b16 a[44:45], v31 offset:8704
  ds_read_b64_tr_b16 a[46:47], v31 offset:8768
  ds_read_b64_tr_b16 a[120:121], v31 offset:8224
  ds_read_b64_tr_b16 a[122:123], v31 offset:8288
  ds_read_b64_tr_b16 a[124:125], v31 offset:8736
  ds_read_b64_tr_b16 a[126:127], v31 offset:8800
  s_waitcnt lgkmcnt(0)
  s_add_u32 s44, s41, 1572864
  s_add_u32 m0, s47, 8192
  buffer_load_dwordx4 v28, s[16:19], s44 offen lds
  s_add_u32 s44, s41, 1703936
  s_add_u32 m0, s47, 9216
  buffer_load_dwordx4 v28, s[16:19], s44 offen lds
  s_add_u32 s44, s41, 1835008
  s_add_u32 m0, s47, 10240
  buffer_load_dwordx4 v28, s[16:19], s44 offen lds
  s_add_u32 s44, s41, 1966080
  s_add_u32 m0, s47, 11264
  buffer_load_dwordx4 v28, s[16:19], s44 offen lds
  s_waitcnt vmcnt(28)
  ds_read_b64_tr_b16 a[48:49], v31 offset:12288
  ds_read_b64_tr_b16 a[50:51], v31 offset:12352
  ds_read_b64_tr_b16 a[52:53], v31 offset:12800
  ds_read_b64_tr_b16 a[54:55], v31 offset:12864
  ds_read_b64_tr_b16 a[128:129], v31 offset:12320
  ds_read_b64_tr_b16 a[130:131], v31 offset:12384
  ds_read_b64_tr_b16 a[132:133], v31 offset:12832
  ds_read_b64_tr_b16 a[134:135], v31 offset:12896
  s_waitcnt lgkmcnt(0)
  s_add_u32 s44, s41, 2097152
  s_add_u32 m0, s47, 12288
  buffer_load_dwordx4 v28, s[16:19], s44 offen lds
  s_add_u32 s44, s41, 2228224
  s_add_u32 m0, s47, 13312
  buffer_load_dwordx4 v28, s[16:19], s44 offen lds
  s_add_u32 s44, s41, 2359296
  s_add_u32 m0, s47, 14336
  buffer_load_dwordx4 v28, s[16:19], s44 offen lds
  s_add_u32 s44, s41, 2490368
  s_add_u32 m0, s47, 15360
  buffer_load_dwordx4 v28, s[16:19], s44 offen lds
  s_waitcnt vmcnt(28)
  ds_read_b64_tr_b16 a[56:57], v31 offset:16384
  ds_read_b64_tr_b16 a[58:59], v31 offset:16448
  ds_read_b64_tr_b16 a[60:61], v31 offset:16896
  ds_read_b64_tr_b16 a[62:63], v31 offset:16960
  ds_read_b64_tr_b16 a[136:137], v31 offset:16416
  ds_read_b64_tr_b16 a[138:139], v31 offset:16480
  ds_read_b64_tr_b16 a[140:141], v31 offset:16928
  ds_read_b64_tr_b16 a[142:143], v31 offset:16992
  s_waitcnt lgkmcnt(0)
  s_mov_b32 s16, s62
  s_and_b32 s17, s63, 0xffff
  s_mov_b32 s18, 5242880
  s_mov_b32 s19, 0x20000
  s_add_u32 s44, s41, 0
  s_add_u32 m0, s47, 16384
  buffer_load_dwordx4 v28, s[16:19], s44 offen lds
  s_add_u32 s44, s41, 131072
  s_add_u32 m0, s47, 17408
  buffer_load_dwordx4 v28, s[16:19], s44 offen lds
  s_add_u32 s44, s41, 262144
  s_add_u32 m0, s47, 18432
  buffer_load_dwordx4 v28, s[16:19], s44 offen lds
  s_add_u32 s44, s41, 393216
  s_add_u32 m0, s47, 19456
  buffer_load_dwordx4 v28, s[16:19], s44 offen lds
  s_waitcnt vmcnt(28)
  ds_read_b64_tr_b16 a[64:65], v31 offset:20480
  ds_read_b64_tr_b16 a[66:67], v31 offset:20544
  ds_read_b64_tr_b16 a[68:69], v31 offset:20992
  ds_read_b64_tr_b16 a[70:71], v31 offset:21056
  ds_read_b64_tr_b16 a[144:145], v31 offset:20512
  ds_read_b64_tr_b16 a[146:147], v31 offset:20576
  ds_read_b64_tr_b16 a[148:149], v31 offset:21024
  ds_read_b64_tr_b16 a[150:151], v31 offset:21088
  s_waitcnt lgkmcnt(0)
  s_add_u32 s44, s41, 524288
  s_add_u32 m0, s47, 20480
  buffer_load_dwordx4 v28, s[16:19], s44 offen lds
  s_add_u32 s44, s41, 655360
  s_add_u32 m0, s47, 21504
  buffer_load_dwordx4 v28, s[16:19], s44 offen lds
  s_add_u32 s44, s41, 786432
  s_add_u32 m0, s47, 22528
  buffer_load_dwordx4 v28, s[16:19], s44 offen lds
  s_add_u32 s44, s41, 917504
  s_add_u32 m0, s47, 23552
  buffer_load_dwordx4 v28, s[16:19], s44 offen lds
  s_waitcnt vmcnt(28)
  ds_read_b64_tr_b16 a[72:73], v32 offset:24576
  ds_read_b64_tr_b16 a[74:75], v32 offset:24832
  ds_read_b64_tr_b16 a[76:77], v32 offset:26624
  ds_read_b64_tr_b16 a[78:79], v32 offset:26880
  ds_read_b64_tr_b16 a[152:153], v32 offset:24608
  ds_read_b64_tr_b16 a[154:155], v32 offset:24864
  ds_read_b64_tr_b16 a[156:157], v32 offset:26656
  ds_read_b64_tr_b16 a[158:159], v32 offset:26912
  s_waitcnt lgkmcnt(0)
  s_add_u32 s44, s41, 1048576
  s_add_u32 m0, s47, 24576
  buffer_load_dwordx4 v28, s[16:19], s44 offen lds
  s_add_u32 s44, s41, 1179648
  s_add_u32 m0, s47, 25600
  buffer_load_dwordx4 v28, s[16:19], s44 offen lds
  s_add_u32 s44, s41, 1310720
  s_add_u32 m0, s47, 26624
  buffer_load_dwordx4 v28, s[16:19], s44 offen lds
  s_add_u32 s44, s41, 1441792
  s_add_u32 m0, s47, 27648
  buffer_load_dwordx4 v28, s[16:19], s44 offen lds
  s_waitcnt vmcnt(28)
  ds_read_b64_tr_b16 a[160:161], v31 offset:28672
  ds_read_b64_tr_b16 a[162:163], v31 offset:28736
  ds_read_b64_tr_b16 a[164:165], v31 offset:29184
  ds_read_b64_tr_b16 a[166:167], v31 offset:29248
  ds_read_b64_tr_b16 a[168:169], v31 offset:28704
  ds_read_b64_tr_b16 a[170:171], v31 offset:28768
  ds_read_b64_tr_b16 a[172:173], v31 offset:29216
  ds_read_b64_tr_b16 a[174:175], v31 offset:29280
  s_waitcnt lgkmcnt(0)
  s_add_u32 s44, s41, 1572864
  s_add_u32 m0, s47, 28672
  buffer_load_dwordx4 v28, s[16:19], s44 offen lds
  s_add_u32 s44, s41, 1703936
  s_add_u32 m0, s47, 29696
  buffer_load_dwordx4 v28, s[16:19], s44 offen lds
  s_add_u32 s44, s41, 1835008
  s_add_u32 m0, s47, 30720
  buffer_load_dwordx4 v28, s[16:19], s44 offen lds
  s_add_u32 s44, s41, 1966080
  s_add_u32 m0, s47, 31744
  buffer_load_dwordx4 v28, s[16:19], s44 offen lds
  s_waitcnt vmcnt(28)
  ds_read_b64_tr_b16 a[176:177], v31 offset:0
  ds_read_b64_tr_b16 a[178:179], v31 offset:64
  ds_read_b64_tr_b16 a[180:181], v31 offset:512
  ds_read_b64_tr_b16 a[182:183], v31 offset:576
  ds_read_b64_tr_b16 a[184:185], v31 offset:32
  ds_read_b64_tr_b16 a[186:187], v31 offset:96
  ds_read_b64_tr_b16 a[188:189], v31 offset:544
  ds_read_b64_tr_b16 a[190:191], v31 offset:608
  s_waitcnt lgkmcnt(0)
  s_add_u32 s44, s41, 2097152
  s_add_u32 m0, s47, 0
  buffer_load_dwordx4 v28, s[16:19], s44 offen lds
  s_add_u32 s44, s41, 2228224
  s_add_u32 m0, s47, 1024
  buffer_load_dwordx4 v28, s[16:19], s44 offen lds
  s_add_u32 s44, s41, 2359296
  s_add_u32 m0, s47, 2048
  buffer_load_dwordx4 v28, s[16:19], s44 offen lds
  s_add_u32 s44, s41, 2490368
  s_add_u32 m0, s47, 3072
  buffer_load_dwordx4 v28, s[16:19], s44 offen lds
  s_waitcnt vmcnt(28)
  ds_read_b64_tr_b16 a[192:193], v31 offset:4096
  ds_read_b64_tr_b16 a[194:195], v31 offset:4160
  ds_read_b64_tr_b16 a[196:197], v31 offset:4608
  ds_read_b64_tr_b16 a[198:199], v31 offset:4672
  ds_read_b64_tr_b16 a[200:201], v31 offset:4128
  ds_read_b64_tr_b16 a[202:203], v31 offset:4192
  ds_read_b64_tr_b16 a[204:205], v31 offset:4640
  ds_read_b64_tr_b16 a[206:207], v31 offset:4704
  s_waitcnt lgkmcnt(0)
  s_mov_b32 s16, s60
  s_and_b32 s17, s61, 0xffff
  s_mov_b32 s18, 5242880
  s_mov_b32 s19, 0x20000
  s_add_u32 s44, s40, 0
  s_add_u32 m0, s47, 4096
  buffer_load_dwordx4 v28, s[16:19], s44 offen lds
  s_add_u32 s44, s40, 131072
  s_add_u32 m0, s47, 5120
  buffer_load_dwordx4 v28, s[16:19], s44 offen lds
  s_add_u32 s44, s40, 262144
  s_add_u32 m0, s47, 6144
  buffer_load_dwordx4 v28, s[16:19], s44 offen lds
  s_add_u32 s44, s40, 393216
  s_add_u32 m0, s47, 7168
  buffer_load_dwordx4 v28, s[16:19], s44 offen lds
  s_waitcnt vmcnt(28)
  ds_read_b64_tr_b16 a[208:209], v31 offset:8192
  ds_read_b64_tr_b16 a[210:211], v31 offset:8256
  ds_read_b64_tr_b16 a[212:213], v31 offset:8704
  ds_read_b64_tr_b16 a[214:215], v31 offset:8768
  ds_read_b64_tr_b16 a[216:217], v31 offset:8224
  ds_read_b64_tr_b16 a[218:219], v31 offset:8288
  ds_read_b64_tr_b16 a[220:221], v31 offset:8736
  ds_read_b64_tr_b16 a[222:223], v31 offset:8800
  s_waitcnt lgkmcnt(0)
  s_waitcnt vmcnt(24)
  ds_read_b64_tr_b16 a[224:225], v32 offset:12288
  ds_read_b64_tr_b16 a[226:227], v32 offset:12544
  ds_read_b64_tr_b16 a[228:229], v32 offset:14336
  ds_read_b64_tr_b16 a[230:231], v32 offset:14592
  ds_read_b64_tr_b16 a[232:233], v32 offset:12320
  ds_read_b64_tr_b16 a[234:235], v32 offset:12576
  ds_read_b64_tr_b16 a[236:237], v32 offset:14368
  ds_read_b64_tr_b16 a[238:239], v32 offset:14624
  s_waitcnt lgkmcnt(0)
  s_waitcnt vmcnt(20)
  ds_read_b64_tr_b16 v[96:97], v31 offset:16384
  ds_read_b64_tr_b16 v[98:99], v31 offset:16448
  ds_read_b64_tr_b16 v[100:101], v31 offset:16896
  ds_read_b64_tr_b16 v[102:103], v31 offset:16960
  ds_read_b64_tr_b16 v[104:105], v31 offset:16416
  ds_read_b64_tr_b16 v[106:107], v31 offset:16480
  ds_read_b64_tr_b16 v[108:109], v31 offset:16928
  ds_read_b64_tr_b16 v[110:111], v31 offset:16992
  s_waitcnt lgkmcnt(0)
  s_waitcnt vmcnt(16)
  ds_read_b64_tr_b16 v[112:113], v31 offset:20480
  ds_read_b64_tr_b16 v[114:115], v31 offset:20544
  ds_read_b64_tr_b16 v[116:117], v31 offset:20992
  ds_read_b64_tr_b16 v[118:119], v31 offset:21056
  ds_read_b64_tr_b16 v[120:121], v31 offset:20512
  ds_read_b64_tr_b16 v[122:123], v31 offset:20576
  ds_read_b64_tr_b16 v[124:125], v31 offset:21024
  ds_read_b64_tr_b16 v[126:127], v31 offset:21088
  s_waitcnt lgkmcnt(0)
  s_waitcnt vmcnt(12)
  ds_read_b64_tr_b16 v[128:129], v31 offset:24576
  ds_read_b64_tr_b16 v[130:131], v31 offset:24640
  ds_read_b64_tr_b16 v[132:133], v31 offset:25088
  ds_read_b64_tr_b16 v[134:135], v31 offset:25152
  ds_read_b64_tr_b16 v[136:137], v31 offset:24608
  ds_read_b64_tr_b16 v[138:139], v31 offset:24672
  ds_read_b64_tr_b16 v[140:141], v31 offset:25120
  ds_read_b64_tr_b16 v[142:143], v31 offset:25184
  s_waitcnt lgkmcnt(0)
  s_waitcnt vmcnt(8)
  ds_read_b64_tr_b16 v[144:145], v31 offset:28672
  ds_read_b64_tr_b16 v[146:147], v31 offset:28736
  ds_read_b64_tr_b16 v[148:149], v31 offset:29184
  ds_read_b64_tr_b16 v[150:151], v31 offset:29248
  ds_read_b64_tr_b16 v[152:153], v31 offset:28704
  ds_read_b64_tr_b16 v[154:155], v31 offset:28768
  ds_read_b64_tr_b16 v[156:157], v31 offset:29216
  ds_read_b64_tr_b16 v[158:159], v31 offset:29280
  s_waitcnt lgkmcnt(0)
  s_waitcnt vmcnt(4)
  ds_read_b64_tr_b16 v[160:161], v32 offset:0
  ds_read_b64_tr_b16 v[162:163], v32 offset:256
  ds_read_b64_tr_b16 v[164:165], v32 offset:2048
  ds_read_b64_tr_b16 v[166:167], v32 offset:2304
  ds_read_b64_tr_b16 v[168:169], v32 offset:32
  ds_read_b64_tr_b16 v[170:171], v32 offset:288
  ds_read_b64_tr_b16 v[172:173], v32 offset:2080
  ds_read_b64_tr_b16 v[174:175], v32 offset:2336
  s_waitcnt lgkmcnt(0)
  s_mov_b32 s16, s62
  s_and_b32 s17, s63, 0xffff
  s_mov_b32 s18, 5242880
  s_mov_b32 s19, 0x20000
  s_add_u32 s44, s40, 0
  s_add_u32 m0, s47, 0
  buffer_load_dwordx4 v28, s[16:19], s44 offen lds
  s_add_u32 s44, s40, 131072
  s_add_u32 m0, s47, 1024
  buffer_load_dwordx4 v28, s[16:19], s44 offen lds
  s_add_u32 s44, s40, 262144
  s_add_u32 m0, s47, 2048
  buffer_load_dwordx4 v28, s[16:19], s44 offen lds
  s_add_u32 s44, s40, 393216
  s_add_u32 m0, s47, 3072
  buffer_load_dwordx4 v28, s[16:19], s44 offen lds
  s_waitcnt vmcnt(4)
  ds_read_b64_tr_b16 a[240:241], v31 offset:4096
  ds_read_b64_tr_b16 a[242:243], v31 offset:4160
  ds_read_b64_tr_b16 a[244:245], v31 offset:4608
  ds_read_b64_tr_b16 a[246:247], v31 offset:4672
  ds_read_b64_tr_b16 a[248:249], v31 offset:4128
  ds_read_b64_tr_b16 a[250:251], v31 offset:4192
  ds_read_b64_tr_b16 a[252:253], v31 offset:4640
  ds_read_b64_tr_b16 a[254:255], v31 offset:4704
  s_waitcnt lgkmcnt(0)
  s_add_u32 s44, s40, 524288
  s_add_u32 m0, s47, 4096
  buffer_load_dwordx4 v28, s[16:19], s44 offen lds
  s_add_u32 s44, s40, 655360
  s_add_u32 m0, s47, 5120
  buffer_load_dwordx4 v28, s[16:19], s44 offen lds
  s_add_u32 s44, s40, 786432
  s_add_u32 m0, s47, 6144
  buffer_load_dwordx4 v28, s[16:19], s44 offen lds
  s_add_u32 s44, s40, 917504
  s_add_u32 m0, s47, 7168
  buffer_load_dwordx4 v28, s[16:19], s44 offen lds
  s_add_u32 s44, s40, 1048576
  s_add_u32 m0, s47, 8192
  buffer_load_dwordx4 v28, s[16:19], s44 offen lds
  s_add_u32 s44, s40, 1179648
  s_add_u32 m0, s47, 9216
  buffer_load_dwordx4 v28, s[16:19], s44 offen lds
  s_add_u32 s44, s40, 1310720
  s_add_u32 m0, s47, 10240
  buffer_load_dwordx4 v28, s[16:19], s44 offen lds
  s_add_u32 s44, s40, 1441792
  s_add_u32 m0, s47, 11264
  buffer_load_dwordx4 v28, s[16:19], s44 offen lds
  s_add_u32 s44, s40, 1572864
  s_add_u32 m0, s47, 12288
  buffer_load_dwordx4 v28, s[16:19], s44 offen lds
  s_add_u32 s44, s40, 1703936
  s_add_u32 m0, s47, 13312
  buffer_load_dwordx4 v28, s[16:19], s44 offen lds
  s_add_u32 s44, s40, 1835008
  s_add_u32 m0, s47, 14336
  buffer_load_dwordx4 v28, s[16:19], s44 offen lds
  s_add_u32 s44, s40, 1966080
  s_add_u32 m0, s47, 15360
  buffer_load_dwordx4 v28, s[16:19], s44 offen lds
  s_add_u32 s44, s40, 2097152
  s_add_u32 m0, s47, 16384
  buffer_load_dwordx4 v28, s[16:19], s44 offen lds
  s_add_u32 s44, s40, 2228224
  s_add_u32 m0, s47, 17408
  buffer_load_dwordx4 v28, s[16:19], s44 offen lds
  s_add_u32 s44, s40, 2359296
  s_add_u32 m0, s47, 18432
  buffer_load_dwordx4 v28, s[16:19], s44 offen lds
  s_add_u32 s44, s40, 2490368
  s_add_u32 m0, s47, 19456
  buffer_load_dwordx4 v28, s[16:19], s44 offen lds
  s_mov_b32 s16, s60
  s_and_b32 s17, s61, 0xffff
  s_mov_b32 s18, 5242880
  s_mov_b32 s19, 0x20000
  s_add_u32 s44, s40, 1048576
  s_add_u32 m0, s47, 20480
  buffer_load_dwordx4 v28, s[16:19], s44 offen lds
  s_add_u32 s44, s40, 1179648
  s_add_u32 m0, s47, 21504
  buffer_load_dwordx4 v28, s[16:19], s44 offen lds
  s_add_u32 s44, s40, 1310720
  s_add_u32 m0, s47, 22528
  buffer_load_dwordx4 v28, s[16:19], s44 offen lds
  s_add_u32 s44, s40, 1441792
  s_add_u32 m0, s47, 23552
  buffer_load_dwordx4 v28, s[16:19], s44 offen lds
  s_add_u32 s44, s40, 1572864
  s_add_u32 m0, s47, 24576
  buffer_load_dwordx4 v28, s[16:19], s44 offen lds
  s_add_u32 s44, s40, 1703936
  s_add_u32 m0, s47, 25600
  buffer_load_dwordx4 v28, s[16:19], s44 offen lds
  s_add_u32 s44, s40, 1835008
  s_add_u32 m0, s47, 26624
  buffer_load_dwordx4 v28, s[16:19], s44 offen lds
  s_add_u32 s44, s40, 1966080
  s_add_u32 m0, s47, 27648
  buffer_load_dwordx4 v28, s[16:19], s44 offen lds
  s_add_u32 s44, s40, 2097152
  s_add_u32 m0, s47, 28672
  buffer_load_dwordx4 v28, s[16:19], s44 offen lds
  s_add_u32 s44, s40, 2228224
  s_add_u32 m0, s47, 29696
  buffer_load_dwordx4 v28, s[16:19], s44 offen lds
  s_add_u32 s44, s40, 2359296
  s_add_u32 m0, s47, 30720
  buffer_load_dwordx4 v28, s[16:19], s44 offen lds
  s_add_u32 s44, s40, 2490368
  s_add_u32 m0, s47, 31744
  buffer_load_dwordx4 v28, s[16:19], s44 offen lds
  s_waitcnt vmcnt(28)
  ds_read_b64_tr_b16 v[42:43], v31 offset:0
  ds_read_b64_tr_b16 v[44:45], v31 offset:64
  ds_read_b64_tr_b16 v[46:47], v31 offset:512
  ds_read_b64_tr_b16 v[48:49], v31 offset:576
  ds_read_b64_tr_b16 v[50:51], v31 offset:32
  ds_read_b64_tr_b16 v[52:53], v31 offset:96
  ds_read_b64_tr_b16 v[54:55], v31 offset:544
  ds_read_b64_tr_b16 v[56:57], v31 offset:608
  s_waitcnt lgkmcnt(0)
  ds_write_b128 v14, v[42:45] offset:0
  ds_write_b128 v14, v[46:49] offset:1024
  ds_write_b128 v14, v[50:53] offset:2048
  ds_write_b128 v14, v[54:57] offset:3072
  s_waitcnt lgkmcnt(0)
  s_add_u32 s44, s40, 524288
  s_add_u32 m0, s46, 0
  buffer_load_dwordx4 v28, s[16:19], s44 offen lds
  s_add_u32 s44, s40, 655360
  s_add_u32 m0, s46, 1024
  buffer_load_dwordx4 v28, s[16:19], s44 offen lds
  s_add_u32 s44, s40, 786432
  s_add_u32 m0, s46, 2048
  buffer_load_dwordx4 v28, s[16:19], s44 offen lds
  s_add_u32 s44, s40, 917504
  s_add_u32 m0, s46, 3072
  buffer_load_dwordx4 v28, s[16:19], s44 offen lds
  s_waitcnt vmcnt(28)
  ds_read_b64_tr_b16 v[42:43], v31 offset:4096
  ds_read_b64_tr_b16 v[44:45], v31 offset:4160
  ds_read_b64_tr_b16 v[46:47], v31 offset:4608
  ds_read_b64_tr_b16 v[48:49], v31 offset:4672
  ds_read_b64_tr_b16 v[50:51], v31 offset:4128
  ds_read_b64_tr_b16 v[52:53], v31 offset:4192
  ds_read_b64_tr_b16 v[54:55], v31 offset:4640
  ds_read_b64_tr_b16 v[56:57], v31 offset:4704
  s_waitcnt lgkmcnt(0)
  ds_write_b128 v14, v[42:45] offset:4096
  ds_write_b128 v14, v[46:49] offset:5120
  ds_write_b128 v14, v[50:53] offset:6144
  ds_write_b128 v14, v[54:57] offset:7168
  s_waitcnt lgkmcnt(0)
  s_waitcnt vmcnt(24)
  ds_read_b64_tr_b16 v[42:43], v31 offset:8192
  ds_read_b64_tr_b16 v[44:45], v31 offset:8256
  ds_read_b64_tr_b16 v[46:47], v31 offset:8704
  ds_read_b64_tr_b16 v[48:49], v31 offset:8768
  ds_read_b64_tr_b16 v[50:51], v31 offset:8224
  ds_read_b64_tr_b16 v[52:53], v31 offset:8288
  ds_read_b64_tr_b16 v[54:55], v31 offset:8736
  ds_read_b64_tr_b16 v[56:57], v31 offset:8800
  s_waitcnt lgkmcnt(0)
  ds_write_b128 v14, v[42:45] offset:8192
  ds_write_b128 v14, v[46:49] offset:9216
  ds_write_b128 v14, v[50:53] offset:10240
  ds_write_b128 v14, v[54:57] offset:11264
  s_waitcnt lgkmcnt(0)
  s_waitcnt vmcnt(20)
  ds_read_b64_tr_b16 v[42:43], v31 offset:12288
  ds_read_b64_tr_b16 v[44:45], v31 offset:12352
  ds_read_b64_tr_b16 v[46:47], v31 offset:12800
  ds_read_b64_tr_b16 v[48:49], v31 offset:12864
  ds_read_b64_tr_b16 v[50:51], v31 offset:12320
  ds_read_b64_tr_b16 v[52:53], v31 offset:12384
  ds_read_b64_tr_b16 v[54:55], v31 offset:12832
  ds_read_b64_tr_b16 v[56:57], v31 offset:12896
  s_waitcnt lgkmcnt(0)
  ds_write_b128 v14, v[42:45] offset:12288
  ds_write_b128 v14, v[46:49] offset:13312
  ds_write_b128 v14, v[50:53] offset:14336
  ds_write_b128 v14, v[54:57] offset:15360
  s_waitcnt lgkmcnt(0)
  s_waitcnt vmcnt(16)
  ds_read_b64_tr_b16 v[42:43], v32 offset:16384
  ds_read_b64_tr_b16 v[44:45], v32 offset:16640
  ds_read_b64_tr_b16 v[46:47], v32 offset:18432
  ds_read_b64_tr_b16 v[48:49], v32 offset:18688
  ds_read_b64_tr_b16 v[50:51], v32 offset:16416
  ds_read_b64_tr_b16 v[52:53], v32 offset:16672
  ds_read_b64_tr_b16 v[54:55], v32 offset:18464
  ds_read_b64_tr_b16 v[56:57], v32 offset:18720
  s_waitcnt lgkmcnt(0)
  ds_write_b128 v14, v[42:45] offset:16384
  ds_write_b128 v14, v[46:49] offset:17408
  ds_write_b128 v14, v[50:53] offset:18432
  ds_write_b128 v14, v[54:57] offset:19456
  s_waitcnt lgkmcnt(0)
  s_waitcnt vmcnt(12)
  ds_read_b64_tr_b16 v[42:43], v31 offset:20480
  ds_read_b64_tr_b16 v[44:45], v31 offset:20544
  ds_read_b64_tr_b16 v[46:47], v31 offset:20992
  ds_read_b64_tr_b16 v[48:49], v31 offset:21056
  ds_read_b64_tr_b16 v[50:51], v31 offset:20512
  ds_read_b64_tr_b16 v[52:53], v31 offset:20576
  ds_read_b64_tr_b16 v[54:55], v31 offset:21024
  ds_read_b64_tr_b16 v[56:57], v31 offset:21088
  s_waitcnt lgkmcnt(0)
  ds_write_b128 v14, v[42:45] offset:20480
  ds_write_b128 v14, v[46:49] offset:21504
  ds_write_b128 v14, v[50:53] offset:22528
  ds_write_b128 v14, v[54:57] offset:23552
  s_waitcnt lgkmcnt(0)
  s_waitcnt vmcnt(8)
  ds_read_b64_tr_b16 v[42:43], v31 offset:24576
  ds_read_b64_tr_b16 v[44:45], v31 offset:24640
  ds_read_b64_tr_b16 v[46:47], v31 offset:25088
  ds_read_b64_tr_b16 v[48:49], v31 offset:25152
  ds_read_b64_tr_b16 v[50:51], v31 offset:24608
  ds_read_b64_tr_b16 v[52:53], v31 offset:24672
  ds_read_b64_tr_b16 v[54:55], v31 offset:25120
  ds_read_b64_tr_b16 v[56:57], v31 offset:25184
  s_waitcnt lgkmcnt(0)
  ds_write_b128 v14, v[42:45] offset:24576
  ds_write_b128 v14, v[46:49] offset:25600
  ds_write_b128 v14, v[50:53] offset:26624
  ds_write_b128 v14, v[54:57] offset:27648
  s_waitcnt lgkmcnt(0)
  s_waitcnt vmcnt(4)
  ds_read_b64_tr_b16 v[42:43], v32 offset:28672
  ds_read_b64_tr_b16 v[44:45], v32 offset:28928
  ds_read_b64_tr_b16 v[46:47], v32 offset:30720
  ds_read_b64_tr_b16 v[48:49], v32 offset:30976
  ds_read_b64_tr_b16 v[50:51], v32 offset:28704
  ds_read_b64_tr_b16 v[52:53], v32 offset:28960
  ds_read_b64_tr_b16 v[54:55], v32 offset:30752
  ds_read_b64_tr_b16 v[56:57], v32 offset:31008
  s_waitcnt lgkmcnt(0)
  ds_write_b128 v14, v[42:45] offset:28672
  ds_write_b128 v14, v[46:49] offset:29696
  ds_write_b128 v14, v[50:53] offset:30720
  ds_write_b128 v14, v[54:57] offset:31744
  s_waitcnt lgkmcnt(0)
  s_waitcnt vmcnt(0)
  v_subrev_u32 v35, s47, v31
  v_add_u32 v35, s46, v35
  ds_read_b64_tr_b16 v[88:89], v35 offset:0
  ds_read_b64_tr_b16 v[90:91], v35 offset:64
  ds_read_b64_tr_b16 v[92:93], v35 offset:512
  ds_read_b64_tr_b16 v[94:95], v35 offset:576
  ds_read_b64_tr_b16 v[50:51], v35 offset:32
  ds_read_b64_tr_b16 v[52:53], v35 offset:96
  ds_read_b64_tr_b16 v[54:55], v35 offset:544
  ds_read_b64_tr_b16 v[56:57], v35 offset:608
  s_waitcnt lgkmcnt(0)
  ds_write_b128 v14, v[50:53] offset:32768
  ds_write_b128 v14, v[54:57] offset:33792
  s_waitcnt lgkmcnt(0)
  s_barrier
  s_cmp_lg_u32 s22, 0
  s_cbranch_scc1 L_m0_0
  v_lshl_or_b32 v62, v74, 16, v62
  v_lshl_or_b32 v63, v75, 16, v63
  v_lshl_or_b32 v64, v76, 16, v64
  v_lshl_or_b32 v65, v77, 16, v65
  v_lshl_or_b32 v70, v82, 16, v70
  v_lshl_or_b32 v71, v83, 16, v71
  v_lshl_or_b32 v72, v84, 16, v72
  v_lshl_or_b32 v73, v85, 16, v73
  ds_write_b128 v1, v[62:65] offset:0
  ds_write_b128 v1, v[66:69] offset:4096
  ds_write_b128 v1, v[70:73] offset:8192
L_m0_0:
  s_cmp_lg_u32 s22, 1
  s_cbranch_scc1 L_m0_1
  v_lshl_or_b32 v62, v74, 16, v62
  v_lshl_or_b32 v63, v75, 16, v63
  v_lshl_or_b32 v64, v76, 16, v64
  v_lshl_or_b32 v65, v77, 16, v65
  v_lshl_or_b32 v66, v78, 16, v66
  v_lshl_or_b32 v67, v79, 16, v67
  v_lshl_or_b32 v68, v80, 16, v68
  v_lshl_or_b32 v69, v81, 16, v69
  ds_write_b128 v1, v[62:65] offset:1024
  ds_write_b128 v1, v[66:69] offset:5120
  ds_write_b128 v1, v[70:73] offset:9216
L_m0_1:
  s_cmp_lg_u32 s22, 2
  s_cbranch_scc1 L_m0_2
  v_lshl_or_b32 v62, v74, 16, v62
  v_lshl_or_b32 v63, v75, 16, v63
  v_lshl_or_b32 v64, v76, 16, v64
  v_lshl_or_b32 v65, v77, 16, v65
  v_lshl_or_b32 v66, v78, 16, v66
  v_lshl_or_b32 v67, v79, 16, v67
  v_lshl_or_b32 v68, v80, 16, v68
  v_lshl_or_b32 v69, v81, 16, v69
  ds_write_b128 v1, v[62:65] offset:2048
  ds_write_b128 v1, v[66:69] offset:6144
L_m0_2:
  s_cmp_lg_u32 s22, 3
  s_cbranch_scc1 L_m0_3
  v_lshl_or_b32 v62, v74, 16, v62
  v_lshl_or_b32 v63, v75, 16, v63
  v_lshl_or_b32 v64, v76, 16, v64
  v_lshl_or_b32 v65, v77, 16, v65
  v_lshl_or_b32 v66, v78, 16, v66
  v_lshl_or_b32 v67, v79, 16, v67
  v_lshl_or_b32 v68, v80, 16, v68
  v_lshl_or_b32 v69, v81, 16, v69
  ds_write_b128 v1, v[62:65] offset:3072
  ds_write_b128 v1, v[66:69] offset:7168
L_m0_3:
  s_waitcnt lgkmcnt(0)
  s_waitcnt vmcnt(0)
  s_barrier
  s_cmp_lg_u32 s22, 0
  s_cbranch_scc1 L_arr_done
  s_mov_b64 exec, 1
  v_mov_b32 v20, 1
  v_mov_b32 v21, 128
  s_mov_b32 s51, 0
L_sb_poll:
  buffer_load_dword v20, v21, s[12:15], 0 offen sc1
  s_waitcnt vmcnt(0)
  v_readfirstlane_b32 s40, v20
  s_add_u32 s51, s51, 1
  s_cmp_ge_u32 s51, 2000000
  s_cbranch_scc1 L_sb_out
  s_cmp_lt_u32 s40, 64
  s_cbranch_scc1 L_sb_poll
L_sb_out:
  s_mov_b64 exec, -1
L_arr_done:
  s_barrier
  s_mov_b32 s23, 0
  s_mov_b32 s31, 0
  s_mov_b32 s32, 0
  s_mov_b32 s39, 0
  s_mov_b32 s52, 0
  s_mov_b32 s60, 0x3e0293ee
  s_mov_b32 s61, 0x3e0293ee
  s_mov_b32 s70, 0
  s_mov_b32 s72, 0
  s_mov_b32 s73, 0
  s_mov_b32 s74, 0
  s_mov_b32 s75, 0
  s_mov_b32 s76, 0
  s_mov_b32 s77, 0
  s_mov_b32 s78, 0
  s_mov_b32 s79, 0
  s_mov_b32 s80, 0
  s_mov_b32 s81, 0
  s_mov_b32 s82, 0
  s_mov_b32 s83, 0
  s_mov_b32 s84, 0
  s_mov_b32 s85, 0
  s_mov_b32 s86, 0
  s_mov_b32 s87, 0
  s_mov_b32 s88, 0
  s_mov_b32 s89, 0
  s_mov_b32 s90, 0
  s_mov_b32 s91, 0
  s_mov_b32 s92, 0
  s_mov_b32 s93, 0
  s_mov_b32 s94, 0
  s_mov_b32 s95, 0
  s_mov_b32 s96, 0
  s_mov_b32 s97, 0
  s_mov_b32 s98, 0
  s_mov_b32 s99, 0
  s_mov_b32 s100, 0
  s_mov_b32 s101, 0
  s_mov_b32 s57, 0
  s_sub_u32 s64, 0, s20
  s_mov_b32 s65, s64
  s_lshl_b32 s62, s20, 5
  s_add_u32 s62, s62, s21
  s_lshl_b32 s62, s62, 10
  s_add_u32 s62, s62, 109068272
  s_mov_b32 s46, 1
  s_lshr_b32 s41, s46, 2
  s_cmp_lt_u32 s41, s57
  s_cbranch_scc1 L_kvw_1
  s_cmp_ge_u32 s41, 16
  s_cbranch_scc1 L_kvw_1
  s_lshl_b32 s42, s41, 7
  s_add_u32 s42, s42, 109051904
  s_add_u32 s57, s41, 1
  s_mov_b32 s51, 0
  v_mov_b32 v16, 0
L_kvw_1_p:
  buffer_load_dword v15, v16, s[8:11], s42 offen sc1
  s_waitcnt vmcnt(0)
  v_readfirstlane_b32 s41, v15
  s_add_u32 s51, s51, 1
  s_cmp_ge_u32 s51, 400000
  s_cbranch_scc1 L_fail
  s_cmp_lt_u32 s41, 32
  s_cbranch_scc1 L_kvw_1_p
L_kvw_1:
  s_mov_b32 s47, 0
  s_cmp_lg_u32 s22, 3
  s_cbranch_scc1 L_w3_2
  s_add_u32 s41, s47, s34
  s_add_u32 s42, s41, 4096
  s_mov_b32 m0, 10240
  s_nop 0
  buffer_load_dwordx4 v1, s[8:11], s41 offen offset:0 lds
  buffer_load_dwordx4 v1, s[8:11], s41 offen offset:1024 lds
  buffer_load_dwordx4 v1, s[8:11], s41 offen offset:2048 lds
  buffer_load_dwordx4 v1, s[8:11], s41 offen offset:3072 lds
  s_mov_b32 m0, 14336
  s_nop 0
  buffer_load_dwordx4 v1, s[8:11], s42 offen offset:0 lds
  buffer_load_dwordx4 v1, s[8:11], s42 offen offset:1024 lds
  buffer_load_dwordx4 v1, s[8:11], s42 offen offset:2048 lds
  buffer_load_dwordx4 v1, s[8:11], s42 offen offset:3072 lds
L_w3_2:
  s_waitcnt vmcnt(0)
  s_barrier
  v_mov_b32 v18, 0
  v_mov_b32 v19, 0
  v_mov_b32 v20, 0
  v_mov_b32 v21, 0
  v_mov_b32 v22, 0
  v_mov_b32 v23, 0
  v_mov_b32 v24, 0
  v_mov_b32 v25, 0
  v_mov_b32 v26, 0
  v_mov_b32 v27, 0
  v_mov_b32 v28, 0
  v_mov_b32 v29, 0
  v_mov_b32 v30, 0
  v_mov_b32 v31, 0
  v_mov_b32 v32, 0
  v_mov_b32 v33, 0
  v_mov_b32 v34, 0
  v_mov_b32 v35, 0
  v_mov_b32 v36, 0
  v_mov_b32 v37, 0
  v_mov_b32 v38, 0
  v_mov_b32 v39, 0
  v_mov_b32 v40, 0
  v_mov_b32 v41, 0
  s_memtime s[66:67]
  s_memrealtime s[58:59]
  s_waitcnt lgkmcnt(0)
  s_sub_u32 s56, s66, s54
  s_mov_b32 s54, s66
L_step:
L_redo_entry:
  ds_read_b128 v[62:65], v14 offset:0
  ds_read_b128 v[66:69], v14 offset:1024
  ds_read_b128 v[70:73], v14 offset:2048
  ds_read_b128 v[74:77], v14 offset:3072
  ds_read_b128 v[78:81], v14 offset:4096
  ds_read_b128 v[82:85], v14 offset:5120
  s_waitcnt lgkmcnt(0)
  s_cmp_lg_u32 s52, 0
  s_cbranch_scc1 L_spinL_full
  ds_read_b128 v[42:45], v1 offset:0
  ds_read_b128 v[46:49], v1 offset:1024
  ds_read_b128 v[50:53], v1 offset:2048
  ds_read_b128 v[54:57], v1 offset:3072
  ds_read_b128 v[58:61], v1 offset:4096
  s_waitcnt lgkmcnt(0)
  v_max3_u32 v15, v42, v46, v50
  v_max3_u32 v15, v15, v54, v58
  v_cmp_eq_u32 vcc, -1, v15
  s_cbranch_vccz L_spinL_ok
  s_mov_b32 s51, 0
  s_cmp_lg_u32 s22, 3
  s_cbranch_scc1 L_spinLf_o
L_spinLf_d:
  s_add_u32 s41, s39, 0
  s_add_u32 s42, s39, 4096
  s_mov_b32 m0, 0
  s_nop 0
  buffer_load_dwordx4 v1, s[8:11], s41 offen offset:0 sc1 lds
  buffer_load_dwordx4 v1, s[8:11], s41 offen offset:1024 sc1 lds
  buffer_load_dwordx4 v1, s[8:11], s41 offen offset:2048 sc1 lds
  buffer_load_dwordx4 v1, s[8:11], s41 offen offset:3072 sc1 lds
  s_mov_b32 m0, 4096
  s_nop 0
  buffer_load_dwordx4 v1, s[8:11], s42 offen sc1 lds
  ds_read_b128 v[42:45], v1 offset:0
  ds_read_b128 v[46:49], v1 offset:1024
  ds_read_b128 v[50:53], v1 offset:2048
  ds_read_b128 v[54:57], v1 offset:3072
  ds_read_b128 v[58:61], v1 offset:4096
  s_add_u32 s51, s51, 1
  s_cmp_ge_u32 s51, 400000
  s_cbranch_scc1 L_fail
  s_waitcnt lgkmcnt(0)
  v_max3_u32 v15, v42, v46, v50
  v_max3_u32 v15, v15, v54, v58
  v_cmp_eq_u32 vcc, -1, v15
  s_cbranch_vccz L_spinL_ok
  s_branch L_spinLf_d
L_spinLf_o:
  ds_read_b128 v[42:45], v1 offset:0
  ds_read_b128 v[46:49], v1 offset:1024
  ds_read_b128 v[50:53], v1 offset:2048
  ds_read_b128 v[54:57], v1 offset:3072
  ds_read_b128 v[58:61], v1 offset:4096
  s_add_u32 s51, s51, 1
  s_cmp_ge_u32 s51, 400000
  s_cbranch_scc1 L_fail
  s_waitcnt lgkmcnt(0)
  v_max3_u32 v15, v42, v46, v50
  v_max3_u32 v15, v15, v54, v58
  v_cmp_eq_u32 vcc, -1, v15
  s_cbranch_vccz L_spinL_ok
  s_branch L_spinLf_o
L_spinL_full:
  ds_read_b128 v[42:45], v1 offset:0
  ds_read_b128 v[46:49], v1 offset:1024
  ds_read_b128 v[50:53], v1 offset:2048
  ds_read_b128 v[54:57], v1 offset:3072
  ds_read_b128 v[58:61], v1 offset:4096
  s_waitcnt lgkmcnt(0)
  v_max3_u32 v15, v42, v43, v44
  v_max3_u32 v16, v45, v46, v47
  v_max3_u32 v86, v48, v49, v50
  v_max3_u32 v87, v51, v52, v53
  v_max3_u32 v15, v15, v54, v55
  v_max3_u32 v16, v16, v56, v57
  v_max3_u32 v86, v86, v58, v59
  v_max3_u32 v87, v87, v60, v61
  v_max3_u32 v15, v15, v16, v86
  v_max_u32 v15, v15, v87
  v_cmp_eq_u32 vcc, -1, v15
  s_cbranch_vccz L_spinL_ok
  s_mov_b32 s51, 0
  s_cmp_lg_u32 s22, 3
  s_cbranch_scc1 L_spinLF_o
L_spinLF_d:
  s_add_u32 s41, s39, 0
  s_add_u32 s42, s39, 4096
  s_mov_b32 m0, 0
  s_nop 0
  buffer_load_dwordx4 v1, s[8:11], s41 offen offset:0 sc1 lds
  buffer_load_dwordx4 v1, s[8:11], s41 offen offset:1024 sc1 lds
  buffer_load_dwordx4 v1, s[8:11], s41 offen offset:2048 sc1 lds
  buffer_load_dwordx4 v1, s[8:11], s41 offen offset:3072 sc1 lds
  s_mov_b32 m0, 4096
  s_nop 0
  buffer_load_dwordx4 v1, s[8:11], s42 offen sc1 lds
  ds_read_b128 v[42:45], v1 offset:0
  ds_read_b128 v[46:49], v1 offset:1024
  ds_read_b128 v[50:53], v1 offset:2048
  ds_read_b128 v[54:57], v1 offset:3072
  ds_read_b128 v[58:61], v1 offset:4096
  s_add_u32 s51, s51, 1
  s_cmp_ge_u32 s51, 400000
  s_cbranch_scc1 L_fail
  s_waitcnt lgkmcnt(0)
  v_max3_u32 v15, v42, v43, v44
  v_max3_u32 v16, v45, v46, v47
  v_max3_u32 v86, v48, v49, v50
  v_max3_u32 v87, v51, v52, v53
  v_max3_u32 v15, v15, v54, v55
  v_max3_u32 v16, v16, v56, v57
  v_max3_u32 v86, v86, v58, v59
  v_max3_u32 v87, v87, v60, v61
  v_max3_u32 v15, v15, v16, v86
  v_max_u32 v15, v15, v87
  v_cmp_eq_u32 vcc, -1, v15
  s_cbranch_vccz L_spinL_ok
  s_branch L_spinLF_d
L_spinLF_o:
  ds_read_b128 v[42:45], v1 offset:0
  ds_read_b128 v[46:49], v1 offset:1024
  ds_read_b128 v[50:53], v1 offset:2048
  ds_read_b128 v[54:57], v1 offset:3072
  ds_read_b128 v[58:61], v1 offset:4096
  s_add_u32 s51, s51, 1
  s_cmp_ge_u32 s51, 400000
  s_cbranch_scc1 L_fail
  s_waitcnt lgkmcnt(0)
  v_max3_u32 v15, v42, v43, v44
  v_max3_u32 v16, v45, v46, v47
  v_max3_u32 v86, v48, v49, v50
  v_max3_u32 v87, v51, v52, v53
  v_max3_u32 v15, v15, v54, v55
  v_max3_u32 v16, v16, v56, v57
  v_max3_u32 v86, v86, v58, v59
  v_max3_u32 v87, v87, v60, v61
  v_max3_u32 v15, v15, v16, v86
  v_max_u32 v15, v15, v87
  v_cmp_eq_u32 vcc, -1, v15
  s_cbranch_vccz L_spinL_ok
  s_branch L_spinLF_o
L_spinL_ok:
  v_smfmac_f32_16x16x64_bf16 v[18:21], v[42:45], a[0:7], v2
  s_cmp_eq_u32 s23, 0
  s_cbranch_scc1 L_rd_3
  s_lshl_b32 s42, s22, 10
  s_add_u32 s41, s39, s42
  s_add_u32 s41, s41, 5120
  s_add_u32 m0, s42, 5120
  s_add_u32 s42, s39, 9216
  buffer_load_dwordx4 v1, s[8:11], s41 offen sc1 lds
  s_mov_b32 m0, 9216
  s_mov_b64 exec, s[4:5]
  buffer_load_dwordx4 v1, s[8:11], s42 offen sc1 lds
  s_mov_b64 exec, -1
L_rd_3:
  v_smfmac_f32_16x16x64_bf16 v[34:37], v[42:45], v[62:69], v2
  ds_read_b128 v[62:65], v14 offset:6144
  ds_read_b128 v[66:69], v14 offset:7168
  v_smfmac_f32_16x16x64_bf16 v[22:25], v[42:45], a[80:87], v2
  v_smfmac_f32_16x16x64_bf16 v[26:29], v[42:45], a[240:247], v2
  v_smfmac_f32_16x16x64_bf16 v[38:41], v[42:45], v[70:77], v2
  ds_read_b128 v[70:73], v14 offset:32768
  ds_read_b128 v[74:77], v14 offset:33792
  v_smfmac_f32_16x16x64_bf16 v[30:33], v[42:45], a[248:255], v2
  v_smfmac_f32_16x16x64_bf16 v[18:21], v[46:49], a[8:15], v2
  v_smfmac_f32_16x16x64_bf16 v[34:37], v[46:49], v[78:85], v2
  ds_read_b128 v[78:81], v14 offset:8192
  ds_read_b128 v[82:85], v14 offset:9216
  v_smfmac_f32_16x16x64_bf16 v[22:25], v[46:49], a[88:95], v2
  v_smfmac_f32_16x16x64_bf16 v[26:29], v[46:49], v[88:95], v2
  s_waitcnt lgkmcnt(4)
  v_smfmac_f32_16x16x64_bf16 v[38:41], v[46:49], v[62:69], v2
  ds_read_b128 v[62:65], v14 offset:20480
  ds_read_b128 v[66:69], v14 offset:21504
  s_waitcnt lgkmcnt(4)
  v_smfmac_f32_16x16x64_bf16 v[30:33], v[46:49], v[70:77], v2
  ds_read_b128 v[70:73], v14 offset:10240
  ds_read_b128 v[74:77], v14 offset:11264
  v_smfmac_f32_16x16x64_bf16 v[18:21], v[50:53], a[16:23], v2
  s_waitcnt lgkmcnt(4)
  v_smfmac_f32_16x16x64_bf16 v[34:37], v[50:53], v[78:85], v2
  ds_read_b128 v[78:81], v14 offset:22528
  ds_read_b128 v[82:85], v14 offset:23552
  v_smfmac_f32_16x16x64_bf16 v[22:25], v[50:53], a[96:103], v2
  s_waitcnt lgkmcnt(4)
  v_smfmac_f32_16x16x64_bf16 v[26:29], v[50:53], v[62:69], v2
  ds_read_b128 v[62:65], v14 offset:12288
  ds_read_b128 v[66:69], v14 offset:13312
  s_waitcnt lgkmcnt(4)
  v_smfmac_f32_16x16x64_bf16 v[38:41], v[50:53], v[70:77], v2
  ds_read_b128 v[70:73], v14 offset:24576
  ds_read_b128 v[74:77], v14 offset:25600
  s_waitcnt lgkmcnt(4)
  v_smfmac_f32_16x16x64_bf16 v[30:33], v[50:53], v[78:85], v2
  ds_read_b128 v[78:81], v14 offset:14336
  ds_read_b128 v[82:85], v14 offset:15360
  v_smfmac_f32_16x16x64_bf16 v[18:21], v[54:57], a[24:31], v2
  s_waitcnt lgkmcnt(4)
  v_smfmac_f32_16x16x64_bf16 v[34:37], v[54:57], v[62:69], v2
  ds_read_b128 v[62:65], v14 offset:26624
  ds_read_b128 v[66:69], v14 offset:27648
  v_smfmac_f32_16x16x64_bf16 v[22:25], v[54:57], a[104:111], v2
  s_waitcnt lgkmcnt(4)
  v_smfmac_f32_16x16x64_bf16 v[26:29], v[54:57], v[70:77], v2
  ds_read_b128 v[70:73], v14 offset:16384
  ds_read_b128 v[74:77], v14 offset:17408
  s_waitcnt lgkmcnt(4)
  v_smfmac_f32_16x16x64_bf16 v[38:41], v[54:57], v[78:85], v2
  ds_read_b128 v[78:81], v14 offset:28672
  ds_read_b128 v[82:85], v14 offset:29696
  s_waitcnt lgkmcnt(4)
  v_smfmac_f32_16x16x64_bf16 v[30:33], v[54:57], v[62:69], v2
  ds_read_b128 v[62:65], v14 offset:18432
  ds_read_b128 v[66:69], v14 offset:19456
  v_smfmac_f32_16x16x64_bf16 v[18:21], v[58:61], a[32:39], v2
  s_waitcnt lgkmcnt(4)
  v_smfmac_f32_16x16x64_bf16 v[34:37], v[58:61], v[70:77], v2
  ds_read_b128 v[70:73], v14 offset:30720
  ds_read_b128 v[74:77], v14 offset:31744
  v_smfmac_f32_16x16x64_bf16 v[22:25], v[58:61], a[112:119], v2
  s_waitcnt lgkmcnt(4)
  v_smfmac_f32_16x16x64_bf16 v[26:29], v[58:61], v[78:85], v2
  s_waitcnt lgkmcnt(2)
  v_smfmac_f32_16x16x64_bf16 v[38:41], v[58:61], v[62:69], v2
  s_waitcnt lgkmcnt(0)
  v_smfmac_f32_16x16x64_bf16 v[30:33], v[58:61], v[70:77], v2
  s_lshl_b32 s47, s23, 18
  s_add_u32 s41, s47, s35
  buffer_load_dwordx4 v[78:81], v1, s[8:11], s41 offen
  buffer_load_dwordx4 v[82:85], v1, s[8:11], s41 offen offset:1024
  s_cmp_lg_u32 s52, 0
  s_cbranch_scc1 L_spinR_full
  ds_read_b128 v[42:45], v1 offset:5120
  ds_read_b128 v[46:49], v1 offset:6144
  ds_read_b128 v[50:53], v1 offset:7168
  ds_read_b128 v[54:57], v1 offset:8192
  ds_read_b128 v[58:61], v1 offset:9216
  s_waitcnt lgkmcnt(0)
  v_max3_u32 v15, v42, v46, v50
  v_max3_u32 v15, v15, v54, v58
  v_cmp_eq_u32 vcc, -1, v15
  s_cbranch_vccz L_spinR_ok
  s_mov_b32 s51, 0
L_spinRf_d:
  s_lshl_b32 s42, s22, 10
  s_add_u32 s41, s39, s42
  s_add_u32 s41, s41, 5120
  s_add_u32 m0, s42, 5120
  s_add_u32 s42, s39, 9216
  buffer_load_dwordx4 v1, s[8:11], s41 offen sc1 lds
  s_mov_b32 m0, 9216
  s_mov_b64 exec, s[4:5]
  buffer_load_dwordx4 v1, s[8:11], s42 offen sc1 lds
  s_mov_b64 exec, -1
L_rd_4:
  ds_read_b128 v[42:45], v1 offset:5120
  ds_read_b128 v[46:49], v1 offset:6144
  ds_read_b128 v[50:53], v1 offset:7168
  ds_read_b128 v[54:57], v1 offset:8192
  ds_read_b128 v[58:61], v1 offset:9216
  s_add_u32 s51, s51, 1
  s_cmp_ge_u32 s51, 400000
  s_cbranch_scc1 L_fail
  s_waitcnt lgkmcnt(0)
  v_max3_u32 v15, v42, v46, v50
  v_max3_u32 v15, v15, v54, v58
  v_cmp_eq_u32 vcc, -1, v15
  s_cbranch_vccz L_spinR_ok
  s_branch L_spinRf_d
L_spinR_full:
  ds_read_b128 v[42:45], v1 offset:5120
  ds_read_b128 v[46:49], v1 offset:6144
  ds_read_b128 v[50:53], v1 offset:7168
  ds_read_b128 v[54:57], v1 offset:8192
  ds_read_b128 v[58:61], v1 offset:9216
  s_waitcnt lgkmcnt(0)
  v_max3_u32 v15, v42, v43, v44
  v_max3_u32 v16, v45, v46, v47
  v_max3_u32 v86, v48, v49, v50
  v_max3_u32 v87, v51, v52, v53
  v_max3_u32 v15, v15, v54, v55
  v_max3_u32 v16, v16, v56, v57
  v_max3_u32 v86, v86, v58, v59
  v_max3_u32 v87, v87, v60, v61
  v_max3_u32 v15, v15, v16, v86
  v_max_u32 v15, v15, v87
  v_cmp_eq_u32 vcc, -1, v15
  s_cbranch_vccz L_spinR_ok
  s_mov_b32 s51, 0
L_spinRF_d:
  s_lshl_b32 s42, s22, 10
  s_add_u32 s41, s39, s42
  s_add_u32 s41, s41, 5120
  s_add_u32 m0, s42, 5120
  s_add_u32 s42, s39, 9216
  buffer_load_dwordx4 v1, s[8:11], s41 offen sc1 lds
  s_mov_b32 m0, 9216
  s_mov_b64 exec, s[4:5]
  buffer_load_dwordx4 v1, s[8:11], s42 offen sc1 lds
  s_mov_b64 exec, -1
L_rd_5:
  ds_read_b128 v[42:45], v1 offset:5120
  ds_read_b128 v[46:49], v1 offset:6144
  ds_read_b128 v[50:53], v1 offset:7168
  ds_read_b128 v[54:57], v1 offset:8192
  ds_read_b128 v[58:61], v1 offset:9216
  s_add_u32 s51, s51, 1
  s_cmp_ge_u32 s51, 400000
  s_cbranch_scc1 L_fail
  s_waitcnt lgkmcnt(0)
  v_max3_u32 v15, v42, v43, v44
  v_max3_u32 v16, v45, v46, v47
  v_max3_u32 v86, v48, v49, v50
  v_max3_u32 v87, v51, v52, v53
  v_max3_u32 v15, v15, v54, v55
  v_max3_u32 v16, v16, v56, v57
  v_max3_u32 v86, v86, v58, v59
  v_max3_u32 v87, v87, v60, v61
  v_max3_u32 v15, v15, v16, v86
  v_max_u32 v15, v15, v87
  v_cmp_eq_u32 vcc, -1, v15
  s_cbranch_vccz L_spinR_ok
  s_branch L_spinRF_d
L_spinR_ok:
  v_smfmac_f32_16x16x64_bf16 v[18:21], v[42:45], a[40:47], v2
  v_smfmac_f32_16x16x64_bf16 v[22:25], v[42:45], a[120:127], v2
  v_smfmac_f32_16x16x64_bf16 v[18:21], v[46:49], a[48:55], v2
  v_smfmac_f32_16x16x64_bf16 v[22:25], v[46:49], a[128:135], v2
  v_smfmac_f32_16x16x64_bf16 v[18:21], v[50:53], a[56:63], v2
  s_add_u32 s41, s47, s53
  v_smfmac_f32_16x16x64_bf16 v[22:25], v[50:53], a[136:143], v2
  v_lshlrev_b32 v15, 7, v0
  v_smfmac_f32_16x16x64_bf16 v[18:21], v[54:57], a[64:71], v2
  s_add_u32 s41, s41, 262144
  v_smfmac_f32_16x16x64_bf16 v[22:25], v[54:57], a[144:151], v2
  v_smfmac_f32_16x16x64_bf16 v[18:21], v[58:61], a[72:79], v2
  v_smfmac_f32_16x16x64_bf16 v[22:25], v[58:61], a[152:159], v2
  v_smfmac_f32_16x16x64_bf16 v[26:29], v[42:45], a[160:167], v2
  s_nop 0
  v_smfmac_f32_16x16x64_bf16 v[30:33], v[42:45], a[168:175], v2
  s_nop 0
  v_smfmac_f32_16x16x64_bf16 v[26:29], v[46:49], a[176:183], v2
  s_nop 0
  v_smfmac_f32_16x16x64_bf16 v[30:33], v[46:49], a[184:191], v2
  s_nop 0
  v_smfmac_f32_16x16x64_bf16 v[26:29], v[50:53], a[192:199], v2
  v_add_f32 v18, v18, v20
  v_add_f32 v19, v19, v21
  v_smfmac_f32_16x16x64_bf16 v[30:33], v[50:53], a[200:207], v2
  v_add_f32 v22, v22, v24
  v_add_f32 v23, v23, v25
  v_cmp_u_f32 vcc, v18, v19
  v_smfmac_f32_16x16x64_bf16 v[26:29], v[54:57], a[208:215], v2
  v_cvt_pk_bf16_f32 v18, v18, v19
  s_cbranch_vccnz L_nan
L_nan_cont:
  v_smfmac_f32_16x16x64_bf16 v[30:33], v[54:57], a[216:223], v2
  v_cvt_pk_bf16_f32 v22, v22, v23
  ds_write_b16 v6, v18 offset:0
  v_smfmac_f32_16x16x64_bf16 v[26:29], v[58:61], a[224:231], v2
  ds_write_b16_d16_hi v6, v18 offset:288
  ds_write_b16 v6, v22 offset:32
  v_smfmac_f32_16x16x64_bf16 v[30:33], v[58:61], a[232:239], v2
  ds_write_b16_d16_hi v6, v22 offset:320
  s_waitcnt vmcnt(0)
  s_mov_b32 m0, 23040
  v_smfmac_f32_16x16x64_bf16 v[34:37], v[42:45], v[96:103], v2
  buffer_load_dword v15, s[8:11], s41 offen lds
  v_smfmac_f32_16x16x64_bf16 v[38:41], v[42:45], v[104:111], v2
  s_nop 0
  v_smfmac_f32_16x16x64_bf16 v[34:37], v[46:49], v[112:119], v2
  s_nop 0
  v_smfmac_f32_16x16x64_bf16 v[38:41], v[46:49], v[120:127], v2
  v_add_f32 v26, v26, v28
  v_add_f32 v27, v27, v29
  v_smfmac_f32_16x16x64_bf16 v[34:37], v[50:53], v[128:135], v2
  v_add_f32 v30, v30, v32
  v_add_f32 v31, v31, v33
  v_smfmac_f32_16x16x64_bf16 v[38:41], v[50:53], v[136:143], v2
  v_cvt_pk_bf16_f32 v86, v26, v27
  v_cvt_pk_bf16_f32 v87, v30, v31
  v_smfmac_f32_16x16x64_bf16 v[34:37], v[54:57], v[144:151], v2
  s_waitcnt lgkmcnt(0)
  s_barrier
  ds_write_b16 v6, v86 offset:2304
  ds_write_b16_d16_hi v6, v86 offset:2592
  v_smfmac_f32_16x16x64_bf16 v[38:41], v[54:57], v[152:159], v2
  ds_write_b16 v6, v87 offset:2336
  ds_write_b16_d16_hi v6, v87 offset:2624
  v_smfmac_f32_16x16x64_bf16 v[34:37], v[58:61], v[160:167], v2
  ds_read_b128 v[62:65], v7 offset:0
  ds_read_b128 v[66:69], v7 offset:64
  v_smfmac_f32_16x16x64_bf16 v[38:41], v[58:61], v[168:175], v2
  ds_read_b128 v[70:73], v7 offset:128
  ds_read_b128 v[74:77], v7 offset:192
  ds_read_b128 v[42:45], v1 offset:10240
  ds_read_b128 v[46:49], v1 offset:14336
  ds_read_b128 v[50:53], v1 offset:11264
  ds_read_b128 v[54:57], v1 offset:15360
  ds_read_b128 v[58:61], v1 offset:12288
  s_waitcnt lgkmcnt(9)
  s_barrier
  ds_read_b128 v[26:29], v12 offset:0
  ds_read_b128 v[30:33], v12 offset:64
  s_waitcnt lgkmcnt(10)
  s_waitcnt lgkmcnt(6)
  v_mfma_f32_16x16x32_bf16 v[18:21], v[42:45], v[62:65], 0
  ds_read_b128 v[42:45], v1 offset:16384
  s_waitcnt lgkmcnt(6)
  v_mfma_f32_16x16x32_bf16 v[22:25], v[46:49], v[62:65], 0
  ds_read_b128 v[46:49], v1 offset:13312
  s_waitcnt lgkmcnt(6)
  v_mfma_f32_16x16x32_bf16 v[18:21], v[50:53], v[66:69], v[18:21]
  ds_read_b128 v[50:53], v1 offset:17408
  v_add_f32 v34, v34, v36
  s_waitcnt lgkmcnt(6)
  v_mfma_f32_16x16x32_bf16 v[22:25], v[54:57], v[66:69], v[22:25]
  ds_read_b128 v[54:57], v12 offset:128
  v_add_f32 v35, v35, v37
  s_waitcnt lgkmcnt(6)
  v_mfma_f32_16x16x32_bf16 v[18:21], v[58:61], v[70:73], v[18:21]
  ds_read_b128 v[58:61], v12 offset:192
  v_add_f32 v38, v38, v40
  s_waitcnt lgkmcnt(4)
  v_mfma_f32_16x16x32_bf16 v[22:25], v[42:45], v[70:73], v[22:25]
  v_add_f32 v39, v39, v41
  s_waitcnt lgkmcnt(3)
  v_mfma_f32_16x16x32_bf16 v[18:21], v[46:49], v[74:77], v[18:21]
  v_cvt_pk_bf16_f32 v34, v34, v35
  s_waitcnt lgkmcnt(2)
  v_mfma_f32_16x16x32_bf16 v[22:25], v[50:53], v[74:77], v[22:25]
  v_cvt_pk_bf16_f32 v38, v38, v39
  v_mfma_f32_16x16x32_bf16 v[42:45], v[26:29], v[62:65], 0
  v_mov_b32 v35, 0
  v_mfma_f32_16x16x32_bf16 v[42:45], v[30:33], v[66:69], v[42:45]
  v_mov_b32 v39, 0
  s_waitcnt lgkmcnt(1)
  v_mfma_f32_16x16x32_bf16 v[42:45], v[54:57], v[70:73], v[42:45]
  v_mov_b64 v[36:37], 0
  s_waitcnt lgkmcnt(0)
  v_mfma_f32_16x16x32_bf16 v[42:45], v[58:61], v[74:77], v[42:45]
  v_mov_b64 v[40:41], 0
  v_max3_f32 v62, v18, v19, v20
  v_max3_f32 v63, v21, v22, v23
  v_max3_f32 v62, v62, v24, v25
  v_mov_b32 v71, 0
  v_mov_b64 v[72:73], 0
  v_cndmask_b32_e64 v86, v86, v34, s[64:65]
  v_cndmask_b32_e64 v87, v87, v38, s[64:65]
  s_lshl_b32 s46, s23, 16
  s_add_u32 s46, s46, s36
  buffer_store_dword v86, v17, s[8:11], s46 offen sc1
  buffer_store_dword v87, v17, s[8:11], s46 offen offset:256 sc1
  s_cmp_eq_u32 s23, 63
  s_cbranch_scc1 L_done
  v_max3_f32 v63, v63, v42, v43
  v_max_f32 v62, v62, v63
  v_mov_b32 v63, v62
  s_nop 1
  v_permlane32_swap_b32 v62, v63
  v_max_f32 v62, v62, v63
  v_mov_b32 v63, v62
  s_nop 1
  v_permlane16_swap_b32 v62, v63
  v_max_f32 v62, v62, v63
  v_mul_f32 v62, s38, v62
  v_pk_fma_f32 v[18:19], v[18:19], s[60:61], v[62:63] op_sel_hi:[1,1,0] neg_lo:[0,0,1] neg_hi:[0,0,1]
  v_pk_fma_f32 v[20:21], v[20:21], s[60:61], v[62:63] op_sel_hi:[1,1,0] neg_lo:[0,0,1] neg_hi:[0,0,1]
  v_pk_fma_f32 v[22:23], v[22:23], s[60:61], v[62:63] op_sel_hi:[1,1,0] neg_lo:[0,0,1] neg_hi:[0,0,1]
  v_pk_fma_f32 v[24:25], v[24:25], s[60:61], v[62:63] op_sel_hi:[1,1,0] neg_lo:[0,0,1] neg_hi:[0,0,1]
  v_pk_fma_f32 v[42:43], v[42:43], s[60:61], v[62:63] op_sel_hi:[1,1,0] neg_lo:[0,0,1] neg_hi:[0,0,1]
  v_exp_f32 v18, v18
  v_exp_f32 v19, v19
  v_exp_f32 v20, v20
  v_exp_f32 v21, v21
  v_exp_f32 v22, v22
  v_exp_f32 v23, v23
  v_exp_f32 v24, v24
  v_exp_f32 v25, v25
  v_exp_f32 v42, v42
  v_exp_f32 v43, v43
  v_cvt_pk_bf16_f32 v66, v18, v19
  v_cvt_pk_bf16_f32 v67, v20, v21
  v_cvt_pk_bf16_f32 v68, v22, v23
  v_cvt_pk_bf16_f32 v69, v24, v25
  v_cvt_pk_bf16_f32 v70, v42, v43
  s_nop 0
  v_mfma_f32_16x16x32_bf16 v[18:21], v[78:81], v[66:69], 0
  v_mov_b32 v30, 0x3f803f80
  v_mov_b32 v31, 0x3f803f80
  v_mfma_f32_16x16x32_bf16 v[22:25], v[82:85], v[66:69], 0
  v_mov_b32 v32, 0x3f803f80
  v_mov_b32 v33, 0x3f803f80
  v_mfma_f32_16x16x32_bf16 v[18:21], v[34:37], v[70:73], v[18:21]
  v_mfma_f32_16x16x32_bf16 v[22:25], v[38:41], v[70:73], v[22:25]
  v_mfma_f32_16x16x32_bf16 v[26:29], v[30:33], v[66:69], 0
  v_mfma_f32_16x16x32_bf16 v[26:29], v[30:33], v[70:73], v[26:29]
  s_nop 5
  v_cndmask_b32_e64 v18, v18, v20, s[2:3]
  v_cndmask_b32_e64 v19, v19, v21, s[2:3]
  v_cndmask_b32_e64 v22, v22, v24, s[2:3]
  v_cndmask_b32_e64 v23, v23, v25, s[2:3]
  v_rcp_f32 v64, v26
  s_nop 0
  v_pk_mul_f32 v[18:19], v[18:19], v[64:65] op_sel_hi:[1,0]
  v_pk_mul_f32 v[22:23], v[22:23], v[64:65] op_sel_hi:[1,0]
  v_cvt_pk_bf16_f32 v30, v18, v19
  v_cvt_pk_bf16_f32 v31, v22, v23
  ds_write_b64 v13, v[30:31]
  v_mov_b64 v[50:51], 0
  v_mov_b64 v[52:53], 0
  v_mov_b64 v[54:55], 0
  v_mov_b64 v[56:57], 0
  v_mov_b64 v[58:59], 0
  v_mov_b64 v[60:61], 0
  v_mov_b64 v[62:63], 0
  v_mov_b64 v[64:65], 0
  v_mov_b64 v[66:67], 0
  v_mov_b64 v[68:69], 0
  s_waitcnt lgkmcnt(0)
  s_barrier
  ds_read_b128 v[42:45], v1 offset:18432
  ds_read_b128 v[46:49], v1 offset:19456
  s_cmp_lg_u32 s22, 3
  s_cbranch_scc1 L_w3_6
  s_cmp_eq_u32 s23, 0
  s_cbranch_scc1 L_w3_6
  buffer_store_dword v2, off, s[8:11], s62 sc1
L_w3_6:
  s_mul_i32 s40, s32, 163840
  s_add_u32 s41, s40, s25
  s_add_u32 s42, s41, s33
  s_add_u32 s43, s41, 131072
  s_waitcnt lgkmcnt(0)
  v_smfmac_f32_16x16x64_bf16 v[50:53], v[42:45], v[176:183], v2
  s_nop 0
  v_smfmac_f32_16x16x64_bf16 v[50:53], v[46:49], v[184:191], v2
  s_nop 0
  v_smfmac_f32_16x16x64_bf16 v[54:57], v[42:45], v[192:199], v2
  s_nop 0
  v_smfmac_f32_16x16x64_bf16 v[54:57], v[46:49], v[200:207], v2
  s_nop 0
  v_smfmac_f32_16x16x64_bf16 v[58:61], v[42:45], v[208:215], v2
  s_nop 0
  v_smfmac_f32_16x16x64_bf16 v[58:61], v[46:49], v[216:223], v2
  v_add_f32 v50, v50, v52
  v_smfmac_f32_16x16x64_bf16 v[62:65], v[42:45], v[224:231], v2
  v_add_f32 v51, v51, v53
  v_smfmac_f32_16x16x64_bf16 v[62:65], v[46:49], v[232:239], v2
  v_cvt_pk_bf16_f32 v18, v50, v51
  v_smfmac_f32_16x16x64_bf16 v[66:69], v[42:45], v[240:247], v2
  v_add_f32 v54, v54, v56
  v_smfmac_f32_16x16x64_bf16 v[66:69], v[46:49], v[248:255], v2
  v_add_f32 v55, v55, v57
  s_nop 1
  v_cvt_pk_bf16_f32 v19, v54, v55
  v_add_f32 v58, v58, v60
  v_add_f32 v59, v59, v61
  v_cvt_pk_bf16_f32 v20, v58, v59
  v_add_f32 v62, v62, v64
  v_add_f32 v63, v63, v65
  v_cvt_pk_bf16_f32 v21, v62, v63
  s_nop 1
  v_add_f32 v66, v66, v68
  v_add_f32 v67, v67, v69
  v_cvt_pk_bf16_f32 v22, v66, v67
  buffer_store_dwordx4 v[18:21], v3, s[8:11], s42 offen
  buffer_store_dword v22, v4, s[8:11], s43 offen
  v_mov_b64 v[26:27], -1
  v_mov_b64 v[28:29], -1
  s_lshl_b32 s46, s22, 10
  v_add_u32 v16, s46, v1
  ds_write_b128 v16, v[26:29] offset:0
  ds_write_b128 v1, v[26:29] offset:4096
  ds_write_b128 v16, v[26:29] offset:5120
  ds_write_b128 v1, v[26:29] offset:9216
  s_add_u32 s40, s40, s26
L_cut:
  s_add_u32 s31, s31, 1
  s_cmp_eq_u32 s31, 3
  s_cselect_b32 s31, 0, s31
  s_mul_i32 s44, s31, 10240
  s_add_u32 s39, s44, s30
  s_add_u32 s45, s31, 2
  s_cmp_ge_u32 s45, 3
  s_cselect_b32 s46, 3, 0
  s_sub_u32 s45, s45, s46
  s_mul_i32 s45, s45, 10240
  s_add_u32 s47, s23, 1
  s_lshl_b32 s47, s47, 18
  s_cmp_eq_u32 s24, -1
  s_cbranch_scc1 L_ro_7
  buffer_load_dwordx4 v[42:45], v1, s[8:11], s40 offen sc1
  buffer_load_dwordx4 v[46:49], v1, s[8:11], s40 offen offset:1024 sc1
L_ro_7:
  v_mov_b64 v[18:19], 0
  v_mov_b64 v[20:21], 0
  v_mov_b64 v[22:23], 0
  v_mov_b64 v[24:25], 0
  v_mov_b64 v[34:35], 0
  v_mov_b64 v[36:37], 0
  v_mov_b64 v[38:39], 0
  v_mov_b64 v[40:41], 0
  v_mov_b64 v[62:63], -1
  v_mov_b64 v[64:65], -1
  s_waitcnt lgkmcnt(0)
  v_mov_b64 v[26:27], 0
  v_mov_b64 v[28:29], 0
  v_mov_b64 v[30:31], 0
  v_mov_b64 v[32:33], 0
  s_nop 15
  s_nop 7
  s_cmp_eq_u32 s24, -1
  s_cbranch_scc1 L_ro_8
  buffer_load_dwordx4 v[50:53], v1, s[8:11], s40 offen sc1
  buffer_load_dwordx4 v[54:57], v1, s[8:11], s40 offen offset:1024 sc1
L_ro_8:
  s_add_u32 s46, s23, 2
  s_lshr_b32 s41, s46, 2
  s_cmp_lt_u32 s41, s57
  s_cbranch_scc1 L_kvw_9
  s_cmp_ge_u32 s41, 16
  s_cbranch_scc1 L_kvw_9
  s_lshl_b32 s42, s41, 7
  s_add_u32 s42, s42, 109051904
  s_add_u32 s57, s41, 1
  s_mov_b32 s51, 0
  v_mov_b32 v16, 0
L_kvw_9_p:
  buffer_load_dword v15, v16, s[8:11], s42 offen sc1
  s_waitcnt vmcnt(0)
  v_readfirstlane_b32 s41, v15
  s_add_u32 s51, s51, 1
  s_cmp_ge_u32 s51, 400000
  s_cbranch_scc1 L_fail
  s_cmp_lt_u32 s41, 32
  s_cbranch_scc1 L_kvw_9_p
L_kvw_9:
  s_cmp_lg_u32 s22, 3
  s_cbranch_scc1 L_w3_10
  s_add_u32 s41, s47, s34
  s_add_u32 s42, s41, 4096
  s_mov_b32 m0, 10240
  s_nop 0
  buffer_load_dwordx4 v1, s[8:11], s41 offen offset:0 lds
  buffer_load_dwordx4 v1, s[8:11], s41 offen offset:1024 lds
  buffer_load_dwordx4 v1, s[8:11], s41 offen offset:2048 lds
  buffer_load_dwordx4 v1, s[8:11], s41 offen offset:3072 lds
  s_mov_b32 m0, 14336
  s_nop 0
  buffer_load_dwordx4 v1, s[8:11], s42 offen offset:0 lds
  buffer_load_dwordx4 v1, s[8:11], s42 offen offset:1024 lds
  buffer_load_dwordx4 v1, s[8:11], s42 offen offset:2048 lds
  buffer_load_dwordx4 v1, s[8:11], s42 offen offset:3072 lds
L_w3_10:
  s_cmp_eq_u32 s24, -1
  s_cbranch_scc1 L_nored
  s_mov_b32 s51, 0
  s_add_u32 s41, s27, s44
  s_add_u32 s42, s28, s44
  s_add_u32 s43, s27, s45
  s_add_u32 s46, s29, s45
L_pollP:
  s_add_u32 s51, s51, 1
  s_cmp_ge_u32 s51, 200000
  s_cbranch_scc1 L_fail
  s_waitcnt vmcnt(2)
  v_max3_u32 v15, v42, v43, v44
  v_max3_u32 v16, v45, v46, v47
  v_max3_u32 v15, v15, v48, v49
  v_max_u32 v15, v15, v16
  v_cmp_eq_u32 vcc, -1, v15
  s_cbranch_vccz L_okA
  buffer_load_dwordx4 v[42:45], v1, s[8:11], s40 offen sc1
  buffer_load_dwordx4 v[46:49], v1, s[8:11], s40 offen offset:1024 sc1
  s_waitcnt vmcnt(2)
  v_max3_u32 v15, v50, v51, v52
  v_max3_u32 v16, v53, v54, v55
  v_max3_u32 v15, v15, v56, v57
  v_max_u32 v15, v15, v16
  v_cmp_eq_u32 vcc, -1, v15
  s_cbranch_vccz L_okB
  buffer_load_dwordx4 v[50:53], v1, s[8:11], s40 offen sc1
  buffer_load_dwordx4 v[54:57], v1, s[8:11], s40 offen offset:1024 sc1
  s_branch L_pollP
L_okB:
  v_mfma_f32_16x16x32_bf16 v[58:61], v[8:11], v[50:53], 0
  v_mfma_f32_16x16x32_bf16 v[58:61], v[8:11], v[54:57], v[58:61]
  s_branch L_okP
L_okA:
  v_mfma_f32_16x16x32_bf16 v[58:61], v[8:11], v[42:45], 0
  v_mfma_f32_16x16x32_bf16 v[58:61], v[8:11], v[46:49], v[58:61]
L_okP:
  s_nop 7
  v_add_f32_dpp v58, v58, v58 row_ror:8 row_mask:0xf bank_mask:0xf
  v_add_f32_dpp v59, v59, v59 row_ror:8 row_mask:0xf bank_mask:0xf
  v_add_f32_dpp v60, v60, v60 row_ror:8 row_mask:0xf bank_mask:0xf
  v_add_f32_dpp v61, v61, v61 row_ror:8 row_mask:0xf bank_mask:0xf
  v_add_f32_dpp v58, v58, v58 row_ror:4 row_mask:0xf bank_mask:0xf
  v_add_f32_dpp v59, v59, v59 row_ror:4 row_mask:0xf bank_mask:0xf
  v_add_f32_dpp v60, v60, v60 row_ror:4 row_mask:0xf bank_mask:0xf
  v_add_f32_dpp v61, v61, v61 row_ror:4 row_mask:0xf bank_mask:0xf
  v_cvt_pk_bf16_f32 v15, v58, v60
  v_cvt_pk_bf16_f32 v16, v59, v61
  v_cndmask_b32_e64 v15, v16, v15, s[6:7]
  s_mov_b64 exec, s[48:49]
  buffer_store_dword v15, v5, s[8:11], s42 offen sc1
  buffer_store_dword v15, v5, s[8:11], s41 offen
  buffer_store_dword v62, v5, s[8:11], s43 offen
  buffer_store_dword v62, v5, s[8:11], s46 offen sc1
  s_mov_b64 exec, -1
  buffer_store_dwordx4 v[62:65], v1, s[8:11], s40 offen
  buffer_store_dwordx4 v[62:65], v1, s[8:11], s40 offen offset:1024
  s_waitcnt vmcnt(6)
L_nored:
  s_barrier
  s_cmp_lg_u32 s22, 3
  s_cbranch_scc1 L_w3_11
  s_nop 15
  s_nop 7
  s_add_u32 s41, s39, 0
  s_add_u32 s42, s39, 4096
  s_mov_b32 m0, 0
  s_nop 0
  buffer_load_dwordx4 v1, s[8:11], s41 offen offset:0 sc1 lds
  buffer_load_dwordx4 v1, s[8:11], s41 offen offset:1024 sc1 lds
  buffer_load_dwordx4 v1, s[8:11], s41 offen offset:2048 sc1 lds
  buffer_load_dwordx4 v1, s[8:11], s41 offen offset:3072 sc1 lds
  s_mov_b32 m0, 4096
  s_nop 0
  buffer_load_dwordx4 v1, s[8:11], s42 offen sc1 lds
L_w3_11:
  s_xor_b32 s32, s32, 1
  s_add_u32 s62, s62, 16
  s_add_u32 s23, s23, 1
  s_mov_b32 s52, 0
  s_branch L_step
L_nan:
  s_cmp_lg_u32 s52, 0
  s_cbranch_scc1 L_nan_cont
  s_mov_b32 s52, 1
  s_nop 15
  s_nop 15
  v_mov_b64 v[18:19], 0
  v_mov_b64 v[20:21], 0
  v_mov_b64 v[22:23], 0
  v_mov_b64 v[24:25], 0
  v_mov_b64 v[26:27], 0
  v_mov_b64 v[28:29], 0
  v_mov_b64 v[30:31], 0
  v_mov_b64 v[32:33], 0
  v_mov_b64 v[34:35], 0
  v_mov_b64 v[36:37], 0
  v_mov_b64 v[38:39], 0
  v_mov_b64 v[40:41], 0
  s_waitcnt lgkmcnt(0)
  s_branch L_redo_entry
L_fail:
  s_mov_b32 s50, 1
  s_mov_b64 exec, -1
L_done:
  s_waitcnt vmcnt(0)
  s_barrier
  s_cmp_lg_u32 s22, 3
  s_cbranch_scc1 L_pe
  buffer_store_dword v2, off, s[8:11], s62 sc1
  s_add_u32 s41, s62, 16
  buffer_store_dword v2, off, s[8:11], s41 sc1
L_pe:
  s_memtime s[66:67]
  s_memrealtime s[60:61]
  s_waitcnt lgkmcnt(0)
  s_mov_b32 s63, s60
  s_sub_u32 s60, s60, s58
  s_sub_u32 s40, s66, s54
  s_lshl_b32 s41, s20, 5
  s_add_u32 s41, s41, s21
  s_lshl_b32 s41, s41, 2
  s_add_u32 s41, s41, s22
  s_lshl_b32 s41, s41, 8
  s_add_u32 s41, s41, 60817408
  v_writelane_b32 v20, s72, 0
  v_writelane_b32 v20, s73, 1
  v_writelane_b32 v20, s74, 2
  v_writelane_b32 v20, s75, 3
  v_writelane_b32 v20, s76, 4
  v_writelane_b32 v20, s77, 5
  v_writelane_b32 v20, s78, 6
  v_writelane_b32 v20, s79, 7
  v_writelane_b32 v20, s80, 8
  v_writelane_b32 v20, s81, 9
  v_writelane_b32 v20, s82, 10
  v_writelane_b32 v20, s83, 11
  v_writelane_b32 v20, s84, 12
  v_writelane_b32 v20, s85, 13
  v_writelane_b32 v20, s86, 14
  v_writelane_b32 v20, s87, 15
  v_writelane_b32 v20, s88, 16
  v_writelane_b32 v20, s89, 17
  v_writelane_b32 v20, s90, 18
  v_writelane_b32 v20, s91, 19
  v_writelane_b32 v20, s92, 20
  v_writelane_b32 v20, s93, 21
  v_writelane_b32 v20, s94, 22
  v_writelane_b32 v20, s95, 23
  v_writelane_b32 v20, s96, 24
  v_writelane_b32 v20, s97, 25
  v_writelane_b32 v20, s98, 26
  v_writelane_b32 v20, s99, 27
  v_writelane_b32 v20, s100, 28
  v_writelane_b32 v20, s101, 29
  v_writelane_b32 v20, s58, 58
  v_writelane_b32 v20, s63, 59
  v_writelane_b32 v20, s60, 60
  v_writelane_b32 v20, s56, 61
  v_writelane_b32 v20, s40, 62
  v_writelane_b32 v20, s50, 63
  v_lshlrev_b32 v21, 2, v0
  buffer_store_dword v20, v21, s[8:11], s41 offen
  s_waitcnt vmcnt(0)
L_end:
  s_endpgm
L_worker:
  s_load_dwordx2 s[4:5], s[0:1], 112
  s_load_dwordx4 s[72:75], s[0:1], 0
  s_load_dwordx4 s[76:79], s[0:1], 16
  s_load_dwordx4 s[80:83], s[0:1], 40
  s_load_dwordx4 s[84:87], s[0:1], 56
  s_load_dwordx2 s[88:89], s[0:1], 72
  s_load_dwordx4 s[92:95], s[0:1], 88
  s_load_dwordx2 s[6:7], s[0:1], 104
  s_waitcnt lgkmcnt(0)
  s_mov_b32 s8, s4
  s_and_b32 s9, s5, 0xffff
  s_mov_b32 s10, 268435456
  s_mov_b32 s11, 0x20000
  s_mov_b32 s64, s6
  s_and_b32 s65, s7, 0xffff
  s_mov_b32 s66, 256
  s_mov_b32 s67, 0x20000
  s_mov_b32 s69, 0
  s_cmp_eq_u32 s22, 0
  s_cselect_b32 s24, s82, s84
  s_cselect_b32 s25, s83, s85
  s_cmp_eq_u32 s22, 2
  s_cselect_b32 s24, s86, s24
  s_cselect_b32 s25, s87, s25
  s_cmp_eq_u32 s22, 3
  s_cselect_b32 s24, s88, s24
  s_cselect_b32 s25, s89, s25
  s_mov_b32 s12, s24
  s_and_b32 s13, s25, 0xffff
  s_mov_b32 s14, 5242880
  s_mov_b32 s15, 0x20000
  s_mul_i32 s26, s2, 20480
  v_lshlrev_b32 v1, 7, v0
  s_lshl_b32 s27, s22, 8
  s_add_u32 m0, s27, 162560
  s_nop 0
  buffer_load_dword v1, s[12:15], s26 offen lds
  s_add_u32 s26, s26, 8192
  buffer_load_dword v1, s[12:15], s26 offen lds
  s_add_u32 s26, s26, 8192
  s_mov_b32 exec_hi, 0
  buffer_load_dword v1, s[12:15], s26 offen lds
  s_mov_b64 exec, -1
L_next:
  s_cmp_lg_u32 s22, 0
  s_cbranch_scc1 L_q_b
  v_mov_b32 v1, 1
  v_mov_b32 v2, 192
  s_mov_b64 exec, 1
  buffer_atomic_add v1, v2, s[64:67], 0 offen sc0
  s_waitcnt vmcnt(0)
  v_mov_b32 v2, 163836
  ds_write_b32 v2, v1
  s_waitcnt lgkmcnt(0)
  s_mov_b64 exec, -1
L_q_b:
  s_barrier
  v_mov_b32 v2, 163836
  ds_read_b32 v1, v2
  s_waitcnt lgkmcnt(0)
  v_readfirstlane_b32 s97, v1
  s_barrier
  s_cmp_lt_u32 s97, 64
  s_cbranch_scc1 L_set_prep
  s_sub_u32 s97, s97, 64
  s_cmp_lt_u32 s97, 512
  s_cbranch_scc1 L_set_kv
  s_sub_u32 s97, s97, 512
  s_cmp_lt_u32 s97, 128
  s_cbranch_scc1 L_set_a1
  s_sub_u32 s97, s97, 128
  s_cmp_lt_u32 s97, 256
  s_cbranch_scc1 L_set_q
  s_sub_u32 s97, s97, 256
  s_cmp_lt_u32 s97, 32
  s_cbranch_scc1 L_set_kvr
  s_sub_u32 s97, s97, 32
  s_cmp_lt_u32 s97, 128
  s_cbranch_scc1 L_set_a2
  s_sub_u32 s97, s97, 128
  s_cmp_lt_u32 s97, 32
  s_cbranch_scc1 L_set_c0
  s_sub_u32 s97, s97, 32
  s_cmp_lt_u32 s97, 32
  s_cbranch_scc1 L_set_c1
  s_sub_u32 s97, s97, 32
  s_cmp_lt_u32 s97, 10
  s_cbranch_scc1 L_set_o0
  s_sub_u32 s97, s97, 10
  s_cmp_lt_u32 s97, 32
  s_cbranch_scc1 L_set_c2
  s_sub_u32 s97, s97, 32
  s_cmp_lt_u32 s97, 10
  s_cbranch_scc1 L_set_o1
  s_sub_u32 s97, s97, 10
  s_cmp_lt_u32 s97, 32
  s_cbranch_scc1 L_set_c3
  s_sub_u32 s97, s97, 32
  s_cmp_lt_u32 s97, 10
  s_cbranch_scc1 L_set_o2
  s_sub_u32 s97, s97, 10
  s_cmp_lt_u32 s97, 32
  s_cbranch_scc1 L_set_c4
  s_sub_u32 s97, s97, 32
  s_cmp_lt_u32 s97, 10
  s_cbranch_scc1 L_set_o3
  s_sub_u32 s97, s97, 10
  s_cmp_lt_u32 s97, 32
  s_cbranch_scc1 L_set_c5
  s_sub_u32 s97, s97, 32
  s_cmp_lt_u32 s97, 10
  s_cbranch_scc1 L_set_o4
  s_sub_u32 s97, s97, 10
  s_cmp_lt_u32 s97, 32
  s_cbranch_scc1 L_set_c6
  s_sub_u32 s97, s97, 32
  s_cmp_lt_u32 s97, 10
  s_cbranch_scc1 L_set_o5
  s_sub_u32 s97, s97, 10
  s_cmp_lt_u32 s97, 32
  s_cbranch_scc1 L_set_c7
  s_sub_u32 s97, s97, 32
  s_cmp_lt_u32 s97, 10
  s_cbranch_scc1 L_set_o6
  s_sub_u32 s97, s97, 10
  s_cmp_lt_u32 s97, 32
  s_cbranch_scc1 L_set_c8
  s_sub_u32 s97, s97, 32
  s_cmp_lt_u32 s97, 10
  s_cbranch_scc1 L_set_o7
  s_sub_u32 s97, s97, 10
  s_cmp_lt_u32 s97, 32
  s_cbranch_scc1 L_set_c9
  s_sub_u32 s97, s97, 32
  s_cmp_lt_u32 s97, 10
  s_cbranch_scc1 L_set_o8
  s_sub_u32 s97, s97, 10
  s_cmp_lt_u32 s97, 32
  s_cbranch_scc1 L_set_c10
  s_sub_u32 s97, s97, 32
  s_cmp_lt_u32 s97, 80
  s_cbranch_scc1 L_set_o15
  s_sub_u32 s97, s97, 80
  s_cmp_lt_u32 s97, 10
  s_cbranch_scc1 L_set_o9
  s_sub_u32 s97, s97, 10
  s_cmp_lt_u32 s97, 32
  s_cbranch_scc1 L_set_c11
  s_sub_u32 s97, s97, 32
  s_cmp_lt_u32 s97, 10
  s_cbranch_scc1 L_set_o10
  s_sub_u32 s97, s97, 10
  s_cmp_lt_u32 s97, 32
  s_cbranch_scc1 L_set_c12
  s_sub_u32 s97, s97, 32
  s_cmp_lt_u32 s97, 10
  s_cbranch_scc1 L_set_o11
  s_sub_u32 s97, s97, 10
  s_cmp_lt_u32 s97, 32
  s_cbranch_scc1 L_set_c13
  s_sub_u32 s97, s97, 32
  s_cmp_lt_u32 s97, 32
  s_cbranch_scc1 L_set_c14
  s_sub_u32 s97, s97, 32
  s_cmp_lt_u32 s97, 32
  s_cbranch_scc1 L_set_c15
  s_sub_u32 s97, s97, 32
  s_branch L_end
L_set_prep:
  s_mov_b32 s23, s97
  s_mov_b32 s68, 109056000
  s_branch JPREP
L_set_kv:
  s_lshr_b32 s24, s97, 5
  s_bfe_u32 s25, s97, 0x10004
  s_and_b32 s26, s97, 15
  s_lshl_b32 s23, s25, 8
  s_lshl_b32 s27, s24, 4
  s_add_u32 s23, s23, s27
  s_add_u32 s23, s23, s26
  s_lshl_b32 s27, s24, 7
  s_add_u32 s68, s27, 109051904
  s_branch JP
L_set_a1:
  s_cmp_lg_u32 s22, 0
  s_cbranch_scc1 L_da1_e
  s_cmp_lg_u32 s69, 0
  s_cbranch_scc1 L_da1_fr_d
  s_mov_b32 s71, 0
  v_mov_b32 v2, 40
L_da1_fr_p:
  buffer_load_dword v1, v2, s[64:67], 0 offen sc1
  s_waitcnt vmcnt(0)
  v_readfirstlane_b32 s96, v1
  s_add_u32 s71, s71, 1
  s_cmp_ge_u32 s71, 2000000
  s_cbranch_scc1 L_da1_fr_s
  s_cmp_eq_u32 s96, 0
  s_cbranch_scc1 L_da1_fr_p
L_da1_fr_s:
  s_mov_b32 s69, 1
L_da1_fr_d:
L_da1_e:
  s_mov_b32 s98, 109056000
  s_cmp_lg_u32 s22, 0
  s_cbranch_scc1 L_da1_b
  s_mov_b32 s71, 0
  v_mov_b32 v2, 0
L_da1_p:
  buffer_load_dword v1, v2, s[8:11], s98 offen sc1
  s_waitcnt vmcnt(0)
  v_readfirstlane_b32 s96, v1
  s_add_u32 s71, s71, 1
  s_cmp_ge_u32 s71, 2000000
  s_cbranch_scc1 L_da1_b
  s_cmp_ge_u32 s96, 64
  s_cbranch_scc1 L_da1_b
  s_sleep 4
  s_branch L_da1_p
L_da1_b:
  s_barrier
  s_mov_b32 s23, s97
  s_mov_b32 s68, 109056128
  s_branch JA1
L_set_q:
  s_add_u32 s23, s97, 512
  s_lshr_b32 s27, s97, 4
  s_lshl_b32 s27, s27, 7
  s_add_u32 s68, s27, 109053952
  s_branch JP
L_set_kvr:
  s_cmp_lg_u32 s22, 0
  s_cbranch_scc1 L_dkvr_e
  s_cmp_lg_u32 s69, 0
  s_cbranch_scc1 L_dkvr_fr_d
  s_mov_b32 s71, 0
  v_mov_b32 v2, 40
L_dkvr_fr_p:
  buffer_load_dword v1, v2, s[64:67], 0 offen sc1
  s_waitcnt vmcnt(0)
  v_readfirstlane_b32 s96, v1
  s_add_u32 s71, s71, 1
  s_cmp_ge_u32 s71, 2000000
  s_cbranch_scc1 L_dkvr_fr_s
  s_cmp_eq_u32 s96, 0
  s_cbranch_scc1 L_dkvr_fr_p
L_dkvr_fr_s:
  s_mov_b32 s69, 1
L_dkvr_fr_d:
L_dkvr_e:
  s_mov_b32 s98, 109056128
  s_cmp_lg_u32 s22, 0
  s_cbranch_scc1 L_dkvr_b
  s_mov_b32 s71, 0
  v_mov_b32 v2, 0
L_dkvr_p:
  buffer_load_dword v1, v2, s[8:11], s98 offen sc1
  s_waitcnt vmcnt(0)
  v_readfirstlane_b32 s96, v1
  s_add_u32 s71, s71, 1
  s_cmp_ge_u32 s71, 2000000
  s_cbranch_scc1 L_dkvr_b
  s_cmp_ge_u32 s96, 128
  s_cbranch_scc1 L_dkvr_b
  s_sleep 4
  s_branch L_dkvr_p
L_dkvr_b:
  s_barrier
  s_mov_b32 s23, s97
  s_mov_b32 s68, 109056256
  s_branch JKVR
L_set_a2:
  s_cmp_lg_u32 s22, 0
  s_cbranch_scc1 L_da2_e
  s_cmp_lg_u32 s69, 0
  s_cbranch_scc1 L_da2_fr_d
  s_mov_b32 s71, 0
  v_mov_b32 v2, 40
L_da2_fr_p:
  buffer_load_dword v1, v2, s[64:67], 0 offen sc1
  s_waitcnt vmcnt(0)
  v_readfirstlane_b32 s96, v1
  s_add_u32 s71, s71, 1
  s_cmp_ge_u32 s71, 2000000
  s_cbranch_scc1 L_da2_fr_s
  s_cmp_eq_u32 s96, 0
  s_cbranch_scc1 L_da2_fr_p
L_da2_fr_s:
  s_mov_b32 s69, 1
L_da2_fr_d:
L_da2_e:
  s_mov_b32 s98, 109056256
  s_cmp_lg_u32 s22, 0
  s_cbranch_scc1 L_da2_b
  s_mov_b32 s71, 0
  v_mov_b32 v2, 0
L_da2_p:
  buffer_load_dword v1, v2, s[8:11], s98 offen sc1
  s_waitcnt vmcnt(0)
  v_readfirstlane_b32 s96, v1
  s_add_u32 s71, s71, 1
  s_cmp_ge_u32 s71, 2000000
  s_cbranch_scc1 L_da2_b
  s_cmp_ge_u32 s96, 32
  s_cbranch_scc1 L_da2_b
  s_sleep 4
  s_branch L_da2_p
L_da2_b:
  s_barrier
  s_mov_b32 s23, s97
  s_lshr_b32 s27, s97, 3
  s_lshl_b32 s27, s27, 7
  s_add_u32 s68, s27, 109056384
  s_branch JA2
L_set_c0:
  s_cmp_lg_u32 s22, 0
  s_cbranch_scc1 L_dc0q_e
  s_cmp_lg_u32 s69, 0
  s_cbranch_scc1 L_dc0q_fr_d
  s_mov_b32 s71, 0
  v_mov_b32 v2, 40
L_dc0q_fr_p:
  buffer_load_dword v1, v2, s[64:67], 0 offen sc1
  s_waitcnt vmcnt(0)
  v_readfirstlane_b32 s96, v1
  s_add_u32 s71, s71, 1
  s_cmp_ge_u32 s71, 2000000
  s_cbranch_scc1 L_dc0q_fr_s
  s_cmp_eq_u32 s96, 0
  s_cbranch_scc1 L_dc0q_fr_p
L_dc0q_fr_s:
  s_mov_b32 s69, 1
L_dc0q_fr_d:
L_dc0q_e:
  s_mov_b32 s98, 109053952
  s_cmp_lg_u32 s22, 0
  s_cbranch_scc1 L_dc0q_b
  s_mov_b32 s71, 0
  v_mov_b32 v2, 0
L_dc0q_p:
  buffer_load_dword v1, v2, s[8:11], s98 offen sc1
  s_waitcnt vmcnt(0)
  v_readfirstlane_b32 s96, v1
  s_add_u32 s71, s71, 1
  s_cmp_ge_u32 s71, 2000000
  s_cbranch_scc1 L_dc0q_b
  s_cmp_ge_u32 s96, 16
  s_cbranch_scc1 L_dc0q_b
  s_sleep 4
  s_branch L_dc0q_p
L_dc0q_b:
  s_barrier
  s_cmp_lg_u32 s22, 0
  s_cbranch_scc1 L_dc0k_e
  s_cmp_lg_u32 s69, 0
  s_cbranch_scc1 L_dc0k_fr_d
  s_mov_b32 s71, 0
  v_mov_b32 v2, 40
L_dc0k_fr_p:
  buffer_load_dword v1, v2, s[64:67], 0 offen sc1
  s_waitcnt vmcnt(0)
  v_readfirstlane_b32 s96, v1
  s_add_u32 s71, s71, 1
  s_cmp_ge_u32 s71, 2000000
  s_cbranch_scc1 L_dc0k_fr_s
  s_cmp_eq_u32 s96, 0
  s_cbranch_scc1 L_dc0k_fr_p
L_dc0k_fr_s:
  s_mov_b32 s69, 1
L_dc0k_fr_d:
L_dc0k_e:
  s_mov_b32 s98, 109051904
  s_cmp_lg_u32 s22, 0
  s_cbranch_scc1 L_dc0k_b
  s_mov_b32 s71, 0
  v_mov_b32 v2, 0
L_dc0k_p:
  buffer_load_dword v1, v2, s[8:11], s98 offen sc1
  s_waitcnt vmcnt(0)
  v_readfirstlane_b32 s96, v1
  s_add_u32 s71, s71, 1
  s_cmp_ge_u32 s71, 2000000
  s_cbranch_scc1 L_dc0k_b
  s_cmp_ge_u32 s96, 32
  s_cbranch_scc1 L_dc0k_b
  s_sleep 4
  s_branch L_dc0k_p
L_dc0k_b:
  s_barrier
  s_add_u32 s23, s97, 0
  s_mov_b32 s68, 109058432
  s_branch JC
L_set_c1:
  s_cmp_lg_u32 s22, 0
  s_cbranch_scc1 L_dc1q_e
  s_cmp_lg_u32 s69, 0
  s_cbranch_scc1 L_dc1q_fr_d
  s_mov_b32 s71, 0
  v_mov_b32 v2, 40
L_dc1q_fr_p:
  buffer_load_dword v1, v2, s[64:67], 0 offen sc1
  s_waitcnt vmcnt(0)
  v_readfirstlane_b32 s96, v1
  s_add_u32 s71, s71, 1
  s_cmp_ge_u32 s71, 2000000
  s_cbranch_scc1 L_dc1q_fr_s
  s_cmp_eq_u32 s96, 0
  s_cbranch_scc1 L_dc1q_fr_p
L_dc1q_fr_s:
  s_mov_b32 s69, 1
L_dc1q_fr_d:
L_dc1q_e:
  s_mov_b32 s98, 109054080
  s_cmp_lg_u32 s22, 0
  s_cbranch_scc1 L_dc1q_b
  s_mov_b32 s71, 0
  v_mov_b32 v2, 0
L_dc1q_p:
  buffer_load_dword v1, v2, s[8:11], s98 offen sc1
  s_waitcnt vmcnt(0)
  v_readfirstlane_b32 s96, v1
  s_add_u32 s71, s71, 1
  s_cmp_ge_u32 s71, 2000000
  s_cbranch_scc1 L_dc1q_b
  s_cmp_ge_u32 s96, 16
  s_cbranch_scc1 L_dc1q_b
  s_sleep 4
  s_branch L_dc1q_p
L_dc1q_b:
  s_barrier
  s_cmp_lg_u32 s22, 0
  s_cbranch_scc1 L_dc1k_e
  s_cmp_lg_u32 s69, 0
  s_cbranch_scc1 L_dc1k_fr_d
  s_mov_b32 s71, 0
  v_mov_b32 v2, 40
L_dc1k_fr_p:
  buffer_load_dword v1, v2, s[64:67], 0 offen sc1
  s_waitcnt vmcnt(0)
  v_readfirstlane_b32 s96, v1
  s_add_u32 s71, s71, 1
  s_cmp_ge_u32 s71, 2000000
  s_cbranch_scc1 L_dc1k_fr_s
  s_cmp_eq_u32 s96, 0
  s_cbranch_scc1 L_dc1k_fr_p
L_dc1k_fr_s:
  s_mov_b32 s69, 1
L_dc1k_fr_d:
L_dc1k_e:
  s_mov_b32 s98, 109052032
  s_cmp_lg_u32 s22, 0
  s_cbranch_scc1 L_dc1k_b
  s_mov_b32 s71, 0
  v_mov_b32 v2, 0
L_dc1k_p:
  buffer_load_dword v1, v2, s[8:11], s98 offen sc1
  s_waitcnt vmcnt(0)
  v_readfirstlane_b32 s96, v1
  s_add_u32 s71, s71, 1
  s_cmp_ge_u32 s71, 2000000
  s_cbranch_scc1 L_dc1k_b
  s_cmp_ge_u32 s96, 32
  s_cbranch_scc1 L_dc1k_b
  s_sleep 4
  s_branch L_dc1k_p
L_dc1k_b:
  s_barrier
  s_add_u32 s23, s97, 32
  s_mov_b32 s68, 109058560
  s_branch JC
L_set_o0:
  s_cmp_lg_u32 s22, 0
  s_cbranch_scc1 L_do0c_e
  s_cmp_lg_u32 s69, 0
  s_cbranch_scc1 L_do0c_fr_d
  s_mov_b32 s71, 0
  v_mov_b32 v2, 40
L_do0c_fr_p:
  buffer_load_dword v1, v2, s[64:67], 0 offen sc1
  s_waitcnt vmcnt(0)
  v_readfirstlane_b32 s96, v1
  s_add_u32 s71, s71, 1
  s_cmp_ge_u32 s71, 2000000
  s_cbranch_scc1 L_do0c_fr_s
  s_cmp_eq_u32 s96, 0
  s_cbranch_scc1 L_do0c_fr_p
L_do0c_fr_s:
  s_mov_b32 s69, 1
L_do0c_fr_d:
L_do0c_e:
  s_mov_b32 s98, 109058432
  s_cmp_lg_u32 s22, 0
  s_cbranch_scc1 L_do0c_b
  s_mov_b32 s71, 0
  v_mov_b32 v2, 0
L_do0c_p:
  buffer_load_dword v1, v2, s[8:11], s98 offen sc1
  s_waitcnt vmcnt(0)
  v_readfirstlane_b32 s96, v1
  s_add_u32 s71, s71, 1
  s_cmp_ge_u32 s71, 2000000
  s_cbranch_scc1 L_do0c_b
  s_cmp_ge_u32 s96, 32
  s_cbranch_scc1 L_do0c_b
  s_sleep 4
  s_branch L_do0c_p
L_do0c_b:
  s_barrier
  s_cmp_lg_u32 s22, 0
  s_cbranch_scc1 L_do0a_e
  s_cmp_lg_u32 s69, 0
  s_cbranch_scc1 L_do0a_fr_d
  s_mov_b32 s71, 0
  v_mov_b32 v2, 40
L_do0a_fr_p:
  buffer_load_dword v1, v2, s[64:67], 0 offen sc1
  s_waitcnt vmcnt(0)
  v_readfirstlane_b32 s96, v1
  s_add_u32 s71, s71, 1
  s_cmp_ge_u32 s71, 2000000
  s_cbranch_scc1 L_do0a_fr_s
  s_cmp_eq_u32 s96, 0
  s_cbranch_scc1 L_do0a_fr_p
L_do0a_fr_s:
  s_mov_b32 s69, 1
L_do0a_fr_d:
L_do0a_e:
  s_mov_b32 s98, 109056384
  s_cmp_lg_u32 s22, 0
  s_cbranch_scc1 L_do0a_b
  s_mov_b32 s71, 0
  v_mov_b32 v2, 0
L_do0a_p:
  buffer_load_dword v1, v2, s[8:11], s98 offen sc1
  s_waitcnt vmcnt(0)
  v_readfirstlane_b32 s96, v1
  s_add_u32 s71, s71, 1
  s_cmp_ge_u32 s71, 2000000
  s_cbranch_scc1 L_do0a_b
  s_cmp_ge_u32 s96, 8
  s_cbranch_scc1 L_do0a_b
  s_sleep 4
  s_branch L_do0a_p
L_do0a_b:
  s_barrier
  s_add_u32 s23, s97, 0
  s_mov_b32 s68, 109060480
  s_branch JO
L_set_c2:
  s_cmp_lg_u32 s22, 0
  s_cbranch_scc1 L_dc2q_e
  s_cmp_lg_u32 s69, 0
  s_cbranch_scc1 L_dc2q_fr_d
  s_mov_b32 s71, 0
  v_mov_b32 v2, 40
L_dc2q_fr_p:
  buffer_load_dword v1, v2, s[64:67], 0 offen sc1
  s_waitcnt vmcnt(0)
  v_readfirstlane_b32 s96, v1
  s_add_u32 s71, s71, 1
  s_cmp_ge_u32 s71, 2000000
  s_cbranch_scc1 L_dc2q_fr_s
  s_cmp_eq_u32 s96, 0
  s_cbranch_scc1 L_dc2q_fr_p
L_dc2q_fr_s:
  s_mov_b32 s69, 1
L_dc2q_fr_d:
L_dc2q_e:
  s_mov_b32 s98, 109054208
  s_cmp_lg_u32 s22, 0
  s_cbranch_scc1 L_dc2q_b
  s_mov_b32 s71, 0
  v_mov_b32 v2, 0
L_dc2q_p:
  buffer_load_dword v1, v2, s[8:11], s98 offen sc1
  s_waitcnt vmcnt(0)
  v_readfirstlane_b32 s96, v1
  s_add_u32 s71, s71, 1
  s_cmp_ge_u32 s71, 2000000
  s_cbranch_scc1 L_dc2q_b
  s_cmp_ge_u32 s96, 16
  s_cbranch_scc1 L_dc2q_b
  s_sleep 4
  s_branch L_dc2q_p
L_dc2q_b:
  s_barrier
  s_cmp_lg_u32 s22, 0
  s_cbranch_scc1 L_dc2k_e
  s_cmp_lg_u32 s69, 0
  s_cbranch_scc1 L_dc2k_fr_d
  s_mov_b32 s71, 0
  v_mov_b32 v2, 40
L_dc2k_fr_p:
  buffer_load_dword v1, v2, s[64:67], 0 offen sc1
  s_waitcnt vmcnt(0)
  v_readfirstlane_b32 s96, v1
  s_add_u32 s71, s71, 1
  s_cmp_ge_u32 s71, 2000000
  s_cbranch_scc1 L_dc2k_fr_s
  s_cmp_eq_u32 s96, 0
  s_cbranch_scc1 L_dc2k_fr_p
L_dc2k_fr_s:
  s_mov_b32 s69, 1
L_dc2k_fr_d:
L_dc2k_e:
  s_mov_b32 s98, 109052160
  s_cmp_lg_u32 s22, 0
  s_cbranch_scc1 L_dc2k_b
  s_mov_b32 s71, 0
  v_mov_b32 v2, 0
L_dc2k_p:
  buffer_load_dword v1, v2, s[8:11], s98 offen sc1
  s_waitcnt vmcnt(0)
  v_readfirstlane_b32 s96, v1
  s_add_u32 s71, s71, 1
  s_cmp_ge_u32 s71, 2000000
  s_cbranch_scc1 L_dc2k_b
  s_cmp_ge_u32 s96, 32
  s_cbranch_scc1 L_dc2k_b
  s_sleep 4
  s_branch L_dc2k_p
L_dc2k_b:
  s_barrier
  s_add_u32 s23, s97, 64
  s_mov_b32 s68, 109058688
  s_branch JC
L_set_o1:
  s_cmp_lg_u32 s22, 0
  s_cbranch_scc1 L_do1c_e
  s_cmp_lg_u32 s69, 0
  s_cbranch_scc1 L_do1c_fr_d
  s_mov_b32 s71, 0
  v_mov_b32 v2, 40
L_do1c_fr_p:
  buffer_load_dword v1, v2, s[64:67], 0 offen sc1
  s_waitcnt vmcnt(0)
  v_readfirstlane_b32 s96, v1
  s_add_u32 s71, s71, 1
  s_cmp_ge_u32 s71, 2000000
  s_cbranch_scc1 L_do1c_fr_s
  s_cmp_eq_u32 s96, 0
  s_cbranch_scc1 L_do1c_fr_p
L_do1c_fr_s:
  s_mov_b32 s69, 1
L_do1c_fr_d:
L_do1c_e:
  s_mov_b32 s98, 109058560
  s_cmp_lg_u32 s22, 0
  s_cbranch_scc1 L_do1c_b
  s_mov_b32 s71, 0
  v_mov_b32 v2, 0
L_do1c_p:
  buffer_load_dword v1, v2, s[8:11], s98 offen sc1
  s_waitcnt vmcnt(0)
  v_readfirstlane_b32 s96, v1
  s_add_u32 s71, s71, 1
  s_cmp_ge_u32 s71, 2000000
  s_cbranch_scc1 L_do1c_b
  s_cmp_ge_u32 s96, 32
  s_cbranch_scc1 L_do1c_b
  s_sleep 4
  s_branch L_do1c_p
L_do1c_b:
  s_barrier
  s_cmp_lg_u32 s22, 0
  s_cbranch_scc1 L_do1a_e
  s_cmp_lg_u32 s69, 0
  s_cbranch_scc1 L_do1a_fr_d
  s_mov_b32 s71, 0
  v_mov_b32 v2, 40
L_do1a_fr_p:
  buffer_load_dword v1, v2, s[64:67], 0 offen sc1
  s_waitcnt vmcnt(0)
  v_readfirstlane_b32 s96, v1
  s_add_u32 s71, s71, 1
  s_cmp_ge_u32 s71, 2000000
  s_cbranch_scc1 L_do1a_fr_s
  s_cmp_eq_u32 s96, 0
  s_cbranch_scc1 L_do1a_fr_p
L_do1a_fr_s:
  s_mov_b32 s69, 1
L_do1a_fr_d:
L_do1a_e:
  s_mov_b32 s98, 109056512
  s_cmp_lg_u32 s22, 0
  s_cbranch_scc1 L_do1a_b
  s_mov_b32 s71, 0
  v_mov_b32 v2, 0
L_do1a_p:
  buffer_load_dword v1, v2, s[8:11], s98 offen sc1
  s_waitcnt vmcnt(0)
  v_readfirstlane_b32 s96, v1
  s_add_u32 s71, s71, 1
  s_cmp_ge_u32 s71, 2000000
  s_cbranch_scc1 L_do1a_b
  s_cmp_ge_u32 s96, 8
  s_cbranch_scc1 L_do1a_b
  s_sleep 4
  s_branch L_do1a_p
L_do1a_b:
  s_barrier
  s_add_u32 s23, s97, 10
  s_mov_b32 s68, 109060480
  s_branch JO
L_set_c3:
  s_cmp_lg_u32 s22, 0
  s_cbranch_scc1 L_dc3q_e
  s_cmp_lg_u32 s69, 0
  s_cbranch_scc1 L_dc3q_fr_d
  s_mov_b32 s71, 0
  v_mov_b32 v2, 40
L_dc3q_fr_p:
  buffer_load_dword v1, v2, s[64:67], 0 offen sc1
  s_waitcnt vmcnt(0)
  v_readfirstlane_b32 s96, v1
  s_add_u32 s71, s71, 1
  s_cmp_ge_u32 s71, 2000000
  s_cbranch_scc1 L_dc3q_fr_s
  s_cmp_eq_u32 s96, 0
  s_cbranch_scc1 L_dc3q_fr_p
L_dc3q_fr_s:
  s_mov_b32 s69, 1
L_dc3q_fr_d:
L_dc3q_e:
  s_mov_b32 s98, 109054336
  s_cmp_lg_u32 s22, 0
  s_cbranch_scc1 L_dc3q_b
  s_mov_b32 s71, 0
  v_mov_b32 v2, 0
L_dc3q_p:
  buffer_load_dword v1, v2, s[8:11], s98 offen sc1
  s_waitcnt vmcnt(0)
  v_readfirstlane_b32 s96, v1
  s_add_u32 s71, s71, 1
  s_cmp_ge_u32 s71, 2000000
  s_cbranch_scc1 L_dc3q_b
  s_cmp_ge_u32 s96, 16
  s_cbranch_scc1 L_dc3q_b
  s_sleep 4
  s_branch L_dc3q_p
L_dc3q_b:
  s_barrier
  s_cmp_lg_u32 s22, 0
  s_cbranch_scc1 L_dc3k_e
  s_cmp_lg_u32 s69, 0
  s_cbranch_scc1 L_dc3k_fr_d
  s_mov_b32 s71, 0
  v_mov_b32 v2, 40
L_dc3k_fr_p:
  buffer_load_dword v1, v2, s[64:67], 0 offen sc1
  s_waitcnt vmcnt(0)
  v_readfirstlane_b32 s96, v1
  s_add_u32 s71, s71, 1
  s_cmp_ge_u32 s71, 2000000
  s_cbranch_scc1 L_dc3k_fr_s
  s_cmp_eq_u32 s96, 0
  s_cbranch_scc1 L_dc3k_fr_p
L_dc3k_fr_s:
  s_mov_b32 s69, 1
L_dc3k_fr_d:
L_dc3k_e:
  s_mov_b32 s98, 109052288
  s_cmp_lg_u32 s22, 0
  s_cbranch_scc1 L_dc3k_b
  s_mov_b32 s71, 0
  v_mov_b32 v2, 0
L_dc3k_p:
  buffer_load_dword v1, v2, s[8:11], s98 offen sc1
  s_waitcnt vmcnt(0)
  v_readfirstlane_b32 s96, v1
  s_add_u32 s71, s71, 1
  s_cmp_ge_u32 s71, 2000000
  s_cbranch_scc1 L_dc3k_b
  s_cmp_ge_u32 s96, 32
  s_cbranch_scc1 L_dc3k_b
  s_sleep 4
  s_branch L_dc3k_p
L_dc3k_b:
  s_barrier
  s_add_u32 s23, s97, 96
  s_mov_b32 s68, 109058816
  s_branch JC
L_set_o2:
  s_cmp_lg_u32 s22, 0
  s_cbranch_scc1 L_do2c_e
  s_cmp_lg_u32 s69, 0
  s_cbranch_scc1 L_do2c_fr_d
  s_mov_b32 s71, 0
  v_mov_b32 v2, 40
L_do2c_fr_p:
  buffer_load_dword v1, v2, s[64:67], 0 offen sc1
  s_waitcnt vmcnt(0)
  v_readfirstlane_b32 s96, v1
  s_add_u32 s71, s71, 1
  s_cmp_ge_u32 s71, 2000000
  s_cbranch_scc1 L_do2c_fr_s
  s_cmp_eq_u32 s96, 0
  s_cbranch_scc1 L_do2c_fr_p
L_do2c_fr_s:
  s_mov_b32 s69, 1
L_do2c_fr_d:
L_do2c_e:
  s_mov_b32 s98, 109058688
  s_cmp_lg_u32 s22, 0
  s_cbranch_scc1 L_do2c_b
  s_mov_b32 s71, 0
  v_mov_b32 v2, 0
L_do2c_p:
  buffer_load_dword v1, v2, s[8:11], s98 offen sc1
  s_waitcnt vmcnt(0)
  v_readfirstlane_b32 s96, v1
  s_add_u32 s71, s71, 1
  s_cmp_ge_u32 s71, 2000000
  s_cbranch_scc1 L_do2c_b
  s_cmp_ge_u32 s96, 32
  s_cbranch_scc1 L_do2c_b
  s_sleep 4
  s_branch L_do2c_p
L_do2c_b:
  s_barrier
  s_cmp_lg_u32 s22, 0
  s_cbranch_scc1 L_do2a_e
  s_cmp_lg_u32 s69, 0
  s_cbranch_scc1 L_do2a_fr_d
  s_mov_b32 s71, 0
  v_mov_b32 v2, 40
L_do2a_fr_p:
  buffer_load_dword v1, v2, s[64:67], 0 offen sc1
  s_waitcnt vmcnt(0)
  v_readfirstlane_b32 s96, v1
  s_add_u32 s71, s71, 1
  s_cmp_ge_u32 s71, 2000000
  s_cbranch_scc1 L_do2a_fr_s
  s_cmp_eq_u32 s96, 0
  s_cbranch_scc1 L_do2a_fr_p
L_do2a_fr_s:
  s_mov_b32 s69, 1
L_do2a_fr_d:
L_do2a_e:
  s_mov_b32 s98, 109056640
  s_cmp_lg_u32 s22, 0
  s_cbranch_scc1 L_do2a_b
  s_mov_b32 s71, 0
  v_mov_b32 v2, 0
L_do2a_p:
  buffer_load_dword v1, v2, s[8:11], s98 offen sc1
  s_waitcnt vmcnt(0)
  v_readfirstlane_b32 s96, v1
  s_add_u32 s71, s71, 1
  s_cmp_ge_u32 s71, 2000000
  s_cbranch_scc1 L_do2a_b
  s_cmp_ge_u32 s96, 8
  s_cbranch_scc1 L_do2a_b
  s_sleep 4
  s_branch L_do2a_p
L_do2a_b:
  s_barrier
  s_add_u32 s23, s97, 20
  s_mov_b32 s68, 109060480
  s_branch JO
L_set_c4:
  s_cmp_lg_u32 s22, 0
  s_cbranch_scc1 L_dc4q_e
  s_cmp_lg_u32 s69, 0
  s_cbranch_scc1 L_dc4q_fr_d
  s_mov_b32 s71, 0
  v_mov_b32 v2, 40
L_dc4q_fr_p:
  buffer_load_dword v1, v2, s[64:67], 0 offen sc1
  s_waitcnt vmcnt(0)
  v_readfirstlane_b32 s96, v1
  s_add_u32 s71, s71, 1
  s_cmp_ge_u32 s71, 2000000
  s_cbranch_scc1 L_dc4q_fr_s
  s_cmp_eq_u32 s96, 0
  s_cbranch_scc1 L_dc4q_fr_p
L_dc4q_fr_s:
  s_mov_b32 s69, 1
L_dc4q_fr_d:
L_dc4q_e:
  s_mov_b32 s98, 109054464
  s_cmp_lg_u32 s22, 0
  s_cbranch_scc1 L_dc4q_b
  s_mov_b32 s71, 0
  v_mov_b32 v2, 0
L_dc4q_p:
  buffer_load_dword v1, v2, s[8:11], s98 offen sc1
  s_waitcnt vmcnt(0)
  v_readfirstlane_b32 s96, v1
  s_add_u32 s71, s71, 1
  s_cmp_ge_u32 s71, 2000000
  s_cbranch_scc1 L_dc4q_b
  s_cmp_ge_u32 s96, 16
  s_cbranch_scc1 L_dc4q_b
  s_sleep 4
  s_branch L_dc4q_p
L_dc4q_b:
  s_barrier
  s_cmp_lg_u32 s22, 0
  s_cbranch_scc1 L_dc4k_e
  s_cmp_lg_u32 s69, 0
  s_cbranch_scc1 L_dc4k_fr_d
  s_mov_b32 s71, 0
  v_mov_b32 v2, 40
L_dc4k_fr_p:
  buffer_load_dword v1, v2, s[64:67], 0 offen sc1
  s_waitcnt vmcnt(0)
  v_readfirstlane_b32 s96, v1
  s_add_u32 s71, s71, 1
  s_cmp_ge_u32 s71, 2000000
  s_cbranch_scc1 L_dc4k_fr_s
  s_cmp_eq_u32 s96, 0
  s_cbranch_scc1 L_dc4k_fr_p
L_dc4k_fr_s:
  s_mov_b32 s69, 1
L_dc4k_fr_d:
L_dc4k_e:
  s_mov_b32 s98, 109052416
  s_cmp_lg_u32 s22, 0
  s_cbranch_scc1 L_dc4k_b
  s_mov_b32 s71, 0
  v_mov_b32 v2, 0
L_dc4k_p:
  buffer_load_dword v1, v2, s[8:11], s98 offen sc1
  s_waitcnt vmcnt(0)
  v_readfirstlane_b32 s96, v1
  s_add_u32 s71, s71, 1
  s_cmp_ge_u32 s71, 2000000
  s_cbranch_scc1 L_dc4k_b
  s_cmp_ge_u32 s96, 32
  s_cbranch_scc1 L_dc4k_b
  s_sleep 4
  s_branch L_dc4k_p
L_dc4k_b:
  s_barrier
  s_add_u32 s23, s97, 128
  s_mov_b32 s68, 109058944
  s_branch JC
L_set_o3:
  s_cmp_lg_u32 s22, 0
  s_cbranch_scc1 L_do3c_e
  s_cmp_lg_u32 s69, 0
  s_cbranch_scc1 L_do3c_fr_d
  s_mov_b32 s71, 0
  v_mov_b32 v2, 40
L_do3c_fr_p:
  buffer_load_dword v1, v2, s[64:67], 0 offen sc1
  s_waitcnt vmcnt(0)
  v_readfirstlane_b32 s96, v1
  s_add_u32 s71, s71, 1
  s_cmp_ge_u32 s71, 2000000
  s_cbranch_scc1 L_do3c_fr_s
  s_cmp_eq_u32 s96, 0
  s_cbranch_scc1 L_do3c_fr_p
L_do3c_fr_s:
  s_mov_b32 s69, 1
L_do3c_fr_d:
L_do3c_e:
  s_mov_b32 s98, 109058816
  s_cmp_lg_u32 s22, 0
  s_cbranch_scc1 L_do3c_b
  s_mov_b32 s71, 0
  v_mov_b32 v2, 0
L_do3c_p:
  buffer_load_dword v1, v2, s[8:11], s98 offen sc1
  s_waitcnt vmcnt(0)
  v_readfirstlane_b32 s96, v1
  s_add_u32 s71, s71, 1
  s_cmp_ge_u32 s71, 2000000
  s_cbranch_scc1 L_do3c_b
  s_cmp_ge_u32 s96, 32
  s_cbranch_scc1 L_do3c_b
  s_sleep 4
  s_branch L_do3c_p
L_do3c_b:
  s_barrier
  s_cmp_lg_u32 s22, 0
  s_cbranch_scc1 L_do3a_e
  s_cmp_lg_u32 s69, 0
  s_cbranch_scc1 L_do3a_fr_d
  s_mov_b32 s71, 0
  v_mov_b32 v2, 40
L_do3a_fr_p:
  buffer_load_dword v1, v2, s[64:67], 0 offen sc1
  s_waitcnt vmcnt(0)
  v_readfirstlane_b32 s96, v1
  s_add_u32 s71, s71, 1
  s_cmp_ge_u32 s71, 2000000
  s_cbranch_scc1 L_do3a_fr_s
  s_cmp_eq_u32 s96, 0
  s_cbranch_scc1 L_do3a_fr_p
L_do3a_fr_s:
  s_mov_b32 s69, 1
L_do3a_fr_d:
L_do3a_e:
  s_mov_b32 s98, 109056768
  s_cmp_lg_u32 s22, 0
  s_cbranch_scc1 L_do3a_b
  s_mov_b32 s71, 0
  v_mov_b32 v2, 0
L_do3a_p:
  buffer_load_dword v1, v2, s[8:11], s98 offen sc1
  s_waitcnt vmcnt(0)
  v_readfirstlane_b32 s96, v1
  s_add_u32 s71, s71, 1
  s_cmp_ge_u32 s71, 2000000
  s_cbranch_scc1 L_do3a_b
  s_cmp_ge_u32 s96, 8
  s_cbranch_scc1 L_do3a_b
  s_sleep 4
  s_branch L_do3a_p
L_do3a_b:
  s_barrier
  s_add_u32 s23, s97, 30
  s_mov_b32 s68, 109060480
  s_branch JO
L_set_c5:
  s_cmp_lg_u32 s22, 0
  s_cbranch_scc1 L_dc5q_e
  s_cmp_lg_u32 s69, 0
  s_cbranch_scc1 L_dc5q_fr_d
  s_mov_b32 s71, 0
  v_mov_b32 v2, 40
L_dc5q_fr_p:
  buffer_load_dword v1, v2, s[64:67], 0 offen sc1
  s_waitcnt vmcnt(0)
  v_readfirstlane_b32 s96, v1
  s_add_u32 s71, s71, 1
  s_cmp_ge_u32 s71, 2000000
  s_cbranch_scc1 L_dc5q_fr_s
  s_cmp_eq_u32 s96, 0
  s_cbranch_scc1 L_dc5q_fr_p
L_dc5q_fr_s:
  s_mov_b32 s69, 1
L_dc5q_fr_d:
L_dc5q_e:
  s_mov_b32 s98, 109054592
  s_cmp_lg_u32 s22, 0
  s_cbranch_scc1 L_dc5q_b
  s_mov_b32 s71, 0
  v_mov_b32 v2, 0
L_dc5q_p:
  buffer_load_dword v1, v2, s[8:11], s98 offen sc1
  s_waitcnt vmcnt(0)
  v_readfirstlane_b32 s96, v1
  s_add_u32 s71, s71, 1
  s_cmp_ge_u32 s71, 2000000
  s_cbranch_scc1 L_dc5q_b
  s_cmp_ge_u32 s96, 16
  s_cbranch_scc1 L_dc5q_b
  s_sleep 4
  s_branch L_dc5q_p
L_dc5q_b:
  s_barrier
  s_cmp_lg_u32 s22, 0
  s_cbranch_scc1 L_dc5k_e
  s_cmp_lg_u32 s69, 0
  s_cbranch_scc1 L_dc5k_fr_d
  s_mov_b32 s71, 0
  v_mov_b32 v2, 40
L_dc5k_fr_p:
  buffer_load_dword v1, v2, s[64:67], 0 offen sc1
  s_waitcnt vmcnt(0)
  v_readfirstlane_b32 s96, v1
  s_add_u32 s71, s71, 1
  s_cmp_ge_u32 s71, 2000000
  s_cbranch_scc1 L_dc5k_fr_s
  s_cmp_eq_u32 s96, 0
  s_cbranch_scc1 L_dc5k_fr_p
L_dc5k_fr_s:
  s_mov_b32 s69, 1
L_dc5k_fr_d:
L_dc5k_e:
  s_mov_b32 s98, 109052544
  s_cmp_lg_u32 s22, 0
  s_cbranch_scc1 L_dc5k_b
  s_mov_b32 s71, 0
  v_mov_b32 v2, 0
L_dc5k_p:
  buffer_load_dword v1, v2, s[8:11], s98 offen sc1
  s_waitcnt vmcnt(0)
  v_readfirstlane_b32 s96, v1
  s_add_u32 s71, s71, 1
  s_cmp_ge_u32 s71, 2000000
  s_cbranch_scc1 L_dc5k_b
  s_cmp_ge_u32 s96, 32
  s_cbranch_scc1 L_dc5k_b
  s_sleep 4
  s_branch L_dc5k_p
L_dc5k_b:
  s_barrier
  s_add_u32 s23, s97, 160
  s_mov_b32 s68, 109059072
  s_branch JC
L_set_o4:
  s_cmp_lg_u32 s22, 0
  s_cbranch_scc1 L_do4c_e
  s_cmp_lg_u32 s69, 0
  s_cbranch_scc1 L_do4c_fr_d
  s_mov_b32 s71, 0
  v_mov_b32 v2, 40
L_do4c_fr_p:
  buffer_load_dword v1, v2, s[64:67], 0 offen sc1
  s_waitcnt vmcnt(0)
  v_readfirstlane_b32 s96, v1
  s_add_u32 s71, s71, 1
  s_cmp_ge_u32 s71, 2000000
  s_cbranch_scc1 L_do4c_fr_s
  s_cmp_eq_u32 s96, 0
  s_cbranch_scc1 L_do4c_fr_p
L_do4c_fr_s:
  s_mov_b32 s69, 1
L_do4c_fr_d:
L_do4c_e:
  s_mov_b32 s98, 109058944
  s_cmp_lg_u32 s22, 0
  s_cbranch_scc1 L_do4c_b
  s_mov_b32 s71, 0
  v_mov_b32 v2, 0
L_do4c_p:
  buffer_load_dword v1, v2, s[8:11], s98 offen sc1
  s_waitcnt vmcnt(0)
  v_readfirstlane_b32 s96, v1
  s_add_u32 s71, s71, 1
  s_cmp_ge_u32 s71, 2000000
  s_cbranch_scc1 L_do4c_b
  s_cmp_ge_u32 s96, 32
  s_cbranch_scc1 L_do4c_b
  s_sleep 4
  s_branch L_do4c_p
L_do4c_b:
  s_barrier
  s_cmp_lg_u32 s22, 0
  s_cbranch_scc1 L_do4a_e
  s_cmp_lg_u32 s69, 0
  s_cbranch_scc1 L_do4a_fr_d
  s_mov_b32 s71, 0
  v_mov_b32 v2, 40
L_do4a_fr_p:
  buffer_load_dword v1, v2, s[64:67], 0 offen sc1
  s_waitcnt vmcnt(0)
  v_readfirstlane_b32 s96, v1
  s_add_u32 s71, s71, 1
  s_cmp_ge_u32 s71, 2000000
  s_cbranch_scc1 L_do4a_fr_s
  s_cmp_eq_u32 s96, 0
  s_cbranch_scc1 L_do4a_fr_p
L_do4a_fr_s:
  s_mov_b32 s69, 1
L_do4a_fr_d:
L_do4a_e:
  s_mov_b32 s98, 109056896
  s_cmp_lg_u32 s22, 0
  s_cbranch_scc1 L_do4a_b
  s_mov_b32 s71, 0
  v_mov_b32 v2, 0
L_do4a_p:
  buffer_load_dword v1, v2, s[8:11], s98 offen sc1
  s_waitcnt vmcnt(0)
  v_readfirstlane_b32 s96, v1
  s_add_u32 s71, s71, 1
  s_cmp_ge_u32 s71, 2000000
  s_cbranch_scc1 L_do4a_b
  s_cmp_ge_u32 s96, 8
  s_cbranch_scc1 L_do4a_b
  s_sleep 4
  s_branch L_do4a_p
L_do4a_b:
  s_barrier
  s_add_u32 s23, s97, 40
  s_mov_b32 s68, 109060480
  s_branch JO
L_set_c6:
  s_cmp_lg_u32 s22, 0
  s_cbranch_scc1 L_dc6q_e
  s_cmp_lg_u32 s69, 0
  s_cbranch_scc1 L_dc6q_fr_d
  s_mov_b32 s71, 0
  v_mov_b32 v2, 40
L_dc6q_fr_p:
  buffer_load_dword v1, v2, s[64:67], 0 offen sc1
  s_waitcnt vmcnt(0)
  v_readfirstlane_b32 s96, v1
  s_add_u32 s71, s71, 1
  s_cmp_ge_u32 s71, 2000000
  s_cbranch_scc1 L_dc6q_fr_s
  s_cmp_eq_u32 s96, 0
  s_cbranch_scc1 L_dc6q_fr_p
L_dc6q_fr_s:
  s_mov_b32 s69, 1
L_dc6q_fr_d:
L_dc6q_e:
  s_mov_b32 s98, 109054720
  s_cmp_lg_u32 s22, 0
  s_cbranch_scc1 L_dc6q_b
  s_mov_b32 s71, 0
  v_mov_b32 v2, 0
L_dc6q_p:
  buffer_load_dword v1, v2, s[8:11], s98 offen sc1
  s_waitcnt vmcnt(0)
  v_readfirstlane_b32 s96, v1
  s_add_u32 s71, s71, 1
  s_cmp_ge_u32 s71, 2000000
  s_cbranch_scc1 L_dc6q_b
  s_cmp_ge_u32 s96, 16
  s_cbranch_scc1 L_dc6q_b
  s_sleep 4
  s_branch L_dc6q_p
L_dc6q_b:
  s_barrier
  s_cmp_lg_u32 s22, 0
  s_cbranch_scc1 L_dc6k_e
  s_cmp_lg_u32 s69, 0
  s_cbranch_scc1 L_dc6k_fr_d
  s_mov_b32 s71, 0
  v_mov_b32 v2, 40
L_dc6k_fr_p:
  buffer_load_dword v1, v2, s[64:67], 0 offen sc1
  s_waitcnt vmcnt(0)
  v_readfirstlane_b32 s96, v1
  s_add_u32 s71, s71, 1
  s_cmp_ge_u32 s71, 2000000
  s_cbranch_scc1 L_dc6k_fr_s
  s_cmp_eq_u32 s96, 0
  s_cbranch_scc1 L_dc6k_fr_p
L_dc6k_fr_s:
  s_mov_b32 s69, 1
L_dc6k_fr_d:
L_dc6k_e:
  s_mov_b32 s98, 109052672
  s_cmp_lg_u32 s22, 0
  s_cbranch_scc1 L_dc6k_b
  s_mov_b32 s71, 0
  v_mov_b32 v2, 0
L_dc6k_p:
  buffer_load_dword v1, v2, s[8:11], s98 offen sc1
  s_waitcnt vmcnt(0)
  v_readfirstlane_b32 s96, v1
  s_add_u32 s71, s71, 1
  s_cmp_ge_u32 s71, 2000000
  s_cbranch_scc1 L_dc6k_b
  s_cmp_ge_u32 s96, 32
  s_cbranch_scc1 L_dc6k_b
  s_sleep 4
  s_branch L_dc6k_p
L_dc6k_b:
  s_barrier
  s_add_u32 s23, s97, 192
  s_mov_b32 s68, 109059200
  s_branch JC
L_set_o5:
  s_cmp_lg_u32 s22, 0
  s_cbranch_scc1 L_do5c_e
  s_cmp_lg_u32 s69, 0
  s_cbranch_scc1 L_do5c_fr_d
  s_mov_b32 s71, 0
  v_mov_b32 v2, 40
L_do5c_fr_p:
  buffer_load_dword v1, v2, s[64:67], 0 offen sc1
  s_waitcnt vmcnt(0)
  v_readfirstlane_b32 s96, v1
  s_add_u32 s71, s71, 1
  s_cmp_ge_u32 s71, 2000000
  s_cbranch_scc1 L_do5c_fr_s
  s_cmp_eq_u32 s96, 0
  s_cbranch_scc1 L_do5c_fr_p
L_do5c_fr_s:
  s_mov_b32 s69, 1
L_do5c_fr_d:
L_do5c_e:
  s_mov_b32 s98, 109059072
  s_cmp_lg_u32 s22, 0
  s_cbranch_scc1 L_do5c_b
  s_mov_b32 s71, 0
  v_mov_b32 v2, 0
L_do5c_p:
  buffer_load_dword v1, v2, s[8:11], s98 offen sc1
  s_waitcnt vmcnt(0)
  v_readfirstlane_b32 s96, v1
  s_add_u32 s71, s71, 1
  s_cmp_ge_u32 s71, 2000000
  s_cbranch_scc1 L_do5c_b
  s_cmp_ge_u32 s96, 32
  s_cbranch_scc1 L_do5c_b
  s_sleep 4
  s_branch L_do5c_p
L_do5c_b:
  s_barrier
  s_cmp_lg_u32 s22, 0
  s_cbranch_scc1 L_do5a_e
  s_cmp_lg_u32 s69, 0
  s_cbranch_scc1 L_do5a_fr_d
  s_mov_b32 s71, 0
  v_mov_b32 v2, 40
L_do5a_fr_p:
  buffer_load_dword v1, v2, s[64:67], 0 offen sc1
  s_waitcnt vmcnt(0)
  v_readfirstlane_b32 s96, v1
  s_add_u32 s71, s71, 1
  s_cmp_ge_u32 s71, 2000000
  s_cbranch_scc1 L_do5a_fr_s
  s_cmp_eq_u32 s96, 0
  s_cbranch_scc1 L_do5a_fr_p
L_do5a_fr_s:
  s_mov_b32 s69, 1
L_do5a_fr_d:
L_do5a_e:
  s_mov_b32 s98, 109057024
  s_cmp_lg_u32 s22, 0
  s_cbranch_scc1 L_do5a_b
  s_mov_b32 s71, 0
  v_mov_b32 v2, 0
L_do5a_p:
  buffer_load_dword v1, v2, s[8:11], s98 offen sc1
  s_waitcnt vmcnt(0)
  v_readfirstlane_b32 s96, v1
  s_add_u32 s71, s71, 1
  s_cmp_ge_u32 s71, 2000000
  s_cbranch_scc1 L_do5a_b
  s_cmp_ge_u32 s96, 8
  s_cbranch_scc1 L_do5a_b
  s_sleep 4
  s_branch L_do5a_p
L_do5a_b:
  s_barrier
  s_add_u32 s23, s97, 50
  s_mov_b32 s68, 109060480
  s_branch JO
L_set_c7:
  s_cmp_lg_u32 s22, 0
  s_cbranch_scc1 L_dc7q_e
  s_cmp_lg_u32 s69, 0
  s_cbranch_scc1 L_dc7q_fr_d
  s_mov_b32 s71, 0
  v_mov_b32 v2, 40
L_dc7q_fr_p:
  buffer_load_dword v1, v2, s[64:67], 0 offen sc1
  s_waitcnt vmcnt(0)
  v_readfirstlane_b32 s96, v1
  s_add_u32 s71, s71, 1
  s_cmp_ge_u32 s71, 2000000
  s_cbranch_scc1 L_dc7q_fr_s
  s_cmp_eq_u32 s96, 0
  s_cbranch_scc1 L_dc7q_fr_p
L_dc7q_fr_s:
  s_mov_b32 s69, 1
L_dc7q_fr_d:
L_dc7q_e:
  s_mov_b32 s98, 109054848
  s_cmp_lg_u32 s22, 0
  s_cbranch_scc1 L_dc7q_b
  s_mov_b32 s71, 0
  v_mov_b32 v2, 0
L_dc7q_p:
  buffer_load_dword v1, v2, s[8:11], s98 offen sc1
  s_waitcnt vmcnt(0)
  v_readfirstlane_b32 s96, v1
  s_add_u32 s71, s71, 1
  s_cmp_ge_u32 s71, 2000000
  s_cbranch_scc1 L_dc7q_b
  s_cmp_ge_u32 s96, 16
  s_cbranch_scc1 L_dc7q_b
  s_sleep 4
  s_branch L_dc7q_p
L_dc7q_b:
  s_barrier
  s_cmp_lg_u32 s22, 0
  s_cbranch_scc1 L_dc7k_e
  s_cmp_lg_u32 s69, 0
  s_cbranch_scc1 L_dc7k_fr_d
  s_mov_b32 s71, 0
  v_mov_b32 v2, 40
L_dc7k_fr_p:
  buffer_load_dword v1, v2, s[64:67], 0 offen sc1
  s_waitcnt vmcnt(0)
  v_readfirstlane_b32 s96, v1
  s_add_u32 s71, s71, 1
  s_cmp_ge_u32 s71, 2000000
  s_cbranch_scc1 L_dc7k_fr_s
  s_cmp_eq_u32 s96, 0
  s_cbranch_scc1 L_dc7k_fr_p
L_dc7k_fr_s:
  s_mov_b32 s69, 1
L_dc7k_fr_d:
L_dc7k_e:
  s_mov_b32 s98, 109052800
  s_cmp_lg_u32 s22, 0
  s_cbranch_scc1 L_dc7k_b
  s_mov_b32 s71, 0
  v_mov_b32 v2, 0
L_dc7k_p:
  buffer_load_dword v1, v2, s[8:11], s98 offen sc1
  s_waitcnt vmcnt(0)
  v_readfirstlane_b32 s96, v1
  s_add_u32 s71, s71, 1
  s_cmp_ge_u32 s71, 2000000
  s_cbranch_scc1 L_dc7k_b
  s_cmp_ge_u32 s96, 32
  s_cbranch_scc1 L_dc7k_b
  s_sleep 4
  s_branch L_dc7k_p
L_dc7k_b:
  s_barrier
  s_add_u32 s23, s97, 224
  s_mov_b32 s68, 109059328
  s_branch JC
L_set_o6:
  s_cmp_lg_u32 s22, 0
  s_cbranch_scc1 L_do6c_e
  s_cmp_lg_u32 s69, 0
  s_cbranch_scc1 L_do6c_fr_d
  s_mov_b32 s71, 0
  v_mov_b32 v2, 40
L_do6c_fr_p:
  buffer_load_dword v1, v2, s[64:67], 0 offen sc1
  s_waitcnt vmcnt(0)
  v_readfirstlane_b32 s96, v1
  s_add_u32 s71, s71, 1
  s_cmp_ge_u32 s71, 2000000
  s_cbranch_scc1 L_do6c_fr_s
  s_cmp_eq_u32 s96, 0
  s_cbranch_scc1 L_do6c_fr_p
L_do6c_fr_s:
  s_mov_b32 s69, 1
L_do6c_fr_d:
L_do6c_e:
  s_mov_b32 s98, 109059200
  s_cmp_lg_u32 s22, 0
  s_cbranch_scc1 L_do6c_b
  s_mov_b32 s71, 0
  v_mov_b32 v2, 0
L_do6c_p:
  buffer_load_dword v1, v2, s[8:11], s98 offen sc1
  s_waitcnt vmcnt(0)
  v_readfirstlane_b32 s96, v1
  s_add_u32 s71, s71, 1
  s_cmp_ge_u32 s71, 2000000
  s_cbranch_scc1 L_do6c_b
  s_cmp_ge_u32 s96, 32
  s_cbranch_scc1 L_do6c_b
  s_sleep 4
  s_branch L_do6c_p
L_do6c_b:
  s_barrier
  s_cmp_lg_u32 s22, 0
  s_cbranch_scc1 L_do6a_e
  s_cmp_lg_u32 s69, 0
  s_cbranch_scc1 L_do6a_fr_d
  s_mov_b32 s71, 0
  v_mov_b32 v2, 40
L_do6a_fr_p:
  buffer_load_dword v1, v2, s[64:67], 0 offen sc1
  s_waitcnt vmcnt(0)
  v_readfirstlane_b32 s96, v1
  s_add_u32 s71, s71, 1
  s_cmp_ge_u32 s71, 2000000
  s_cbranch_scc1 L_do6a_fr_s
  s_cmp_eq_u32 s96, 0
  s_cbranch_scc1 L_do6a_fr_p
L_do6a_fr_s:
  s_mov_b32 s69, 1
L_do6a_fr_d:
L_do6a_e:
  s_mov_b32 s98, 109057152
  s_cmp_lg_u32 s22, 0
  s_cbranch_scc1 L_do6a_b
  s_mov_b32 s71, 0
  v_mov_b32 v2, 0
L_do6a_p:
  buffer_load_dword v1, v2, s[8:11], s98 offen sc1
  s_waitcnt vmcnt(0)
  v_readfirstlane_b32 s96, v1
  s_add_u32 s71, s71, 1
  s_cmp_ge_u32 s71, 2000000
  s_cbranch_scc1 L_do6a_b
  s_cmp_ge_u32 s96, 8
  s_cbranch_scc1 L_do6a_b
  s_sleep 4
  s_branch L_do6a_p
L_do6a_b:
  s_barrier
  s_add_u32 s23, s97, 60
  s_mov_b32 s68, 109060480
  s_branch JO
L_set_c8:
  s_cmp_lg_u32 s22, 0
  s_cbranch_scc1 L_dc8q_e
  s_cmp_lg_u32 s69, 0
  s_cbranch_scc1 L_dc8q_fr_d
  s_mov_b32 s71, 0
  v_mov_b32 v2, 40
L_dc8q_fr_p:
  buffer_load_dword v1, v2, s[64:67], 0 offen sc1
  s_waitcnt vmcnt(0)
  v_readfirstlane_b32 s96, v1
  s_add_u32 s71, s71, 1
  s_cmp_ge_u32 s71, 2000000
  s_cbranch_scc1 L_dc8q_fr_s
  s_cmp_eq_u32 s96, 0
  s_cbranch_scc1 L_dc8q_fr_p
L_dc8q_fr_s:
  s_mov_b32 s69, 1
L_dc8q_fr_d:
L_dc8q_e:
  s_mov_b32 s98, 109054976
  s_cmp_lg_u32 s22, 0
  s_cbranch_scc1 L_dc8q_b
  s_mov_b32 s71, 0
  v_mov_b32 v2, 0
L_dc8q_p:
  buffer_load_dword v1, v2, s[8:11], s98 offen sc1
  s_waitcnt vmcnt(0)
  v_readfirstlane_b32 s96, v1
  s_add_u32 s71, s71, 1
  s_cmp_ge_u32 s71, 2000000
  s_cbranch_scc1 L_dc8q_b
  s_cmp_ge_u32 s96, 16
  s_cbranch_scc1 L_dc8q_b
  s_sleep 4
  s_branch L_dc8q_p
L_dc8q_b:
  s_barrier
  s_cmp_lg_u32 s22, 0
  s_cbranch_scc1 L_dc8k_e
  s_cmp_lg_u32 s69, 0
  s_cbranch_scc1 L_dc8k_fr_d
  s_mov_b32 s71, 0
  v_mov_b32 v2, 40
L_dc8k_fr_p:
  buffer_load_dword v1, v2, s[64:67], 0 offen sc1
  s_waitcnt vmcnt(0)
  v_readfirstlane_b32 s96, v1
  s_add_u32 s71, s71, 1
  s_cmp_ge_u32 s71, 2000000
  s_cbranch_scc1 L_dc8k_fr_s
  s_cmp_eq_u32 s96, 0
  s_cbranch_scc1 L_dc8k_fr_p
L_dc8k_fr_s:
  s_mov_b32 s69, 1
L_dc8k_fr_d:
L_dc8k_e:
  s_mov_b32 s98, 109052928
  s_cmp_lg_u32 s22, 0
  s_cbranch_scc1 L_dc8k_b
  s_mov_b32 s71, 0
  v_mov_b32 v2, 0
L_dc8k_p:
  buffer_load_dword v1, v2, s[8:11], s98 offen sc1
  s_waitcnt vmcnt(0)
  v_readfirstlane_b32 s96, v1
  s_add_u32 s71, s71, 1
  s_cmp_ge_u32 s71, 2000000
  s_cbranch_scc1 L_dc8k_b
  s_cmp_ge_u32 s96, 32
  s_cbranch_scc1 L_dc8k_b
  s_sleep 4
  s_branch L_dc8k_p
L_dc8k_b:
  s_barrier
  s_add_u32 s23, s97, 256
  s_mov_b32 s68, 109059456
  s_branch JC
L_set_o7:
  s_cmp_lg_u32 s22, 0
  s_cbranch_scc1 L_do7c_e
  s_cmp_lg_u32 s69, 0
  s_cbranch_scc1 L_do7c_fr_d
  s_mov_b32 s71, 0
  v_mov_b32 v2, 40
L_do7c_fr_p:
  buffer_load_dword v1, v2, s[64:67], 0 offen sc1
  s_waitcnt vmcnt(0)
  v_readfirstlane_b32 s96, v1
  s_add_u32 s71, s71, 1
  s_cmp_ge_u32 s71, 2000000
  s_cbranch_scc1 L_do7c_fr_s
  s_cmp_eq_u32 s96, 0
  s_cbranch_scc1 L_do7c_fr_p
L_do7c_fr_s:
  s_mov_b32 s69, 1
L_do7c_fr_d:
L_do7c_e:
  s_mov_b32 s98, 109059328
  s_cmp_lg_u32 s22, 0
  s_cbranch_scc1 L_do7c_b
  s_mov_b32 s71, 0
  v_mov_b32 v2, 0
L_do7c_p:
  buffer_load_dword v1, v2, s[8:11], s98 offen sc1
  s_waitcnt vmcnt(0)
  v_readfirstlane_b32 s96, v1
  s_add_u32 s71, s71, 1
  s_cmp_ge_u32 s71, 2000000
  s_cbranch_scc1 L_do7c_b
  s_cmp_ge_u32 s96, 32
  s_cbranch_scc1 L_do7c_b
  s_sleep 4
  s_branch L_do7c_p
L_do7c_b:
  s_barrier
  s_cmp_lg_u32 s22, 0
  s_cbranch_scc1 L_do7a_e
  s_cmp_lg_u32 s69, 0
  s_cbranch_scc1 L_do7a_fr_d
  s_mov_b32 s71, 0
  v_mov_b32 v2, 40
L_do7a_fr_p:
  buffer_load_dword v1, v2, s[64:67], 0 offen sc1
  s_waitcnt vmcnt(0)
  v_readfirstlane_b32 s96, v1
  s_add_u32 s71, s71, 1
  s_cmp_ge_u32 s71, 2000000
  s_cbranch_scc1 L_do7a_fr_s
  s_cmp_eq_u32 s96, 0
  s_cbranch_scc1 L_do7a_fr_p
L_do7a_fr_s:
  s_mov_b32 s69, 1
L_do7a_fr_d:
L_do7a_e:
  s_mov_b32 s98, 109057280
  s_cmp_lg_u32 s22, 0
  s_cbranch_scc1 L_do7a_b
  s_mov_b32 s71, 0
  v_mov_b32 v2, 0
L_do7a_p:
  buffer_load_dword v1, v2, s[8:11], s98 offen sc1
  s_waitcnt vmcnt(0)
  v_readfirstlane_b32 s96, v1
  s_add_u32 s71, s71, 1
  s_cmp_ge_u32 s71, 2000000
  s_cbranch_scc1 L_do7a_b
  s_cmp_ge_u32 s96, 8
  s_cbranch_scc1 L_do7a_b
  s_sleep 4
  s_branch L_do7a_p
L_do7a_b:
  s_barrier
  s_add_u32 s23, s97, 70
  s_mov_b32 s68, 109060480
  s_branch JO
L_set_c9:
  s_cmp_lg_u32 s22, 0
  s_cbranch_scc1 L_dc9q_e
  s_cmp_lg_u32 s69, 0
  s_cbranch_scc1 L_dc9q_fr_d
  s_mov_b32 s71, 0
  v_mov_b32 v2, 40
L_dc9q_fr_p:
  buffer_load_dword v1, v2, s[64:67], 0 offen sc1
  s_waitcnt vmcnt(0)
  v_readfirstlane_b32 s96, v1
  s_add_u32 s71, s71, 1
  s_cmp_ge_u32 s71, 2000000
  s_cbranch_scc1 L_dc9q_fr_s
  s_cmp_eq_u32 s96, 0
  s_cbranch_scc1 L_dc9q_fr_p
L_dc9q_fr_s:
  s_mov_b32 s69, 1
L_dc9q_fr_d:
L_dc9q_e:
  s_mov_b32 s98, 109055104
  s_cmp_lg_u32 s22, 0
  s_cbranch_scc1 L_dc9q_b
  s_mov_b32 s71, 0
  v_mov_b32 v2, 0
L_dc9q_p:
  buffer_load_dword v1, v2, s[8:11], s98 offen sc1
  s_waitcnt vmcnt(0)
  v_readfirstlane_b32 s96, v1
  s_add_u32 s71, s71, 1
  s_cmp_ge_u32 s71, 2000000
  s_cbranch_scc1 L_dc9q_b
  s_cmp_ge_u32 s96, 16
  s_cbranch_scc1 L_dc9q_b
  s_sleep 4
  s_branch L_dc9q_p
L_dc9q_b:
  s_barrier
  s_cmp_lg_u32 s22, 0
  s_cbranch_scc1 L_dc9k_e
  s_cmp_lg_u32 s69, 0
  s_cbranch_scc1 L_dc9k_fr_d
  s_mov_b32 s71, 0
  v_mov_b32 v2, 40
L_dc9k_fr_p:
  buffer_load_dword v1, v2, s[64:67], 0 offen sc1
  s_waitcnt vmcnt(0)
  v_readfirstlane_b32 s96, v1
  s_add_u32 s71, s71, 1
  s_cmp_ge_u32 s71, 2000000
  s_cbranch_scc1 L_dc9k_fr_s
  s_cmp_eq_u32 s96, 0
  s_cbranch_scc1 L_dc9k_fr_p
L_dc9k_fr_s:
  s_mov_b32 s69, 1
L_dc9k_fr_d:
L_dc9k_e:
  s_mov_b32 s98, 109053056
  s_cmp_lg_u32 s22, 0
  s_cbranch_scc1 L_dc9k_b
  s_mov_b32 s71, 0
  v_mov_b32 v2, 0
L_dc9k_p:
  buffer_load_dword v1, v2, s[8:11], s98 offen sc1
  s_waitcnt vmcnt(0)
  v_readfirstlane_b32 s96, v1
  s_add_u32 s71, s71, 1
  s_cmp_ge_u32 s71, 2000000
  s_cbranch_scc1 L_dc9k_b
  s_cmp_ge_u32 s96, 32
  s_cbranch_scc1 L_dc9k_b
  s_sleep 4
  s_branch L_dc9k_p
L_dc9k_b:
  s_barrier
  s_add_u32 s23, s97, 288
  s_mov_b32 s68, 109059584
  s_branch JC
L_set_o8:
  s_cmp_lg_u32 s22, 0
  s_cbranch_scc1 L_do8c_e
  s_cmp_lg_u32 s69, 0
  s_cbranch_scc1 L_do8c_fr_d
  s_mov_b32 s71, 0
  v_mov_b32 v2, 40
L_do8c_fr_p:
  buffer_load_dword v1, v2, s[64:67], 0 offen sc1
  s_waitcnt vmcnt(0)
  v_readfirstlane_b32 s96, v1
  s_add_u32 s71, s71, 1
  s_cmp_ge_u32 s71, 2000000
  s_cbranch_scc1 L_do8c_fr_s
  s_cmp_eq_u32 s96, 0
  s_cbranch_scc1 L_do8c_fr_p
L_do8c_fr_s:
  s_mov_b32 s69, 1
L_do8c_fr_d:
L_do8c_e:
  s_mov_b32 s98, 109059456
  s_cmp_lg_u32 s22, 0
  s_cbranch_scc1 L_do8c_b
  s_mov_b32 s71, 0
  v_mov_b32 v2, 0
L_do8c_p:
  buffer_load_dword v1, v2, s[8:11], s98 offen sc1
  s_waitcnt vmcnt(0)
  v_readfirstlane_b32 s96, v1
  s_add_u32 s71, s71, 1
  s_cmp_ge_u32 s71, 2000000
  s_cbranch_scc1 L_do8c_b
  s_cmp_ge_u32 s96, 32
  s_cbranch_scc1 L_do8c_b
  s_sleep 4
  s_branch L_do8c_p
L_do8c_b:
  s_barrier
  s_cmp_lg_u32 s22, 0
  s_cbranch_scc1 L_do8a_e
  s_cmp_lg_u32 s69, 0
  s_cbranch_scc1 L_do8a_fr_d
  s_mov_b32 s71, 0
  v_mov_b32 v2, 40
L_do8a_fr_p:
  buffer_load_dword v1, v2, s[64:67], 0 offen sc1
  s_waitcnt vmcnt(0)
  v_readfirstlane_b32 s96, v1
  s_add_u32 s71, s71, 1
  s_cmp_ge_u32 s71, 2000000
  s_cbranch_scc1 L_do8a_fr_s
  s_cmp_eq_u32 s96, 0
  s_cbranch_scc1 L_do8a_fr_p
L_do8a_fr_s:
  s_mov_b32 s69, 1
L_do8a_fr_d:
L_do8a_e:
  s_mov_b32 s98, 109057408
  s_cmp_lg_u32 s22, 0
  s_cbranch_scc1 L_do8a_b
  s_mov_b32 s71, 0
  v_mov_b32 v2, 0
L_do8a_p:
  buffer_load_dword v1, v2, s[8:11], s98 offen sc1
  s_waitcnt vmcnt(0)
  v_readfirstlane_b32 s96, v1
  s_add_u32 s71, s71, 1
  s_cmp_ge_u32 s71, 2000000
  s_cbranch_scc1 L_do8a_b
  s_cmp_ge_u32 s96, 8
  s_cbranch_scc1 L_do8a_b
  s_sleep 4
  s_branch L_do8a_p
L_do8a_b:
  s_barrier
  s_add_u32 s23, s97, 80
  s_mov_b32 s68, 109060480
  s_branch JO
L_set_c10:
  s_cmp_lg_u32 s22, 0
  s_cbranch_scc1 L_dc10q_e
  s_cmp_lg_u32 s69, 0
  s_cbranch_scc1 L_dc10q_fr_d
  s_mov_b32 s71, 0
  v_mov_b32 v2, 40
L_dc10q_fr_p:
  buffer_load_dword v1, v2, s[64:67], 0 offen sc1
  s_waitcnt vmcnt(0)
  v_readfirstlane_b32 s96, v1
  s_add_u32 s71, s71, 1
  s_cmp_ge_u32 s71, 2000000
  s_cbranch_scc1 L_dc10q_fr_s
  s_cmp_eq_u32 s96, 0
  s_cbranch_scc1 L_dc10q_fr_p
L_dc10q_fr_s:
  s_mov_b32 s69, 1
L_dc10q_fr_d:
L_dc10q_e:
  s_mov_b32 s98, 109055232
  s_cmp_lg_u32 s22, 0
  s_cbranch_scc1 L_dc10q_b
  s_mov_b32 s71, 0
  v_mov_b32 v2, 0
L_dc10q_p:
  buffer_load_dword v1, v2, s[8:11], s98 offen sc1
  s_waitcnt vmcnt(0)
  v_readfirstlane_b32 s96, v1
  s_add_u32 s71, s71, 1
  s_cmp_ge_u32 s71, 2000000
  s_cbranch_scc1 L_dc10q_b
  s_cmp_ge_u32 s96, 16
  s_cbranch_scc1 L_dc10q_b
  s_sleep 4
  s_branch L_dc10q_p
L_dc10q_b:
  s_barrier
  s_cmp_lg_u32 s22, 0
  s_cbranch_scc1 L_dc10k_e
  s_cmp_lg_u32 s69, 0
  s_cbranch_scc1 L_dc10k_fr_d
  s_mov_b32 s71, 0
  v_mov_b32 v2, 40
L_dc10k_fr_p:
  buffer_load_dword v1, v2, s[64:67], 0 offen sc1
  s_waitcnt vmcnt(0)
  v_readfirstlane_b32 s96, v1
  s_add_u32 s71, s71, 1
  s_cmp_ge_u32 s71, 2000000
  s_cbranch_scc1 L_dc10k_fr_s
  s_cmp_eq_u32 s96, 0
  s_cbranch_scc1 L_dc10k_fr_p
L_dc10k_fr_s:
  s_mov_b32 s69, 1
L_dc10k_fr_d:
L_dc10k_e:
  s_mov_b32 s98, 109053184
  s_cmp_lg_u32 s22, 0
  s_cbranch_scc1 L_dc10k_b
  s_mov_b32 s71, 0
  v_mov_b32 v2, 0
L_dc10k_p:
  buffer_load_dword v1, v2, s[8:11], s98 offen sc1
  s_waitcnt vmcnt(0)
  v_readfirstlane_b32 s96, v1
  s_add_u32 s71, s71, 1
  s_cmp_ge_u32 s71, 2000000
  s_cbranch_scc1 L_dc10k_b
  s_cmp_ge_u32 s96, 32
  s_cbranch_scc1 L_dc10k_b
  s_sleep 4
  s_branch L_dc10k_p
L_dc10k_b:
  s_barrier
  s_add_u32 s23, s97, 320
  s_mov_b32 s68, 109059712
  s_branch JC
L_set_o15:
  s_mov_b32 s23, s97
  s_mov_b32 s68, 109060480
  s_branch JOP
L_set_o9:
  s_cmp_lg_u32 s22, 0
  s_cbranch_scc1 L_do9c_e
  s_cmp_lg_u32 s69, 0
  s_cbranch_scc1 L_do9c_fr_d
  s_mov_b32 s71, 0
  v_mov_b32 v2, 40
L_do9c_fr_p:
  buffer_load_dword v1, v2, s[64:67], 0 offen sc1
  s_waitcnt vmcnt(0)
  v_readfirstlane_b32 s96, v1
  s_add_u32 s71, s71, 1
  s_cmp_ge_u32 s71, 2000000
  s_cbranch_scc1 L_do9c_fr_s
  s_cmp_eq_u32 s96, 0
  s_cbranch_scc1 L_do9c_fr_p
L_do9c_fr_s:
  s_mov_b32 s69, 1
L_do9c_fr_d:
L_do9c_e:
  s_mov_b32 s98, 109059584
  s_cmp_lg_u32 s22, 0
  s_cbranch_scc1 L_do9c_b
  s_mov_b32 s71, 0
  v_mov_b32 v2, 0
L_do9c_p:
  buffer_load_dword v1, v2, s[8:11], s98 offen sc1
  s_waitcnt vmcnt(0)
  v_readfirstlane_b32 s96, v1
  s_add_u32 s71, s71, 1
  s_cmp_ge_u32 s71, 2000000
  s_cbranch_scc1 L_do9c_b
  s_cmp_ge_u32 s96, 32
  s_cbranch_scc1 L_do9c_b
  s_sleep 4
  s_branch L_do9c_p
L_do9c_b:
  s_barrier
  s_cmp_lg_u32 s22, 0
  s_cbranch_scc1 L_do9a_e
  s_cmp_lg_u32 s69, 0
  s_cbranch_scc1 L_do9a_fr_d
  s_mov_b32 s71, 0
  v_mov_b32 v2, 40
L_do9a_fr_p:
  buffer_load_dword v1, v2, s[64:67], 0 offen sc1
  s_waitcnt vmcnt(0)
  v_readfirstlane_b32 s96, v1
  s_add_u32 s71, s71, 1
  s_cmp_ge_u32 s71, 2000000
  s_cbranch_scc1 L_do9a_fr_s
  s_cmp_eq_u32 s96, 0
  s_cbranch_scc1 L_do9a_fr_p
L_do9a_fr_s:
  s_mov_b32 s69, 1
L_do9a_fr_d:
L_do9a_e:
  s_mov_b32 s98, 109057536
  s_cmp_lg_u32 s22, 0
  s_cbranch_scc1 L_do9a_b
  s_mov_b32 s71, 0
  v_mov_b32 v2, 0
L_do9a_p:
  buffer_load_dword v1, v2, s[8:11], s98 offen sc1
  s_waitcnt vmcnt(0)
  v_readfirstlane_b32 s96, v1
  s_add_u32 s71, s71, 1
  s_cmp_ge_u32 s71, 2000000
  s_cbranch_scc1 L_do9a_b
  s_cmp_ge_u32 s96, 8
  s_cbranch_scc1 L_do9a_b
  s_sleep 4
  s_branch L_do9a_p
L_do9a_b:
  s_barrier
  s_add_u32 s23, s97, 90
  s_mov_b32 s68, 109060480
  s_branch JO
L_set_c11:
  s_cmp_lg_u32 s22, 0
  s_cbranch_scc1 L_dc11q_e
  s_cmp_lg_u32 s69, 0
  s_cbranch_scc1 L_dc11q_fr_d
  s_mov_b32 s71, 0
  v_mov_b32 v2, 40
L_dc11q_fr_p:
  buffer_load_dword v1, v2, s[64:67], 0 offen sc1
  s_waitcnt vmcnt(0)
  v_readfirstlane_b32 s96, v1
  s_add_u32 s71, s71, 1
  s_cmp_ge_u32 s71, 2000000
  s_cbranch_scc1 L_dc11q_fr_s
  s_cmp_eq_u32 s96, 0
  s_cbranch_scc1 L_dc11q_fr_p
L_dc11q_fr_s:
  s_mov_b32 s69, 1
L_dc11q_fr_d:
L_dc11q_e:
  s_mov_b32 s98, 109055360
  s_cmp_lg_u32 s22, 0
  s_cbranch_scc1 L_dc11q_b
  s_mov_b32 s71, 0
  v_mov_b32 v2, 0
L_dc11q_p:
  buffer_load_dword v1, v2, s[8:11], s98 offen sc1
  s_waitcnt vmcnt(0)
  v_readfirstlane_b32 s96, v1
  s_add_u32 s71, s71, 1
  s_cmp_ge_u32 s71, 2000000
  s_cbranch_scc1 L_dc11q_b
  s_cmp_ge_u32 s96, 16
  s_cbranch_scc1 L_dc11q_b
  s_sleep 4
  s_branch L_dc11q_p
L_dc11q_b:
  s_barrier
  s_cmp_lg_u32 s22, 0
  s_cbranch_scc1 L_dc11k_e
  s_cmp_lg_u32 s69, 0
  s_cbranch_scc1 L_dc11k_fr_d
  s_mov_b32 s71, 0
  v_mov_b32 v2, 40
L_dc11k_fr_p:
  buffer_load_dword v1, v2, s[64:67], 0 offen sc1
  s_waitcnt vmcnt(0)
  v_readfirstlane_b32 s96, v1
  s_add_u32 s71, s71, 1
  s_cmp_ge_u32 s71, 2000000
  s_cbranch_scc1 L_dc11k_fr_s
  s_cmp_eq_u32 s96, 0
  s_cbranch_scc1 L_dc11k_fr_p
L_dc11k_fr_s:
  s_mov_b32 s69, 1
L_dc11k_fr_d:
L_dc11k_e:
  s_mov_b32 s98, 109053312
  s_cmp_lg_u32 s22, 0
  s_cbranch_scc1 L_dc11k_b
  s_mov_b32 s71, 0
  v_mov_b32 v2, 0
L_dc11k_p:
  buffer_load_dword v1, v2, s[8:11], s98 offen sc1
  s_waitcnt vmcnt(0)
  v_readfirstlane_b32 s96, v1
  s_add_u32 s71, s71, 1
  s_cmp_ge_u32 s71, 2000000
  s_cbranch_scc1 L_dc11k_b
  s_cmp_ge_u32 s96, 32
  s_cbranch_scc1 L_dc11k_b
  s_sleep 4
  s_branch L_dc11k_p
L_dc11k_b:
  s_barrier
  s_add_u32 s23, s97, 352
  s_mov_b32 s68, 109059840
  s_branch JC
L_set_o10:
  s_cmp_lg_u32 s22, 0
  s_cbranch_scc1 L_do10c_e
  s_cmp_lg_u32 s69, 0
  s_cbranch_scc1 L_do10c_fr_d
  s_mov_b32 s71, 0
  v_mov_b32 v2, 40
L_do10c_fr_p:
  buffer_load_dword v1, v2, s[64:67], 0 offen sc1
  s_waitcnt vmcnt(0)
  v_readfirstlane_b32 s96, v1
  s_add_u32 s71, s71, 1
  s_cmp_ge_u32 s71, 2000000
  s_cbranch_scc1 L_do10c_fr_s
  s_cmp_eq_u32 s96, 0
  s_cbranch_scc1 L_do10c_fr_p
L_do10c_fr_s:
  s_mov_b32 s69, 1
L_do10c_fr_d:
L_do10c_e:
  s_mov_b32 s98, 109059712
  s_cmp_lg_u32 s22, 0
  s_cbranch_scc1 L_do10c_b
  s_mov_b32 s71, 0
  v_mov_b32 v2, 0
L_do10c_p:
  buffer_load_dword v1, v2, s[8:11], s98 offen sc1
  s_waitcnt vmcnt(0)
  v_readfirstlane_b32 s96, v1
  s_add_u32 s71, s71, 1
  s_cmp_ge_u32 s71, 2000000
  s_cbranch_scc1 L_do10c_b
  s_cmp_ge_u32 s96, 32
  s_cbranch_scc1 L_do10c_b
  s_sleep 4
  s_branch L_do10c_p
L_do10c_b:
  s_barrier
  s_cmp_lg_u32 s22, 0
  s_cbranch_scc1 L_do10a_e
  s_cmp_lg_u32 s69, 0
  s_cbranch_scc1 L_do10a_fr_d
  s_mov_b32 s71, 0
  v_mov_b32 v2, 40
L_do10a_fr_p:
  buffer_load_dword v1, v2, s[64:67], 0 offen sc1
  s_waitcnt vmcnt(0)
  v_readfirstlane_b32 s96, v1
  s_add_u32 s71, s71, 1
  s_cmp_ge_u32 s71, 2000000
  s_cbranch_scc1 L_do10a_fr_s
  s_cmp_eq_u32 s96, 0
  s_cbranch_scc1 L_do10a_fr_p
L_do10a_fr_s:
  s_mov_b32 s69, 1
L_do10a_fr_d:
L_do10a_e:
  s_mov_b32 s98, 109057664
  s_cmp_lg_u32 s22, 0
  s_cbranch_scc1 L_do10a_b
  s_mov_b32 s71, 0
  v_mov_b32 v2, 0
L_do10a_p:
  buffer_load_dword v1, v2, s[8:11], s98 offen sc1
  s_waitcnt vmcnt(0)
  v_readfirstlane_b32 s96, v1
  s_add_u32 s71, s71, 1
  s_cmp_ge_u32 s71, 2000000
  s_cbranch_scc1 L_do10a_b
  s_cmp_ge_u32 s96, 8
  s_cbranch_scc1 L_do10a_b
  s_sleep 4
  s_branch L_do10a_p
L_do10a_b:
  s_barrier
  s_add_u32 s23, s97, 100
  s_mov_b32 s68, 109060480
  s_branch JO
L_set_c12:
  s_cmp_lg_u32 s22, 0
  s_cbranch_scc1 L_dc12q_e
  s_cmp_lg_u32 s69, 0
  s_cbranch_scc1 L_dc12q_fr_d
  s_mov_b32 s71, 0
  v_mov_b32 v2, 40
L_dc12q_fr_p:
  buffer_load_dword v1, v2, s[64:67], 0 offen sc1
  s_waitcnt vmcnt(0)
  v_readfirstlane_b32 s96, v1
  s_add_u32 s71, s71, 1
  s_cmp_ge_u32 s71, 2000000
  s_cbranch_scc1 L_dc12q_fr_s
  s_cmp_eq_u32 s96, 0
  s_cbranch_scc1 L_dc12q_fr_p
L_dc12q_fr_s:
  s_mov_b32 s69, 1
L_dc12q_fr_d:
L_dc12q_e:
  s_mov_b32 s98, 109055488
  s_cmp_lg_u32 s22, 0
  s_cbranch_scc1 L_dc12q_b
  s_mov_b32 s71, 0
  v_mov_b32 v2, 0
L_dc12q_p:
  buffer_load_dword v1, v2, s[8:11], s98 offen sc1
  s_waitcnt vmcnt(0)
  v_readfirstlane_b32 s96, v1
  s_add_u32 s71, s71, 1
  s_cmp_ge_u32 s71, 2000000
  s_cbranch_scc1 L_dc12q_b
  s_cmp_ge_u32 s96, 16
  s_cbranch_scc1 L_dc12q_b
  s_sleep 4
  s_branch L_dc12q_p
L_dc12q_b:
  s_barrier
  s_cmp_lg_u32 s22, 0
  s_cbranch_scc1 L_dc12k_e
  s_cmp_lg_u32 s69, 0
  s_cbranch_scc1 L_dc12k_fr_d
  s_mov_b32 s71, 0
  v_mov_b32 v2, 40
L_dc12k_fr_p:
  buffer_load_dword v1, v2, s[64:67], 0 offen sc1
  s_waitcnt vmcnt(0)
  v_readfirstlane_b32 s96, v1
  s_add_u32 s71, s71, 1
  s_cmp_ge_u32 s71, 2000000
  s_cbranch_scc1 L_dc12k_fr_s
  s_cmp_eq_u32 s96, 0
  s_cbranch_scc1 L_dc12k_fr_p
L_dc12k_fr_s:
  s_mov_b32 s69, 1
L_dc12k_fr_d:
L_dc12k_e:
  s_mov_b32 s98, 109053440
  s_cmp_lg_u32 s22, 0
  s_cbranch_scc1 L_dc12k_b
  s_mov_b32 s71, 0
  v_mov_b32 v2, 0
L_dc12k_p:
  buffer_load_dword v1, v2, s[8:11], s98 offen sc1
  s_waitcnt vmcnt(0)
  v_readfirstlane_b32 s96, v1
  s_add_u32 s71, s71, 1
  s_cmp_ge_u32 s71, 2000000
  s_cbranch_scc1 L_dc12k_b
  s_cmp_ge_u32 s96, 32
  s_cbranch_scc1 L_dc12k_b
  s_sleep 4
  s_branch L_dc12k_p
L_dc12k_b:
  s_barrier
  s_add_u32 s23, s97, 384
  s_mov_b32 s68, 109059968
  s_branch JC
L_set_o11:
  s_cmp_lg_u32 s22, 0
  s_cbranch_scc1 L_do11c_e
  s_cmp_lg_u32 s69, 0
  s_cbranch_scc1 L_do11c_fr_d
  s_mov_b32 s71, 0
  v_mov_b32 v2, 40
L_do11c_fr_p:
  buffer_load_dword v1, v2, s[64:67], 0 offen sc1
  s_waitcnt vmcnt(0)
  v_readfirstlane_b32 s96, v1
  s_add_u32 s71, s71, 1
  s_cmp_ge_u32 s71, 2000000
  s_cbranch_scc1 L_do11c_fr_s
  s_cmp_eq_u32 s96, 0
  s_cbranch_scc1 L_do11c_fr_p
L_do11c_fr_s:
  s_mov_b32 s69, 1
L_do11c_fr_d:
L_do11c_e:
  s_mov_b32 s98, 109059840
  s_cmp_lg_u32 s22, 0
  s_cbranch_scc1 L_do11c_b
  s_mov_b32 s71, 0
  v_mov_b32 v2, 0
L_do11c_p:
  buffer_load_dword v1, v2, s[8:11], s98 offen sc1
  s_waitcnt vmcnt(0)
  v_readfirstlane_b32 s96, v1
  s_add_u32 s71, s71, 1
  s_cmp_ge_u32 s71, 2000000
  s_cbranch_scc1 L_do11c_b
  s_cmp_ge_u32 s96, 32
  s_cbranch_scc1 L_do11c_b
  s_sleep 4
  s_branch L_do11c_p
L_do11c_b:
  s_barrier
  s_cmp_lg_u32 s22, 0
  s_cbranch_scc1 L_do11a_e
  s_cmp_lg_u32 s69, 0
  s_cbranch_scc1 L_do11a_fr_d
  s_mov_b32 s71, 0
  v_mov_b32 v2, 40
L_do11a_fr_p:
  buffer_load_dword v1, v2, s[64:67], 0 offen sc1
  s_waitcnt vmcnt(0)
  v_readfirstlane_b32 s96, v1
  s_add_u32 s71, s71, 1
  s_cmp_ge_u32 s71, 2000000
  s_cbranch_scc1 L_do11a_fr_s
  s_cmp_eq_u32 s96, 0
  s_cbranch_scc1 L_do11a_fr_p
L_do11a_fr_s:
  s_mov_b32 s69, 1
L_do11a_fr_d:
L_do11a_e:
  s_mov_b32 s98, 109057792
  s_cmp_lg_u32 s22, 0
  s_cbranch_scc1 L_do11a_b
  s_mov_b32 s71, 0
  v_mov_b32 v2, 0
L_do11a_p:
  buffer_load_dword v1, v2, s[8:11], s98 offen sc1
  s_waitcnt vmcnt(0)
  v_readfirstlane_b32 s96, v1
  s_add_u32 s71, s71, 1
  s_cmp_ge_u32 s71, 2000000
  s_cbranch_scc1 L_do11a_b
  s_cmp_ge_u32 s96, 8
  s_cbranch_scc1 L_do11a_b
  s_sleep 4
  s_branch L_do11a_p
L_do11a_b:
  s_barrier
  s_add_u32 s23, s97, 110
  s_mov_b32 s68, 109060480
  s_branch JO
L_set_c13:
  s_cmp_lg_u32 s22, 0
  s_cbranch_scc1 L_dc13q_e
  s_cmp_lg_u32 s69, 0
  s_cbranch_scc1 L_dc13q_fr_d
  s_mov_b32 s71, 0
  v_mov_b32 v2, 40
L_dc13q_fr_p:
  buffer_load_dword v1, v2, s[64:67], 0 offen sc1
  s_waitcnt vmcnt(0)
  v_readfirstlane_b32 s96, v1
  s_add_u32 s71, s71, 1
  s_cmp_ge_u32 s71, 2000000
  s_cbranch_scc1 L_dc13q_fr_s
  s_cmp_eq_u32 s96, 0
  s_cbranch_scc1 L_dc13q_fr_p
L_dc13q_fr_s:
  s_mov_b32 s69, 1
L_dc13q_fr_d:
L_dc13q_e:
  s_mov_b32 s98, 109055616
  s_cmp_lg_u32 s22, 0
  s_cbranch_scc1 L_dc13q_b
  s_mov_b32 s71, 0
  v_mov_b32 v2, 0
L_dc13q_p:
  buffer_load_dword v1, v2, s[8:11], s98 offen sc1
  s_waitcnt vmcnt(0)
  v_readfirstlane_b32 s96, v1
  s_add_u32 s71, s71, 1
  s_cmp_ge_u32 s71, 2000000
  s_cbranch_scc1 L_dc13q_b
  s_cmp_ge_u32 s96, 16
  s_cbranch_scc1 L_dc13q_b
  s_sleep 4
  s_branch L_dc13q_p
L_dc13q_b:
  s_barrier
  s_cmp_lg_u32 s22, 0
  s_cbranch_scc1 L_dc13k_e
  s_cmp_lg_u32 s69, 0
  s_cbranch_scc1 L_dc13k_fr_d
  s_mov_b32 s71, 0
  v_mov_b32 v2, 40
L_dc13k_fr_p:
  buffer_load_dword v1, v2, s[64:67], 0 offen sc1
  s_waitcnt vmcnt(0)
  v_readfirstlane_b32 s96, v1
  s_add_u32 s71, s71, 1
  s_cmp_ge_u32 s71, 2000000
  s_cbranch_scc1 L_dc13k_fr_s
  s_cmp_eq_u32 s96, 0
  s_cbranch_scc1 L_dc13k_fr_p
L_dc13k_fr_s:
  s_mov_b32 s69, 1
L_dc13k_fr_d:
L_dc13k_e:
  s_mov_b32 s98, 109053568
  s_cmp_lg_u32 s22, 0
  s_cbranch_scc1 L_dc13k_b
  s_mov_b32 s71, 0
  v_mov_b32 v2, 0
L_dc13k_p:
  buffer_load_dword v1, v2, s[8:11], s98 offen sc1
  s_waitcnt vmcnt(0)
  v_readfirstlane_b32 s96, v1
  s_add_u32 s71, s71, 1
  s_cmp_ge_u32 s71, 2000000
  s_cbranch_scc1 L_dc13k_b
  s_cmp_ge_u32 s96, 32
  s_cbranch_scc1 L_dc13k_b
  s_sleep 4
  s_branch L_dc13k_p
L_dc13k_b:
  s_barrier
  s_add_u32 s23, s97, 416
  s_mov_b32 s68, 109060096
  s_branch JC
L_set_c14:
  s_cmp_lg_u32 s22, 0
  s_cbranch_scc1 L_dc14q_e
  s_cmp_lg_u32 s69, 0
  s_cbranch_scc1 L_dc14q_fr_d
  s_mov_b32 s71, 0
  v_mov_b32 v2, 40
L_dc14q_fr_p:
  buffer_load_dword v1, v2, s[64:67], 0 offen sc1
  s_waitcnt vmcnt(0)
  v_readfirstlane_b32 s96, v1
  s_add_u32 s71, s71, 1
  s_cmp_ge_u32 s71, 2000000
  s_cbranch_scc1 L_dc14q_fr_s
  s_cmp_eq_u32 s96, 0
  s_cbranch_scc1 L_dc14q_fr_p
L_dc14q_fr_s:
  s_mov_b32 s69, 1
L_dc14q_fr_d:
L_dc14q_e:
  s_mov_b32 s98, 109055744
  s_cmp_lg_u32 s22, 0
  s_cbranch_scc1 L_dc14q_b
  s_mov_b32 s71, 0
  v_mov_b32 v2, 0
L_dc14q_p:
  buffer_load_dword v1, v2, s[8:11], s98 offen sc1
  s_waitcnt vmcnt(0)
  v_readfirstlane_b32 s96, v1
  s_add_u32 s71, s71, 1
  s_cmp_ge_u32 s71, 2000000
  s_cbranch_scc1 L_dc14q_b
  s_cmp_ge_u32 s96, 16
  s_cbranch_scc1 L_dc14q_b
  s_sleep 4
  s_branch L_dc14q_p
L_dc14q_b:
  s_barrier
  s_cmp_lg_u32 s22, 0
  s_cbranch_scc1 L_dc14k_e
  s_cmp_lg_u32 s69, 0
  s_cbranch_scc1 L_dc14k_fr_d
  s_mov_b32 s71, 0
  v_mov_b32 v2, 40
L_dc14k_fr_p:
  buffer_load_dword v1, v2, s[64:67], 0 offen sc1
  s_waitcnt vmcnt(0)
  v_readfirstlane_b32 s96, v1
  s_add_u32 s71, s71, 1
  s_cmp_ge_u32 s71, 2000000
  s_cbranch_scc1 L_dc14k_fr_s
  s_cmp_eq_u32 s96, 0
  s_cbranch_scc1 L_dc14k_fr_p
L_dc14k_fr_s:
  s_mov_b32 s69, 1
L_dc14k_fr_d:
L_dc14k_e:
  s_mov_b32 s98, 109053696
  s_cmp_lg_u32 s22, 0
  s_cbranch_scc1 L_dc14k_b
  s_mov_b32 s71, 0
  v_mov_b32 v2, 0
L_dc14k_p:
  buffer_load_dword v1, v2, s[8:11], s98 offen sc1
  s_waitcnt vmcnt(0)
  v_readfirstlane_b32 s96, v1
  s_add_u32 s71, s71, 1
  s_cmp_ge_u32 s71, 2000000
  s_cbranch_scc1 L_dc14k_b
  s_cmp_ge_u32 s96, 32
  s_cbranch_scc1 L_dc14k_b
  s_sleep 4
  s_branch L_dc14k_p
L_dc14k_b:
  s_barrier
  s_add_u32 s23, s97, 448
  s_mov_b32 s68, 109060224
  s_branch JC
L_set_c15:
  s_cmp_lg_u32 s22, 0
  s_cbranch_scc1 L_dc15q_e
  s_cmp_lg_u32 s69, 0
  s_cbranch_scc1 L_dc15q_fr_d
  s_mov_b32 s71, 0
  v_mov_b32 v2, 40
L_dc15q_fr_p:
  buffer_load_dword v1, v2, s[64:67], 0 offen sc1
  s_waitcnt vmcnt(0)
  v_readfirstlane_b32 s96, v1
  s_add_u32 s71, s71, 1
  s_cmp_ge_u32 s71, 2000000
  s_cbranch_scc1 L_dc15q_fr_s
  s_cmp_eq_u32 s96, 0
  s_cbranch_scc1 L_dc15q_fr_p
L_dc15q_fr_s:
  s_mov_b32 s69, 1
L_dc15q_fr_d:
L_dc15q_e:
  s_mov_b32 s98, 109055872
  s_cmp_lg_u32 s22, 0
  s_cbranch_scc1 L_dc15q_b
  s_mov_b32 s71, 0
  v_mov_b32 v2, 0
L_dc15q_p:
  buffer_load_dword v1, v2, s[8:11], s98 offen sc1
  s_waitcnt vmcnt(0)
  v_readfirstlane_b32 s96, v1
  s_add_u32 s71, s71, 1
  s_cmp_ge_u32 s71, 2000000
  s_cbranch_scc1 L_dc15q_b
  s_cmp_ge_u32 s96, 16
  s_cbranch_scc1 L_dc15q_b
  s_sleep 4
  s_branch L_dc15q_p
L_dc15q_b:
  s_barrier
  s_cmp_lg_u32 s22, 0
  s_cbranch_scc1 L_dc15k_e
  s_cmp_lg_u32 s69, 0
  s_cbranch_scc1 L_dc15k_fr_d
  s_mov_b32 s71, 0
  v_mov_b32 v2, 40
L_dc15k_fr_p:
  buffer_load_dword v1, v2, s[64:67], 0 offen sc1
  s_waitcnt vmcnt(0)
  v_readfirstlane_b32 s96, v1
  s_add_u32 s71, s71, 1
  s_cmp_ge_u32 s71, 2000000
  s_cbranch_scc1 L_dc15k_fr_s
  s_cmp_eq_u32 s96, 0
  s_cbranch_scc1 L_dc15k_fr_p
L_dc15k_fr_s:
  s_mov_b32 s69, 1
L_dc15k_fr_d:
L_dc15k_e:
  s_mov_b32 s98, 109053824
  s_cmp_lg_u32 s22, 0
  s_cbranch_scc1 L_dc15k_b
  s_mov_b32 s71, 0
  v_mov_b32 v2, 0
L_dc15k_p:
  buffer_load_dword v1, v2, s[8:11], s98 offen sc1
  s_waitcnt vmcnt(0)
  v_readfirstlane_b32 s96, v1
  s_add_u32 s71, s71, 1
  s_cmp_ge_u32 s71, 2000000
  s_cbranch_scc1 L_dc15k_b
  s_cmp_ge_u32 s96, 32
  s_cbranch_scc1 L_dc15k_b
  s_sleep 4
  s_branch L_dc15k_p
L_dc15k_b:
  s_barrier
  s_add_u32 s23, s97, 480
  s_mov_b32 s68, 109060352
  s_branch JC
L_jobdone:
  s_waitcnt vmcnt(0) lgkmcnt(0)
  s_barrier
  s_cmp_lg_u32 s22, 0
  s_cbranch_scc1 L_next
  s_cmp_lg_u32 s69, 0
  s_cbranch_scc1 L_fr_d
  s_mov_b32 s71, 0
  v_mov_b32 v2, 40
L_fr_p:
  buffer_load_dword v1, v2, s[64:67], 0 offen sc1
  s_waitcnt vmcnt(0)
  v_readfirstlane_b32 s96, v1
  s_add_u32 s71, s71, 1
  s_cmp_ge_u32 s71, 2000000
  s_cbranch_scc1 L_fr_s
  s_cmp_eq_u32 s96, 0
  s_cbranch_scc1 L_fr_p
L_fr_s:
  s_mov_b32 s69, 1
L_fr_d:
  v_mov_b32 v1, 1
  v_mov_b32 v2, 0
  s_mov_b64 exec, 1
  buffer_atomic_add v1, v2, s[8:11], s68 offen
  s_mov_b64 exec, -1
  s_branch L_next
JP:
  s_lshr_b32 s24, s23, 8
  s_bfe_u32 s25, s23, 0x40004
  s_and_b32 s26, s23, 15
  s_mov_b32 s40, 8192
  s_mov_b32 s12, s72
  s_and_b32 s13, s73, 0xffff
  s_mov_b32 s14, 2621440
  s_mov_b32 s15, 0x20000
  s_cmp_eq_u32 s24, 0
  s_cselect_b32 s28, s84, s86
  s_cselect_b32 s29, s85, s87
  s_cmp_eq_u32 s24, 2
  s_cselect_b32 s28, s82, s28
  s_cselect_b32 s29, s83, s29
  s_mov_b32 s16, s28
  s_and_b32 s17, s29, 0xffff
  s_mov_b32 s18, 5242880
  s_mov_b32 s19, 0x20000
  v_lshrrev_b32 v14, 3, v0
  v_mul_u32_u24 v14, 1280, v14
  v_and_b32 v15, 7, v0
  v_lshrrev_b32 v16, 4, v0
  v_xor_b32 v17, v15, v16
  v_lshl_add_u32 v2, v17, 4, v14
  v_xor_b32 v17, 4, v17
  v_lshl_add_u32 v3, v17, 4, v14
  v_lshrrev_b32 v14, 5, v0
  v_mul_lo_u32 v14, v14, s40
  v_and_b32 v15, 31, v0
  v_lshrrev_b32 v16, 5, v0
  v_lshlrev_b32 v16, 2, v16
  v_xor_b32 v17, v15, v16
  v_lshl_add_u32 v4, v17, 4, v14
  v_xor_b32 v17, 8, v17
  v_lshl_add_u32 v5, v17, 4, v14
  s_and_b32 s41, s22, 1
  s_lshl_b32 s41, s41, 13
  v_and_b32 v14, 31, v0
  v_lshlrev_b32 v15, 7, v14
  s_add_u32 s41, s41, 98304
  v_add_u32 v15, s41, v15
  v_lshrrev_b32 v16, 1, v14
  v_and_b32 v16, 7, v16
  v_lshrrev_b32 v17, 5, v0
  v_xor_b32 v16, v16, v17
  v_xor_b32 v17, 0, v16
  v_lshl_add_u32 v6, v17, 4, v15
  v_xor_b32 v17, 2, v16
  v_lshl_add_u32 v7, v17, 4, v15
  v_xor_b32 v17, 4, v16
  v_lshl_add_u32 v8, v17, 4, v15
  v_xor_b32 v17, 6, v16
  v_lshl_add_u32 v9, v17, 4, v15
  v_bfe_u32 v14, v0, 2, 2
  v_lshrrev_b32 v15, 5, v0
  v_lshlrev_b32 v15, 3, v15
  v_add_u32 v15, v15, v14
  v_lshlrev_b32 v15, 9, v15
  v_bfe_u32 v16, v0, 4, 1
  v_lshl_add_u32 v15, v16, 5, v15
  v_and_b32 v16, 3, v0
  v_lshl_add_u32 v15, v16, 3, v15
  s_lshr_b32 s41, s22, 1
  s_lshl_b32 s41, s41, 2
  s_add_u32 s42, s41, 0
  v_xor_b32 v16, s42, v14
  v_lshl_add_u32 v10, v16, 6, v15
  v_add_u32 v64, 0x10000, v10
  s_add_u32 s42, s41, 1
  v_xor_b32 v16, s42, v14
  v_lshl_add_u32 v11, v16, 6, v15
  v_add_u32 v65, 0x10000, v11
  s_add_u32 s42, s41, 2
  v_xor_b32 v16, s42, v14
  v_lshl_add_u32 v12, v16, 6, v15
  v_add_u32 v66, 0x10000, v12
  s_add_u32 s42, s41, 3
  v_xor_b32 v16, s42, v14
  v_lshl_add_u32 v13, v16, 6, v15
  v_add_u32 v67, 0x10000, v13
  s_mul_i32 s45, s22, 40960
  s_add_u32 s46, s45, 0
  s_add_u32 s47, s45, 10240
  s_add_u32 s48, s45, 20480
  s_add_u32 s49, s45, 30720
  s_mul_i32 s45, s22, s40
  s_lshl_b32 s45, s45, 4
  s_mul_i32 s44, s40, 0
  s_add_u32 s52, s45, s44
  s_mul_i32 s44, s40, 2
  s_add_u32 s53, s45, s44
  s_mul_i32 s44, s40, 4
  s_add_u32 s54, s45, s44
  s_mul_i32 s44, s40, 6
  s_add_u32 s55, s45, s44
  s_mul_i32 s44, s40, 8
  s_add_u32 s56, s45, s44
  s_mul_i32 s44, s40, 10
  s_add_u32 s57, s45, s44
  s_mul_i32 s44, s40, 12
  s_add_u32 s58, s45, s44
  s_mul_i32 s44, s40, 14
  s_add_u32 s59, s45, s44
  s_lshl_b32 s50, s22, 12
  s_lshl_b32 s51, s22, 13
  s_mul_i32 s30, s25, 163840
  s_lshl_b32 s31, s26, 9
  s_add_u32 s44, s30, s46
  s_add_u32 m0, s50, 98304
  buffer_load_dwordx4 v2, s[12:15], s44 offen lds
  s_add_u32 s44, s30, s47
  s_add_u32 m0, s50, 99328
  buffer_load_dwordx4 v3, s[12:15], s44 offen lds
  s_add_u32 s44, s30, s48
  s_add_u32 m0, s50, 100352
  buffer_load_dwordx4 v2, s[12:15], s44 offen lds
  s_add_u32 s44, s30, s49
  s_add_u32 m0, s50, 101376
  buffer_load_dwordx4 v3, s[12:15], s44 offen lds
  s_add_u32 s44, s31, s52
  s_add_u32 m0, s51, 0
  buffer_load_dwordx4 v4, s[16:19], s44 offen lds
  s_add_u32 s44, s31, s53
  s_add_u32 m0, s51, 1024
  buffer_load_dwordx4 v5, s[16:19], s44 offen lds
  s_add_u32 s44, s31, s54
  s_add_u32 m0, s51, 2048
  buffer_load_dwordx4 v4, s[16:19], s44 offen lds
  s_add_u32 s44, s31, s55
  s_add_u32 m0, s51, 3072
  buffer_load_dwordx4 v5, s[16:19], s44 offen lds
  s_add_u32 s44, s31, s56
  s_add_u32 m0, s51, 4096
  buffer_load_dwordx4 v4, s[16:19], s44 offen lds
  s_add_u32 s44, s31, s57
  s_add_u32 m0, s51, 5120
  buffer_load_dwordx4 v5, s[16:19], s44 offen lds
  s_add_u32 s44, s31, s58
  s_add_u32 m0, s51, 6144
  buffer_load_dwordx4 v4, s[16:19], s44 offen lds
  s_add_u32 s44, s31, s59
  s_add_u32 m0, s51, 7168
  buffer_load_dwordx4 v5, s[16:19], s44 offen lds
  s_add_u32 s30, s30, 128
  s_add_u32 s31, s31, 524288
  s_add_u32 s44, s30, s46
  s_add_u32 m0, s50, 114688
  buffer_load_dwordx4 v2, s[12:15], s44 offen lds
  s_add_u32 s44, s30, s47
  s_add_u32 m0, s50, 115712
  buffer_load_dwordx4 v3, s[12:15], s44 offen lds
  s_add_u32 s44, s30, s48
  s_add_u32 m0, s50, 116736
  buffer_load_dwordx4 v2, s[12:15], s44 offen lds
  s_add_u32 s44, s30, s49
  s_add_u32 m0, s50, 117760
  buffer_load_dwordx4 v3, s[12:15], s44 offen lds
  s_add_u32 s44, s31, s52
  s_add_u32 m0, s51, 32768
  buffer_load_dwordx4 v4, s[16:19], s44 offen lds
  s_add_u32 s44, s31, s53
  s_add_u32 m0, s51, 33792
  buffer_load_dwordx4 v5, s[16:19], s44 offen lds
  s_add_u32 s44, s31, s54
  s_add_u32 m0, s51, 34816
  buffer_load_dwordx4 v4, s[16:19], s44 offen lds
  s_add_u32 s44, s31, s55
  s_add_u32 m0, s51, 35840
  buffer_load_dwordx4 v5, s[16:19], s44 offen lds
  s_add_u32 s44, s31, s56
  s_add_u32 m0, s51, 36864
  buffer_load_dwordx4 v4, s[16:19], s44 offen lds
  s_add_u32 s44, s31, s57
  s_add_u32 m0, s51, 37888
  buffer_load_dwordx4 v5, s[16:19], s44 offen lds
  s_add_u32 s44, s31, s58
  s_add_u32 m0, s51, 38912
  buffer_load_dwordx4 v4, s[16:19], s44 offen lds
  s_add_u32 s44, s31, s59
  s_add_u32 m0, s51, 39936
  buffer_load_dwordx4 v5, s[16:19], s44 offen lds
  s_add_u32 s30, s30, 128
  s_add_u32 s31, s31, 524288
  s_cmp_eq_u32 s24, 1
  s_cbranch_scc1 JP_sw0
JP_sw1:
  s_waitcnt vmcnt(12)
  s_barrier
  ds_read_b128 v[16:19], v6 offset:0
  ds_read_b128 v[20:23], v6 offset:4096
  ds_read_b64_tr_b16 v[32:33], v10 offset:0
  ds_read_b64_tr_b16 v[34:35], v10 offset:2048
  ds_read_b64_tr_b16 v[36:37], v11 offset:0
  ds_read_b64_tr_b16 v[38:39], v11 offset:2048
  ds_read_b64_tr_b16 v[40:41], v12 offset:0
  ds_read_b64_tr_b16 v[42:43], v12 offset:2048
  ds_read_b64_tr_b16 v[44:45], v13 offset:0
  ds_read_b64_tr_b16 v[46:47], v13 offset:2048
  ds_read_b128 v[24:27], v7 offset:0
  ds_read_b128 v[28:31], v7 offset:4096
  ds_read_b64_tr_b16 v[48:49], v10 offset:8192
  ds_read_b64_tr_b16 v[50:51], v10 offset:10240
  ds_read_b64_tr_b16 v[52:53], v11 offset:8192
  ds_read_b64_tr_b16 v[54:55], v11 offset:10240
  ds_read_b64_tr_b16 v[56:57], v12 offset:8192
  ds_read_b64_tr_b16 v[58:59], v12 offset:10240
  ds_read_b64_tr_b16 v[60:61], v13 offset:8192
  ds_read_b64_tr_b16 v[62:63], v13 offset:10240
  s_waitcnt lgkmcnt(10)
  v_mfma_f32_32x32x16_bf16 v[128:143], v[32:35], v[16:19], 0
  v_mfma_f32_32x32x16_bf16 v[144:159], v[36:39], v[16:19], 0
  s_add_u32 s44, s30, s46
  s_add_u32 m0, s50, 131072
  buffer_load_dwordx4 v2, s[12:15], s44 offen lds
  v_mfma_f32_32x32x16_bf16 v[160:175], v[40:43], v[16:19], 0
  v_mfma_f32_32x32x16_bf16 v[176:191], v[44:47], v[16:19], 0
  s_add_u32 s44, s30, s47
  s_add_u32 m0, s50, 132096
  buffer_load_dwordx4 v3, s[12:15], s44 offen lds
  v_mfma_f32_32x32x16_bf16 v[192:207], v[32:35], v[20:23], 0
  v_mfma_f32_32x32x16_bf16 v[208:223], v[36:39], v[20:23], 0
  s_add_u32 s44, s30, s48
  s_add_u32 m0, s50, 133120
  buffer_load_dwordx4 v2, s[12:15], s44 offen lds
  v_mfma_f32_32x32x16_bf16 v[224:239], v[40:43], v[20:23], 0
  v_mfma_f32_32x32x16_bf16 v[240:255], v[44:47], v[20:23], 0
  s_add_u32 s44, s30, s49
  s_add_u32 m0, s50, 134144
  buffer_load_dwordx4 v3, s[12:15], s44 offen lds
  ds_read_b128 v[16:19], v8 offset:0
  ds_read_b128 v[20:23], v8 offset:4096
  ds_read_b64_tr_b16 v[32:33], v10 offset:16384
  ds_read_b64_tr_b16 v[34:35], v10 offset:18432
  ds_read_b64_tr_b16 v[36:37], v11 offset:16384
  ds_read_b64_tr_b16 v[38:39], v11 offset:18432
  ds_read_b64_tr_b16 v[40:41], v12 offset:16384
  ds_read_b64_tr_b16 v[42:43], v12 offset:18432
  ds_read_b64_tr_b16 v[44:45], v13 offset:16384
  ds_read_b64_tr_b16 v[46:47], v13 offset:18432
  s_waitcnt lgkmcnt(10)
  v_mfma_f32_32x32x16_bf16 v[128:143], v[48:51], v[24:27], v[128:143]
  v_mfma_f32_32x32x16_bf16 v[144:159], v[52:55], v[24:27], v[144:159]
  s_add_u32 s44, s31, s52
  s_add_u32 m0, s51, 65536
  buffer_load_dwordx4 v4, s[16:19], s44 offen lds
  v_mfma_f32_32x32x16_bf16 v[160:175], v[56:59], v[24:27], v[160:175]
  v_mfma_f32_32x32x16_bf16 v[176:191], v[60:63], v[24:27], v[176:191]
  s_add_u32 s44, s31, s53
  s_add_u32 m0, s51, 66560
  buffer_load_dwordx4 v5, s[16:19], s44 offen lds
  v_mfma_f32_32x32x16_bf16 v[192:207], v[48:51], v[28:31], v[192:207]
  v_mfma_f32_32x32x16_bf16 v[208:223], v[52:55], v[28:31], v[208:223]
  s_add_u32 s44, s31, s54
  s_add_u32 m0, s51, 67584
  buffer_load_dwordx4 v4, s[16:19], s44 offen lds
  v_mfma_f32_32x32x16_bf16 v[224:239], v[56:59], v[28:31], v[224:239]
  v_mfma_f32_32x32x16_bf16 v[240:255], v[60:63], v[28:31], v[240:255]
  s_add_u32 s44, s31, s55
  s_add_u32 m0, s51, 68608
  buffer_load_dwordx4 v5, s[16:19], s44 offen lds
  ds_read_b128 v[24:27], v9 offset:0
  ds_read_b128 v[28:31], v9 offset:4096
  ds_read_b64_tr_b16 v[48:49], v10 offset:24576
  ds_read_b64_tr_b16 v[50:51], v10 offset:26624
  ds_read_b64_tr_b16 v[52:53], v11 offset:24576
  ds_read_b64_tr_b16 v[54:55], v11 offset:26624
  ds_read_b64_tr_b16 v[56:57], v12 offset:24576
  ds_read_b64_tr_b16 v[58:59], v12 offset:26624
  ds_read_b64_tr_b16 v[60:61], v13 offset:24576
  ds_read_b64_tr_b16 v[62:63], v13 offset:26624
  s_waitcnt lgkmcnt(10)
  v_mfma_f32_32x32x16_bf16 v[128:143], v[32:35], v[16:19], v[128:143]
  v_mfma_f32_32x32x16_bf16 v[144:159], v[36:39], v[16:19], v[144:159]
  s_add_u32 s44, s31, s56
  s_add_u32 m0, s51, 69632
  buffer_load_dwordx4 v4, s[16:19], s44 offen lds
  v_mfma_f32_32x32x16_bf16 v[160:175], v[40:43], v[16:19], v[160:175]
  v_mfma_f32_32x32x16_bf16 v[176:191], v[44:47], v[16:19], v[176:191]
  s_add_u32 s44, s31, s57
  s_add_u32 m0, s51, 70656
  buffer_load_dwordx4 v5, s[16:19], s44 offen lds
  v_mfma_f32_32x32x16_bf16 v[192:207], v[32:35], v[20:23], v[192:207]
  v_mfma_f32_32x32x16_bf16 v[208:223], v[36:39], v[20:23], v[208:223]
  s_add_u32 s44, s31, s58
  s_add_u32 m0, s51, 71680
  buffer_load_dwordx4 v4, s[16:19], s44 offen lds
  v_mfma_f32_32x32x16_bf16 v[224:239], v[40:43], v[20:23], v[224:239]
  v_mfma_f32_32x32x16_bf16 v[240:255], v[44:47], v[20:23], v[240:255]
  s_add_u32 s44, s31, s59
  s_add_u32 m0, s51, 72704
  buffer_load_dwordx4 v5, s[16:19], s44 offen lds
  s_waitcnt lgkmcnt(0)
  v_mfma_f32_32x32x16_bf16 v[128:143], v[48:51], v[24:27], v[128:143]
  v_mfma_f32_32x32x16_bf16 v[144:159], v[52:55], v[24:27], v[144:159]
  s_add_u32 s30, s30, 128
  s_add_u32 s31, s31, 524288
  v_mfma_f32_32x32x16_bf16 v[160:175], v[56:59], v[24:27], v[160:175]
  v_mfma_f32_32x32x16_bf16 v[176:191], v[60:63], v[24:27], v[176:191]
  v_mfma_f32_32x32x16_bf16 v[192:207], v[48:51], v[28:31], v[192:207]
  v_mfma_f32_32x32x16_bf16 v[208:223], v[52:55], v[28:31], v[208:223]
  v_mfma_f32_32x32x16_bf16 v[224:239], v[56:59], v[28:31], v[224:239]
  v_mfma_f32_32x32x16_bf16 v[240:255], v[60:63], v[28:31], v[240:255]
  s_waitcnt vmcnt(12)
  s_barrier
  ds_read_b128 v[16:19], v6 offset:16384
  ds_read_b128 v[20:23], v6 offset:20480
  ds_read_b64_tr_b16 v[32:33], v10 offset:32768
  ds_read_b64_tr_b16 v[34:35], v10 offset:34816
  ds_read_b64_tr_b16 v[36:37], v11 offset:32768
  ds_read_b64_tr_b16 v[38:39], v11 offset:34816
  ds_read_b64_tr_b16 v[40:41], v12 offset:32768
  ds_read_b64_tr_b16 v[42:43], v12 offset:34816
  ds_read_b64_tr_b16 v[44:45], v13 offset:32768
  ds_read_b64_tr_b16 v[46:47], v13 offset:34816
  ds_read_b128 v[24:27], v7 offset:16384
  ds_read_b128 v[28:31], v7 offset:20480
  ds_read_b64_tr_b16 v[48:49], v10 offset:40960
  ds_read_b64_tr_b16 v[50:51], v10 offset:43008
  ds_read_b64_tr_b16 v[52:53], v11 offset:40960
  ds_read_b64_tr_b16 v[54:55], v11 offset:43008
  ds_read_b64_tr_b16 v[56:57], v12 offset:40960
  ds_read_b64_tr_b16 v[58:59], v12 offset:43008
  ds_read_b64_tr_b16 v[60:61], v13 offset:40960
  ds_read_b64_tr_b16 v[62:63], v13 offset:43008
  s_waitcnt lgkmcnt(10)
  v_mfma_f32_32x32x16_bf16 v[128:143], v[32:35], v[16:19], v[128:143]
  v_mfma_f32_32x32x16_bf16 v[144:159], v[36:39], v[16:19], v[144:159]
  s_add_u32 s44, s30, s46
  s_add_u32 m0, s50, 98304
  buffer_load_dwordx4 v2, s[12:15], s44 offen lds
  v_mfma_f32_32x32x16_bf16 v[160:175], v[40:43], v[16:19], v[160:175]
  v_mfma_f32_32x32x16_bf16 v[176:191], v[44:47], v[16:19], v[176:191]
  s_add_u32 s44, s30, s47
  s_add_u32 m0, s50, 99328
  buffer_load_dwordx4 v3, s[12:15], s44 offen lds
  v_mfma_f32_32x32x16_bf16 v[192:207], v[32:35], v[20:23], v[192:207]
  v_mfma_f32_32x32x16_bf16 v[208:223], v[36:39], v[20:23], v[208:223]
  s_add_u32 s44, s30, s48
  s_add_u32 m0, s50, 100352
  buffer_load_dwordx4 v2, s[12:15], s44 offen lds
  v_mfma_f32_32x32x16_bf16 v[224:239], v[40:43], v[20:23], v[224:239]
  v_mfma_f32_32x32x16_bf16 v[240:255], v[44:47], v[20:23], v[240:255]
  s_add_u32 s44, s30, s49
  s_add_u32 m0, s50, 101376
  buffer_load_dwordx4 v3, s[12:15], s44 offen lds
  ds_read_b128 v[16:19], v8 offset:16384
  ds_read_b128 v[20:23], v8 offset:20480
  ds_read_b64_tr_b16 v[32:33], v10 offset:49152
  ds_read_b64_tr_b16 v[34:35], v10 offset:51200
  ds_read_b64_tr_b16 v[36:37], v11 offset:49152
  ds_read_b64_tr_b16 v[38:39], v11 offset:51200
  ds_read_b64_tr_b16 v[40:41], v12 offset:49152
  ds_read_b64_tr_b16 v[42:43], v12 offset:51200
  ds_read_b64_tr_b16 v[44:45], v13 offset:49152
  ds_read_b64_tr_b16 v[46:47], v13 offset:51200
  s_waitcnt lgkmcnt(10)
  v_mfma_f32_32x32x16_bf16 v[128:143], v[48:51], v[24:27], v[128:143]
  v_mfma_f32_32x32x16_bf16 v[144:159], v[52:55], v[24:27], v[144:159]
  s_add_u32 s44, s31, s52
  s_add_u32 m0, s51, 0
  buffer_load_dwordx4 v4, s[16:19], s44 offen lds
  v_mfma_f32_32x32x16_bf16 v[160:175], v[56:59], v[24:27], v[160:175]
  v_mfma_f32_32x32x16_bf16 v[176:191], v[60:63], v[24:27], v[176:191]
  s_add_u32 s44, s31, s53
  s_add_u32 m0, s51, 1024
  buffer_load_dwordx4 v5, s[16:19], s44 offen lds
  v_mfma_f32_32x32x16_bf16 v[192:207], v[48:51], v[28:31], v[192:207]
  v_mfma_f32_32x32x16_bf16 v[208:223], v[52:55], v[28:31], v[208:223]
  s_add_u32 s44, s31, s54
  s_add_u32 m0, s51, 2048
  buffer_load_dwordx4 v4, s[16:19], s44 offen lds
  v_mfma_f32_32x32x16_bf16 v[224:239], v[56:59], v[28:31], v[224:239]
  v_mfma_f32_32x32x16_bf16 v[240:255], v[60:63], v[28:31], v[240:255]
  s_add_u32 s44, s31, s55
  s_add_u32 m0, s51, 3072
  buffer_load_dwordx4 v5, s[16:19], s44 offen lds
  ds_read_b128 v[24:27], v9 offset:16384
  ds_read_b128 v[28:31], v9 offset:20480
  ds_read_b64_tr_b16 v[48:49], v10 offset:57344
  ds_read_b64_tr_b16 v[50:51], v10 offset:59392
  ds_read_b64_tr_b16 v[52:53], v11 offset:57344
  ds_read_b64_tr_b16 v[54:55], v11 offset:59392
  ds_read_b64_tr_b16 v[56:57], v12 offset:57344
  ds_read_b64_tr_b16 v[58:59], v12 offset:59392
  ds_read_b64_tr_b16 v[60:61], v13 offset:57344
  ds_read_b64_tr_b16 v[62:63], v13 offset:59392
  s_waitcnt lgkmcnt(10)
  v_mfma_f32_32x32x16_bf16 v[128:143], v[32:35], v[16:19], v[128:143]
  v_mfma_f32_32x32x16_bf16 v[144:159], v[36:39], v[16:19], v[144:159]
  s_add_u32 s44, s31, s56
  s_add_u32 m0, s51, 4096
  buffer_load_dwordx4 v4, s[16:19], s44 offen lds
  v_mfma_f32_32x32x16_bf16 v[160:175], v[40:43], v[16:19], v[160:175]
  v_mfma_f32_32x32x16_bf16 v[176:191], v[44:47], v[16:19], v[176:191]
  s_add_u32 s44, s31, s57
  s_add_u32 m0, s51, 5120
  buffer_load_dwordx4 v5, s[16:19], s44 offen lds
  v_mfma_f32_32x32x16_bf16 v[192:207], v[32:35], v[20:23], v[192:207]
  v_mfma_f32_32x32x16_bf16 v[208:223], v[36:39], v[20:23], v[208:223]
  s_add_u32 s44, s31, s58
  s_add_u32 m0, s51, 6144
  buffer_load_dwordx4 v4, s[16:19], s44 offen lds
  v_mfma_f32_32x32x16_bf16 v[224:239], v[40:43], v[20:23], v[224:239]
  v_mfma_f32_32x32x16_bf16 v[240:255], v[44:47], v[20:23], v[240:255]
  s_add_u32 s44, s31, s59
  s_add_u32 m0, s51, 7168
  buffer_load_dwordx4 v5, s[16:19], s44 offen lds
  s_waitcnt lgkmcnt(0)
  v_mfma_f32_32x32x16_bf16 v[128:143], v[48:51], v[24:27], v[128:143]
  v_mfma_f32_32x32x16_bf16 v[144:159], v[52:55], v[24:27], v[144:159]
  s_add_u32 s30, s30, 128
  s_add_u32 s31, s31, 524288
  v_mfma_f32_32x32x16_bf16 v[160:175], v[56:59], v[24:27], v[160:175]
  v_mfma_f32_32x32x16_bf16 v[176:191], v[60:63], v[24:27], v[176:191]
  v_mfma_f32_32x32x16_bf16 v[192:207], v[48:51], v[28:31], v[192:207]
  v_mfma_f32_32x32x16_bf16 v[208:223], v[52:55], v[28:31], v[208:223]
  v_mfma_f32_32x32x16_bf16 v[224:239], v[56:59], v[28:31], v[224:239]
  v_mfma_f32_32x32x16_bf16 v[240:255], v[60:63], v[28:31], v[240:255]
  s_waitcnt vmcnt(12)
  s_barrier
  ds_read_b128 v[16:19], v6 offset:32768
  ds_read_b128 v[20:23], v6 offset:36864
  ds_read_b64_tr_b16 v[32:33], v64 offset:0
  ds_read_b64_tr_b16 v[34:35], v64 offset:2048
  ds_read_b64_tr_b16 v[36:37], v65 offset:0
  ds_read_b64_tr_b16 v[38:39], v65 offset:2048
  ds_read_b64_tr_b16 v[40:41], v66 offset:0
  ds_read_b64_tr_b16 v[42:43], v66 offset:2048
  ds_read_b64_tr_b16 v[44:45], v67 offset:0
  ds_read_b64_tr_b16 v[46:47], v67 offset:2048
  ds_read_b128 v[24:27], v7 offset:32768
  ds_read_b128 v[28:31], v7 offset:36864
  ds_read_b64_tr_b16 v[48:49], v64 offset:8192
  ds_read_b64_tr_b16 v[50:51], v64 offset:10240
  ds_read_b64_tr_b16 v[52:53], v65 offset:8192
  ds_read_b64_tr_b16 v[54:55], v65 offset:10240
  ds_read_b64_tr_b16 v[56:57], v66 offset:8192
  ds_read_b64_tr_b16 v[58:59], v66 offset:10240
  ds_read_b64_tr_b16 v[60:61], v67 offset:8192
  ds_read_b64_tr_b16 v[62:63], v67 offset:10240
  s_waitcnt lgkmcnt(10)
  v_mfma_f32_32x32x16_bf16 v[128:143], v[32:35], v[16:19], v[128:143]
  v_mfma_f32_32x32x16_bf16 v[144:159], v[36:39], v[16:19], v[144:159]
  s_add_u32 s44, s30, s46
  s_add_u32 m0, s50, 114688
  buffer_load_dwordx4 v2, s[12:15], s44 offen lds
  v_mfma_f32_32x32x16_bf16 v[160:175], v[40:43], v[16:19], v[160:175]
  v_mfma_f32_32x32x16_bf16 v[176:191], v[44:47], v[16:19], v[176:191]
  s_add_u32 s44, s30, s47
  s_add_u32 m0, s50, 115712
  buffer_load_dwordx4 v3, s[12:15], s44 offen lds
  v_mfma_f32_32x32x16_bf16 v[192:207], v[32:35], v[20:23], v[192:207]
  v_mfma_f32_32x32x16_bf16 v[208:223], v[36:39], v[20:23], v[208:223]
  s_add_u32 s44, s30, s48
  s_add_u32 m0, s50, 116736
  buffer_load_dwordx4 v2, s[12:15], s44 offen lds
  v_mfma_f32_32x32x16_bf16 v[224:239], v[40:43], v[20:23], v[224:239]
  v_mfma_f32_32x32x16_bf16 v[240:255], v[44:47], v[20:23], v[240:255]
  s_add_u32 s44, s30, s49
  s_add_u32 m0, s50, 117760
  buffer_load_dwordx4 v3, s[12:15], s44 offen lds
  ds_read_b128 v[16:19], v8 offset:32768
  ds_read_b128 v[20:23], v8 offset:36864
  ds_read_b64_tr_b16 v[32:33], v64 offset:16384
  ds_read_b64_tr_b16 v[34:35], v64 offset:18432
  ds_read_b64_tr_b16 v[36:37], v65 offset:16384
  ds_read_b64_tr_b16 v[38:39], v65 offset:18432
  ds_read_b64_tr_b16 v[40:41], v66 offset:16384
  ds_read_b64_tr_b16 v[42:43], v66 offset:18432
  ds_read_b64_tr_b16 v[44:45], v67 offset:16384
  ds_read_b64_tr_b16 v[46:47], v67 offset:18432
  s_waitcnt lgkmcnt(10)
  v_mfma_f32_32x32x16_bf16 v[128:143], v[48:51], v[24:27], v[128:143]
  v_mfma_f32_32x32x16_bf16 v[144:159], v[52:55], v[24:27], v[144:159]
  s_add_u32 s44, s31, s52
  s_add_u32 m0, s51, 32768
  buffer_load_dwordx4 v4, s[16:19], s44 offen lds
  v_mfma_f32_32x32x16_bf16 v[160:175], v[56:59], v[24:27], v[160:175]
  v_mfma_f32_32x32x16_bf16 v[176:191], v[60:63], v[24:27], v[176:191]
  s_add_u32 s44, s31, s53
  s_add_u32 m0, s51, 33792
  buffer_load_dwordx4 v5, s[16:19], s44 offen lds
  v_mfma_f32_32x32x16_bf16 v[192:207], v[48:51], v[28:31], v[192:207]
  v_mfma_f32_32x32x16_bf16 v[208:223], v[52:55], v[28:31], v[208:223]
  s_add_u32 s44, s31, s54
  s_add_u32 m0, s51, 34816
  buffer_load_dwordx4 v4, s[16:19], s44 offen lds
  v_mfma_f32_32x32x16_bf16 v[224:239], v[56:59], v[28:31], v[224:239]
  v_mfma_f32_32x32x16_bf16 v[240:255], v[60:63], v[28:31], v[240:255]
  s_add_u32 s44, s31, s55
  s_add_u32 m0, s51, 35840
  buffer_load_dwordx4 v5, s[16:19], s44 offen lds
  ds_read_b128 v[24:27], v9 offset:32768
  ds_read_b128 v[28:31], v9 offset:36864
  ds_read_b64_tr_b16 v[48:49], v64 offset:24576
  ds_read_b64_tr_b16 v[50:51], v64 offset:26624
  ds_read_b64_tr_b16 v[52:53], v65 offset:24576
  ds_read_b64_tr_b16 v[54:55], v65 offset:26624
  ds_read_b64_tr_b16 v[56:57], v66 offset:24576
  ds_read_b64_tr_b16 v[58:59], v66 offset:26624
  ds_read_b64_tr_b16 v[60:61], v67 offset:24576
  ds_read_b64_tr_b16 v[62:63], v67 offset:26624
  s_waitcnt lgkmcnt(10)
  v_mfma_f32_32x32x16_bf16 v[128:143], v[32:35], v[16:19], v[128:143]
  v_mfma_f32_32x32x16_bf16 v[144:159], v[36:39], v[16:19], v[144:159]
  s_add_u32 s44, s31, s56
  s_add_u32 m0, s51, 36864
  buffer_load_dwordx4 v4, s[16:19], s44 offen lds
  v_mfma_f32_32x32x16_bf16 v[160:175], v[40:43], v[16:19], v[160:175]
  v_mfma_f32_32x32x16_bf16 v[176:191], v[44:47], v[16:19], v[176:191]
  s_add_u32 s44, s31, s57
  s_add_u32 m0, s51, 37888
  buffer_load_dwordx4 v5, s[16:19], s44 offen lds
  v_mfma_f32_32x32x16_bf16 v[192:207], v[32:35], v[20:23], v[192:207]
  v_mfma_f32_32x32x16_bf16 v[208:223], v[36:39], v[20:23], v[208:223]
  s_add_u32 s44, s31, s58
  s_add_u32 m0, s51, 38912
  buffer_load_dwordx4 v4, s[16:19], s44 offen lds
  v_mfma_f32_32x32x16_bf16 v[224:239], v[40:43], v[20:23], v[224:239]
  v_mfma_f32_32x32x16_bf16 v[240:255], v[44:47], v[20:23], v[240:255]
  s_add_u32 s44, s31, s59
  s_add_u32 m0, s51, 39936
  buffer_load_dwordx4 v5, s[16:19], s44 offen lds
  s_waitcnt lgkmcnt(0)
  v_mfma_f32_32x32x16_bf16 v[128:143], v[48:51], v[24:27], v[128:143]
  v_mfma_f32_32x32x16_bf16 v[144:159], v[52:55], v[24:27], v[144:159]
  s_add_u32 s30, s30, 128
  s_add_u32 s31, s31, 524288
  v_mfma_f32_32x32x16_bf16 v[160:175], v[56:59], v[24:27], v[160:175]
  v_mfma_f32_32x32x16_bf16 v[176:191], v[60:63], v[24:27], v[176:191]
  v_mfma_f32_32x32x16_bf16 v[192:207], v[48:51], v[28:31], v[192:207]
  v_mfma_f32_32x32x16_bf16 v[208:223], v[52:55], v[28:31], v[208:223]
  v_mfma_f32_32x32x16_bf16 v[224:239], v[56:59], v[28:31], v[224:239]
  v_mfma_f32_32x32x16_bf16 v[240:255], v[60:63], v[28:31], v[240:255]
  s_waitcnt vmcnt(12)
  s_barrier
  ds_read_b128 v[16:19], v6 offset:0
  ds_read_b128 v[20:23], v6 offset:4096
  ds_read_b64_tr_b16 v[32:33], v10 offset:0
  ds_read_b64_tr_b16 v[34:35], v10 offset:2048
  ds_read_b64_tr_b16 v[36:37], v11 offset:0
  ds_read_b64_tr_b16 v[38:39], v11 offset:2048
  ds_read_b64_tr_b16 v[40:41], v12 offset:0
  ds_read_b64_tr_b16 v[42:43], v12 offset:2048
  ds_read_b64_tr_b16 v[44:45], v13 offset:0
  ds_read_b64_tr_b16 v[46:47], v13 offset:2048
  ds_read_b128 v[24:27], v7 offset:0
  ds_read_b128 v[28:31], v7 offset:4096
  ds_read_b64_tr_b16 v[48:49], v10 offset:8192
  ds_read_b64_tr_b16 v[50:51], v10 offset:10240
  ds_read_b64_tr_b16 v[52:53], v11 offset:8192
  ds_read_b64_tr_b16 v[54:55], v11 offset:10240
  ds_read_b64_tr_b16 v[56:57], v12 offset:8192
  ds_read_b64_tr_b16 v[58:59], v12 offset:10240
  ds_read_b64_tr_b16 v[60:61], v13 offset:8192
  ds_read_b64_tr_b16 v[62:63], v13 offset:10240
  s_waitcnt lgkmcnt(10)
  v_mfma_f32_32x32x16_bf16 v[128:143], v[32:35], v[16:19], v[128:143]
  v_mfma_f32_32x32x16_bf16 v[144:159], v[36:39], v[16:19], v[144:159]
  s_add_u32 s44, s30, s46
  s_add_u32 m0, s50, 131072
  buffer_load_dwordx4 v2, s[12:15], s44 offen lds
  v_mfma_f32_32x32x16_bf16 v[160:175], v[40:43], v[16:19], v[160:175]
  v_mfma_f32_32x32x16_bf16 v[176:191], v[44:47], v[16:19], v[176:191]
  s_add_u32 s44, s30, s47
  s_add_u32 m0, s50, 132096
  buffer_load_dwordx4 v3, s[12:15], s44 offen lds
  v_mfma_f32_32x32x16_bf16 v[192:207], v[32:35], v[20:23], v[192:207]
  v_mfma_f32_32x32x16_bf16 v[208:223], v[36:39], v[20:23], v[208:223]
  s_add_u32 s44, s30, s48
  s_add_u32 m0, s50, 133120
  buffer_load_dwordx4 v2, s[12:15], s44 offen lds
  v_mfma_f32_32x32x16_bf16 v[224:239], v[40:43], v[20:23], v[224:239]
  v_mfma_f32_32x32x16_bf16 v[240:255], v[44:47], v[20:23], v[240:255]
  s_add_u32 s44, s30, s49
  s_add_u32 m0, s50, 134144
  buffer_load_dwordx4 v3, s[12:15], s44 offen lds
  ds_read_b128 v[16:19], v8 offset:0
  ds_read_b128 v[20:23], v8 offset:4096
  ds_read_b64_tr_b16 v[32:33], v10 offset:16384
  ds_read_b64_tr_b16 v[34:35], v10 offset:18432
  ds_read_b64_tr_b16 v[36:37], v11 offset:16384
  ds_read_b64_tr_b16 v[38:39], v11 offset:18432
  ds_read_b64_tr_b16 v[40:41], v12 offset:16384
  ds_read_b64_tr_b16 v[42:43], v12 offset:18432
  ds_read_b64_tr_b16 v[44:45], v13 offset:16384
  ds_read_b64_tr_b16 v[46:47], v13 offset:18432
  s_waitcnt lgkmcnt(10)
  v_mfma_f32_32x32x16_bf16 v[128:143], v[48:51], v[24:27], v[128:143]
  v_mfma_f32_32x32x16_bf16 v[144:159], v[52:55], v[24:27], v[144:159]
  s_add_u32 s44, s31, s52
  s_add_u32 m0, s51, 65536
  buffer_load_dwordx4 v4, s[16:19], s44 offen lds
  v_mfma_f32_32x32x16_bf16 v[160:175], v[56:59], v[24:27], v[160:175]
  v_mfma_f32_32x32x16_bf16 v[176:191], v[60:63], v[24:27], v[176:191]
  s_add_u32 s44, s31, s53
  s_add_u32 m0, s51, 66560
  buffer_load_dwordx4 v5, s[16:19], s44 offen lds
  v_mfma_f32_32x32x16_bf16 v[192:207], v[48:51], v[28:31], v[192:207]
  v_mfma_f32_32x32x16_bf16 v[208:223], v[52:55], v[28:31], v[208:223]
  s_add_u32 s44, s31, s54
  s_add_u32 m0, s51, 67584
  buffer_load_dwordx4 v4, s[16:19], s44 offen lds
  v_mfma_f32_32x32x16_bf16 v[224:239], v[56:59], v[28:31], v[224:239]
  v_mfma_f32_32x32x16_bf16 v[240:255], v[60:63], v[28:31], v[240:255]
  s_add_u32 s44, s31, s55
  s_add_u32 m0, s51, 68608
  buffer_load_dwordx4 v5, s[16:19], s44 offen lds
  ds_read_b128 v[24:27], v9 offset:0
  ds_read_b128 v[28:31], v9 offset:4096
  ds_read_b64_tr_b16 v[48:49], v10 offset:24576
  ds_read_b64_tr_b16 v[50:51], v10 offset:26624
  ds_read_b64_tr_b16 v[52:53], v11 offset:24576
  ds_read_b64_tr_b16 v[54:55], v11 offset:26624
  ds_read_b64_tr_b16 v[56:57], v12 offset:24576
  ds_read_b64_tr_b16 v[58:59], v12 offset:26624
  ds_read_b64_tr_b16 v[60:61], v13 offset:24576
  ds_read_b64_tr_b16 v[62:63], v13 offset:26624
  s_waitcnt lgkmcnt(10)
  v_mfma_f32_32x32x16_bf16 v[128:143], v[32:35], v[16:19], v[128:143]
  v_mfma_f32_32x32x16_bf16 v[144:159], v[36:39], v[16:19], v[144:159]
  s_add_u32 s44, s31, s56
  s_add_u32 m0, s51, 69632
  buffer_load_dwordx4 v4, s[16:19], s44 offen lds
  v_mfma_f32_32x32x16_bf16 v[160:175], v[40:43], v[16:19], v[160:175]
  v_mfma_f32_32x32x16_bf16 v[176:191], v[44:47], v[16:19], v[176:191]
  s_add_u32 s44, s31, s57
  s_add_u32 m0, s51, 70656
  buffer_load_dwordx4 v5, s[16:19], s44 offen lds
  v_mfma_f32_32x32x16_bf16 v[192:207], v[32:35], v[20:23], v[192:207]
  v_mfma_f32_32x32x16_bf16 v[208:223], v[36:39], v[20:23], v[208:223]
  s_add_u32 s44, s31, s58
  s_add_u32 m0, s51, 71680
  buffer_load_dwordx4 v4, s[16:19], s44 offen lds
  v_mfma_f32_32x32x16_bf16 v[224:239], v[40:43], v[20:23], v[224:239]
  v_mfma_f32_32x32x16_bf16 v[240:255], v[44:47], v[20:23], v[240:255]
  s_add_u32 s44, s31, s59
  s_add_u32 m0, s51, 72704
  buffer_load_dwordx4 v5, s[16:19], s44 offen lds
  s_waitcnt lgkmcnt(0)
  v_mfma_f32_32x32x16_bf16 v[128:143], v[48:51], v[24:27], v[128:143]
  v_mfma_f32_32x32x16_bf16 v[144:159], v[52:55], v[24:27], v[144:159]
  s_add_u32 s30, s30, 128
  s_add_u32 s31, s31, 524288
  v_mfma_f32_32x32x16_bf16 v[160:175], v[56:59], v[24:27], v[160:175]
  v_mfma_f32_32x32x16_bf16 v[176:191], v[60:63], v[24:27], v[176:191]
  v_mfma_f32_32x32x16_bf16 v[192:207], v[48:51], v[28:31], v[192:207]
  v_mfma_f32_32x32x16_bf16 v[208:223], v[52:55], v[28:31], v[208:223]
  v_mfma_f32_32x32x16_bf16 v[224:239], v[56:59], v[28:31], v[224:239]
  v_mfma_f32_32x32x16_bf16 v[240:255], v[60:63], v[28:31], v[240:255]
  s_waitcnt vmcnt(12)
  s_barrier
  ds_read_b128 v[16:19], v6 offset:16384
  ds_read_b128 v[20:23], v6 offset:20480
  ds_read_b64_tr_b16 v[32:33], v10 offset:32768
  ds_read_b64_tr_b16 v[34:35], v10 offset:34816
  ds_read_b64_tr_b16 v[36:37], v11 offset:32768
  ds_read_b64_tr_b16 v[38:39], v11 offset:34816
  ds_read_b64_tr_b16 v[40:41], v12 offset:32768
  ds_read_b64_tr_b16 v[42:43], v12 offset:34816
  ds_read_b64_tr_b16 v[44:45], v13 offset:32768
  ds_read_b64_tr_b16 v[46:47], v13 offset:34816
  ds_read_b128 v[24:27], v7 offset:16384
  ds_read_b128 v[28:31], v7 offset:20480
  ds_read_b64_tr_b16 v[48:49], v10 offset:40960
  ds_read_b64_tr_b16 v[50:51], v10 offset:43008
  ds_read_b64_tr_b16 v[52:53], v11 offset:40960
  ds_read_b64_tr_b16 v[54:55], v11 offset:43008
  ds_read_b64_tr_b16 v[56:57], v12 offset:40960
  ds_read_b64_tr_b16 v[58:59], v12 offset:43008
  ds_read_b64_tr_b16 v[60:61], v13 offset:40960
  ds_read_b64_tr_b16 v[62:63], v13 offset:43008
  s_waitcnt lgkmcnt(10)
  v_mfma_f32_32x32x16_bf16 v[128:143], v[32:35], v[16:19], v[128:143]
  v_mfma_f32_32x32x16_bf16 v[144:159], v[36:39], v[16:19], v[144:159]
  s_add_u32 s44, s30, s46
  s_add_u32 m0, s50, 98304
  buffer_load_dwordx4 v2, s[12:15], s44 offen lds
  v_mfma_f32_32x32x16_bf16 v[160:175], v[40:43], v[16:19], v[160:175]
  v_mfma_f32_32x32x16_bf16 v[176:191], v[44:47], v[16:19], v[176:191]
  s_add_u32 s44, s30, s47
  s_add_u32 m0, s50, 99328
  buffer_load_dwordx4 v3, s[12:15], s44 offen lds
  v_mfma_f32_32x32x16_bf16 v[192:207], v[32:35], v[20:23], v[192:207]
  v_mfma_f32_32x32x16_bf16 v[208:223], v[36:39], v[20:23], v[208:223]
  s_add_u32 s44, s30, s48
  s_add_u32 m0, s50, 100352
  buffer_load_dwordx4 v2, s[12:15], s44 offen lds
  v_mfma_f32_32x32x16_bf16 v[224:239], v[40:43], v[20:23], v[224:239]
  v_mfma_f32_32x32x16_bf16 v[240:255], v[44:47], v[20:23], v[240:255]
  s_add_u32 s44, s30, s49
  s_add_u32 m0, s50, 101376
  buffer_load_dwordx4 v3, s[12:15], s44 offen lds
  ds_read_b128 v[16:19], v8 offset:16384
  ds_read_b128 v[20:23], v8 offset:20480
  ds_read_b64_tr_b16 v[32:33], v10 offset:49152
  ds_read_b64_tr_b16 v[34:35], v10 offset:51200
  ds_read_b64_tr_b16 v[36:37], v11 offset:49152
  ds_read_b64_tr_b16 v[38:39], v11 offset:51200
  ds_read_b64_tr_b16 v[40:41], v12 offset:49152
  ds_read_b64_tr_b16 v[42:43], v12 offset:51200
  ds_read_b64_tr_b16 v[44:45], v13 offset:49152
  ds_read_b64_tr_b16 v[46:47], v13 offset:51200
  s_waitcnt lgkmcnt(10)
  v_mfma_f32_32x32x16_bf16 v[128:143], v[48:51], v[24:27], v[128:143]
  v_mfma_f32_32x32x16_bf16 v[144:159], v[52:55], v[24:27], v[144:159]
  s_add_u32 s44, s31, s52
  s_add_u32 m0, s51, 0
  buffer_load_dwordx4 v4, s[16:19], s44 offen lds
  v_mfma_f32_32x32x16_bf16 v[160:175], v[56:59], v[24:27], v[160:175]
  v_mfma_f32_32x32x16_bf16 v[176:191], v[60:63], v[24:27], v[176:191]
  s_add_u32 s44, s31, s53
  s_add_u32 m0, s51, 1024
  buffer_load_dwordx4 v5, s[16:19], s44 offen lds
  v_mfma_f32_32x32x16_bf16 v[192:207], v[48:51], v[28:31], v[192:207]
  v_mfma_f32_32x32x16_bf16 v[208:223], v[52:55], v[28:31], v[208:223]
  s_add_u32 s44, s31, s54
  s_add_u32 m0, s51, 2048
  buffer_load_dwordx4 v4, s[16:19], s44 offen lds
  v_mfma_f32_32x32x16_bf16 v[224:239], v[56:59], v[28:31], v[224:239]
  v_mfma_f32_32x32x16_bf16 v[240:255], v[60:63], v[28:31], v[240:255]
  s_add_u32 s44, s31, s55
  s_add_u32 m0, s51, 3072
  buffer_load_dwordx4 v5, s[16:19], s44 offen lds
  ds_read_b128 v[24:27], v9 offset:16384
  ds_read_b128 v[28:31], v9 offset:20480
  ds_read_b64_tr_b16 v[48:49], v10 offset:57344
  ds_read_b64_tr_b16 v[50:51], v10 offset:59392
  ds_read_b64_tr_b16 v[52:53], v11 offset:57344
  ds_read_b64_tr_b16 v[54:55], v11 offset:59392
  ds_read_b64_tr_b16 v[56:57], v12 offset:57344
  ds_read_b64_tr_b16 v[58:59], v12 offset:59392
  ds_read_b64_tr_b16 v[60:61], v13 offset:57344
  ds_read_b64_tr_b16 v[62:63], v13 offset:59392
  s_waitcnt lgkmcnt(10)
  v_mfma_f32_32x32x16_bf16 v[128:143], v[32:35], v[16:19], v[128:143]
  v_mfma_f32_32x32x16_bf16 v[144:159], v[36:39], v[16:19], v[144:159]
  s_add_u32 s44, s31, s56
  s_add_u32 m0, s51, 4096
  buffer_load_dwordx4 v4, s[16:19], s44 offen lds
  v_mfma_f32_32x32x16_bf16 v[160:175], v[40:43], v[16:19], v[160:175]
  v_mfma_f32_32x32x16_bf16 v[176:191], v[44:47], v[16:19], v[176:191]
  s_add_u32 s44, s31, s57
  s_add_u32 m0, s51, 5120
  buffer_load_dwordx4 v5, s[16:19], s44 offen lds
  v_mfma_f32_32x32x16_bf16 v[192:207], v[32:35], v[20:23], v[192:207]
  v_mfma_f32_32x32x16_bf16 v[208:223], v[36:39], v[20:23], v[208:223]
  s_add_u32 s44, s31, s58
  s_add_u32 m0, s51, 6144
  buffer_load_dwordx4 v4, s[16:19], s44 offen lds
  v_mfma_f32_32x32x16_bf16 v[224:239], v[40:43], v[20:23], v[224:239]
  v_mfma_f32_32x32x16_bf16 v[240:255], v[44:47], v[20:23], v[240:255]
  s_add_u32 s44, s31, s59
  s_add_u32 m0, s51, 7168
  buffer_load_dwordx4 v5, s[16:19], s44 offen lds
  s_waitcnt lgkmcnt(0)
  v_mfma_f32_32x32x16_bf16 v[128:143], v[48:51], v[24:27], v[128:143]
  v_mfma_f32_32x32x16_bf16 v[144:159], v[52:55], v[24:27], v[144:159]
  s_add_u32 s30, s30, 128
  s_add_u32 s31, s31, 524288
  v_mfma_f32_32x32x16_bf16 v[160:175], v[56:59], v[24:27], v[160:175]
  v_mfma_f32_32x32x16_bf16 v[176:191], v[60:63], v[24:27], v[176:191]
  v_mfma_f32_32x32x16_bf16 v[192:207], v[48:51], v[28:31], v[192:207]
  v_mfma_f32_32x32x16_bf16 v[208:223], v[52:55], v[28:31], v[208:223]
  v_mfma_f32_32x32x16_bf16 v[224:239], v[56:59], v[28:31], v[224:239]
  v_mfma_f32_32x32x16_bf16 v[240:255], v[60:63], v[28:31], v[240:255]
  s_waitcnt vmcnt(12)
  s_barrier
  ds_read_b128 v[16:19], v6 offset:32768
  ds_read_b128 v[20:23], v6 offset:36864
  ds_read_b64_tr_b16 v[32:33], v64 offset:0
  ds_read_b64_tr_b16 v[34:35], v64 offset:2048
  ds_read_b64_tr_b16 v[36:37], v65 offset:0
  ds_read_b64_tr_b16 v[38:39], v65 offset:2048
  ds_read_b64_tr_b16 v[40:41], v66 offset:0
  ds_read_b64_tr_b16 v[42:43], v66 offset:2048
  ds_read_b64_tr_b16 v[44:45], v67 offset:0
  ds_read_b64_tr_b16 v[46:47], v67 offset:2048
  ds_read_b128 v[24:27], v7 offset:32768
  ds_read_b128 v[28:31], v7 offset:36864
  ds_read_b64_tr_b16 v[48:49], v64 offset:8192
  ds_read_b64_tr_b16 v[50:51], v64 offset:10240
  ds_read_b64_tr_b16 v[52:53], v65 offset:8192
  ds_read_b64_tr_b16 v[54:55], v65 offset:10240
  ds_read_b64_tr_b16 v[56:57], v66 offset:8192
  ds_read_b64_tr_b16 v[58:59], v66 offset:10240
  ds_read_b64_tr_b16 v[60:61], v67 offset:8192
  ds_read_b64_tr_b16 v[62:63], v67 offset:10240
  s_waitcnt lgkmcnt(10)
  v_mfma_f32_32x32x16_bf16 v[128:143], v[32:35], v[16:19], v[128:143]
  v_mfma_f32_32x32x16_bf16 v[144:159], v[36:39], v[16:19], v[144:159]
  s_add_u32 s44, s30, s46
  s_add_u32 m0, s50, 114688
  buffer_load_dwordx4 v2, s[12:15], s44 offen lds
  v_mfma_f32_32x32x16_bf16 v[160:175], v[40:43], v[16:19], v[160:175]
  v_mfma_f32_32x32x16_bf16 v[176:191], v[44:47], v[16:19], v[176:191]
  s_add_u32 s44, s30, s47
  s_add_u32 m0, s50, 115712
  buffer_load_dwordx4 v3, s[12:15], s44 offen lds
  v_mfma_f32_32x32x16_bf16 v[192:207], v[32:35], v[20:23], v[192:207]
  v_mfma_f32_32x32x16_bf16 v[208:223], v[36:39], v[20:23], v[208:223]
  s_add_u32 s44, s30, s48
  s_add_u32 m0, s50, 116736
  buffer_load_dwordx4 v2, s[12:15], s44 offen lds
  v_mfma_f32_32x32x16_bf16 v[224:239], v[40:43], v[20:23], v[224:239]
  v_mfma_f32_32x32x16_bf16 v[240:255], v[44:47], v[20:23], v[240:255]
  s_add_u32 s44, s30, s49
  s_add_u32 m0, s50, 117760
  buffer_load_dwordx4 v3, s[12:15], s44 offen lds
  ds_read_b128 v[16:19], v8 offset:32768
  ds_read_b128 v[20:23], v8 offset:36864
  ds_read_b64_tr_b16 v[32:33], v64 offset:16384
  ds_read_b64_tr_b16 v[34:35], v64 offset:18432
  ds_read_b64_tr_b16 v[36:37], v65 offset:16384
  ds_read_b64_tr_b16 v[38:39], v65 offset:18432
  ds_read_b64_tr_b16 v[40:41], v66 offset:16384
  ds_read_b64_tr_b16 v[42:43], v66 offset:18432
  ds_read_b64_tr_b16 v[44:45], v67 offset:16384
  ds_read_b64_tr_b16 v[46:47], v67 offset:18432
  s_waitcnt lgkmcnt(10)
  v_mfma_f32_32x32x16_bf16 v[128:143], v[48:51], v[24:27], v[128:143]
  v_mfma_f32_32x32x16_bf16 v[144:159], v[52:55], v[24:27], v[144:159]
  s_add_u32 s44, s31, s52
  s_add_u32 m0, s51, 32768
  buffer_load_dwordx4 v4, s[16:19], s44 offen lds
  v_mfma_f32_32x32x16_bf16 v[160:175], v[56:59], v[24:27], v[160:175]
  v_mfma_f32_32x32x16_bf16 v[176:191], v[60:63], v[24:27], v[176:191]
  s_add_u32 s44, s31, s53
  s_add_u32 m0, s51, 33792
  buffer_load_dwordx4 v5, s[16:19], s44 offen lds
  v_mfma_f32_32x32x16_bf16 v[192:207], v[48:51], v[28:31], v[192:207]
  v_mfma_f32_32x32x16_bf16 v[208:223], v[52:55], v[28:31], v[208:223]
  s_add_u32 s44, s31, s54
  s_add_u32 m0, s51, 34816
  buffer_load_dwordx4 v4, s[16:19], s44 offen lds
  v_mfma_f32_32x32x16_bf16 v[224:239], v[56:59], v[28:31], v[224:239]
  v_mfma_f32_32x32x16_bf16 v[240:255], v[60:63], v[28:31], v[240:255]
  s_add_u32 s44, s31, s55
  s_add_u32 m0, s51, 35840
  buffer_load_dwordx4 v5, s[16:19], s44 offen lds
  ds_read_b128 v[24:27], v9 offset:32768
  ds_read_b128 v[28:31], v9 offset:36864
  ds_read_b64_tr_b16 v[48:49], v64 offset:24576
  ds_read_b64_tr_b16 v[50:51], v64 offset:26624
  ds_read_b64_tr_b16 v[52:53], v65 offset:24576
  ds_read_b64_tr_b16 v[54:55], v65 offset:26624
  ds_read_b64_tr_b16 v[56:57], v66 offset:24576
  ds_read_b64_tr_b16 v[58:59], v66 offset:26624
  ds_read_b64_tr_b16 v[60:61], v67 offset:24576
  ds_read_b64_tr_b16 v[62:63], v67 offset:26624
  s_waitcnt lgkmcnt(10)
  v_mfma_f32_32x32x16_bf16 v[128:143], v[32:35], v[16:19], v[128:143]
  v_mfma_f32_32x32x16_bf16 v[144:159], v[36:39], v[16:19], v[144:159]
  s_add_u32 s44, s31, s56
  s_add_u32 m0, s51, 36864
  buffer_load_dwordx4 v4, s[16:19], s44 offen lds
  v_mfma_f32_32x32x16_bf16 v[160:175], v[40:43], v[16:19], v[160:175]
  v_mfma_f32_32x32x16_bf16 v[176:191], v[44:47], v[16:19], v[176:191]
  s_add_u32 s44, s31, s57
  s_add_u32 m0, s51, 37888
  buffer_load_dwordx4 v5, s[16:19], s44 offen lds
  v_mfma_f32_32x32x16_bf16 v[192:207], v[32:35], v[20:23], v[192:207]
  v_mfma_f32_32x32x16_bf16 v[208:223], v[36:39], v[20:23], v[208:223]
  s_add_u32 s44, s31, s58
  s_add_u32 m0, s51, 38912
  buffer_load_dwordx4 v4, s[16:19], s44 offen lds
  v_mfma_f32_32x32x16_bf16 v[224:239], v[40:43], v[20:23], v[224:239]
  v_mfma_f32_32x32x16_bf16 v[240:255], v[44:47], v[20:23], v[240:255]
  s_add_u32 s44, s31, s59
  s_add_u32 m0, s51, 39936
  buffer_load_dwordx4 v5, s[16:19], s44 offen lds
  s_waitcnt lgkmcnt(0)
  v_mfma_f32_32x32x16_bf16 v[128:143], v[48:51], v[24:27], v[128:143]
  v_mfma_f32_32x32x16_bf16 v[144:159], v[52:55], v[24:27], v[144:159]
  s_add_u32 s30, s30, 128
  s_add_u32 s31, s31, 524288
  v_mfma_f32_32x32x16_bf16 v[160:175], v[56:59], v[24:27], v[160:175]
  v_mfma_f32_32x32x16_bf16 v[176:191], v[60:63], v[24:27], v[176:191]
  v_mfma_f32_32x32x16_bf16 v[192:207], v[48:51], v[28:31], v[192:207]
  v_mfma_f32_32x32x16_bf16 v[208:223], v[52:55], v[28:31], v[208:223]
  v_mfma_f32_32x32x16_bf16 v[224:239], v[56:59], v[28:31], v[224:239]
  v_mfma_f32_32x32x16_bf16 v[240:255], v[60:63], v[28:31], v[240:255]
  s_waitcnt vmcnt(12)
  s_barrier
  ds_read_b128 v[16:19], v6 offset:0
  ds_read_b128 v[20:23], v6 offset:4096
  ds_read_b64_tr_b16 v[32:33], v10 offset:0
  ds_read_b64_tr_b16 v[34:35], v10 offset:2048
  ds_read_b64_tr_b16 v[36:37], v11 offset:0
  ds_read_b64_tr_b16 v[38:39], v11 offset:2048
  ds_read_b64_tr_b16 v[40:41], v12 offset:0
  ds_read_b64_tr_b16 v[42:43], v12 offset:2048
  ds_read_b64_tr_b16 v[44:45], v13 offset:0
  ds_read_b64_tr_b16 v[46:47], v13 offset:2048
  ds_read_b128 v[24:27], v7 offset:0
  ds_read_b128 v[28:31], v7 offset:4096
  ds_read_b64_tr_b16 v[48:49], v10 offset:8192
  ds_read_b64_tr_b16 v[50:51], v10 offset:10240
  ds_read_b64_tr_b16 v[52:53], v11 offset:8192
  ds_read_b64_tr_b16 v[54:55], v11 offset:10240
  ds_read_b64_tr_b16 v[56:57], v12 offset:8192
  ds_read_b64_tr_b16 v[58:59], v12 offset:10240
  ds_read_b64_tr_b16 v[60:61], v13 offset:8192
  ds_read_b64_tr_b16 v[62:63], v13 offset:10240
  s_waitcnt lgkmcnt(10)
  v_mfma_f32_32x32x16_bf16 v[128:143], v[32:35], v[16:19], v[128:143]
  v_mfma_f32_32x32x16_bf16 v[144:159], v[36:39], v[16:19], v[144:159]
  s_add_u32 s44, s30, s46
  s_add_u32 m0, s50, 131072
  buffer_load_dwordx4 v2, s[12:15], s44 offen lds
  v_mfma_f32_32x32x16_bf16 v[160:175], v[40:43], v[16:19], v[160:175]
  v_mfma_f32_32x32x16_bf16 v[176:191], v[44:47], v[16:19], v[176:191]
  s_add_u32 s44, s30, s47
  s_add_u32 m0, s50, 132096
  buffer_load_dwordx4 v3, s[12:15], s44 offen lds
  v_mfma_f32_32x32x16_bf16 v[192:207], v[32:35], v[20:23], v[192:207]
  v_mfma_f32_32x32x16_bf16 v[208:223], v[36:39], v[20:23], v[208:223]
  s_add_u32 s44, s30, s48
  s_add_u32 m0, s50, 133120
  buffer_load_dwordx4 v2, s[12:15], s44 offen lds
  v_mfma_f32_32x32x16_bf16 v[224:239], v[40:43], v[20:23], v[224:239]
  v_mfma_f32_32x32x16_bf16 v[240:255], v[44:47], v[20:23], v[240:255]
  s_add_u32 s44, s30, s49
  s_add_u32 m0, s50, 134144
  buffer_load_dwordx4 v3, s[12:15], s44 offen lds
  ds_read_b128 v[16:19], v8 offset:0
  ds_read_b128 v[20:23], v8 offset:4096
  ds_read_b64_tr_b16 v[32:33], v10 offset:16384
  ds_read_b64_tr_b16 v[34:35], v10 offset:18432
  ds_read_b64_tr_b16 v[36:37], v11 offset:16384
  ds_read_b64_tr_b16 v[38:39], v11 offset:18432
  ds_read_b64_tr_b16 v[40:41], v12 offset:16384
  ds_read_b64_tr_b16 v[42:43], v12 offset:18432
  ds_read_b64_tr_b16 v[44:45], v13 offset:16384
  ds_read_b64_tr_b16 v[46:47], v13 offset:18432
  s_waitcnt lgkmcnt(10)
  v_mfma_f32_32x32x16_bf16 v[128:143], v[48:51], v[24:27], v[128:143]
  v_mfma_f32_32x32x16_bf16 v[144:159], v[52:55], v[24:27], v[144:159]
  s_add_u32 s44, s31, s52
  s_add_u32 m0, s51, 65536
  buffer_load_dwordx4 v4, s[16:19], s44 offen lds
  v_mfma_f32_32x32x16_bf16 v[160:175], v[56:59], v[24:27], v[160:175]
  v_mfma_f32_32x32x16_bf16 v[176:191], v[60:63], v[24:27], v[176:191]
  s_add_u32 s44, s31, s53
  s_add_u32 m0, s51, 66560
  buffer_load_dwordx4 v5, s[16:19], s44 offen lds
  v_mfma_f32_32x32x16_bf16 v[192:207], v[48:51], v[28:31], v[192:207]
  v_mfma_f32_32x32x16_bf16 v[208:223], v[52:55], v[28:31], v[208:223]
  s_add_u32 s44, s31, s54
  s_add_u32 m0, s51, 67584
  buffer_load_dwordx4 v4, s[16:19], s44 offen lds
  v_mfma_f32_32x32x16_bf16 v[224:239], v[56:59], v[28:31], v[224:239]
  v_mfma_f32_32x32x16_bf16 v[240:255], v[60:63], v[28:31], v[240:255]
  s_add_u32 s44, s31, s55
  s_add_u32 m0, s51, 68608
  buffer_load_dwordx4 v5, s[16:19], s44 offen lds
  ds_read_b128 v[24:27], v9 offset:0
  ds_read_b128 v[28:31], v9 offset:4096
  ds_read_b64_tr_b16 v[48:49], v10 offset:24576
  ds_read_b64_tr_b16 v[50:51], v10 offset:26624
  ds_read_b64_tr_b16 v[52:53], v11 offset:24576
  ds_read_b64_tr_b16 v[54:55], v11 offset:26624
  ds_read_b64_tr_b16 v[56:57], v12 offset:24576
  ds_read_b64_tr_b16 v[58:59], v12 offset:26624
  ds_read_b64_tr_b16 v[60:61], v13 offset:24576
  ds_read_b64_tr_b16 v[62:63], v13 offset:26624
  s_waitcnt lgkmcnt(10)
  v_mfma_f32_32x32x16_bf16 v[128:143], v[32:35], v[16:19], v[128:143]
  v_mfma_f32_32x32x16_bf16 v[144:159], v[36:39], v[16:19], v[144:159]
  s_add_u32 s44, s31, s56
  s_add_u32 m0, s51, 69632
  buffer_load_dwordx4 v4, s[16:19], s44 offen lds
  v_mfma_f32_32x32x16_bf16 v[160:175], v[40:43], v[16:19], v[160:175]
  v_mfma_f32_32x32x16_bf16 v[176:191], v[44:47], v[16:19], v[176:191]
  s_add_u32 s44, s31, s57
  s_add_u32 m0, s51, 70656
  buffer_load_dwordx4 v5, s[16:19], s44 offen lds
  v_mfma_f32_32x32x16_bf16 v[192:207], v[32:35], v[20:23], v[192:207]
  v_mfma_f32_32x32x16_bf16 v[208:223], v[36:39], v[20:23], v[208:223]
  s_add_u32 s44, s31, s58
  s_add_u32 m0, s51, 71680
  buffer_load_dwordx4 v4, s[16:19], s44 offen lds
  v_mfma_f32_32x32x16_bf16 v[224:239], v[40:43], v[20:23], v[224:239]
  v_mfma_f32_32x32x16_bf16 v[240:255], v[44:47], v[20:23], v[240:255]
  s_add_u32 s44, s31, s59
  s_add_u32 m0, s51, 72704
  buffer_load_dwordx4 v5, s[16:19], s44 offen lds
  s_waitcnt lgkmcnt(0)
  v_mfma_f32_32x32x16_bf16 v[128:143], v[48:51], v[24:27], v[128:143]
  v_mfma_f32_32x32x16_bf16 v[144:159], v[52:55], v[24:27], v[144:159]
  s_add_u32 s30, s30, 128
  s_add_u32 s31, s31, 524288
  v_mfma_f32_32x32x16_bf16 v[160:175], v[56:59], v[24:27], v[160:175]
  v_mfma_f32_32x32x16_bf16 v[176:191], v[60:63], v[24:27], v[176:191]
  v_mfma_f32_32x32x16_bf16 v[192:207], v[48:51], v[28:31], v[192:207]
  v_mfma_f32_32x32x16_bf16 v[208:223], v[52:55], v[28:31], v[208:223]
  v_mfma_f32_32x32x16_bf16 v[224:239], v[56:59], v[28:31], v[224:239]
  v_mfma_f32_32x32x16_bf16 v[240:255], v[60:63], v[28:31], v[240:255]
  s_waitcnt vmcnt(12)
  s_barrier
  ds_read_b128 v[16:19], v6 offset:16384
  ds_read_b128 v[20:23], v6 offset:20480
  ds_read_b64_tr_b16 v[32:33], v10 offset:32768
  ds_read_b64_tr_b16 v[34:35], v10 offset:34816
  ds_read_b64_tr_b16 v[36:37], v11 offset:32768
  ds_read_b64_tr_b16 v[38:39], v11 offset:34816
  ds_read_b64_tr_b16 v[40:41], v12 offset:32768
  ds_read_b64_tr_b16 v[42:43], v12 offset:34816
  ds_read_b64_tr_b16 v[44:45], v13 offset:32768
  ds_read_b64_tr_b16 v[46:47], v13 offset:34816
  ds_read_b128 v[24:27], v7 offset:16384
  ds_read_b128 v[28:31], v7 offset:20480
  ds_read_b64_tr_b16 v[48:49], v10 offset:40960
  ds_read_b64_tr_b16 v[50:51], v10 offset:43008
  ds_read_b64_tr_b16 v[52:53], v11 offset:40960
  ds_read_b64_tr_b16 v[54:55], v11 offset:43008
  ds_read_b64_tr_b16 v[56:57], v12 offset:40960
  ds_read_b64_tr_b16 v[58:59], v12 offset:43008
  ds_read_b64_tr_b16 v[60:61], v13 offset:40960
  ds_read_b64_tr_b16 v[62:63], v13 offset:43008
  s_waitcnt lgkmcnt(10)
  v_mfma_f32_32x32x16_bf16 v[128:143], v[32:35], v[16:19], v[128:143]
  v_mfma_f32_32x32x16_bf16 v[144:159], v[36:39], v[16:19], v[144:159]
  s_add_u32 s44, s30, s46
  s_add_u32 m0, s50, 98304
  buffer_load_dwordx4 v2, s[12:15], s44 offen lds
  v_mfma_f32_32x32x16_bf16 v[160:175], v[40:43], v[16:19], v[160:175]
  v_mfma_f32_32x32x16_bf16 v[176:191], v[44:47], v[16:19], v[176:191]
  s_add_u32 s44, s30, s47
  s_add_u32 m0, s50, 99328
  buffer_load_dwordx4 v3, s[12:15], s44 offen lds
  v_mfma_f32_32x32x16_bf16 v[192:207], v[32:35], v[20:23], v[192:207]
  v_mfma_f32_32x32x16_bf16 v[208:223], v[36:39], v[20:23], v[208:223]
  s_add_u32 s44, s30, s48
  s_add_u32 m0, s50, 100352
  buffer_load_dwordx4 v2, s[12:15], s44 offen lds
  v_mfma_f32_32x32x16_bf16 v[224:239], v[40:43], v[20:23], v[224:239]
  v_mfma_f32_32x32x16_bf16 v[240:255], v[44:47], v[20:23], v[240:255]
  s_add_u32 s44, s30, s49
  s_add_u32 m0, s50, 101376
  buffer_load_dwordx4 v3, s[12:15], s44 offen lds
  ds_read_b128 v[16:19], v8 offset:16384
  ds_read_b128 v[20:23], v8 offset:20480
  ds_read_b64_tr_b16 v[32:33], v10 offset:49152
  ds_read_b64_tr_b16 v[34:35], v10 offset:51200
  ds_read_b64_tr_b16 v[36:37], v11 offset:49152
  ds_read_b64_tr_b16 v[38:39], v11 offset:51200
  ds_read_b64_tr_b16 v[40:41], v12 offset:49152
  ds_read_b64_tr_b16 v[42:43], v12 offset:51200
  ds_read_b64_tr_b16 v[44:45], v13 offset:49152
  ds_read_b64_tr_b16 v[46:47], v13 offset:51200
  s_waitcnt lgkmcnt(10)
  v_mfma_f32_32x32x16_bf16 v[128:143], v[48:51], v[24:27], v[128:143]
  v_mfma_f32_32x32x16_bf16 v[144:159], v[52:55], v[24:27], v[144:159]
  s_add_u32 s44, s31, s52
  s_add_u32 m0, s51, 0
  buffer_load_dwordx4 v4, s[16:19], s44 offen lds
  v_mfma_f32_32x32x16_bf16 v[160:175], v[56:59], v[24:27], v[160:175]
  v_mfma_f32_32x32x16_bf16 v[176:191], v[60:63], v[24:27], v[176:191]
  s_add_u32 s44, s31, s53
  s_add_u32 m0, s51, 1024
  buffer_load_dwordx4 v5, s[16:19], s44 offen lds
  v_mfma_f32_32x32x16_bf16 v[192:207], v[48:51], v[28:31], v[192:207]
  v_mfma_f32_32x32x16_bf16 v[208:223], v[52:55], v[28:31], v[208:223]
  s_add_u32 s44, s31, s54
  s_add_u32 m0, s51, 2048
  buffer_load_dwordx4 v4, s[16:19], s44 offen lds
  v_mfma_f32_32x32x16_bf16 v[224:239], v[56:59], v[28:31], v[224:239]
  v_mfma_f32_32x32x16_bf16 v[240:255], v[60:63], v[28:31], v[240:255]
  s_add_u32 s44, s31, s55
  s_add_u32 m0, s51, 3072
  buffer_load_dwordx4 v5, s[16:19], s44 offen lds
  ds_read_b128 v[24:27], v9 offset:16384
  ds_read_b128 v[28:31], v9 offset:20480
  ds_read_b64_tr_b16 v[48:49], v10 offset:57344
  ds_read_b64_tr_b16 v[50:51], v10 offset:59392
  ds_read_b64_tr_b16 v[52:53], v11 offset:57344
  ds_read_b64_tr_b16 v[54:55], v11 offset:59392
  ds_read_b64_tr_b16 v[56:57], v12 offset:57344
  ds_read_b64_tr_b16 v[58:59], v12 offset:59392
  ds_read_b64_tr_b16 v[60:61], v13 offset:57344
  ds_read_b64_tr_b16 v[62:63], v13 offset:59392
  s_waitcnt lgkmcnt(10)
  v_mfma_f32_32x32x16_bf16 v[128:143], v[32:35], v[16:19], v[128:143]
  v_mfma_f32_32x32x16_bf16 v[144:159], v[36:39], v[16:19], v[144:159]
  s_add_u32 s44, s31, s56
  s_add_u32 m0, s51, 4096
  buffer_load_dwordx4 v4, s[16:19], s44 offen lds
  v_mfma_f32_32x32x16_bf16 v[160:175], v[40:43], v[16:19], v[160:175]
  v_mfma_f32_32x32x16_bf16 v[176:191], v[44:47], v[16:19], v[176:191]
  s_add_u32 s44, s31, s57
  s_add_u32 m0, s51, 5120
  buffer_load_dwordx4 v5, s[16:19], s44 offen lds
  v_mfma_f32_32x32x16_bf16 v[192:207], v[32:35], v[20:23], v[192:207]
  v_mfma_f32_32x32x16_bf16 v[208:223], v[36:39], v[20:23], v[208:223]
  s_add_u32 s44, s31, s58
  s_add_u32 m0, s51, 6144
  buffer_load_dwordx4 v4, s[16:19], s44 offen lds
  v_mfma_f32_32x32x16_bf16 v[224:239], v[40:43], v[20:23], v[224:239]
  v_mfma_f32_32x32x16_bf16 v[240:255], v[44:47], v[20:23], v[240:255]
  s_add_u32 s44, s31, s59
  s_add_u32 m0, s51, 7168
  buffer_load_dwordx4 v5, s[16:19], s44 offen lds
  s_waitcnt lgkmcnt(0)
  v_mfma_f32_32x32x16_bf16 v[128:143], v[48:51], v[24:27], v[128:143]
  v_mfma_f32_32x32x16_bf16 v[144:159], v[52:55], v[24:27], v[144:159]
  s_add_u32 s30, s30, 128
  s_add_u32 s31, s31, 524288
  v_mfma_f32_32x32x16_bf16 v[160:175], v[56:59], v[24:27], v[160:175]
  v_mfma_f32_32x32x16_bf16 v[176:191], v[60:63], v[24:27], v[176:191]
  v_mfma_f32_32x32x16_bf16 v[192:207], v[48:51], v[28:31], v[192:207]
  v_mfma_f32_32x32x16_bf16 v[208:223], v[52:55], v[28:31], v[208:223]
  v_mfma_f32_32x32x16_bf16 v[224:239], v[56:59], v[28:31], v[224:239]
  v_mfma_f32_32x32x16_bf16 v[240:255], v[60:63], v[28:31], v[240:255]
  s_waitcnt vmcnt(12)
  s_barrier
  ds_read_b128 v[16:19], v6 offset:32768
  ds_read_b128 v[20:23], v6 offset:36864
  ds_read_b64_tr_b16 v[32:33], v64 offset:0
  ds_read_b64_tr_b16 v[34:35], v64 offset:2048
  ds_read_b64_tr_b16 v[36:37], v65 offset:0
  ds_read_b64_tr_b16 v[38:39], v65 offset:2048
  ds_read_b64_tr_b16 v[40:41], v66 offset:0
  ds_read_b64_tr_b16 v[42:43], v66 offset:2048
  ds_read_b64_tr_b16 v[44:45], v67 offset:0
  ds_read_b64_tr_b16 v[46:47], v67 offset:2048
  ds_read_b128 v[24:27], v7 offset:32768
  ds_read_b128 v[28:31], v7 offset:36864
  ds_read_b64_tr_b16 v[48:49], v64 offset:8192
  ds_read_b64_tr_b16 v[50:51], v64 offset:10240
  ds_read_b64_tr_b16 v[52:53], v65 offset:8192
  ds_read_b64_tr_b16 v[54:55], v65 offset:10240
  ds_read_b64_tr_b16 v[56:57], v66 offset:8192
  ds_read_b64_tr_b16 v[58:59], v66 offset:10240
  ds_read_b64_tr_b16 v[60:61], v67 offset:8192
  ds_read_b64_tr_b16 v[62:63], v67 offset:10240
  s_waitcnt lgkmcnt(10)
  v_mfma_f32_32x32x16_bf16 v[128:143], v[32:35], v[16:19], v[128:143]
  v_mfma_f32_32x32x16_bf16 v[144:159], v[36:39], v[16:19], v[144:159]
  v_mfma_f32_32x32x16_bf16 v[160:175], v[40:43], v[16:19], v[160:175]
  v_mfma_f32_32x32x16_bf16 v[176:191], v[44:47], v[16:19], v[176:191]
  v_mfma_f32_32x32x16_bf16 v[192:207], v[32:35], v[20:23], v[192:207]
  v_mfma_f32_32x32x16_bf16 v[208:223], v[36:39], v[20:23], v[208:223]
  v_mfma_f32_32x32x16_bf16 v[224:239], v[40:43], v[20:23], v[224:239]
  v_mfma_f32_32x32x16_bf16 v[240:255], v[44:47], v[20:23], v[240:255]
  ds_read_b128 v[16:19], v8 offset:32768
  ds_read_b128 v[20:23], v8 offset:36864
  ds_read_b64_tr_b16 v[32:33], v64 offset:16384
  ds_read_b64_tr_b16 v[34:35], v64 offset:18432
  ds_read_b64_tr_b16 v[36:37], v65 offset:16384
  ds_read_b64_tr_b16 v[38:39], v65 offset:18432
  ds_read_b64_tr_b16 v[40:41], v66 offset:16384
  ds_read_b64_tr_b16 v[42:43], v66 offset:18432
  ds_read_b64_tr_b16 v[44:45], v67 offset:16384
  ds_read_b64_tr_b16 v[46:47], v67 offset:18432
  s_waitcnt lgkmcnt(10)
  v_mfma_f32_32x32x16_bf16 v[128:143], v[48:51], v[24:27], v[128:143]
  v_mfma_f32_32x32x16_bf16 v[144:159], v[52:55], v[24:27], v[144:159]
  v_mfma_f32_32x32x16_bf16 v[160:175], v[56:59], v[24:27], v[160:175]
  v_mfma_f32_32x32x16_bf16 v[176:191], v[60:63], v[24:27], v[176:191]
  v_mfma_f32_32x32x16_bf16 v[192:207], v[48:51], v[28:31], v[192:207]
  v_mfma_f32_32x32x16_bf16 v[208:223], v[52:55], v[28:31], v[208:223]
  v_mfma_f32_32x32x16_bf16 v[224:239], v[56:59], v[28:31], v[224:239]
  v_mfma_f32_32x32x16_bf16 v[240:255], v[60:63], v[28:31], v[240:255]
  ds_read_b128 v[24:27], v9 offset:32768
  ds_read_b128 v[28:31], v9 offset:36864
  ds_read_b64_tr_b16 v[48:49], v64 offset:24576
  ds_read_b64_tr_b16 v[50:51], v64 offset:26624
  ds_read_b64_tr_b16 v[52:53], v65 offset:24576
  ds_read_b64_tr_b16 v[54:55], v65 offset:26624
  ds_read_b64_tr_b16 v[56:57], v66 offset:24576
  ds_read_b64_tr_b16 v[58:59], v66 offset:26624
  ds_read_b64_tr_b16 v[60:61], v67 offset:24576
  ds_read_b64_tr_b16 v[62:63], v67 offset:26624
  s_waitcnt lgkmcnt(10)
  v_mfma_f32_32x32x16_bf16 v[128:143], v[32:35], v[16:19], v[128:143]
  v_mfma_f32_32x32x16_bf16 v[144:159], v[36:39], v[16:19], v[144:159]
  v_mfma_f32_32x32x16_bf16 v[160:175], v[40:43], v[16:19], v[160:175]
  v_mfma_f32_32x32x16_bf16 v[176:191], v[44:47], v[16:19], v[176:191]
  v_mfma_f32_32x32x16_bf16 v[192:207], v[32:35], v[20:23], v[192:207]
  v_mfma_f32_32x32x16_bf16 v[208:223], v[36:39], v[20:23], v[208:223]
  v_mfma_f32_32x32x16_bf16 v[224:239], v[40:43], v[20:23], v[224:239]
  v_mfma_f32_32x32x16_bf16 v[240:255], v[44:47], v[20:23], v[240:255]
  s_waitcnt lgkmcnt(0)
  v_mfma_f32_32x32x16_bf16 v[128:143], v[48:51], v[24:27], v[128:143]
  v_mfma_f32_32x32x16_bf16 v[144:159], v[52:55], v[24:27], v[144:159]
  v_mfma_f32_32x32x16_bf16 v[160:175], v[56:59], v[24:27], v[160:175]
  v_mfma_f32_32x32x16_bf16 v[176:191], v[60:63], v[24:27], v[176:191]
  v_mfma_f32_32x32x16_bf16 v[192:207], v[48:51], v[28:31], v[192:207]
  v_mfma_f32_32x32x16_bf16 v[208:223], v[52:55], v[28:31], v[208:223]
  v_mfma_f32_32x32x16_bf16 v[224:239], v[56:59], v[28:31], v[224:239]
  v_mfma_f32_32x32x16_bf16 v[240:255], v[60:63], v[28:31], v[240:255]
  s_waitcnt vmcnt(0)
  s_barrier
  ds_read_b128 v[16:19], v6 offset:0
  ds_read_b128 v[20:23], v6 offset:4096
  ds_read_b64_tr_b16 v[32:33], v10 offset:0
  ds_read_b64_tr_b16 v[34:35], v10 offset:2048
  ds_read_b64_tr_b16 v[36:37], v11 offset:0
  ds_read_b64_tr_b16 v[38:39], v11 offset:2048
  ds_read_b64_tr_b16 v[40:41], v12 offset:0
  ds_read_b64_tr_b16 v[42:43], v12 offset:2048
  ds_read_b64_tr_b16 v[44:45], v13 offset:0
  ds_read_b64_tr_b16 v[46:47], v13 offset:2048
  ds_read_b128 v[24:27], v7 offset:0
  ds_read_b128 v[28:31], v7 offset:4096
  ds_read_b64_tr_b16 v[48:49], v10 offset:8192
  ds_read_b64_tr_b16 v[50:51], v10 offset:10240
  ds_read_b64_tr_b16 v[52:53], v11 offset:8192
  ds_read_b64_tr_b16 v[54:55], v11 offset:10240
  ds_read_b64_tr_b16 v[56:57], v12 offset:8192
  ds_read_b64_tr_b16 v[58:59], v12 offset:10240
  ds_read_b64_tr_b16 v[60:61], v13 offset:8192
  ds_read_b64_tr_b16 v[62:63], v13 offset:10240
  s_waitcnt lgkmcnt(10)
  v_mfma_f32_32x32x16_bf16 v[128:143], v[32:35], v[16:19], v[128:143]
  v_mfma_f32_32x32x16_bf16 v[144:159], v[36:39], v[16:19], v[144:159]
  v_mfma_f32_32x32x16_bf16 v[160:175], v[40:43], v[16:19], v[160:175]
  v_mfma_f32_32x32x16_bf16 v[176:191], v[44:47], v[16:19], v[176:191]
  v_mfma_f32_32x32x16_bf16 v[192:207], v[32:35], v[20:23], v[192:207]
  v_mfma_f32_32x32x16_bf16 v[208:223], v[36:39], v[20:23], v[208:223]
  v_mfma_f32_32x32x16_bf16 v[224:239], v[40:43], v[20:23], v[224:239]
  v_mfma_f32_32x32x16_bf16 v[240:255], v[44:47], v[20:23], v[240:255]
  ds_read_b128 v[16:19], v8 offset:0
  ds_read_b128 v[20:23], v8 offset:4096
  ds_read_b64_tr_b16 v[32:33], v10 offset:16384
  ds_read_b64_tr_b16 v[34:35], v10 offset:18432
  ds_read_b64_tr_b16 v[36:37], v11 offset:16384
  ds_read_b64_tr_b16 v[38:39], v11 offset:18432
  ds_read_b64_tr_b16 v[40:41], v12 offset:16384
  ds_read_b64_tr_b16 v[42:43], v12 offset:18432
  ds_read_b64_tr_b16 v[44:45], v13 offset:16384
  ds_read_b64_tr_b16 v[46:47], v13 offset:18432
  s_waitcnt lgkmcnt(10)
  v_mfma_f32_32x32x16_bf16 v[128:143], v[48:51], v[24:27], v[128:143]
  v_mfma_f32_32x32x16_bf16 v[144:159], v[52:55], v[24:27], v[144:159]
  v_mfma_f32_32x32x16_bf16 v[160:175], v[56:59], v[24:27], v[160:175]
  v_mfma_f32_32x32x16_bf16 v[176:191], v[60:63], v[24:27], v[176:191]
  v_mfma_f32_32x32x16_bf16 v[192:207], v[48:51], v[28:31], v[192:207]
  v_mfma_f32_32x32x16_bf16 v[208:223], v[52:55], v[28:31], v[208:223]
  v_mfma_f32_32x32x16_bf16 v[224:239], v[56:59], v[28:31], v[224:239]
  v_mfma_f32_32x32x16_bf16 v[240:255], v[60:63], v[28:31], v[240:255]
  ds_read_b128 v[24:27], v9 offset:0
  ds_read_b128 v[28:31], v9 offset:4096
  ds_read_b64_tr_b16 v[48:49], v10 offset:24576
  ds_read_b64_tr_b16 v[50:51], v10 offset:26624
  ds_read_b64_tr_b16 v[52:53], v11 offset:24576
  ds_read_b64_tr_b16 v[54:55], v11 offset:26624
  ds_read_b64_tr_b16 v[56:57], v12 offset:24576
  ds_read_b64_tr_b16 v[58:59], v12 offset:26624
  ds_read_b64_tr_b16 v[60:61], v13 offset:24576
  ds_read_b64_tr_b16 v[62:63], v13 offset:26624
  s_waitcnt lgkmcnt(10)
  v_mfma_f32_32x32x16_bf16 v[128:143], v[32:35], v[16:19], v[128:143]
  v_mfma_f32_32x32x16_bf16 v[144:159], v[36:39], v[16:19], v[144:159]
  v_mfma_f32_32x32x16_bf16 v[160:175], v[40:43], v[16:19], v[160:175]
  v_mfma_f32_32x32x16_bf16 v[176:191], v[44:47], v[16:19], v[176:191]
  v_mfma_f32_32x32x16_bf16 v[192:207], v[32:35], v[20:23], v[192:207]
  v_mfma_f32_32x32x16_bf16 v[208:223], v[36:39], v[20:23], v[208:223]
  v_mfma_f32_32x32x16_bf16 v[224:239], v[40:43], v[20:23], v[224:239]
  v_mfma_f32_32x32x16_bf16 v[240:255], v[44:47], v[20:23], v[240:255]
  s_waitcnt lgkmcnt(0)
  v_mfma_f32_32x32x16_bf16 v[128:143], v[48:51], v[24:27], v[128:143]
  v_mfma_f32_32x32x16_bf16 v[144:159], v[52:55], v[24:27], v[144:159]
  v_mfma_f32_32x32x16_bf16 v[160:175], v[56:59], v[24:27], v[160:175]
  v_mfma_f32_32x32x16_bf16 v[176:191], v[60:63], v[24:27], v[176:191]
  v_mfma_f32_32x32x16_bf16 v[192:207], v[48:51], v[28:31], v[192:207]
  v_mfma_f32_32x32x16_bf16 v[208:223], v[52:55], v[28:31], v[208:223]
  v_mfma_f32_32x32x16_bf16 v[224:239], v[56:59], v[28:31], v[224:239]
  v_mfma_f32_32x32x16_bf16 v[240:255], v[60:63], v[28:31], v[240:255]
  s_nop 15
  s_nop 3
  s_lshl_b32 s32, s25, 2
  s_and_b32 s33, s22, 1
  s_lshl_b32 s33, s33, 1
  s_add_u32 s32, s32, s33
  s_lshl_b32 s32, s32, 5
  s_lshl_b32 s33, s26, 1
  s_add_u32 s32, s32, s33
  s_lshr_b32 s33, s22, 1
  s_add_u32 s32, s32, s33
  s_lshl_b32 s32, s32, 13
  s_lshl_b32 s33, s24, 24
  s_add_u32 s32, s32, s33
  v_lshrrev_b32 v14, 5, v0
  v_and_b32 v15, 31, v0
  v_bfe_u32 v16, v15, 3, 1
  v_lshlrev_b32 v16, 12, v16
  v_lshrrev_b32 v17, 4, v15
  v_lshlrev_b32 v17, 3, v17
  v_bfe_u32 v18, v15, 2, 1
  v_lshl_add_u32 v17, v18, 2, v17
  v_and_b32 v18, 3, v15
  v_add_u32 v17, v17, v18
  v_lshl_add_u32 v17, v14, 4, v17
  v_lshl_add_u32 v16, v17, 4, v16
  v_cvt_pk_bf16_f32 v20, v128, v129
  v_cvt_pk_bf16_f32 v21, v130, v131
  v_cvt_pk_bf16_f32 v22, v132, v133
  v_cvt_pk_bf16_f32 v23, v134, v135
  buffer_store_dwordx4 v[20:23], v16, s[8:11], s32 offen offset:0 sc1
  v_cvt_pk_bf16_f32 v24, v136, v137
  v_cvt_pk_bf16_f32 v25, v138, v139
  v_cvt_pk_bf16_f32 v26, v140, v141
  v_cvt_pk_bf16_f32 v27, v142, v143
  buffer_store_dwordx4 v[24:27], v16, s[8:11], s32 offen offset:512 sc1
  v_cvt_pk_bf16_f32 v28, v144, v145
  v_cvt_pk_bf16_f32 v29, v146, v147
  v_cvt_pk_bf16_f32 v30, v148, v149
  v_cvt_pk_bf16_f32 v31, v150, v151
  buffer_store_dwordx4 v[28:31], v16, s[8:11], s32 offen offset:1024 sc1
  v_cvt_pk_bf16_f32 v32, v152, v153
  v_cvt_pk_bf16_f32 v33, v154, v155
  v_cvt_pk_bf16_f32 v34, v156, v157
  v_cvt_pk_bf16_f32 v35, v158, v159
  buffer_store_dwordx4 v[32:35], v16, s[8:11], s32 offen offset:1536 sc1
  v_cvt_pk_bf16_f32 v20, v160, v161
  v_cvt_pk_bf16_f32 v21, v162, v163
  v_cvt_pk_bf16_f32 v22, v164, v165
  v_cvt_pk_bf16_f32 v23, v166, v167
  buffer_store_dwordx4 v[20:23], v16, s[8:11], s32 offen offset:2048 sc1
  v_cvt_pk_bf16_f32 v24, v168, v169
  v_cvt_pk_bf16_f32 v25, v170, v171
  v_cvt_pk_bf16_f32 v26, v172, v173
  v_cvt_pk_bf16_f32 v27, v174, v175
  buffer_store_dwordx4 v[24:27], v16, s[8:11], s32 offen offset:2560 sc1
  v_cvt_pk_bf16_f32 v28, v176, v177
  v_cvt_pk_bf16_f32 v29, v178, v179
  v_cvt_pk_bf16_f32 v30, v180, v181
  v_cvt_pk_bf16_f32 v31, v182, v183
  buffer_store_dwordx4 v[28:31], v16, s[8:11], s32 offen offset:3072 sc1
  v_cvt_pk_bf16_f32 v32, v184, v185
  v_cvt_pk_bf16_f32 v33, v186, v187
  v_cvt_pk_bf16_f32 v34, v188, v189
  v_cvt_pk_bf16_f32 v35, v190, v191
  buffer_store_dwordx4 v[32:35], v16, s[8:11], s32 offen offset:3584 sc1
  s_add_u32 s32, s32, 262144
  v_cvt_pk_bf16_f32 v20, v192, v193
  v_cvt_pk_bf16_f32 v21, v194, v195
  v_cvt_pk_bf16_f32 v22, v196, v197
  v_cvt_pk_bf16_f32 v23, v198, v199
  buffer_store_dwordx4 v[20:23], v16, s[8:11], s32 offen offset:0 sc1
  v_cvt_pk_bf16_f32 v24, v200, v201
  v_cvt_pk_bf16_f32 v25, v202, v203
  v_cvt_pk_bf16_f32 v26, v204, v205
  v_cvt_pk_bf16_f32 v27, v206, v207
  buffer_store_dwordx4 v[24:27], v16, s[8:11], s32 offen offset:512 sc1
  v_cvt_pk_bf16_f32 v28, v208, v209
  v_cvt_pk_bf16_f32 v29, v210, v211
  v_cvt_pk_bf16_f32 v30, v212, v213
  v_cvt_pk_bf16_f32 v31, v214, v215
  buffer_store_dwordx4 v[28:31], v16, s[8:11], s32 offen offset:1024 sc1
  v_cvt_pk_bf16_f32 v32, v216, v217
  v_cvt_pk_bf16_f32 v33, v218, v219
  v_cvt_pk_bf16_f32 v34, v220, v221
  v_cvt_pk_bf16_f32 v35, v222, v223
  buffer_store_dwordx4 v[32:35], v16, s[8:11], s32 offen offset:1536 sc1
  v_cvt_pk_bf16_f32 v20, v224, v225
  v_cvt_pk_bf16_f32 v21, v226, v227
  v_cvt_pk_bf16_f32 v22, v228, v229
  v_cvt_pk_bf16_f32 v23, v230, v231
  buffer_store_dwordx4 v[20:23], v16, s[8:11], s32 offen offset:2048 sc1
  v_cvt_pk_bf16_f32 v24, v232, v233
  v_cvt_pk_bf16_f32 v25, v234, v235
  v_cvt_pk_bf16_f32 v26, v236, v237
  v_cvt_pk_bf16_f32 v27, v238, v239
  buffer_store_dwordx4 v[24:27], v16, s[8:11], s32 offen offset:2560 sc1
  v_cvt_pk_bf16_f32 v28, v240, v241
  v_cvt_pk_bf16_f32 v29, v242, v243
  v_cvt_pk_bf16_f32 v30, v244, v245
  v_cvt_pk_bf16_f32 v31, v246, v247
  buffer_store_dwordx4 v[28:31], v16, s[8:11], s32 offen offset:3072 sc1
  v_cvt_pk_bf16_f32 v32, v248, v249
  v_cvt_pk_bf16_f32 v33, v250, v251
  v_cvt_pk_bf16_f32 v34, v252, v253
  v_cvt_pk_bf16_f32 v35, v254, v255
  buffer_store_dwordx4 v[32:35], v16, s[8:11], s32 offen offset:3584 sc1
  s_branch L_jobdone
JP_sw0:
  s_waitcnt vmcnt(12)
  s_barrier
  ds_read_b128 v[16:19], v6 offset:0
  ds_read_b128 v[20:23], v6 offset:4096
  ds_read_b64_tr_b16 v[32:33], v10 offset:0
  ds_read_b64_tr_b16 v[34:35], v10 offset:2048
  ds_read_b64_tr_b16 v[36:37], v11 offset:0
  ds_read_b64_tr_b16 v[38:39], v11 offset:2048
  ds_read_b64_tr_b16 v[40:41], v12 offset:0
  ds_read_b64_tr_b16 v[42:43], v12 offset:2048
  ds_read_b64_tr_b16 v[44:45], v13 offset:0
  ds_read_b64_tr_b16 v[46:47], v13 offset:2048
  ds_read_b128 v[24:27], v7 offset:0
  ds_read_b128 v[28:31], v7 offset:4096
  ds_read_b64_tr_b16 v[48:49], v10 offset:8192
  ds_read_b64_tr_b16 v[50:51], v10 offset:10240
  ds_read_b64_tr_b16 v[52:53], v11 offset:8192
  ds_read_b64_tr_b16 v[54:55], v11 offset:10240
  ds_read_b64_tr_b16 v[56:57], v12 offset:8192
  ds_read_b64_tr_b16 v[58:59], v12 offset:10240
  ds_read_b64_tr_b16 v[60:61], v13 offset:8192
  ds_read_b64_tr_b16 v[62:63], v13 offset:10240
  s_waitcnt lgkmcnt(10)
  v_mfma_f32_32x32x16_bf16 v[128:143], v[16:19], v[32:35], 0
  v_mfma_f32_32x32x16_bf16 v[144:159], v[16:19], v[36:39], 0
  s_add_u32 s44, s30, s46
  s_add_u32 m0, s50, 131072
  buffer_load_dwordx4 v2, s[12:15], s44 offen lds
  v_mfma_f32_32x32x16_bf16 v[160:175], v[16:19], v[40:43], 0
  v_mfma_f32_32x32x16_bf16 v[176:191], v[16:19], v[44:47], 0
  s_add_u32 s44, s30, s47
  s_add_u32 m0, s50, 132096
  buffer_load_dwordx4 v3, s[12:15], s44 offen lds
  v_mfma_f32_32x32x16_bf16 v[192:207], v[20:23], v[32:35], 0
  v_mfma_f32_32x32x16_bf16 v[208:223], v[20:23], v[36:39], 0
  s_add_u32 s44, s30, s48
  s_add_u32 m0, s50, 133120
  buffer_load_dwordx4 v2, s[12:15], s44 offen lds
  v_mfma_f32_32x32x16_bf16 v[224:239], v[20:23], v[40:43], 0
  v_mfma_f32_32x32x16_bf16 v[240:255], v[20:23], v[44:47], 0
  s_add_u32 s44, s30, s49
  s_add_u32 m0, s50, 134144
  buffer_load_dwordx4 v3, s[12:15], s44 offen lds
  ds_read_b128 v[16:19], v8 offset:0
  ds_read_b128 v[20:23], v8 offset:4096
  ds_read_b64_tr_b16 v[32:33], v10 offset:16384
  ds_read_b64_tr_b16 v[34:35], v10 offset:18432
  ds_read_b64_tr_b16 v[36:37], v11 offset:16384
  ds_read_b64_tr_b16 v[38:39], v11 offset:18432
  ds_read_b64_tr_b16 v[40:41], v12 offset:16384
  ds_read_b64_tr_b16 v[42:43], v12 offset:18432
  ds_read_b64_tr_b16 v[44:45], v13 offset:16384
  ds_read_b64_tr_b16 v[46:47], v13 offset:18432
  s_waitcnt lgkmcnt(10)
  v_mfma_f32_32x32x16_bf16 v[128:143], v[24:27], v[48:51], v[128:143]
  v_mfma_f32_32x32x16_bf16 v[144:159], v[24:27], v[52:55], v[144:159]
  s_add_u32 s44, s31, s52
  s_add_u32 m0, s51, 65536
  buffer_load_dwordx4 v4, s[16:19], s44 offen lds
  v_mfma_f32_32x32x16_bf16 v[160:175], v[24:27], v[56:59], v[160:175]
  v_mfma_f32_32x32x16_bf16 v[176:191], v[24:27], v[60:63], v[176:191]
  s_add_u32 s44, s31, s53
  s_add_u32 m0, s51, 66560
  buffer_load_dwordx4 v5, s[16:19], s44 offen lds
  v_mfma_f32_32x32x16_bf16 v[192:207], v[28:31], v[48:51], v[192:207]
  v_mfma_f32_32x32x16_bf16 v[208:223], v[28:31], v[52:55], v[208:223]
  s_add_u32 s44, s31, s54
  s_add_u32 m0, s51, 67584
  buffer_load_dwordx4 v4, s[16:19], s44 offen lds
  v_mfma_f32_32x32x16_bf16 v[224:239], v[28:31], v[56:59], v[224:239]
  v_mfma_f32_32x32x16_bf16 v[240:255], v[28:31], v[60:63], v[240:255]
  s_add_u32 s44, s31, s55
  s_add_u32 m0, s51, 68608
  buffer_load_dwordx4 v5, s[16:19], s44 offen lds
  ds_read_b128 v[24:27], v9 offset:0
  ds_read_b128 v[28:31], v9 offset:4096
  ds_read_b64_tr_b16 v[48:49], v10 offset:24576
  ds_read_b64_tr_b16 v[50:51], v10 offset:26624
  ds_read_b64_tr_b16 v[52:53], v11 offset:24576
  ds_read_b64_tr_b16 v[54:55], v11 offset:26624
  ds_read_b64_tr_b16 v[56:57], v12 offset:24576
  ds_read_b64_tr_b16 v[58:59], v12 offset:26624
  ds_read_b64_tr_b16 v[60:61], v13 offset:24576
  ds_read_b64_tr_b16 v[62:63], v13 offset:26624
  s_waitcnt lgkmcnt(10)
  v_mfma_f32_32x32x16_bf16 v[128:143], v[16:19], v[32:35], v[128:143]
  v_mfma_f32_32x32x16_bf16 v[144:159], v[16:19], v[36:39], v[144:159]
  s_add_u32 s44, s31, s56
  s_add_u32 m0, s51, 69632
  buffer_load_dwordx4 v4, s[16:19], s44 offen lds
  v_mfma_f32_32x32x16_bf16 v[160:175], v[16:19], v[40:43], v[160:175]
  v_mfma_f32_32x32x16_bf16 v[176:191], v[16:19], v[44:47], v[176:191]
  s_add_u32 s44, s31, s57
  s_add_u32 m0, s51, 70656
  buffer_load_dwordx4 v5, s[16:19], s44 offen lds
  v_mfma_f32_32x32x16_bf16 v[192:207], v[20:23], v[32:35], v[192:207]
  v_mfma_f32_32x32x16_bf16 v[208:223], v[20:23], v[36:39], v[208:223]
  s_add_u32 s44, s31, s58
  s_add_u32 m0, s51, 71680
  buffer_load_dwordx4 v4, s[16:19], s44 offen lds
  v_mfma_f32_32x32x16_bf16 v[224:239], v[20:23], v[40:43], v[224:239]
  v_mfma_f32_32x32x16_bf16 v[240:255], v[20:23], v[44:47], v[240:255]
  s_add_u32 s44, s31, s59
  s_add_u32 m0, s51, 72704
  buffer_load_dwordx4 v5, s[16:19], s44 offen lds
  s_waitcnt lgkmcnt(0)
  v_mfma_f32_32x32x16_bf16 v[128:143], v[24:27], v[48:51], v[128:143]
  v_mfma_f32_32x32x16_bf16 v[144:159], v[24:27], v[52:55], v[144:159]
  s_add_u32 s30, s30, 128
  s_add_u32 s31, s31, 524288
  v_mfma_f32_32x32x16_bf16 v[160:175], v[24:27], v[56:59], v[160:175]
  v_mfma_f32_32x32x16_bf16 v[176:191], v[24:27], v[60:63], v[176:191]
  v_mfma_f32_32x32x16_bf16 v[192:207], v[28:31], v[48:51], v[192:207]
  v_mfma_f32_32x32x16_bf16 v[208:223], v[28:31], v[52:55], v[208:223]
  v_mfma_f32_32x32x16_bf16 v[224:239], v[28:31], v[56:59], v[224:239]
  v_mfma_f32_32x32x16_bf16 v[240:255], v[28:31], v[60:63], v[240:255]
  s_waitcnt vmcnt(12)
  s_barrier
  ds_read_b128 v[16:19], v6 offset:16384
  ds_read_b128 v[20:23], v6 offset:20480
  ds_read_b64_tr_b16 v[32:33], v10 offset:32768
  ds_read_b64_tr_b16 v[34:35], v10 offset:34816
  ds_read_b64_tr_b16 v[36:37], v11 offset:32768
  ds_read_b64_tr_b16 v[38:39], v11 offset:34816
  ds_read_b64_tr_b16 v[40:41], v12 offset:32768
  ds_read_b64_tr_b16 v[42:43], v12 offset:34816
  ds_read_b64_tr_b16 v[44:45], v13 offset:32768
  ds_read_b64_tr_b16 v[46:47], v13 offset:34816
  ds_read_b128 v[24:27], v7 offset:16384
  ds_read_b128 v[28:31], v7 offset:20480
  ds_read_b64_tr_b16 v[48:49], v10 offset:40960
  ds_read_b64_tr_b16 v[50:51], v10 offset:43008
  ds_read_b64_tr_b16 v[52:53], v11 offset:40960
  ds_read_b64_tr_b16 v[54:55], v11 offset:43008
  ds_read_b64_tr_b16 v[56:57], v12 offset:40960
  ds_read_b64_tr_b16 v[58:59], v12 offset:43008
  ds_read_b64_tr_b16 v[60:61], v13 offset:40960
  ds_read_b64_tr_b16 v[62:63], v13 offset:43008
  s_waitcnt lgkmcnt(10)
  v_mfma_f32_32x32x16_bf16 v[128:143], v[16:19], v[32:35], v[128:143]
  v_mfma_f32_32x32x16_bf16 v[144:159], v[16:19], v[36:39], v[144:159]
  s_add_u32 s44, s30, s46
  s_add_u32 m0, s50, 98304
  buffer_load_dwordx4 v2, s[12:15], s44 offen lds
  v_mfma_f32_32x32x16_bf16 v[160:175], v[16:19], v[40:43], v[160:175]
  v_mfma_f32_32x32x16_bf16 v[176:191], v[16:19], v[44:47], v[176:191]
  s_add_u32 s44, s30, s47
  s_add_u32 m0, s50, 99328
  buffer_load_dwordx4 v3, s[12:15], s44 offen lds
  v_mfma_f32_32x32x16_bf16 v[192:207], v[20:23], v[32:35], v[192:207]
  v_mfma_f32_32x32x16_bf16 v[208:223], v[20:23], v[36:39], v[208:223]
  s_add_u32 s44, s30, s48
  s_add_u32 m0, s50, 100352
  buffer_load_dwordx4 v2, s[12:15], s44 offen lds
  v_mfma_f32_32x32x16_bf16 v[224:239], v[20:23], v[40:43], v[224:239]
  v_mfma_f32_32x32x16_bf16 v[240:255], v[20:23], v[44:47], v[240:255]
  s_add_u32 s44, s30, s49
  s_add_u32 m0, s50, 101376
  buffer_load_dwordx4 v3, s[12:15], s44 offen lds
  ds_read_b128 v[16:19], v8 offset:16384
  ds_read_b128 v[20:23], v8 offset:20480
  ds_read_b64_tr_b16 v[32:33], v10 offset:49152
  ds_read_b64_tr_b16 v[34:35], v10 offset:51200
  ds_read_b64_tr_b16 v[36:37], v11 offset:49152
  ds_read_b64_tr_b16 v[38:39], v11 offset:51200
  ds_read_b64_tr_b16 v[40:41], v12 offset:49152
  ds_read_b64_tr_b16 v[42:43], v12 offset:51200
  ds_read_b64_tr_b16 v[44:45], v13 offset:49152
  ds_read_b64_tr_b16 v[46:47], v13 offset:51200
  s_waitcnt lgkmcnt(10)
  v_mfma_f32_32x32x16_bf16 v[128:143], v[24:27], v[48:51], v[128:143]
  v_mfma_f32_32x32x16_bf16 v[144:159], v[24:27], v[52:55], v[144:159]
  s_add_u32 s44, s31, s52
  s_add_u32 m0, s51, 0
  buffer_load_dwordx4 v4, s[16:19], s44 offen lds
  v_mfma_f32_32x32x16_bf16 v[160:175], v[24:27], v[56:59], v[160:175]
  v_mfma_f32_32x32x16_bf16 v[176:191], v[24:27], v[60:63], v[176:191]
  s_add_u32 s44, s31, s53
  s_add_u32 m0, s51, 1024
  buffer_load_dwordx4 v5, s[16:19], s44 offen lds
  v_mfma_f32_32x32x16_bf16 v[192:207], v[28:31], v[48:51], v[192:207]
  v_mfma_f32_32x32x16_bf16 v[208:223], v[28:31], v[52:55], v[208:223]
  s_add_u32 s44, s31, s54
  s_add_u32 m0, s51, 2048
  buffer_load_dwordx4 v4, s[16:19], s44 offen lds
  v_mfma_f32_32x32x16_bf16 v[224:239], v[28:31], v[56:59], v[224:239]
  v_mfma_f32_32x32x16_bf16 v[240:255], v[28:31], v[60:63], v[240:255]
  s_add_u32 s44, s31, s55
  s_add_u32 m0, s51, 3072
  buffer_load_dwordx4 v5, s[16:19], s44 offen lds
  ds_read_b128 v[24:27], v9 offset:16384
  ds_read_b128 v[28:31], v9 offset:20480
  ds_read_b64_tr_b16 v[48:49], v10 offset:57344
  ds_read_b64_tr_b16 v[50:51], v10 offset:59392
  ds_read_b64_tr_b16 v[52:53], v11 offset:57344
  ds_read_b64_tr_b16 v[54:55], v11 offset:59392
  ds_read_b64_tr_b16 v[56:57], v12 offset:57344
  ds_read_b64_tr_b16 v[58:59], v12 offset:59392
  ds_read_b64_tr_b16 v[60:61], v13 offset:57344
  ds_read_b64_tr_b16 v[62:63], v13 offset:59392
  s_waitcnt lgkmcnt(10)
  v_mfma_f32_32x32x16_bf16 v[128:143], v[16:19], v[32:35], v[128:143]
  v_mfma_f32_32x32x16_bf16 v[144:159], v[16:19], v[36:39], v[144:159]
  s_add_u32 s44, s31, s56
  s_add_u32 m0, s51, 4096
  buffer_load_dwordx4 v4, s[16:19], s44 offen lds
  v_mfma_f32_32x32x16_bf16 v[160:175], v[16:19], v[40:43], v[160:175]
  v_mfma_f32_32x32x16_bf16 v[176:191], v[16:19], v[44:47], v[176:191]
  s_add_u32 s44, s31, s57
  s_add_u32 m0, s51, 5120
  buffer_load_dwordx4 v5, s[16:19], s44 offen lds
  v_mfma_f32_32x32x16_bf16 v[192:207], v[20:23], v[32:35], v[192:207]
  v_mfma_f32_32x32x16_bf16 v[208:223], v[20:23], v[36:39], v[208:223]
  s_add_u32 s44, s31, s58
  s_add_u32 m0, s51, 6144
  buffer_load_dwordx4 v4, s[16:19], s44 offen lds
  v_mfma_f32_32x32x16_bf16 v[224:239], v[20:23], v[40:43], v[224:239]
  v_mfma_f32_32x32x16_bf16 v[240:255], v[20:23], v[44:47], v[240:255]
  s_add_u32 s44, s31, s59
  s_add_u32 m0, s51, 7168
  buffer_load_dwordx4 v5, s[16:19], s44 offen lds
  s_waitcnt lgkmcnt(0)
  v_mfma_f32_32x32x16_bf16 v[128:143], v[24:27], v[48:51], v[128:143]
  v_mfma_f32_32x32x16_bf16 v[144:159], v[24:27], v[52:55], v[144:159]
  s_add_u32 s30, s30, 128
  s_add_u32 s31, s31, 524288
  v_mfma_f32_32x32x16_bf16 v[160:175], v[24:27], v[56:59], v[160:175]
  v_mfma_f32_32x32x16_bf16 v[176:191], v[24:27], v[60:63], v[176:191]
  v_mfma_f32_32x32x16_bf16 v[192:207], v[28:31], v[48:51], v[192:207]
  v_mfma_f32_32x32x16_bf16 v[208:223], v[28:31], v[52:55], v[208:223]
  v_mfma_f32_32x32x16_bf16 v[224:239], v[28:31], v[56:59], v[224:239]
  v_mfma_f32_32x32x16_bf16 v[240:255], v[28:31], v[60:63], v[240:255]
  s_waitcnt vmcnt(12)
  s_barrier
  ds_read_b128 v[16:19], v6 offset:32768
  ds_read_b128 v[20:23], v6 offset:36864
  ds_read_b64_tr_b16 v[32:33], v64 offset:0
  ds_read_b64_tr_b16 v[34:35], v64 offset:2048
  ds_read_b64_tr_b16 v[36:37], v65 offset:0
  ds_read_b64_tr_b16 v[38:39], v65 offset:2048
  ds_read_b64_tr_b16 v[40:41], v66 offset:0
  ds_read_b64_tr_b16 v[42:43], v66 offset:2048
  ds_read_b64_tr_b16 v[44:45], v67 offset:0
  ds_read_b64_tr_b16 v[46:47], v67 offset:2048
  ds_read_b128 v[24:27], v7 offset:32768
  ds_read_b128 v[28:31], v7 offset:36864
  ds_read_b64_tr_b16 v[48:49], v64 offset:8192
  ds_read_b64_tr_b16 v[50:51], v64 offset:10240
  ds_read_b64_tr_b16 v[52:53], v65 offset:8192
  ds_read_b64_tr_b16 v[54:55], v65 offset:10240
  ds_read_b64_tr_b16 v[56:57], v66 offset:8192
  ds_read_b64_tr_b16 v[58:59], v66 offset:10240
  ds_read_b64_tr_b16 v[60:61], v67 offset:8192
  ds_read_b64_tr_b16 v[62:63], v67 offset:10240
  s_waitcnt lgkmcnt(10)
  v_mfma_f32_32x32x16_bf16 v[128:143], v[16:19], v[32:35], v[128:143]
  v_mfma_f32_32x32x16_bf16 v[144:159], v[16:19], v[36:39], v[144:159]
  s_add_u32 s44, s30, s46
  s_add_u32 m0, s50, 114688
  buffer_load_dwordx4 v2, s[12:15], s44 offen lds
  v_mfma_f32_32x32x16_bf16 v[160:175], v[16:19], v[40:43], v[160:175]
  v_mfma_f32_32x32x16_bf16 v[176:191], v[16:19], v[44:47], v[176:191]
  s_add_u32 s44, s30, s47
  s_add_u32 m0, s50, 115712
  buffer_load_dwordx4 v3, s[12:15], s44 offen lds
  v_mfma_f32_32x32x16_bf16 v[192:207], v[20:23], v[32:35], v[192:207]
  v_mfma_f32_32x32x16_bf16 v[208:223], v[20:23], v[36:39], v[208:223]
  s_add_u32 s44, s30, s48
  s_add_u32 m0, s50, 116736
  buffer_load_dwordx4 v2, s[12:15], s44 offen lds
  v_mfma_f32_32x32x16_bf16 v[224:239], v[20:23], v[40:43], v[224:239]
  v_mfma_f32_32x32x16_bf16 v[240:255], v[20:23], v[44:47], v[240:255]
  s_add_u32 s44, s30, s49
  s_add_u32 m0, s50, 117760
  buffer_load_dwordx4 v3, s[12:15], s44 offen lds
  ds_read_b128 v[16:19], v8 offset:32768
  ds_read_b128 v[20:23], v8 offset:36864
  ds_read_b64_tr_b16 v[32:33], v64 offset:16384
  ds_read_b64_tr_b16 v[34:35], v64 offset:18432
  ds_read_b64_tr_b16 v[36:37], v65 offset:16384
  ds_read_b64_tr_b16 v[38:39], v65 offset:18432
  ds_read_b64_tr_b16 v[40:41], v66 offset:16384
  ds_read_b64_tr_b16 v[42:43], v66 offset:18432
  ds_read_b64_tr_b16 v[44:45], v67 offset:16384
  ds_read_b64_tr_b16 v[46:47], v67 offset:18432
  s_waitcnt lgkmcnt(10)
  v_mfma_f32_32x32x16_bf16 v[128:143], v[24:27], v[48:51], v[128:143]
  v_mfma_f32_32x32x16_bf16 v[144:159], v[24:27], v[52:55], v[144:159]
  s_add_u32 s44, s31, s52
  s_add_u32 m0, s51, 32768
  buffer_load_dwordx4 v4, s[16:19], s44 offen lds
  v_mfma_f32_32x32x16_bf16 v[160:175], v[24:27], v[56:59], v[160:175]
  v_mfma_f32_32x32x16_bf16 v[176:191], v[24:27], v[60:63], v[176:191]
  s_add_u32 s44, s31, s53
  s_add_u32 m0, s51, 33792
  buffer_load_dwordx4 v5, s[16:19], s44 offen lds
  v_mfma_f32_32x32x16_bf16 v[192:207], v[28:31], v[48:51], v[192:207]
  v_mfma_f32_32x32x16_bf16 v[208:223], v[28:31], v[52:55], v[208:223]
  s_add_u32 s44, s31, s54
  s_add_u32 m0, s51, 34816
  buffer_load_dwordx4 v4, s[16:19], s44 offen lds
  v_mfma_f32_32x32x16_bf16 v[224:239], v[28:31], v[56:59], v[224:239]
  v_mfma_f32_32x32x16_bf16 v[240:255], v[28:31], v[60:63], v[240:255]
  s_add_u32 s44, s31, s55
  s_add_u32 m0, s51, 35840
  buffer_load_dwordx4 v5, s[16:19], s44 offen lds
  ds_read_b128 v[24:27], v9 offset:32768
  ds_read_b128 v[28:31], v9 offset:36864
  ds_read_b64_tr_b16 v[48:49], v64 offset:24576
  ds_read_b64_tr_b16 v[50:51], v64 offset:26624
  ds_read_b64_tr_b16 v[52:53], v65 offset:24576
  ds_read_b64_tr_b16 v[54:55], v65 offset:26624
  ds_read_b64_tr_b16 v[56:57], v66 offset:24576
  ds_read_b64_tr_b16 v[58:59], v66 offset:26624
  ds_read_b64_tr_b16 v[60:61], v67 offset:24576
  ds_read_b64_tr_b16 v[62:63], v67 offset:26624
  s_waitcnt lgkmcnt(10)
  v_mfma_f32_32x32x16_bf16 v[128:143], v[16:19], v[32:35], v[128:143]
  v_mfma_f32_32x32x16_bf16 v[144:159], v[16:19], v[36:39], v[144:159]
  s_add_u32 s44, s31, s56
  s_add_u32 m0, s51, 36864
  buffer_load_dwordx4 v4, s[16:19], s44 offen lds
  v_mfma_f32_32x32x16_bf16 v[160:175], v[16:19], v[40:43], v[160:175]
  v_mfma_f32_32x32x16_bf16 v[176:191], v[16:19], v[44:47], v[176:191]
  s_add_u32 s44, s31, s57
  s_add_u32 m0, s51, 37888
  buffer_load_dwordx4 v5, s[16:19], s44 offen lds
  v_mfma_f32_32x32x16_bf16 v[192:207], v[20:23], v[32:35], v[192:207]
  v_mfma_f32_32x32x16_bf16 v[208:223], v[20:23], v[36:39], v[208:223]
  s_add_u32 s44, s31, s58
  s_add_u32 m0, s51, 38912
  buffer_load_dwordx4 v4, s[16:19], s44 offen lds
  v_mfma_f32_32x32x16_bf16 v[224:239], v[20:23], v[40:43], v[224:239]
  v_mfma_f32_32x32x16_bf16 v[240:255], v[20:23], v[44:47], v[240:255]
  s_add_u32 s44, s31, s59
  s_add_u32 m0, s51, 39936
  buffer_load_dwordx4 v5, s[16:19], s44 offen lds
  s_waitcnt lgkmcnt(0)
  v_mfma_f32_32x32x16_bf16 v[128:143], v[24:27], v[48:51], v[128:143]
  v_mfma_f32_32x32x16_bf16 v[144:159], v[24:27], v[52:55], v[144:159]
  s_add_u32 s30, s30, 128
  s_add_u32 s31, s31, 524288
  v_mfma_f32_32x32x16_bf16 v[160:175], v[24:27], v[56:59], v[160:175]
  v_mfma_f32_32x32x16_bf16 v[176:191], v[24:27], v[60:63], v[176:191]
  v_mfma_f32_32x32x16_bf16 v[192:207], v[28:31], v[48:51], v[192:207]
  v_mfma_f32_32x32x16_bf16 v[208:223], v[28:31], v[52:55], v[208:223]
  v_mfma_f32_32x32x16_bf16 v[224:239], v[28:31], v[56:59], v[224:239]
  v_mfma_f32_32x32x16_bf16 v[240:255], v[28:31], v[60:63], v[240:255]
  s_waitcnt vmcnt(12)
  s_barrier
  ds_read_b128 v[16:19], v6 offset:0
  ds_read_b128 v[20:23], v6 offset:4096
  ds_read_b64_tr_b16 v[32:33], v10 offset:0
  ds_read_b64_tr_b16 v[34:35], v10 offset:2048
  ds_read_b64_tr_b16 v[36:37], v11 offset:0
  ds_read_b64_tr_b16 v[38:39], v11 offset:2048
  ds_read_b64_tr_b16 v[40:41], v12 offset:0
  ds_read_b64_tr_b16 v[42:43], v12 offset:2048
  ds_read_b64_tr_b16 v[44:45], v13 offset:0
  ds_read_b64_tr_b16 v[46:47], v13 offset:2048
  ds_read_b128 v[24:27], v7 offset:0
  ds_read_b128 v[28:31], v7 offset:4096
  ds_read_b64_tr_b16 v[48:49], v10 offset:8192
  ds_read_b64_tr_b16 v[50:51], v10 offset:10240
  ds_read_b64_tr_b16 v[52:53], v11 offset:8192
  ds_read_b64_tr_b16 v[54:55], v11 offset:10240
  ds_read_b64_tr_b16 v[56:57], v12 offset:8192
  ds_read_b64_tr_b16 v[58:59], v12 offset:10240
  ds_read_b64_tr_b16 v[60:61], v13 offset:8192
  ds_read_b64_tr_b16 v[62:63], v13 offset:10240
  s_waitcnt lgkmcnt(10)
  v_mfma_f32_32x32x16_bf16 v[128:143], v[16:19], v[32:35], v[128:143]
  v_mfma_f32_32x32x16_bf16 v[144:159], v[16:19], v[36:39], v[144:159]
  s_add_u32 s44, s30, s46
  s_add_u32 m0, s50, 131072
  buffer_load_dwordx4 v2, s[12:15], s44 offen lds
  v_mfma_f32_32x32x16_bf16 v[160:175], v[16:19], v[40:43], v[160:175]
  v_mfma_f32_32x32x16_bf16 v[176:191], v[16:19], v[44:47], v[176:191]
  s_add_u32 s44, s30, s47
  s_add_u32 m0, s50, 132096
  buffer_load_dwordx4 v3, s[12:15], s44 offen lds
  v_mfma_f32_32x32x16_bf16 v[192:207], v[20:23], v[32:35], v[192:207]
  v_mfma_f32_32x32x16_bf16 v[208:223], v[20:23], v[36:39], v[208:223]
  s_add_u32 s44, s30, s48
  s_add_u32 m0, s50, 133120
  buffer_load_dwordx4 v2, s[12:15], s44 offen lds
  v_mfma_f32_32x32x16_bf16 v[224:239], v[20:23], v[40:43], v[224:239]
  v_mfma_f32_32x32x16_bf16 v[240:255], v[20:23], v[44:47], v[240:255]
  s_add_u32 s44, s30, s49
  s_add_u32 m0, s50, 134144
  buffer_load_dwordx4 v3, s[12:15], s44 offen lds
  ds_read_b128 v[16:19], v8 offset:0
  ds_read_b128 v[20:23], v8 offset:4096
  ds_read_b64_tr_b16 v[32:33], v10 offset:16384
  ds_read_b64_tr_b16 v[34:35], v10 offset:18432
  ds_read_b64_tr_b16 v[36:37], v11 offset:16384
  ds_read_b64_tr_b16 v[38:39], v11 offset:18432
  ds_read_b64_tr_b16 v[40:41], v12 offset:16384
  ds_read_b64_tr_b16 v[42:43], v12 offset:18432
  ds_read_b64_tr_b16 v[44:45], v13 offset:16384
  ds_read_b64_tr_b16 v[46:47], v13 offset:18432
  s_waitcnt lgkmcnt(10)
  v_mfma_f32_32x32x16_bf16 v[128:143], v[24:27], v[48:51], v[128:143]
  v_mfma_f32_32x32x16_bf16 v[144:159], v[24:27], v[52:55], v[144:159]
  s_add_u32 s44, s31, s52
  s_add_u32 m0, s51, 65536
  buffer_load_dwordx4 v4, s[16:19], s44 offen lds
  v_mfma_f32_32x32x16_bf16 v[160:175], v[24:27], v[56:59], v[160:175]
  v_mfma_f32_32x32x16_bf16 v[176:191], v[24:27], v[60:63], v[176:191]
  s_add_u32 s44, s31, s53
  s_add_u32 m0, s51, 66560
  buffer_load_dwordx4 v5, s[16:19], s44 offen lds
  v_mfma_f32_32x32x16_bf16 v[192:207], v[28:31], v[48:51], v[192:207]
  v_mfma_f32_32x32x16_bf16 v[208:223], v[28:31], v[52:55], v[208:223]
  s_add_u32 s44, s31, s54
  s_add_u32 m0, s51, 67584
  buffer_load_dwordx4 v4, s[16:19], s44 offen lds
  v_mfma_f32_32x32x16_bf16 v[224:239], v[28:31], v[56:59], v[224:239]
  v_mfma_f32_32x32x16_bf16 v[240:255], v[28:31], v[60:63], v[240:255]
  s_add_u32 s44, s31, s55
  s_add_u32 m0, s51, 68608
  buffer_load_dwordx4 v5, s[16:19], s44 offen lds
  ds_read_b128 v[24:27], v9 offset:0
  ds_read_b128 v[28:31], v9 offset:4096
  ds_read_b64_tr_b16 v[48:49], v10 offset:24576
  ds_read_b64_tr_b16 v[50:51], v10 offset:26624
  ds_read_b64_tr_b16 v[52:53], v11 offset:24576
  ds_read_b64_tr_b16 v[54:55], v11 offset:26624
  ds_read_b64_tr_b16 v[56:57], v12 offset:24576
  ds_read_b64_tr_b16 v[58:59], v12 offset:26624
  ds_read_b64_tr_b16 v[60:61], v13 offset:24576
  ds_read_b64_tr_b16 v[62:63], v13 offset:26624
  s_waitcnt lgkmcnt(10)
  v_mfma_f32_32x32x16_bf16 v[128:143], v[16:19], v[32:35], v[128:143]
  v_mfma_f32_32x32x16_bf16 v[144:159], v[16:19], v[36:39], v[144:159]
  s_add_u32 s44, s31, s56
  s_add_u32 m0, s51, 69632
  buffer_load_dwordx4 v4, s[16:19], s44 offen lds
  v_mfma_f32_32x32x16_bf16 v[160:175], v[16:19], v[40:43], v[160:175]
  v_mfma_f32_32x32x16_bf16 v[176:191], v[16:19], v[44:47], v[176:191]
  s_add_u32 s44, s31, s57
  s_add_u32 m0, s51, 70656
  buffer_load_dwordx4 v5, s[16:19], s44 offen lds
  v_mfma_f32_32x32x16_bf16 v[192:207], v[20:23], v[32:35], v[192:207]
  v_mfma_f32_32x32x16_bf16 v[208:223], v[20:23], v[36:39], v[208:223]
  s_add_u32 s44, s31, s58
  s_add_u32 m0, s51, 71680
  buffer_load_dwordx4 v4, s[16:19], s44 offen lds
  v_mfma_f32_32x32x16_bf16 v[224:239], v[20:23], v[40:43], v[224:239]
  v_mfma_f32_32x32x16_bf16 v[240:255], v[20:23], v[44:47], v[240:255]
  s_add_u32 s44, s31, s59
  s_add_u32 m0, s51, 72704
  buffer_load_dwordx4 v5, s[16:19], s44 offen lds
  s_waitcnt lgkmcnt(0)
  v_mfma_f32_32x32x16_bf16 v[128:143], v[24:27], v[48:51], v[128:143]
  v_mfma_f32_32x32x16_bf16 v[144:159], v[24:27], v[52:55], v[144:159]
  s_add_u32 s30, s30, 128
  s_add_u32 s31, s31, 524288
  v_mfma_f32_32x32x16_bf16 v[160:175], v[24:27], v[56:59], v[160:175]
  v_mfma_f32_32x32x16_bf16 v[176:191], v[24:27], v[60:63], v[176:191]
  v_mfma_f32_32x32x16_bf16 v[192:207], v[28:31], v[48:51], v[192:207]
  v_mfma_f32_32x32x16_bf16 v[208:223], v[28:31], v[52:55], v[208:223]
  v_mfma_f32_32x32x16_bf16 v[224:239], v[28:31], v[56:59], v[224:239]
  v_mfma_f32_32x32x16_bf16 v[240:255], v[28:31], v[60:63], v[240:255]
  s_waitcnt vmcnt(12)
  s_barrier
  ds_read_b128 v[16:19], v6 offset:16384
  ds_read_b128 v[20:23], v6 offset:20480
  ds_read_b64_tr_b16 v[32:33], v10 offset:32768
  ds_read_b64_tr_b16 v[34:35], v10 offset:34816
  ds_read_b64_tr_b16 v[36:37], v11 offset:32768
  ds_read_b64_tr_b16 v[38:39], v11 offset:34816
  ds_read_b64_tr_b16 v[40:41], v12 offset:32768
  ds_read_b64_tr_b16 v[42:43], v12 offset:34816
  ds_read_b64_tr_b16 v[44:45], v13 offset:32768
  ds_read_b64_tr_b16 v[46:47], v13 offset:34816
  ds_read_b128 v[24:27], v7 offset:16384
  ds_read_b128 v[28:31], v7 offset:20480
  ds_read_b64_tr_b16 v[48:49], v10 offset:40960
  ds_read_b64_tr_b16 v[50:51], v10 offset:43008
  ds_read_b64_tr_b16 v[52:53], v11 offset:40960
  ds_read_b64_tr_b16 v[54:55], v11 offset:43008
  ds_read_b64_tr_b16 v[56:57], v12 offset:40960
  ds_read_b64_tr_b16 v[58:59], v12 offset:43008
  ds_read_b64_tr_b16 v[60:61], v13 offset:40960
  ds_read_b64_tr_b16 v[62:63], v13 offset:43008
  s_waitcnt lgkmcnt(10)
  v_mfma_f32_32x32x16_bf16 v[128:143], v[16:19], v[32:35], v[128:143]
  v_mfma_f32_32x32x16_bf16 v[144:159], v[16:19], v[36:39], v[144:159]
  s_add_u32 s44, s30, s46
  s_add_u32 m0, s50, 98304
  buffer_load_dwordx4 v2, s[12:15], s44 offen lds
  v_mfma_f32_32x32x16_bf16 v[160:175], v[16:19], v[40:43], v[160:175]
  v_mfma_f32_32x32x16_bf16 v[176:191], v[16:19], v[44:47], v[176:191]
  s_add_u32 s44, s30, s47
  s_add_u32 m0, s50, 99328
  buffer_load_dwordx4 v3, s[12:15], s44 offen lds
  v_mfma_f32_32x32x16_bf16 v[192:207], v[20:23], v[32:35], v[192:207]
  v_mfma_f32_32x32x16_bf16 v[208:223], v[20:23], v[36:39], v[208:223]
  s_add_u32 s44, s30, s48
  s_add_u32 m0, s50, 100352
  buffer_load_dwordx4 v2, s[12:15], s44 offen lds
  v_mfma_f32_32x32x16_bf16 v[224:239], v[20:23], v[40:43], v[224:239]
  v_mfma_f32_32x32x16_bf16 v[240:255], v[20:23], v[44:47], v[240:255]
  s_add_u32 s44, s30, s49
  s_add_u32 m0, s50, 101376
  buffer_load_dwordx4 v3, s[12:15], s44 offen lds
  ds_read_b128 v[16:19], v8 offset:16384
  ds_read_b128 v[20:23], v8 offset:20480
  ds_read_b64_tr_b16 v[32:33], v10 offset:49152
  ds_read_b64_tr_b16 v[34:35], v10 offset:51200
  ds_read_b64_tr_b16 v[36:37], v11 offset:49152
  ds_read_b64_tr_b16 v[38:39], v11 offset:51200
  ds_read_b64_tr_b16 v[40:41], v12 offset:49152
  ds_read_b64_tr_b16 v[42:43], v12 offset:51200
  ds_read_b64_tr_b16 v[44:45], v13 offset:49152
  ds_read_b64_tr_b16 v[46:47], v13 offset:51200
  s_waitcnt lgkmcnt(10)
  v_mfma_f32_32x32x16_bf16 v[128:143], v[24:27], v[48:51], v[128:143]
  v_mfma_f32_32x32x16_bf16 v[144:159], v[24:27], v[52:55], v[144:159]
  s_add_u32 s44, s31, s52
  s_add_u32 m0, s51, 0
  buffer_load_dwordx4 v4, s[16:19], s44 offen lds
  v_mfma_f32_32x32x16_bf16 v[160:175], v[24:27], v[56:59], v[160:175]
  v_mfma_f32_32x32x16_bf16 v[176:191], v[24:27], v[60:63], v[176:191]
  s_add_u32 s44, s31, s53
  s_add_u32 m0, s51, 1024
  buffer_load_dwordx4 v5, s[16:19], s44 offen lds
  v_mfma_f32_32x32x16_bf16 v[192:207], v[28:31], v[48:51], v[192:207]
  v_mfma_f32_32x32x16_bf16 v[208:223], v[28:31], v[52:55], v[208:223]
  s_add_u32 s44, s31, s54
  s_add_u32 m0, s51, 2048
  buffer_load_dwordx4 v4, s[16:19], s44 offen lds
  v_mfma_f32_32x32x16_bf16 v[224:239], v[28:31], v[56:59], v[224:239]
  v_mfma_f32_32x32x16_bf16 v[240:255], v[28:31], v[60:63], v[240:255]
  s_add_u32 s44, s31, s55
  s_add_u32 m0, s51, 3072
  buffer_load_dwordx4 v5, s[16:19], s44 offen lds
  ds_read_b128 v[24:27], v9 offset:16384
  ds_read_b128 v[28:31], v9 offset:20480
  ds_read_b64_tr_b16 v[48:49], v10 offset:57344
  ds_read_b64_tr_b16 v[50:51], v10 offset:59392
  ds_read_b64_tr_b16 v[52:53], v11 offset:57344
  ds_read_b64_tr_b16 v[54:55], v11 offset:59392
  ds_read_b64_tr_b16 v[56:57], v12 offset:57344
  ds_read_b64_tr_b16 v[58:59], v12 offset:59392
  ds_read_b64_tr_b16 v[60:61], v13 offset:57344
  ds_read_b64_tr_b16 v[62:63], v13 offset:59392
  s_waitcnt lgkmcnt(10)
  v_mfma_f32_32x32x16_bf16 v[128:143], v[16:19], v[32:35], v[128:143]
  v_mfma_f32_32x32x16_bf16 v[144:159], v[16:19], v[36:39], v[144:159]
  s_add_u32 s44, s31, s56
  s_add_u32 m0, s51, 4096
  buffer_load_dwordx4 v4, s[16:19], s44 offen lds
  v_mfma_f32_32x32x16_bf16 v[160:175], v[16:19], v[40:43], v[160:175]
  v_mfma_f32_32x32x16_bf16 v[176:191], v[16:19], v[44:47], v[176:191]
  s_add_u32 s44, s31, s57
  s_add_u32 m0, s51, 5120
  buffer_load_dwordx4 v5, s[16:19], s44 offen lds
  v_mfma_f32_32x32x16_bf16 v[192:207], v[20:23], v[32:35], v[192:207]
  v_mfma_f32_32x32x16_bf16 v[208:223], v[20:23], v[36:39], v[208:223]
  s_add_u32 s44, s31, s58
  s_add_u32 m0, s51, 6144
  buffer_load_dwordx4 v4, s[16:19], s44 offen lds
  v_mfma_f32_32x32x16_bf16 v[224:239], v[20:23], v[40:43], v[224:239]
  v_mfma_f32_32x32x16_bf16 v[240:255], v[20:23], v[44:47], v[240:255]
  s_add_u32 s44, s31, s59
  s_add_u32 m0, s51, 7168
  buffer_load_dwordx4 v5, s[16:19], s44 offen lds
  s_waitcnt lgkmcnt(0)
  v_mfma_f32_32x32x16_bf16 v[128:143], v[24:27], v[48:51], v[128:143]
  v_mfma_f32_32x32x16_bf16 v[144:159], v[24:27], v[52:55], v[144:159]
  s_add_u32 s30, s30, 128
  s_add_u32 s31, s31, 524288
  v_mfma_f32_32x32x16_bf16 v[160:175], v[24:27], v[56:59], v[160:175]
  v_mfma_f32_32x32x16_bf16 v[176:191], v[24:27], v[60:63], v[176:191]
  v_mfma_f32_32x32x16_bf16 v[192:207], v[28:31], v[48:51], v[192:207]
  v_mfma_f32_32x32x16_bf16 v[208:223], v[28:31], v[52:55], v[208:223]
  v_mfma_f32_32x32x16_bf16 v[224:239], v[28:31], v[56:59], v[224:239]
  v_mfma_f32_32x32x16_bf16 v[240:255], v[28:31], v[60:63], v[240:255]
  s_waitcnt vmcnt(12)
  s_barrier
  ds_read_b128 v[16:19], v6 offset:32768
  ds_read_b128 v[20:23], v6 offset:36864
  ds_read_b64_tr_b16 v[32:33], v64 offset:0
  ds_read_b64_tr_b16 v[34:35], v64 offset:2048
  ds_read_b64_tr_b16 v[36:37], v65 offset:0
  ds_read_b64_tr_b16 v[38:39], v65 offset:2048
  ds_read_b64_tr_b16 v[40:41], v66 offset:0
  ds_read_b64_tr_b16 v[42:43], v66 offset:2048
  ds_read_b64_tr_b16 v[44:45], v67 offset:0
  ds_read_b64_tr_b16 v[46:47], v67 offset:2048
  ds_read_b128 v[24:27], v7 offset:32768
  ds_read_b128 v[28:31], v7 offset:36864
  ds_read_b64_tr_b16 v[48:49], v64 offset:8192
  ds_read_b64_tr_b16 v[50:51], v64 offset:10240
  ds_read_b64_tr_b16 v[52:53], v65 offset:8192
  ds_read_b64_tr_b16 v[54:55], v65 offset:10240
  ds_read_b64_tr_b16 v[56:57], v66 offset:8192
  ds_read_b64_tr_b16 v[58:59], v66 offset:10240
  ds_read_b64_tr_b16 v[60:61], v67 offset:8192
  ds_read_b64_tr_b16 v[62:63], v67 offset:10240
  s_waitcnt lgkmcnt(10)
  v_mfma_f32_32x32x16_bf16 v[128:143], v[16:19], v[32:35], v[128:143]
  v_mfma_f32_32x32x16_bf16 v[144:159], v[16:19], v[36:39], v[144:159]
  s_add_u32 s44, s30, s46
  s_add_u32 m0, s50, 114688
  buffer_load_dwordx4 v2, s[12:15], s44 offen lds
  v_mfma_f32_32x32x16_bf16 v[160:175], v[16:19], v[40:43], v[160:175]
  v_mfma_f32_32x32x16_bf16 v[176:191], v[16:19], v[44:47], v[176:191]
  s_add_u32 s44, s30, s47
  s_add_u32 m0, s50, 115712
  buffer_load_dwordx4 v3, s[12:15], s44 offen lds
  v_mfma_f32_32x32x16_bf16 v[192:207], v[20:23], v[32:35], v[192:207]
  v_mfma_f32_32x32x16_bf16 v[208:223], v[20:23], v[36:39], v[208:223]
  s_add_u32 s44, s30, s48
  s_add_u32 m0, s50, 116736
  buffer_load_dwordx4 v2, s[12:15], s44 offen lds
  v_mfma_f32_32x32x16_bf16 v[224:239], v[20:23], v[40:43], v[224:239]
  v_mfma_f32_32x32x16_bf16 v[240:255], v[20:23], v[44:47], v[240:255]
  s_add_u32 s44, s30, s49
  s_add_u32 m0, s50, 117760
  buffer_load_dwordx4 v3, s[12:15], s44 offen lds
  ds_read_b128 v[16:19], v8 offset:32768
  ds_read_b128 v[20:23], v8 offset:36864
  ds_read_b64_tr_b16 v[32:33], v64 offset:16384
  ds_read_b64_tr_b16 v[34:35], v64 offset:18432
  ds_read_b64_tr_b16 v[36:37], v65 offset:16384
  ds_read_b64_tr_b16 v[38:39], v65 offset:18432
  ds_read_b64_tr_b16 v[40:41], v66 offset:16384
  ds_read_b64_tr_b16 v[42:43], v66 offset:18432
  ds_read_b64_tr_b16 v[44:45], v67 offset:16384
  ds_read_b64_tr_b16 v[46:47], v67 offset:18432
  s_waitcnt lgkmcnt(10)
  v_mfma_f32_32x32x16_bf16 v[128:143], v[24:27], v[48:51], v[128:143]
  v_mfma_f32_32x32x16_bf16 v[144:159], v[24:27], v[52:55], v[144:159]
  s_add_u32 s44, s31, s52
  s_add_u32 m0, s51, 32768
  buffer_load_dwordx4 v4, s[16:19], s44 offen lds
  v_mfma_f32_32x32x16_bf16 v[160:175], v[24:27], v[56:59], v[160:175]
  v_mfma_f32_32x32x16_bf16 v[176:191], v[24:27], v[60:63], v[176:191]
  s_add_u32 s44, s31, s53
  s_add_u32 m0, s51, 33792
  buffer_load_dwordx4 v5, s[16:19], s44 offen lds
  v_mfma_f32_32x32x16_bf16 v[192:207], v[28:31], v[48:51], v[192:207]
  v_mfma_f32_32x32x16_bf16 v[208:223], v[28:31], v[52:55], v[208:223]
  s_add_u32 s44, s31, s54
  s_add_u32 m0, s51, 34816
  buffer_load_dwordx4 v4, s[16:19], s44 offen lds
  v_mfma_f32_32x32x16_bf16 v[224:239], v[28:31], v[56:59], v[224:239]
  v_mfma_f32_32x32x16_bf16 v[240:255], v[28:31], v[60:63], v[240:255]
  s_add_u32 s44, s31, s55
  s_add_u32 m0, s51, 35840
  buffer_load_dwordx4 v5, s[16:19], s44 offen lds
  ds_read_b128 v[24:27], v9 offset:32768
  ds_read_b128 v[28:31], v9 offset:36864
  ds_read_b64_tr_b16 v[48:49], v64 offset:24576
  ds_read_b64_tr_b16 v[50:51], v64 offset:26624
  ds_read_b64_tr_b16 v[52:53], v65 offset:24576
  ds_read_b64_tr_b16 v[54:55], v65 offset:26624
  ds_read_b64_tr_b16 v[56:57], v66 offset:24576
  ds_read_b64_tr_b16 v[58:59], v66 offset:26624
  ds_read_b64_tr_b16 v[60:61], v67 offset:24576
  ds_read_b64_tr_b16 v[62:63], v67 offset:26624
  s_waitcnt lgkmcnt(10)
  v_mfma_f32_32x32x16_bf16 v[128:143], v[16:19], v[32:35], v[128:143]
  v_mfma_f32_32x32x16_bf16 v[144:159], v[16:19], v[36:39], v[144:159]
  s_add_u32 s44, s31, s56
  s_add_u32 m0, s51, 36864
  buffer_load_dwordx4 v4, s[16:19], s44 offen lds
  v_mfma_f32_32x32x16_bf16 v[160:175], v[16:19], v[40:43], v[160:175]
  v_mfma_f32_32x32x16_bf16 v[176:191], v[16:19], v[44:47], v[176:191]
  s_add_u32 s44, s31, s57
  s_add_u32 m0, s51, 37888
  buffer_load_dwordx4 v5, s[16:19], s44 offen lds
  v_mfma_f32_32x32x16_bf16 v[192:207], v[20:23], v[32:35], v[192:207]
  v_mfma_f32_32x32x16_bf16 v[208:223], v[20:23], v[36:39], v[208:223]
  s_add_u32 s44, s31, s58
  s_add_u32 m0, s51, 38912
  buffer_load_dwordx4 v4, s[16:19], s44 offen lds
  v_mfma_f32_32x32x16_bf16 v[224:239], v[20:23], v[40:43], v[224:239]
  v_mfma_f32_32x32x16_bf16 v[240:255], v[20:23], v[44:47], v[240:255]
  s_add_u32 s44, s31, s59
  s_add_u32 m0, s51, 39936
  buffer_load_dwordx4 v5, s[16:19], s44 offen lds
  s_waitcnt lgkmcnt(0)
  v_mfma_f32_32x32x16_bf16 v[128:143], v[24:27], v[48:51], v[128:143]
  v_mfma_f32_32x32x16_bf16 v[144:159], v[24:27], v[52:55], v[144:159]
  s_add_u32 s30, s30, 128
  s_add_u32 s31, s31, 524288
  v_mfma_f32_32x32x16_bf16 v[160:175], v[24:27], v[56:59], v[160:175]
  v_mfma_f32_32x32x16_bf16 v[176:191], v[24:27], v[60:63], v[176:191]
  v_mfma_f32_32x32x16_bf16 v[192:207], v[28:31], v[48:51], v[192:207]
  v_mfma_f32_32x32x16_bf16 v[208:223], v[28:31], v[52:55], v[208:223]
  v_mfma_f32_32x32x16_bf16 v[224:239], v[28:31], v[56:59], v[224:239]
  v_mfma_f32_32x32x16_bf16 v[240:255], v[28:31], v[60:63], v[240:255]
  s_waitcnt vmcnt(12)
  s_barrier
  ds_read_b128 v[16:19], v6 offset:0
  ds_read_b128 v[20:23], v6 offset:4096
  ds_read_b64_tr_b16 v[32:33], v10 offset:0
  ds_read_b64_tr_b16 v[34:35], v10 offset:2048
  ds_read_b64_tr_b16 v[36:37], v11 offset:0
  ds_read_b64_tr_b16 v[38:39], v11 offset:2048
  ds_read_b64_tr_b16 v[40:41], v12 offset:0
  ds_read_b64_tr_b16 v[42:43], v12 offset:2048
  ds_read_b64_tr_b16 v[44:45], v13 offset:0
  ds_read_b64_tr_b16 v[46:47], v13 offset:2048
  ds_read_b128 v[24:27], v7 offset:0
  ds_read_b128 v[28:31], v7 offset:4096
  ds_read_b64_tr_b16 v[48:49], v10 offset:8192
  ds_read_b64_tr_b16 v[50:51], v10 offset:10240
  ds_read_b64_tr_b16 v[52:53], v11 offset:8192
  ds_read_b64_tr_b16 v[54:55], v11 offset:10240
  ds_read_b64_tr_b16 v[56:57], v12 offset:8192
  ds_read_b64_tr_b16 v[58:59], v12 offset:10240
  ds_read_b64_tr_b16 v[60:61], v13 offset:8192
  ds_read_b64_tr_b16 v[62:63], v13 offset:10240
  s_waitcnt lgkmcnt(10)
  v_mfma_f32_32x32x16_bf16 v[128:143], v[16:19], v[32:35], v[128:143]
  v_mfma_f32_32x32x16_bf16 v[144:159], v[16:19], v[36:39], v[144:159]
  s_add_u32 s44, s30, s46
  s_add_u32 m0, s50, 131072
  buffer_load_dwordx4 v2, s[12:15], s44 offen lds
  v_mfma_f32_32x32x16_bf16 v[160:175], v[16:19], v[40:43], v[160:175]
  v_mfma_f32_32x32x16_bf16 v[176:191], v[16:19], v[44:47], v[176:191]
  s_add_u32 s44, s30, s47
  s_add_u32 m0, s50, 132096
  buffer_load_dwordx4 v3, s[12:15], s44 offen lds
  v_mfma_f32_32x32x16_bf16 v[192:207], v[20:23], v[32:35], v[192:207]
  v_mfma_f32_32x32x16_bf16 v[208:223], v[20:23], v[36:39], v[208:223]
  s_add_u32 s44, s30, s48
  s_add_u32 m0, s50, 133120
  buffer_load_dwordx4 v2, s[12:15], s44 offen lds
  v_mfma_f32_32x32x16_bf16 v[224:239], v[20:23], v[40:43], v[224:239]
  v_mfma_f32_32x32x16_bf16 v[240:255], v[20:23], v[44:47], v[240:255]
  s_add_u32 s44, s30, s49
  s_add_u32 m0, s50, 134144
  buffer_load_dwordx4 v3, s[12:15], s44 offen lds
  ds_read_b128 v[16:19], v8 offset:0
  ds_read_b128 v[20:23], v8 offset:4096
  ds_read_b64_tr_b16 v[32:33], v10 offset:16384
  ds_read_b64_tr_b16 v[34:35], v10 offset:18432
  ds_read_b64_tr_b16 v[36:37], v11 offset:16384
  ds_read_b64_tr_b16 v[38:39], v11 offset:18432
  ds_read_b64_tr_b16 v[40:41], v12 offset:16384
  ds_read_b64_tr_b16 v[42:43], v12 offset:18432
  ds_read_b64_tr_b16 v[44:45], v13 offset:16384
  ds_read_b64_tr_b16 v[46:47], v13 offset:18432
  s_waitcnt lgkmcnt(10)
  v_mfma_f32_32x32x16_bf16 v[128:143], v[24:27], v[48:51], v[128:143]
  v_mfma_f32_32x32x16_bf16 v[144:159], v[24:27], v[52:55], v[144:159]
  s_add_u32 s44, s31, s52
  s_add_u32 m0, s51, 65536
  buffer_load_dwordx4 v4, s[16:19], s44 offen lds
  v_mfma_f32_32x32x16_bf16 v[160:175], v[24:27], v[56:59], v[160:175]
  v_mfma_f32_32x32x16_bf16 v[176:191], v[24:27], v[60:63], v[176:191]
  s_add_u32 s44, s31, s53
  s_add_u32 m0, s51, 66560
  buffer_load_dwordx4 v5, s[16:19], s44 offen lds
  v_mfma_f32_32x32x16_bf16 v[192:207], v[28:31], v[48:51], v[192:207]
  v_mfma_f32_32x32x16_bf16 v[208:223], v[28:31], v[52:55], v[208:223]
  s_add_u32 s44, s31, s54
  s_add_u32 m0, s51, 67584
  buffer_load_dwordx4 v4, s[16:19], s44 offen lds
  v_mfma_f32_32x32x16_bf16 v[224:239], v[28:31], v[56:59], v[224:239]
  v_mfma_f32_32x32x16_bf16 v[240:255], v[28:31], v[60:63], v[240:255]
  s_add_u32 s44, s31, s55
  s_add_u32 m0, s51, 68608
  buffer_load_dwordx4 v5, s[16:19], s44 offen lds
  ds_read_b128 v[24:27], v9 offset:0
  ds_read_b128 v[28:31], v9 offset:4096
  ds_read_b64_tr_b16 v[48:49], v10 offset:24576
  ds_read_b64_tr_b16 v[50:51], v10 offset:26624
  ds_read_b64_tr_b16 v[52:53], v11 offset:24576
  ds_read_b64_tr_b16 v[54:55], v11 offset:26624
  ds_read_b64_tr_b16 v[56:57], v12 offset:24576
  ds_read_b64_tr_b16 v[58:59], v12 offset:26624
  ds_read_b64_tr_b16 v[60:61], v13 offset:24576
  ds_read_b64_tr_b16 v[62:63], v13 offset:26624
  s_waitcnt lgkmcnt(10)
  v_mfma_f32_32x32x16_bf16 v[128:143], v[16:19], v[32:35], v[128:143]
  v_mfma_f32_32x32x16_bf16 v[144:159], v[16:19], v[36:39], v[144:159]
  s_add_u32 s44, s31, s56
  s_add_u32 m0, s51, 69632
  buffer_load_dwordx4 v4, s[16:19], s44 offen lds
  v_mfma_f32_32x32x16_bf16 v[160:175], v[16:19], v[40:43], v[160:175]
  v_mfma_f32_32x32x16_bf16 v[176:191], v[16:19], v[44:47], v[176:191]
  s_add_u32 s44, s31, s57
  s_add_u32 m0, s51, 70656
  buffer_load_dwordx4 v5, s[16:19], s44 offen lds
  v_mfma_f32_32x32x16_bf16 v[192:207], v[20:23], v[32:35], v[192:207]
  v_mfma_f32_32x32x16_bf16 v[208:223], v[20:23], v[36:39], v[208:223]
  s_add_u32 s44, s31, s58
  s_add_u32 m0, s51, 71680
  buffer_load_dwordx4 v4, s[16:19], s44 offen lds
  v_mfma_f32_32x32x16_bf16 v[224:239], v[20:23], v[40:43], v[224:239]
  v_mfma_f32_32x32x16_bf16 v[240:255], v[20:23], v[44:47], v[240:255]
  s_add_u32 s44, s31, s59
  s_add_u32 m0, s51, 72704
  buffer_load_dwordx4 v5, s[16:19], s44 offen lds
  s_waitcnt lgkmcnt(0)
  v_mfma_f32_32x32x16_bf16 v[128:143], v[24:27], v[48:51], v[128:143]
  v_mfma_f32_32x32x16_bf16 v[144:159], v[24:27], v[52:55], v[144:159]
  s_add_u32 s30, s30, 128
  s_add_u32 s31, s31, 524288
  v_mfma_f32_32x32x16_bf16 v[160:175], v[24:27], v[56:59], v[160:175]
  v_mfma_f32_32x32x16_bf16 v[176:191], v[24:27], v[60:63], v[176:191]
  v_mfma_f32_32x32x16_bf16 v[192:207], v[28:31], v[48:51], v[192:207]
  v_mfma_f32_32x32x16_bf16 v[208:223], v[28:31], v[52:55], v[208:223]
  v_mfma_f32_32x32x16_bf16 v[224:239], v[28:31], v[56:59], v[224:239]
  v_mfma_f32_32x32x16_bf16 v[240:255], v[28:31], v[60:63], v[240:255]
  s_waitcnt vmcnt(12)
  s_barrier
  ds_read_b128 v[16:19], v6 offset:16384
  ds_read_b128 v[20:23], v6 offset:20480
  ds_read_b64_tr_b16 v[32:33], v10 offset:32768
  ds_read_b64_tr_b16 v[34:35], v10 offset:34816
  ds_read_b64_tr_b16 v[36:37], v11 offset:32768
  ds_read_b64_tr_b16 v[38:39], v11 offset:34816
  ds_read_b64_tr_b16 v[40:41], v12 offset:32768
  ds_read_b64_tr_b16 v[42:43], v12 offset:34816
  ds_read_b64_tr_b16 v[44:45], v13 offset:32768
  ds_read_b64_tr_b16 v[46:47], v13 offset:34816
  ds_read_b128 v[24:27], v7 offset:16384
  ds_read_b128 v[28:31], v7 offset:20480
  ds_read_b64_tr_b16 v[48:49], v10 offset:40960
  ds_read_b64_tr_b16 v[50:51], v10 offset:43008
  ds_read_b64_tr_b16 v[52:53], v11 offset:40960
  ds_read_b64_tr_b16 v[54:55], v11 offset:43008
  ds_read_b64_tr_b16 v[56:57], v12 offset:40960
  ds_read_b64_tr_b16 v[58:59], v12 offset:43008
  ds_read_b64_tr_b16 v[60:61], v13 offset:40960
  ds_read_b64_tr_b16 v[62:63], v13 offset:43008
  s_waitcnt lgkmcnt(10)
  v_mfma_f32_32x32x16_bf16 v[128:143], v[16:19], v[32:35], v[128:143]
  v_mfma_f32_32x32x16_bf16 v[144:159], v[16:19], v[36:39], v[144:159]
  s_add_u32 s44, s30, s46
  s_add_u32 m0, s50, 98304
  buffer_load_dwordx4 v2, s[12:15], s44 offen lds
  v_mfma_f32_32x32x16_bf16 v[160:175], v[16:19], v[40:43], v[160:175]
  v_mfma_f32_32x32x16_bf16 v[176:191], v[16:19], v[44:47], v[176:191]
  s_add_u32 s44, s30, s47
  s_add_u32 m0, s50, 99328
  buffer_load_dwordx4 v3, s[12:15], s44 offen lds
  v_mfma_f32_32x32x16_bf16 v[192:207], v[20:23], v[32:35], v[192:207]
  v_mfma_f32_32x32x16_bf16 v[208:223], v[20:23], v[36:39], v[208:223]
  s_add_u32 s44, s30, s48
  s_add_u32 m0, s50, 100352
  buffer_load_dwordx4 v2, s[12:15], s44 offen lds
  v_mfma_f32_32x32x16_bf16 v[224:239], v[20:23], v[40:43], v[224:239]
  v_mfma_f32_32x32x16_bf16 v[240:255], v[20:23], v[44:47], v[240:255]
  s_add_u32 s44, s30, s49
  s_add_u32 m0, s50, 101376
  buffer_load_dwordx4 v3, s[12:15], s44 offen lds
  ds_read_b128 v[16:19], v8 offset:16384
  ds_read_b128 v[20:23], v8 offset:20480
  ds_read_b64_tr_b16 v[32:33], v10 offset:49152
  ds_read_b64_tr_b16 v[34:35], v10 offset:51200
  ds_read_b64_tr_b16 v[36:37], v11 offset:49152
  ds_read_b64_tr_b16 v[38:39], v11 offset:51200
  ds_read_b64_tr_b16 v[40:41], v12 offset:49152
  ds_read_b64_tr_b16 v[42:43], v12 offset:51200
  ds_read_b64_tr_b16 v[44:45], v13 offset:49152
  ds_read_b64_tr_b16 v[46:47], v13 offset:51200
  s_waitcnt lgkmcnt(10)
  v_mfma_f32_32x32x16_bf16 v[128:143], v[24:27], v[48:51], v[128:143]
  v_mfma_f32_32x32x16_bf16 v[144:159], v[24:27], v[52:55], v[144:159]
  s_add_u32 s44, s31, s52
  s_add_u32 m0, s51, 0
  buffer_load_dwordx4 v4, s[16:19], s44 offen lds
  v_mfma_f32_32x32x16_bf16 v[160:175], v[24:27], v[56:59], v[160:175]
  v_mfma_f32_32x32x16_bf16 v[176:191], v[24:27], v[60:63], v[176:191]
  s_add_u32 s44, s31, s53
  s_add_u32 m0, s51, 1024
  buffer_load_dwordx4 v5, s[16:19], s44 offen lds
  v_mfma_f32_32x32x16_bf16 v[192:207], v[28:31], v[48:51], v[192:207]
  v_mfma_f32_32x32x16_bf16 v[208:223], v[28:31], v[52:55], v[208:223]
  s_add_u32 s44, s31, s54
  s_add_u32 m0, s51, 2048
  buffer_load_dwordx4 v4, s[16:19], s44 offen lds
  v_mfma_f32_32x32x16_bf16 v[224:239], v[28:31], v[56:59], v[224:239]
  v_mfma_f32_32x32x16_bf16 v[240:255], v[28:31], v[60:63], v[240:255]
  s_add_u32 s44, s31, s55
  s_add_u32 m0, s51, 3072
  buffer_load_dwordx4 v5, s[16:19], s44 offen lds
  ds_read_b128 v[24:27], v9 offset:16384
  ds_read_b128 v[28:31], v9 offset:20480
  ds_read_b64_tr_b16 v[48:49], v10 offset:57344
  ds_read_b64_tr_b16 v[50:51], v10 offset:59392
  ds_read_b64_tr_b16 v[52:53], v11 offset:57344
  ds_read_b64_tr_b16 v[54:55], v11 offset:59392
  ds_read_b64_tr_b16 v[56:57], v12 offset:57344
  ds_read_b64_tr_b16 v[58:59], v12 offset:59392
  ds_read_b64_tr_b16 v[60:61], v13 offset:57344
  ds_read_b64_tr_b16 v[62:63], v13 offset:59392
  s_waitcnt lgkmcnt(10)
  v_mfma_f32_32x32x16_bf16 v[128:143], v[16:19], v[32:35], v[128:143]
  v_mfma_f32_32x32x16_bf16 v[144:159], v[16:19], v[36:39], v[144:159]
  s_add_u32 s44, s31, s56
  s_add_u32 m0, s51, 4096
  buffer_load_dwordx4 v4, s[16:19], s44 offen lds
  v_mfma_f32_32x32x16_bf16 v[160:175], v[16:19], v[40:43], v[160:175]
  v_mfma_f32_32x32x16_bf16 v[176:191], v[16:19], v[44:47], v[176:191]
  s_add_u32 s44, s31, s57
  s_add_u32 m0, s51, 5120
  buffer_load_dwordx4 v5, s[16:19], s44 offen lds
  v_mfma_f32_32x32x16_bf16 v[192:207], v[20:23], v[32:35], v[192:207]
  v_mfma_f32_32x32x16_bf16 v[208:223], v[20:23], v[36:39], v[208:223]
  s_add_u32 s44, s31, s58
  s_add_u32 m0, s51, 6144
  buffer_load_dwordx4 v4, s[16:19], s44 offen lds
  v_mfma_f32_32x32x16_bf16 v[224:239], v[20:23], v[40:43], v[224:239]
  v_mfma_f32_32x32x16_bf16 v[240:255], v[20:23], v[44:47], v[240:255]
  s_add_u32 s44, s31, s59
  s_add_u32 m0, s51, 7168
  buffer_load_dwordx4 v5, s[16:19], s44 offen lds
  s_waitcnt lgkmcnt(0)
  v_mfma_f32_32x32x16_bf16 v[128:143], v[24:27], v[48:51], v[128:143]
  v_mfma_f32_32x32x16_bf16 v[144:159], v[24:27], v[52:55], v[144:159]
  s_add_u32 s30, s30, 128
  s_add_u32 s31, s31, 524288
  v_mfma_f32_32x32x16_bf16 v[160:175], v[24:27], v[56:59], v[160:175]
  v_mfma_f32_32x32x16_bf16 v[176:191], v[24:27], v[60:63], v[176:191]
  v_mfma_f32_32x32x16_bf16 v[192:207], v[28:31], v[48:51], v[192:207]
  v_mfma_f32_32x32x16_bf16 v[208:223], v[28:31], v[52:55], v[208:223]
  v_mfma_f32_32x32x16_bf16 v[224:239], v[28:31], v[56:59], v[224:239]
  v_mfma_f32_32x32x16_bf16 v[240:255], v[28:31], v[60:63], v[240:255]
  s_waitcnt vmcnt(12)
  s_barrier
  ds_read_b128 v[16:19], v6 offset:32768
  ds_read_b128 v[20:23], v6 offset:36864
  ds_read_b64_tr_b16 v[32:33], v64 offset:0
  ds_read_b64_tr_b16 v[34:35], v64 offset:2048
  ds_read_b64_tr_b16 v[36:37], v65 offset:0
  ds_read_b64_tr_b16 v[38:39], v65 offset:2048
  ds_read_b64_tr_b16 v[40:41], v66 offset:0
  ds_read_b64_tr_b16 v[42:43], v66 offset:2048
  ds_read_b64_tr_b16 v[44:45], v67 offset:0
  ds_read_b64_tr_b16 v[46:47], v67 offset:2048
  ds_read_b128 v[24:27], v7 offset:32768
  ds_read_b128 v[28:31], v7 offset:36864
  ds_read_b64_tr_b16 v[48:49], v64 offset:8192
  ds_read_b64_tr_b16 v[50:51], v64 offset:10240
  ds_read_b64_tr_b16 v[52:53], v65 offset:8192
  ds_read_b64_tr_b16 v[54:55], v65 offset:10240
  ds_read_b64_tr_b16 v[56:57], v66 offset:8192
  ds_read_b64_tr_b16 v[58:59], v66 offset:10240
  ds_read_b64_tr_b16 v[60:61], v67 offset:8192
  ds_read_b64_tr_b16 v[62:63], v67 offset:10240
  s_waitcnt lgkmcnt(10)
  v_mfma_f32_32x32x16_bf16 v[128:143], v[16:19], v[32:35], v[128:143]
  v_mfma_f32_32x32x16_bf16 v[144:159], v[16:19], v[36:39], v[144:159]
  v_mfma_f32_32x32x16_bf16 v[160:175], v[16:19], v[40:43], v[160:175]
  v_mfma_f32_32x32x16_bf16 v[176:191], v[16:19], v[44:47], v[176:191]
  v_mfma_f32_32x32x16_bf16 v[192:207], v[20:23], v[32:35], v[192:207]
  v_mfma_f32_32x32x16_bf16 v[208:223], v[20:23], v[36:39], v[208:223]
  v_mfma_f32_32x32x16_bf16 v[224:239], v[20:23], v[40:43], v[224:239]
  v_mfma_f32_32x32x16_bf16 v[240:255], v[20:23], v[44:47], v[240:255]
  ds_read_b128 v[16:19], v8 offset:32768
  ds_read_b128 v[20:23], v8 offset:36864
  ds_read_b64_tr_b16 v[32:33], v64 offset:16384
  ds_read_b64_tr_b16 v[34:35], v64 offset:18432
  ds_read_b64_tr_b16 v[36:37], v65 offset:16384
  ds_read_b64_tr_b16 v[38:39], v65 offset:18432
  ds_read_b64_tr_b16 v[40:41], v66 offset:16384
  ds_read_b64_tr_b16 v[42:43], v66 offset:18432
  ds_read_b64_tr_b16 v[44:45], v67 offset:16384
  ds_read_b64_tr_b16 v[46:47], v67 offset:18432
  s_waitcnt lgkmcnt(10)
  v_mfma_f32_32x32x16_bf16 v[128:143], v[24:27], v[48:51], v[128:143]
  v_mfma_f32_32x32x16_bf16 v[144:159], v[24:27], v[52:55], v[144:159]
  v_mfma_f32_32x32x16_bf16 v[160:175], v[24:27], v[56:59], v[160:175]
  v_mfma_f32_32x32x16_bf16 v[176:191], v[24:27], v[60:63], v[176:191]
  v_mfma_f32_32x32x16_bf16 v[192:207], v[28:31], v[48:51], v[192:207]
  v_mfma_f32_32x32x16_bf16 v[208:223], v[28:31], v[52:55], v[208:223]
  v_mfma_f32_32x32x16_bf16 v[224:239], v[28:31], v[56:59], v[224:239]
  v_mfma_f32_32x32x16_bf16 v[240:255], v[28:31], v[60:63], v[240:255]
  ds_read_b128 v[24:27], v9 offset:32768
  ds_read_b128 v[28:31], v9 offset:36864
  ds_read_b64_tr_b16 v[48:49], v64 offset:24576
  ds_read_b64_tr_b16 v[50:51], v64 offset:26624
  ds_read_b64_tr_b16 v[52:53], v65 offset:24576
  ds_read_b64_tr_b16 v[54:55], v65 offset:26624
  ds_read_b64_tr_b16 v[56:57], v66 offset:24576
  ds_read_b64_tr_b16 v[58:59], v66 offset:26624
  ds_read_b64_tr_b16 v[60:61], v67 offset:24576
  ds_read_b64_tr_b16 v[62:63], v67 offset:26624
  s_waitcnt lgkmcnt(10)
  v_mfma_f32_32x32x16_bf16 v[128:143], v[16:19], v[32:35], v[128:143]
  v_mfma_f32_32x32x16_bf16 v[144:159], v[16:19], v[36:39], v[144:159]
  v_mfma_f32_32x32x16_bf16 v[160:175], v[16:19], v[40:43], v[160:175]
  v_mfma_f32_32x32x16_bf16 v[176:191], v[16:19], v[44:47], v[176:191]
  v_mfma_f32_32x32x16_bf16 v[192:207], v[20:23], v[32:35], v[192:207]
  v_mfma_f32_32x32x16_bf16 v[208:223], v[20:23], v[36:39], v[208:223]
  v_mfma_f32_32x32x16_bf16 v[224:239], v[20:23], v[40:43], v[224:239]
  v_mfma_f32_32x32x16_bf16 v[240:255], v[20:23], v[44:47], v[240:255]
  s_waitcnt lgkmcnt(0)
  v_mfma_f32_32x32x16_bf16 v[128:143], v[24:27], v[48:51], v[128:143]
  v_mfma_f32_32x32x16_bf16 v[144:159], v[24:27], v[52:55], v[144:159]
  v_mfma_f32_32x32x16_bf16 v[160:175], v[24:27], v[56:59], v[160:175]
  v_mfma_f32_32x32x16_bf16 v[176:191], v[24:27], v[60:63], v[176:191]
  v_mfma_f32_32x32x16_bf16 v[192:207], v[28:31], v[48:51], v[192:207]
  v_mfma_f32_32x32x16_bf16 v[208:223], v[28:31], v[52:55], v[208:223]
  v_mfma_f32_32x32x16_bf16 v[224:239], v[28:31], v[56:59], v[224:239]
  v_mfma_f32_32x32x16_bf16 v[240:255], v[28:31], v[60:63], v[240:255]
  s_waitcnt vmcnt(0)
  s_barrier
  ds_read_b128 v[16:19], v6 offset:0
  ds_read_b128 v[20:23], v6 offset:4096
  ds_read_b64_tr_b16 v[32:33], v10 offset:0
  ds_read_b64_tr_b16 v[34:35], v10 offset:2048
  ds_read_b64_tr_b16 v[36:37], v11 offset:0
  ds_read_b64_tr_b16 v[38:39], v11 offset:2048
  ds_read_b64_tr_b16 v[40:41], v12 offset:0
  ds_read_b64_tr_b16 v[42:43], v12 offset:2048
  ds_read_b64_tr_b16 v[44:45], v13 offset:0
  ds_read_b64_tr_b16 v[46:47], v13 offset:2048
  ds_read_b128 v[24:27], v7 offset:0
  ds_read_b128 v[28:31], v7 offset:4096
  ds_read_b64_tr_b16 v[48:49], v10 offset:8192
  ds_read_b64_tr_b16 v[50:51], v10 offset:10240
  ds_read_b64_tr_b16 v[52:53], v11 offset:8192
  ds_read_b64_tr_b16 v[54:55], v11 offset:10240
  ds_read_b64_tr_b16 v[56:57], v12 offset:8192
  ds_read_b64_tr_b16 v[58:59], v12 offset:10240
  ds_read_b64_tr_b16 v[60:61], v13 offset:8192
  ds_read_b64_tr_b16 v[62:63], v13 offset:10240
  s_waitcnt lgkmcnt(10)
  v_mfma_f32_32x32x16_bf16 v[128:143], v[16:19], v[32:35], v[128:143]
  v_mfma_f32_32x32x16_bf16 v[144:159], v[16:19], v[36:39], v[144:159]
  v_mfma_f32_32x32x16_bf16 v[160:175], v[16:19], v[40:43], v[160:175]
  v_mfma_f32_32x32x16_bf16 v[176:191], v[16:19], v[44:47], v[176:191]
  v_mfma_f32_32x32x16_bf16 v[192:207], v[20:23], v[32:35], v[192:207]
  v_mfma_f32_32x32x16_bf16 v[208:223], v[20:23], v[36:39], v[208:223]
  v_mfma_f32_32x32x16_bf16 v[224:239], v[20:23], v[40:43], v[224:239]
  v_mfma_f32_32x32x16_bf16 v[240:255], v[20:23], v[44:47], v[240:255]
  ds_read_b128 v[16:19], v8 offset:0
  ds_read_b128 v[20:23], v8 offset:4096
  ds_read_b64_tr_b16 v[32:33], v10 offset:16384
  ds_read_b64_tr_b16 v[34:35], v10 offset:18432
  ds_read_b64_tr_b16 v[36:37], v11 offset:16384
  ds_read_b64_tr_b16 v[38:39], v11 offset:18432
  ds_read_b64_tr_b16 v[40:41], v12 offset:16384
  ds_read_b64_tr_b16 v[42:43], v12 offset:18432
  ds_read_b64_tr_b16 v[44:45], v13 offset:16384
  ds_read_b64_tr_b16 v[46:47], v13 offset:18432
  s_waitcnt lgkmcnt(10)
  v_mfma_f32_32x32x16_bf16 v[128:143], v[24:27], v[48:51], v[128:143]
  v_mfma_f32_32x32x16_bf16 v[144:159], v[24:27], v[52:55], v[144:159]
  v_mfma_f32_32x32x16_bf16 v[160:175], v[24:27], v[56:59], v[160:175]
  v_mfma_f32_32x32x16_bf16 v[176:191], v[24:27], v[60:63], v[176:191]
  v_mfma_f32_32x32x16_bf16 v[192:207], v[28:31], v[48:51], v[192:207]
  v_mfma_f32_32x32x16_bf16 v[208:223], v[28:31], v[52:55], v[208:223]
  v_mfma_f32_32x32x16_bf16 v[224:239], v[28:31], v[56:59], v[224:239]
  v_mfma_f32_32x32x16_bf16 v[240:255], v[28:31], v[60:63], v[240:255]
  ds_read_b128 v[24:27], v9 offset:0
  ds_read_b128 v[28:31], v9 offset:4096
  ds_read_b64_tr_b16 v[48:49], v10 offset:24576
  ds_read_b64_tr_b16 v[50:51], v10 offset:26624
  ds_read_b64_tr_b16 v[52:53], v11 offset:24576
  ds_read_b64_tr_b16 v[54:55], v11 offset:26624
  ds_read_b64_tr_b16 v[56:57], v12 offset:24576
  ds_read_b64_tr_b16 v[58:59], v12 offset:26624
  ds_read_b64_tr_b16 v[60:61], v13 offset:24576
  ds_read_b64_tr_b16 v[62:63], v13 offset:26624
  s_waitcnt lgkmcnt(10)
  v_mfma_f32_32x32x16_bf16 v[128:143], v[16:19], v[32:35], v[128:143]
  v_mfma_f32_32x32x16_bf16 v[144:159], v[16:19], v[36:39], v[144:159]
  v_mfma_f32_32x32x16_bf16 v[160:175], v[16:19], v[40:43], v[160:175]
  v_mfma_f32_32x32x16_bf16 v[176:191], v[16:19], v[44:47], v[176:191]
  v_mfma_f32_32x32x16_bf16 v[192:207], v[20:23], v[32:35], v[192:207]
  v_mfma_f32_32x32x16_bf16 v[208:223], v[20:23], v[36:39], v[208:223]
  v_mfma_f32_32x32x16_bf16 v[224:239], v[20:23], v[40:43], v[224:239]
  v_mfma_f32_32x32x16_bf16 v[240:255], v[20:23], v[44:47], v[240:255]
  s_waitcnt lgkmcnt(0)
  v_mfma_f32_32x32x16_bf16 v[128:143], v[24:27], v[48:51], v[128:143]
  v_mfma_f32_32x32x16_bf16 v[144:159], v[24:27], v[52:55], v[144:159]
  v_mfma_f32_32x32x16_bf16 v[160:175], v[24:27], v[56:59], v[160:175]
  v_mfma_f32_32x32x16_bf16 v[176:191], v[24:27], v[60:63], v[176:191]
  v_mfma_f32_32x32x16_bf16 v[192:207], v[28:31], v[48:51], v[192:207]
  v_mfma_f32_32x32x16_bf16 v[208:223], v[28:31], v[52:55], v[208:223]
  v_mfma_f32_32x32x16_bf16 v[224:239], v[28:31], v[56:59], v[224:239]
  v_mfma_f32_32x32x16_bf16 v[240:255], v[28:31], v[60:63], v[240:255]
  s_nop 15
  s_nop 3
  s_lshl_b32 s32, s25, 2
  s_and_b32 s33, s22, 1
  s_lshl_b32 s33, s33, 1
  s_add_u32 s32, s32, s33
  s_lshl_b32 s32, s32, 5
  s_lshl_b32 s33, s26, 1
  s_add_u32 s32, s32, s33
  s_lshr_b32 s33, s22, 1
  s_add_u32 s32, s32, s33
  s_lshl_b32 s32, s32, 13
  s_lshl_b32 s33, s24, 24
  s_add_u32 s32, s32, s33
  v_lshrrev_b32 v14, 5, v0
  v_and_b32 v15, 31, v0
  v_lshrrev_b32 v16, 4, v15
  v_lshlrev_b32 v16, 10, v16
  v_and_b32 v17, 15, v15
  v_lshl_add_u32 v17, v14, 4, v17
  v_lshl_add_u32 v16, v17, 4, v16
  v_cvt_pk_bf16_f32 v20, v128, v129
  v_cvt_pk_bf16_f32 v21, v130, v131
  v_cvt_pk_bf16_f32 v22, v132, v133
  v_cvt_pk_bf16_f32 v23, v134, v135
  buffer_store_dwordx4 v[20:23], v16, s[8:11], s32 offen offset:0 sc1
  v_cvt_pk_bf16_f32 v24, v136, v137
  v_cvt_pk_bf16_f32 v25, v138, v139
  v_cvt_pk_bf16_f32 v26, v140, v141
  v_cvt_pk_bf16_f32 v27, v142, v143
  buffer_store_dwordx4 v[24:27], v16, s[8:11], s32 offen offset:512 sc1
  v_cvt_pk_bf16_f32 v28, v144, v145
  v_cvt_pk_bf16_f32 v29, v146, v147
  v_cvt_pk_bf16_f32 v30, v148, v149
  v_cvt_pk_bf16_f32 v31, v150, v151
  buffer_store_dwordx4 v[28:31], v16, s[8:11], s32 offen offset:2048 sc1
  v_cvt_pk_bf16_f32 v32, v152, v153
  v_cvt_pk_bf16_f32 v33, v154, v155
  v_cvt_pk_bf16_f32 v34, v156, v157
  v_cvt_pk_bf16_f32 v35, v158, v159
  buffer_store_dwordx4 v[32:35], v16, s[8:11], s32 offen offset:2560 sc1
  v_cvt_pk_bf16_f32 v20, v160, v161
  v_cvt_pk_bf16_f32 v21, v162, v163
  v_cvt_pk_bf16_f32 v22, v164, v165
  v_cvt_pk_bf16_f32 v23, v166, v167
  s_add_u32 s33, s32, 4096
  buffer_store_dwordx4 v[20:23], v16, s[8:11], s33 offen offset:0 sc1
  v_cvt_pk_bf16_f32 v24, v168, v169
  v_cvt_pk_bf16_f32 v25, v170, v171
  v_cvt_pk_bf16_f32 v26, v172, v173
  v_cvt_pk_bf16_f32 v27, v174, v175
  s_add_u32 s33, s32, 4096
  buffer_store_dwordx4 v[24:27], v16, s[8:11], s33 offen offset:512 sc1
  v_cvt_pk_bf16_f32 v28, v176, v177
  v_cvt_pk_bf16_f32 v29, v178, v179
  v_cvt_pk_bf16_f32 v30, v180, v181
  v_cvt_pk_bf16_f32 v31, v182, v183
  s_add_u32 s33, s32, 4096
  buffer_store_dwordx4 v[28:31], v16, s[8:11], s33 offen offset:2048 sc1
  v_cvt_pk_bf16_f32 v32, v184, v185
  v_cvt_pk_bf16_f32 v33, v186, v187
  v_cvt_pk_bf16_f32 v34, v188, v189
  v_cvt_pk_bf16_f32 v35, v190, v191
  s_add_u32 s33, s32, 4096
  buffer_store_dwordx4 v[32:35], v16, s[8:11], s33 offen offset:2560 sc1
  s_add_u32 s32, s32, 262144
  v_cvt_pk_bf16_f32 v20, v192, v193
  v_cvt_pk_bf16_f32 v21, v194, v195
  v_cvt_pk_bf16_f32 v22, v196, v197
  v_cvt_pk_bf16_f32 v23, v198, v199
  buffer_store_dwordx4 v[20:23], v16, s[8:11], s32 offen offset:0 sc1
  v_cvt_pk_bf16_f32 v24, v200, v201
  v_cvt_pk_bf16_f32 v25, v202, v203
  v_cvt_pk_bf16_f32 v26, v204, v205
  v_cvt_pk_bf16_f32 v27, v206, v207
  buffer_store_dwordx4 v[24:27], v16, s[8:11], s32 offen offset:512 sc1
  v_cvt_pk_bf16_f32 v28, v208, v209
  v_cvt_pk_bf16_f32 v29, v210, v211
  v_cvt_pk_bf16_f32 v30, v212, v213
  v_cvt_pk_bf16_f32 v31, v214, v215
  buffer_store_dwordx4 v[28:31], v16, s[8:11], s32 offen offset:2048 sc1
  v_cvt_pk_bf16_f32 v32, v216, v217
  v_cvt_pk_bf16_f32 v33, v218, v219
  v_cvt_pk_bf16_f32 v34, v220, v221
  v_cvt_pk_bf16_f32 v35, v222, v223
  buffer_store_dwordx4 v[32:35], v16, s[8:11], s32 offen offset:2560 sc1
  v_cvt_pk_bf16_f32 v20, v224, v225
  v_cvt_pk_bf16_f32 v21, v226, v227
  v_cvt_pk_bf16_f32 v22, v228, v229
  v_cvt_pk_bf16_f32 v23, v230, v231
  s_add_u32 s33, s32, 4096
  buffer_store_dwordx4 v[20:23], v16, s[8:11], s33 offen offset:0 sc1
  v_cvt_pk_bf16_f32 v24, v232, v233
  v_cvt_pk_bf16_f32 v25, v234, v235
  v_cvt_pk_bf16_f32 v26, v236, v237
  v_cvt_pk_bf16_f32 v27, v238, v239
  s_add_u32 s33, s32, 4096
  buffer_store_dwordx4 v[24:27], v16, s[8:11], s33 offen offset:512 sc1
  v_cvt_pk_bf16_f32 v28, v240, v241
  v_cvt_pk_bf16_f32 v29, v242, v243
  v_cvt_pk_bf16_f32 v30, v244, v245
  v_cvt_pk_bf16_f32 v31, v246, v247
  s_add_u32 s33, s32, 4096
  buffer_store_dwordx4 v[28:31], v16, s[8:11], s33 offen offset:2048 sc1
  v_cvt_pk_bf16_f32 v32, v248, v249
  v_cvt_pk_bf16_f32 v33, v250, v251
  v_cvt_pk_bf16_f32 v34, v252, v253
  v_cvt_pk_bf16_f32 v35, v254, v255
  s_add_u32 s33, s32, 4096
  buffer_store_dwordx4 v[32:35], v16, s[8:11], s33 offen offset:2560 sc1
  s_branch L_jobdone
JPREP:
  s_mov_b32 s12, s74
  s_and_b32 s13, s75, 0xffff
  s_mov_b32 s14, 2457600
  s_mov_b32 s15, 0x20000
  s_mov_b32 s16, s76
  s_and_b32 s17, s77, 0xffff
  s_mov_b32 s18, 25600
  s_mov_b32 s19, 0x20000
  s_lshr_b32 s24, s23, 1
  s_and_b32 s25, s23, 1
  s_lshl_b32 s26, s22, 6
  v_add_u32 v1, s26, v0
  s_mul_i32 s27, s24, 800
  v_lshlrev_b32 v2, 2, v1
  v_cmp_gt_u32 vcc, 200, v1
  s_and_saveexec_b64 s[28:29], vcc
  buffer_load_dword v3, v2, s[16:19], s27 offen
  s_waitcnt vmcnt(0)
  v_lshlrev_b32 v4, 16, v3
  v_and_b32 v5, 0xffff0000, v3
  v_lshlrev_b32 v6, 3, v1
  ds_write_b64 v6, v[4:5]
  s_mov_b64 exec, s[28:29]
  s_waitcnt lgkmcnt(0)
  s_barrier
  s_mul_i32 s27, s24, 40
  s_mul_i32 s28, s25, 1280
  s_add_u32 s27, s27, s28
  s_mul_i32 s30, s24, 40
  s_add_u32 s30, s30, s28
  s_add_u32 s30, s30, 100663296
  s_mov_b32 s31, 0
JPREP_row:
  v_add_u32 v2, s31, v1
  v_cmp_gt_u32 vcc, 640, v2
  s_and_saveexec_b64 s[28:29], vcc
  s_cbranch_execz JPREP_skip
  v_mul_u32_u24 v3, 3840, v2
  buffer_load_dwordx2 v[10:11], v3, s[12:15], s27 offen offset:0
  buffer_load_dwordx2 v[12:13], v3, s[12:15], s27 offen offset:8
  buffer_load_dwordx2 v[14:15], v3, s[12:15], s27 offen offset:16
  buffer_load_dwordx2 v[16:17], v3, s[12:15], s27 offen offset:24
  buffer_load_dwordx2 v[18:19], v3, s[12:15], s27 offen offset:32
  s_waitcnt vmcnt(0)
  v_lshlrev_b32 v20, 16, v10
  v_and_b32 v21, 0xffff0000, v10
  v_lshlrev_b32 v22, 16, v11
  v_and_b32 v23, 0xffff0000, v11
  v_lshlrev_b32 v24, 16, v12
  v_and_b32 v25, 0xffff0000, v12
  v_lshlrev_b32 v26, 16, v13
  v_and_b32 v27, 0xffff0000, v13
  v_lshlrev_b32 v28, 16, v14
  v_and_b32 v29, 0xffff0000, v14
  v_lshlrev_b32 v30, 16, v15
  v_and_b32 v31, 0xffff0000, v15
  v_lshlrev_b32 v32, 16, v16
  v_and_b32 v33, 0xffff0000, v16
  v_lshlrev_b32 v34, 16, v17
  v_and_b32 v35, 0xffff0000, v17
  v_lshlrev_b32 v36, 16, v18
  v_and_b32 v37, 0xffff0000, v18
  v_lshlrev_b32 v38, 16, v19
  v_and_b32 v39, 0xffff0000, v19
  v_mov_b32 v4, 0
  ds_read_b128 v[44:47], v4 offset:0
  ds_read_b128 v[48:51], v4 offset:80
  ds_read_b128 v[52:55], v4 offset:160
  ds_read_b128 v[56:59], v4 offset:240
  s_waitcnt lgkmcnt(0)
  v_mul_f32 v60, v20, v44
  v_mul_f32 v61, v20, v45
  v_mul_f32 v62, v20, v46
  v_mul_f32 v63, v20, v47
  v_fmac_f32 v60, v21, v48
  v_fmac_f32 v61, v21, v49
  v_fmac_f32 v62, v21, v50
  v_fmac_f32 v63, v21, v51
  v_fmac_f32 v60, v22, v52
  v_fmac_f32 v61, v22, v53
  v_fmac_f32 v62, v22, v54
  v_fmac_f32 v63, v22, v55
  v_fmac_f32 v60, v23, v56
  v_fmac_f32 v61, v23, v57
  v_fmac_f32 v62, v23, v58
  v_fmac_f32 v63, v23, v59
  ds_read_b128 v[44:47], v4 offset:320
  ds_read_b128 v[48:51], v4 offset:400
  ds_read_b128 v[52:55], v4 offset:480
  ds_read_b128 v[56:59], v4 offset:560
  s_waitcnt lgkmcnt(0)
  v_fmac_f32 v60, v24, v44
  v_fmac_f32 v61, v24, v45
  v_fmac_f32 v62, v24, v46
  v_fmac_f32 v63, v24, v47
  v_fmac_f32 v60, v25, v48
  v_fmac_f32 v61, v25, v49
  v_fmac_f32 v62, v25, v50
  v_fmac_f32 v63, v25, v51
  v_fmac_f32 v60, v26, v52
  v_fmac_f32 v61, v26, v53
  v_fmac_f32 v62, v26, v54
  v_fmac_f32 v63, v26, v55
  v_fmac_f32 v60, v27, v56
  v_fmac_f32 v61, v27, v57
  v_fmac_f32 v62, v27, v58
  v_fmac_f32 v63, v27, v59
  ds_read_b128 v[44:47], v4 offset:640
  ds_read_b128 v[48:51], v4 offset:720
  ds_read_b128 v[52:55], v4 offset:800
  ds_read_b128 v[56:59], v4 offset:880
  s_waitcnt lgkmcnt(0)
  v_fmac_f32 v60, v28, v44
  v_fmac_f32 v61, v28, v45
  v_fmac_f32 v62, v28, v46
  v_fmac_f32 v63, v28, v47
  v_fmac_f32 v60, v29, v48
  v_fmac_f32 v61, v29, v49
  v_fmac_f32 v62, v29, v50
  v_fmac_f32 v63, v29, v51
  v_fmac_f32 v60, v30, v52
  v_fmac_f32 v61, v30, v53
  v_fmac_f32 v62, v30, v54
  v_fmac_f32 v63, v30, v55
  v_fmac_f32 v60, v31, v56
  v_fmac_f32 v61, v31, v57
  v_fmac_f32 v62, v31, v58
  v_fmac_f32 v63, v31, v59
  ds_read_b128 v[44:47], v4 offset:960
  ds_read_b128 v[48:51], v4 offset:1040
  ds_read_b128 v[52:55], v4 offset:1120
  ds_read_b128 v[56:59], v4 offset:1200
  s_waitcnt lgkmcnt(0)
  v_fmac_f32 v60, v32, v44
  v_fmac_f32 v61, v32, v45
  v_fmac_f32 v62, v32, v46
  v_fmac_f32 v63, v32, v47
  v_fmac_f32 v60, v33, v48
  v_fmac_f32 v61, v33, v49
  v_fmac_f32 v62, v33, v50
  v_fmac_f32 v63, v33, v51
  v_fmac_f32 v60, v34, v52
  v_fmac_f32 v61, v34, v53
  v_fmac_f32 v62, v34, v54
  v_fmac_f32 v63, v34, v55
  v_fmac_f32 v60, v35, v56
  v_fmac_f32 v61, v35, v57
  v_fmac_f32 v62, v35, v58
  v_fmac_f32 v63, v35, v59
  ds_read_b128 v[44:47], v4 offset:1280
  ds_read_b128 v[48:51], v4 offset:1360
  ds_read_b128 v[52:55], v4 offset:1440
  ds_read_b128 v[56:59], v4 offset:1520
  s_waitcnt lgkmcnt(0)
  v_fmac_f32 v60, v36, v44
  v_fmac_f32 v61, v36, v45
  v_fmac_f32 v62, v36, v46
  v_fmac_f32 v63, v36, v47
  v_fmac_f32 v60, v37, v48
  v_fmac_f32 v61, v37, v49
  v_fmac_f32 v62, v37, v50
  v_fmac_f32 v63, v37, v51
  v_fmac_f32 v60, v38, v52
  v_fmac_f32 v61, v38, v53
  v_fmac_f32 v62, v38, v54
  v_fmac_f32 v63, v38, v55
  v_fmac_f32 v60, v39, v56
  v_fmac_f32 v61, v39, v57
  v_fmac_f32 v62, v39, v58
  v_fmac_f32 v63, v39, v59
  v_cvt_pk_bf16_f32 v64, v60, v61
  v_cvt_pk_bf16_f32 v65, v62, v63
  ds_read_b128 v[44:47], v4 offset:16
  ds_read_b128 v[48:51], v4 offset:96
  ds_read_b128 v[52:55], v4 offset:176
  ds_read_b128 v[56:59], v4 offset:256
  s_waitcnt lgkmcnt(0)
  v_mul_f32 v60, v20, v44
  v_mul_f32 v61, v20, v45
  v_mul_f32 v62, v20, v46
  v_mul_f32 v63, v20, v47
  v_fmac_f32 v60, v21, v48
  v_fmac_f32 v61, v21, v49
  v_fmac_f32 v62, v21, v50
  v_fmac_f32 v63, v21, v51
  v_fmac_f32 v60, v22, v52
  v_fmac_f32 v61, v22, v53
  v_fmac_f32 v62, v22, v54
  v_fmac_f32 v63, v22, v55
  v_fmac_f32 v60, v23, v56
  v_fmac_f32 v61, v23, v57
  v_fmac_f32 v62, v23, v58
  v_fmac_f32 v63, v23, v59
  ds_read_b128 v[44:47], v4 offset:336
  ds_read_b128 v[48:51], v4 offset:416
  ds_read_b128 v[52:55], v4 offset:496
  ds_read_b128 v[56:59], v4 offset:576
  s_waitcnt lgkmcnt(0)
  v_fmac_f32 v60, v24, v44
  v_fmac_f32 v61, v24, v45
  v_fmac_f32 v62, v24, v46
  v_fmac_f32 v63, v24, v47
  v_fmac_f32 v60, v25, v48
  v_fmac_f32 v61, v25, v49
  v_fmac_f32 v62, v25, v50
  v_fmac_f32 v63, v25, v51
  v_fmac_f32 v60, v26, v52
  v_fmac_f32 v61, v26, v53
  v_fmac_f32 v62, v26, v54
  v_fmac_f32 v63, v26, v55
  v_fmac_f32 v60, v27, v56
  v_fmac_f32 v61, v27, v57
  v_fmac_f32 v62, v27, v58
  v_fmac_f32 v63, v27, v59
  ds_read_b128 v[44:47], v4 offset:656
  ds_read_b128 v[48:51], v4 offset:736
  ds_read_b128 v[52:55], v4 offset:816
  ds_read_b128 v[56:59], v4 offset:896
  s_waitcnt lgkmcnt(0)
  v_fmac_f32 v60, v28, v44
  v_fmac_f32 v61, v28, v45
  v_fmac_f32 v62, v28, v46
  v_fmac_f32 v63, v28, v47
  v_fmac_f32 v60, v29, v48
  v_fmac_f32 v61, v29, v49
  v_fmac_f32 v62, v29, v50
  v_fmac_f32 v63, v29, v51
  v_fmac_f32 v60, v30, v52
  v_fmac_f32 v61, v30, v53
  v_fmac_f32 v62, v30, v54
  v_fmac_f32 v63, v30, v55
  v_fmac_f32 v60, v31, v56
  v_fmac_f32 v61, v31, v57
  v_fmac_f32 v62, v31, v58
  v_fmac_f32 v63, v31, v59
  ds_read_b128 v[44:47], v4 offset:976
  ds_read_b128 v[48:51], v4 offset:1056
  ds_read_b128 v[52:55], v4 offset:1136
  ds_read_b128 v[56:59], v4 offset:1216
  s_waitcnt lgkmcnt(0)
  v_fmac_f32 v60, v32, v44
  v_fmac_f32 v61, v32, v45
  v_fmac_f32 v62, v32, v46
  v_fmac_f32 v63, v32, v47
  v_fmac_f32 v60, v33, v48
  v_fmac_f32 v61, v33, v49
  v_fmac_f32 v62, v33, v50
  v_fmac_f32 v63, v33, v51
  v_fmac_f32 v60, v34, v52
  v_fmac_f32 v61, v34, v53
  v_fmac_f32 v62, v34, v54
  v_fmac_f32 v63, v34, v55
  v_fmac_f32 v60, v35, v56
  v_fmac_f32 v61, v35, v57
  v_fmac_f32 v62, v35, v58
  v_fmac_f32 v63, v35, v59
  ds_read_b128 v[44:47], v4 offset:1296
  ds_read_b128 v[48:51], v4 offset:1376
  ds_read_b128 v[52:55], v4 offset:1456
  ds_read_b128 v[56:59], v4 offset:1536
  s_waitcnt lgkmcnt(0)
  v_fmac_f32 v60, v36, v44
  v_fmac_f32 v61, v36, v45
  v_fmac_f32 v62, v36, v46
  v_fmac_f32 v63, v36, v47
  v_fmac_f32 v60, v37, v48
  v_fmac_f32 v61, v37, v49
  v_fmac_f32 v62, v37, v50
  v_fmac_f32 v63, v37, v51
  v_fmac_f32 v60, v38, v52
  v_fmac_f32 v61, v38, v53
  v_fmac_f32 v62, v38, v54
  v_fmac_f32 v63, v38, v55
  v_fmac_f32 v60, v39, v56
  v_fmac_f32 v61, v39, v57
  v_fmac_f32 v62, v39, v58
  v_fmac_f32 v63, v39, v59
  v_cvt_pk_bf16_f32 v66, v60, v61
  v_cvt_pk_bf16_f32 v67, v62, v63
  ds_read_b128 v[44:47], v4 offset:32
  ds_read_b128 v[48:51], v4 offset:112
  ds_read_b128 v[52:55], v4 offset:192
  ds_read_b128 v[56:59], v4 offset:272
  s_waitcnt lgkmcnt(0)
  v_mul_f32 v60, v20, v44
  v_mul_f32 v61, v20, v45
  v_mul_f32 v62, v20, v46
  v_mul_f32 v63, v20, v47
  v_fmac_f32 v60, v21, v48
  v_fmac_f32 v61, v21, v49
  v_fmac_f32 v62, v21, v50
  v_fmac_f32 v63, v21, v51
  v_fmac_f32 v60, v22, v52
  v_fmac_f32 v61, v22, v53
  v_fmac_f32 v62, v22, v54
  v_fmac_f32 v63, v22, v55
  v_fmac_f32 v60, v23, v56
  v_fmac_f32 v61, v23, v57
  v_fmac_f32 v62, v23, v58
  v_fmac_f32 v63, v23, v59
  ds_read_b128 v[44:47], v4 offset:352
  ds_read_b128 v[48:51], v4 offset:432
  ds_read_b128 v[52:55], v4 offset:512
  ds_read_b128 v[56:59], v4 offset:592
  s_waitcnt lgkmcnt(0)
  v_fmac_f32 v60, v24, v44
  v_fmac_f32 v61, v24, v45
  v_fmac_f32 v62, v24, v46
  v_fmac_f32 v63, v24, v47
  v_fmac_f32 v60, v25, v48
  v_fmac_f32 v61, v25, v49
  v_fmac_f32 v62, v25, v50
  v_fmac_f32 v63, v25, v51
  v_fmac_f32 v60, v26, v52
  v_fmac_f32 v61, v26, v53
  v_fmac_f32 v62, v26, v54
  v_fmac_f32 v63, v26, v55
  v_fmac_f32 v60, v27, v56
  v_fmac_f32 v61, v27, v57
  v_fmac_f32 v62, v27, v58
  v_fmac_f32 v63, v27, v59
  ds_read_b128 v[44:47], v4 offset:672
  ds_read_b128 v[48:51], v4 offset:752
  ds_read_b128 v[52:55], v4 offset:832
  ds_read_b128 v[56:59], v4 offset:912
  s_waitcnt lgkmcnt(0)
  v_fmac_f32 v60, v28, v44
  v_fmac_f32 v61, v28, v45
  v_fmac_f32 v62, v28, v46
  v_fmac_f32 v63, v28, v47
  v_fmac_f32 v60, v29, v48
  v_fmac_f32 v61, v29, v49
  v_fmac_f32 v62, v29, v50
  v_fmac_f32 v63, v29, v51
  v_fmac_f32 v60, v30, v52
  v_fmac_f32 v61, v30, v53
  v_fmac_f32 v62, v30, v54
  v_fmac_f32 v63, v30, v55
  v_fmac_f32 v60, v31, v56
  v_fmac_f32 v61, v31, v57
  v_fmac_f32 v62, v31, v58
  v_fmac_f32 v63, v31, v59
  ds_read_b128 v[44:47], v4 offset:992
  ds_read_b128 v[48:51], v4 offset:1072
  ds_read_b128 v[52:55], v4 offset:1152
  ds_read_b128 v[56:59], v4 offset:1232
  s_waitcnt lgkmcnt(0)
  v_fmac_f32 v60, v32, v44
  v_fmac_f32 v61, v32, v45
  v_fmac_f32 v62, v32, v46
  v_fmac_f32 v63, v32, v47
  v_fmac_f32 v60, v33, v48
  v_fmac_f32 v61, v33, v49
  v_fmac_f32 v62, v33, v50
  v_fmac_f32 v63, v33, v51
  v_fmac_f32 v60, v34, v52
  v_fmac_f32 v61, v34, v53
  v_fmac_f32 v62, v34, v54
  v_fmac_f32 v63, v34, v55
  v_fmac_f32 v60, v35, v56
  v_fmac_f32 v61, v35, v57
  v_fmac_f32 v62, v35, v58
  v_fmac_f32 v63, v35, v59
  ds_read_b128 v[44:47], v4 offset:1312
  ds_read_b128 v[48:51], v4 offset:1392
  ds_read_b128 v[52:55], v4 offset:1472
  ds_read_b128 v[56:59], v4 offset:1552
  s_waitcnt lgkmcnt(0)
  v_fmac_f32 v60, v36, v44
  v_fmac_f32 v61, v36, v45
  v_fmac_f32 v62, v36, v46
  v_fmac_f32 v63, v36, v47
  v_fmac_f32 v60, v37, v48
  v_fmac_f32 v61, v37, v49
  v_fmac_f32 v62, v37, v50
  v_fmac_f32 v63, v37, v51
  v_fmac_f32 v60, v38, v52
  v_fmac_f32 v61, v38, v53
  v_fmac_f32 v62, v38, v54
  v_fmac_f32 v63, v38, v55
  v_fmac_f32 v60, v39, v56
  v_fmac_f32 v61, v39, v57
  v_fmac_f32 v62, v39, v58
  v_fmac_f32 v63, v39, v59
  v_cvt_pk_bf16_f32 v68, v60, v61
  v_cvt_pk_bf16_f32 v69, v62, v63
  ds_read_b128 v[44:47], v4 offset:48
  ds_read_b128 v[48:51], v4 offset:128
  ds_read_b128 v[52:55], v4 offset:208
  ds_read_b128 v[56:59], v4 offset:288
  s_waitcnt lgkmcnt(0)
  v_mul_f32 v60, v20, v44
  v_mul_f32 v61, v20, v45
  v_mul_f32 v62, v20, v46
  v_mul_f32 v63, v20, v47
  v_fmac_f32 v60, v21, v48
  v_fmac_f32 v61, v21, v49
  v_fmac_f32 v62, v21, v50
  v_fmac_f32 v63, v21, v51
  v_fmac_f32 v60, v22, v52
  v_fmac_f32 v61, v22, v53
  v_fmac_f32 v62, v22, v54
  v_fmac_f32 v63, v22, v55
  v_fmac_f32 v60, v23, v56
  v_fmac_f32 v61, v23, v57
  v_fmac_f32 v62, v23, v58
  v_fmac_f32 v63, v23, v59
  ds_read_b128 v[44:47], v4 offset:368
  ds_read_b128 v[48:51], v4 offset:448
  ds_read_b128 v[52:55], v4 offset:528
  ds_read_b128 v[56:59], v4 offset:608
  s_waitcnt lgkmcnt(0)
  v_fmac_f32 v60, v24, v44
  v_fmac_f32 v61, v24, v45
  v_fmac_f32 v62, v24, v46
  v_fmac_f32 v63, v24, v47
  v_fmac_f32 v60, v25, v48
  v_fmac_f32 v61, v25, v49
  v_fmac_f32 v62, v25, v50
  v_fmac_f32 v63, v25, v51
  v_fmac_f32 v60, v26, v52
  v_fmac_f32 v61, v26, v53
  v_fmac_f32 v62, v26, v54
  v_fmac_f32 v63, v26, v55
  v_fmac_f32 v60, v27, v56
  v_fmac_f32 v61, v27, v57
  v_fmac_f32 v62, v27, v58
  v_fmac_f32 v63, v27, v59
  ds_read_b128 v[44:47], v4 offset:688
  ds_read_b128 v[48:51], v4 offset:768
  ds_read_b128 v[52:55], v4 offset:848
  ds_read_b128 v[56:59], v4 offset:928
  s_waitcnt lgkmcnt(0)
  v_fmac_f32 v60, v28, v44
  v_fmac_f32 v61, v28, v45
  v_fmac_f32 v62, v28, v46
  v_fmac_f32 v63, v28, v47
  v_fmac_f32 v60, v29, v48
  v_fmac_f32 v61, v29, v49
  v_fmac_f32 v62, v29, v50
  v_fmac_f32 v63, v29, v51
  v_fmac_f32 v60, v30, v52
  v_fmac_f32 v61, v30, v53
  v_fmac_f32 v62, v30, v54
  v_fmac_f32 v63, v30, v55
  v_fmac_f32 v60, v31, v56
  v_fmac_f32 v61, v31, v57
  v_fmac_f32 v62, v31, v58
  v_fmac_f32 v63, v31, v59
  ds_read_b128 v[44:47], v4 offset:1008
  ds_read_b128 v[48:51], v4 offset:1088
  ds_read_b128 v[52:55], v4 offset:1168
  ds_read_b128 v[56:59], v4 offset:1248
  s_waitcnt lgkmcnt(0)
  v_fmac_f32 v60, v32, v44
  v_fmac_f32 v61, v32, v45
  v_fmac_f32 v62, v32, v46
  v_fmac_f32 v63, v32, v47
  v_fmac_f32 v60, v33, v48
  v_fmac_f32 v61, v33, v49
  v_fmac_f32 v62, v33, v50
  v_fmac_f32 v63, v33, v51
  v_fmac_f32 v60, v34, v52
  v_fmac_f32 v61, v34, v53
  v_fmac_f32 v62, v34, v54
  v_fmac_f32 v63, v34, v55
  v_fmac_f32 v60, v35, v56
  v_fmac_f32 v61, v35, v57
  v_fmac_f32 v62, v35, v58
  v_fmac_f32 v63, v35, v59
  ds_read_b128 v[44:47], v4 offset:1328
  ds_read_b128 v[48:51], v4 offset:1408
  ds_read_b128 v[52:55], v4 offset:1488
  ds_read_b128 v[56:59], v4 offset:1568
  s_waitcnt lgkmcnt(0)
  v_fmac_f32 v60, v36, v44
  v_fmac_f32 v61, v36, v45
  v_fmac_f32 v62, v36, v46
  v_fmac_f32 v63, v36, v47
  v_fmac_f32 v60, v37, v48
  v_fmac_f32 v61, v37, v49
  v_fmac_f32 v62, v37, v50
  v_fmac_f32 v63, v37, v51
  v_fmac_f32 v60, v38, v52
  v_fmac_f32 v61, v38, v53
  v_fmac_f32 v62, v38, v54
  v_fmac_f32 v63, v38, v55
  v_fmac_f32 v60, v39, v56
  v_fmac_f32 v61, v39, v57
  v_fmac_f32 v62, v39, v58
  v_fmac_f32 v63, v39, v59
  v_cvt_pk_bf16_f32 v70, v60, v61
  v_cvt_pk_bf16_f32 v71, v62, v63
  ds_read_b128 v[44:47], v4 offset:64
  ds_read_b128 v[48:51], v4 offset:144
  ds_read_b128 v[52:55], v4 offset:224
  ds_read_b128 v[56:59], v4 offset:304
  s_waitcnt lgkmcnt(0)
  v_mul_f32 v60, v20, v44
  v_mul_f32 v61, v20, v45
  v_mul_f32 v62, v20, v46
  v_mul_f32 v63, v20, v47
  v_fmac_f32 v60, v21, v48
  v_fmac_f32 v61, v21, v49
  v_fmac_f32 v62, v21, v50
  v_fmac_f32 v63, v21, v51
  v_fmac_f32 v60, v22, v52
  v_fmac_f32 v61, v22, v53
  v_fmac_f32 v62, v22, v54
  v_fmac_f32 v63, v22, v55
  v_fmac_f32 v60, v23, v56
  v_fmac_f32 v61, v23, v57
  v_fmac_f32 v62, v23, v58
  v_fmac_f32 v63, v23, v59
  ds_read_b128 v[44:47], v4 offset:384
  ds_read_b128 v[48:51], v4 offset:464
  ds_read_b128 v[52:55], v4 offset:544
  ds_read_b128 v[56:59], v4 offset:624
  s_waitcnt lgkmcnt(0)
  v_fmac_f32 v60, v24, v44
  v_fmac_f32 v61, v24, v45
  v_fmac_f32 v62, v24, v46
  v_fmac_f32 v63, v24, v47
  v_fmac_f32 v60, v25, v48
  v_fmac_f32 v61, v25, v49
  v_fmac_f32 v62, v25, v50
  v_fmac_f32 v63, v25, v51
  v_fmac_f32 v60, v26, v52
  v_fmac_f32 v61, v26, v53
  v_fmac_f32 v62, v26, v54
  v_fmac_f32 v63, v26, v55
  v_fmac_f32 v60, v27, v56
  v_fmac_f32 v61, v27, v57
  v_fmac_f32 v62, v27, v58
  v_fmac_f32 v63, v27, v59
  ds_read_b128 v[44:47], v4 offset:704
  ds_read_b128 v[48:51], v4 offset:784
  ds_read_b128 v[52:55], v4 offset:864
  ds_read_b128 v[56:59], v4 offset:944
  s_waitcnt lgkmcnt(0)
  v_fmac_f32 v60, v28, v44
  v_fmac_f32 v61, v28, v45
  v_fmac_f32 v62, v28, v46
  v_fmac_f32 v63, v28, v47
  v_fmac_f32 v60, v29, v48
  v_fmac_f32 v61, v29, v49
  v_fmac_f32 v62, v29, v50
  v_fmac_f32 v63, v29, v51
  v_fmac_f32 v60, v30, v52
  v_fmac_f32 v61, v30, v53
  v_fmac_f32 v62, v30, v54
  v_fmac_f32 v63, v30, v55
  v_fmac_f32 v60, v31, v56
  v_fmac_f32 v61, v31, v57
  v_fmac_f32 v62, v31, v58
  v_fmac_f32 v63, v31, v59
  ds_read_b128 v[44:47], v4 offset:1024
  ds_read_b128 v[48:51], v4 offset:1104
  ds_read_b128 v[52:55], v4 offset:1184
  ds_read_b128 v[56:59], v4 offset:1264
  s_waitcnt lgkmcnt(0)
  v_fmac_f32 v60, v32, v44
  v_fmac_f32 v61, v32, v45
  v_fmac_f32 v62, v32, v46
  v_fmac_f32 v63, v32, v47
  v_fmac_f32 v60, v33, v48
  v_fmac_f32 v61, v33, v49
  v_fmac_f32 v62, v33, v50
  v_fmac_f32 v63, v33, v51
  v_fmac_f32 v60, v34, v52
  v_fmac_f32 v61, v34, v53
  v_fmac_f32 v62, v34, v54
  v_fmac_f32 v63, v34, v55
  v_fmac_f32 v60, v35, v56
  v_fmac_f32 v61, v35, v57
  v_fmac_f32 v62, v35, v58
  v_fmac_f32 v63, v35, v59
  ds_read_b128 v[44:47], v4 offset:1344
  ds_read_b128 v[48:51], v4 offset:1424
  ds_read_b128 v[52:55], v4 offset:1504
  ds_read_b128 v[56:59], v4 offset:1584
  s_waitcnt lgkmcnt(0)
  v_fmac_f32 v60, v36, v44
  v_fmac_f32 v61, v36, v45
  v_fmac_f32 v62, v36, v46
  v_fmac_f32 v63, v36, v47
  v_fmac_f32 v60, v37, v48
  v_fmac_f32 v61, v37, v49
  v_fmac_f32 v62, v37, v50
  v_fmac_f32 v63, v37, v51
  v_fmac_f32 v60, v38, v52
  v_fmac_f32 v61, v38, v53
  v_fmac_f32 v62, v38, v54
  v_fmac_f32 v63, v38, v55
  v_fmac_f32 v60, v39, v56
  v_fmac_f32 v61, v39, v57
  v_fmac_f32 v62, v39, v58
  v_fmac_f32 v63, v39, v59
  v_cvt_pk_bf16_f32 v72, v60, v61
  v_cvt_pk_bf16_f32 v73, v62, v63
  v_mul_u32_u24 v3, 2560, v2
  buffer_store_dwordx2 v[64:65], v3, s[8:11], s30 offen offset:0 sc1
  buffer_store_dwordx2 v[66:67], v3, s[8:11], s30 offen offset:8 sc1
  buffer_store_dwordx2 v[68:69], v3, s[8:11], s30 offen offset:16 sc1
  buffer_store_dwordx2 v[70:71], v3, s[8:11], s30 offen offset:24 sc1
  buffer_store_dwordx2 v[72:73], v3, s[8:11], s30 offen offset:32 sc1
JPREP_skip:
  s_mov_b64 exec, s[28:29]
  s_add_u32 s31, s31, 256
  s_cmp_lt_u32 s31, 768
  s_cbranch_scc1 JPREP_row
  s_mov_b32 s12, s72
  s_and_b32 s13, s73, 0xffff
  s_mov_b32 s14, 2621440
  s_mov_b32 s15, 0x20000
  s_mov_b32 s16, s92
  s_and_b32 s17, s93, 0xffff
  s_mov_b32 s18, 1280
  s_mov_b32 s19, 0x20000
  v_mul_u32_u24 v2, 20, v0
  buffer_load_dword v10, v2, s[16:19], 0 offen offset:0
  buffer_load_dword v11, v2, s[16:19], 0 offen offset:4
  buffer_load_dword v12, v2, s[16:19], 0 offen offset:8
  buffer_load_dword v13, v2, s[16:19], 0 offen offset:12
  buffer_load_dword v14, v2, s[16:19], 0 offen offset:16
  s_lshl_b32 s24, s23, 5
  s_lshl_b32 s25, s22, 3
  s_add_u32 s24, s24, s25
  s_mul_i32 s25, s24, 1280
  buffer_load_dword v20, v2, s[12:15], s25 offen offset:0
  buffer_load_dword v21, v2, s[12:15], s25 offen offset:4
  buffer_load_dword v22, v2, s[12:15], s25 offen offset:8
  buffer_load_dword v23, v2, s[12:15], s25 offen offset:12
  buffer_load_dword v24, v2, s[12:15], s25 offen offset:16
  s_add_u32 s25, s25, 1280
  buffer_load_dword v25, v2, s[12:15], s25 offen offset:0
  buffer_load_dword v26, v2, s[12:15], s25 offen offset:4
  buffer_load_dword v27, v2, s[12:15], s25 offen offset:8
  buffer_load_dword v28, v2, s[12:15], s25 offen offset:12
  buffer_load_dword v29, v2, s[12:15], s25 offen offset:16
  s_add_u32 s25, s25, 1280
  buffer_load_dword v30, v2, s[12:15], s25 offen offset:0
  buffer_load_dword v31, v2, s[12:15], s25 offen offset:4
  buffer_load_dword v32, v2, s[12:15], s25 offen offset:8
  buffer_load_dword v33, v2, s[12:15], s25 offen offset:12
  buffer_load_dword v34, v2, s[12:15], s25 offen offset:16
  s_add_u32 s25, s25, 1280
  buffer_load_dword v35, v2, s[12:15], s25 offen offset:0
  buffer_load_dword v36, v2, s[12:15], s25 offen offset:4
  buffer_load_dword v37, v2, s[12:15], s25 offen offset:8
  buffer_load_dword v38, v2, s[12:15], s25 offen offset:12
  buffer_load_dword v39, v2, s[12:15], s25 offen offset:16
  s_add_u32 s25, s25, 1280
  buffer_load_dword v40, v2, s[12:15], s25 offen offset:0
  buffer_load_dword v41, v2, s[12:15], s25 offen offset:4
  buffer_load_dword v42, v2, s[12:15], s25 offen offset:8
  buffer_load_dword v43, v2, s[12:15], s25 offen offset:12
  buffer_load_dword v44, v2, s[12:15], s25 offen offset:16
  s_add_u32 s25, s25, 1280
  buffer_load_dword v45, v2, s[12:15], s25 offen offset:0
  buffer_load_dword v46, v2, s[12:15], s25 offen offset:4
  buffer_load_dword v47, v2, s[12:15], s25 offen offset:8
  buffer_load_dword v48, v2, s[12:15], s25 offen offset:12
  buffer_load_dword v49, v2, s[12:15], s25 offen offset:16
  s_add_u32 s25, s25, 1280
  buffer_load_dword v50, v2, s[12:15], s25 offen offset:0
  buffer_load_dword v51, v2, s[12:15], s25 offen offset:4
  buffer_load_dword v52, v2, s[12:15], s25 offen offset:8
  buffer_load_dword v53, v2, s[12:15], s25 offen offset:12
  buffer_load_dword v54, v2, s[12:15], s25 offen offset:16
  s_add_u32 s25, s25, 1280
  buffer_load_dword v55, v2, s[12:15], s25 offen offset:0
  buffer_load_dword v56, v2, s[12:15], s25 offen offset:4
  buffer_load_dword v57, v2, s[12:15], s25 offen offset:8
  buffer_load_dword v58, v2, s[12:15], s25 offen offset:12
  buffer_load_dword v59, v2, s[12:15], s25 offen offset:16
  s_add_u32 s25, s25, 1280
  s_waitcnt vmcnt(0)
  v_lshlrev_b32 v60, 16, v10
  v_and_b32 v61, 0xffff0000, v10
  v_lshlrev_b32 v62, 16, v11
  v_and_b32 v63, 0xffff0000, v11
  v_lshlrev_b32 v64, 16, v12
  v_and_b32 v65, 0xffff0000, v12
  v_lshlrev_b32 v66, 16, v13
  v_and_b32 v67, 0xffff0000, v13
  v_lshlrev_b32 v68, 16, v14
  v_and_b32 v69, 0xffff0000, v14
  v_lshlrev_b32 v70, 16, v20
  v_and_b32 v71, 0xffff0000, v20
  v_mul_f32 v72, v70, v60
  v_fmac_f32 v72, v71, v61
  v_lshlrev_b32 v70, 16, v21
  v_and_b32 v71, 0xffff0000, v21
  v_fmac_f32 v72, v70, v62
  v_fmac_f32 v72, v71, v63
  v_lshlrev_b32 v70, 16, v22
  v_and_b32 v71, 0xffff0000, v22
  v_fmac_f32 v72, v70, v64
  v_fmac_f32 v72, v71, v65
  v_lshlrev_b32 v70, 16, v23
  v_and_b32 v71, 0xffff0000, v23
  v_fmac_f32 v72, v70, v66
  v_fmac_f32 v72, v71, v67
  v_lshlrev_b32 v70, 16, v24
  v_and_b32 v71, 0xffff0000, v24
  v_fmac_f32 v72, v70, v68
  v_fmac_f32 v72, v71, v69
  v_lshlrev_b32 v70, 16, v25
  v_and_b32 v71, 0xffff0000, v25
  v_mul_f32 v73, v70, v60
  v_fmac_f32 v73, v71, v61
  v_lshlrev_b32 v70, 16, v26
  v_and_b32 v71, 0xffff0000, v26
  v_fmac_f32 v73, v70, v62
  v_fmac_f32 v73, v71, v63
  v_lshlrev_b32 v70, 16, v27
  v_and_b32 v71, 0xffff0000, v27
  v_fmac_f32 v73, v70, v64
  v_fmac_f32 v73, v71, v65
  v_lshlrev_b32 v70, 16, v28
  v_and_b32 v71, 0xffff0000, v28
  v_fmac_f32 v73, v70, v66
  v_fmac_f32 v73, v71, v67
  v_lshlrev_b32 v70, 16, v29
  v_and_b32 v71, 0xffff0000, v29
  v_fmac_f32 v73, v70, v68
  v_fmac_f32 v73, v71, v69
  v_lshlrev_b32 v70, 16, v30
  v_and_b32 v71, 0xffff0000, v30
  v_mul_f32 v74, v70, v60
  v_fmac_f32 v74, v71, v61
  v_lshlrev_b32 v70, 16, v31
  v_and_b32 v71, 0xffff0000, v31
  v_fmac_f32 v74, v70, v62
  v_fmac_f32 v74, v71, v63
  v_lshlrev_b32 v70, 16, v32
  v_and_b32 v71, 0xffff0000, v32
  v_fmac_f32 v74, v70, v64
  v_fmac_f32 v74, v71, v65
  v_lshlrev_b32 v70, 16, v33
  v_and_b32 v71, 0xffff0000, v33
  v_fmac_f32 v74, v70, v66
  v_fmac_f32 v74, v71, v67
  v_lshlrev_b32 v70, 16, v34
  v_and_b32 v71, 0xffff0000, v34
  v_fmac_f32 v74, v70, v68
  v_fmac_f32 v74, v71, v69
  v_lshlrev_b32 v70, 16, v35
  v_and_b32 v71, 0xffff0000, v35
  v_mul_f32 v75, v70, v60
  v_fmac_f32 v75, v71, v61
  v_lshlrev_b32 v70, 16, v36
  v_and_b32 v71, 0xffff0000, v36
  v_fmac_f32 v75, v70, v62
  v_fmac_f32 v75, v71, v63
  v_lshlrev_b32 v70, 16, v37
  v_and_b32 v71, 0xffff0000, v37
  v_fmac_f32 v75, v70, v64
  v_fmac_f32 v75, v71, v65
  v_lshlrev_b32 v70, 16, v38
  v_and_b32 v71, 0xffff0000, v38
  v_fmac_f32 v75, v70, v66
  v_fmac_f32 v75, v71, v67
  v_lshlrev_b32 v70, 16, v39
  v_and_b32 v71, 0xffff0000, v39
  v_fmac_f32 v75, v70, v68
  v_fmac_f32 v75, v71, v69
  v_lshlrev_b32 v70, 16, v40
  v_and_b32 v71, 0xffff0000, v40
  v_mul_f32 v76, v70, v60
  v_fmac_f32 v76, v71, v61
  v_lshlrev_b32 v70, 16, v41
  v_and_b32 v71, 0xffff0000, v41
  v_fmac_f32 v76, v70, v62
  v_fmac_f32 v76, v71, v63
  v_lshlrev_b32 v70, 16, v42
  v_and_b32 v71, 0xffff0000, v42
  v_fmac_f32 v76, v70, v64
  v_fmac_f32 v76, v71, v65
  v_lshlrev_b32 v70, 16, v43
  v_and_b32 v71, 0xffff0000, v43
  v_fmac_f32 v76, v70, v66
  v_fmac_f32 v76, v71, v67
  v_lshlrev_b32 v70, 16, v44
  v_and_b32 v71, 0xffff0000, v44
  v_fmac_f32 v76, v70, v68
  v_fmac_f32 v76, v71, v69
  v_lshlrev_b32 v70, 16, v45
  v_and_b32 v71, 0xffff0000, v45
  v_mul_f32 v77, v70, v60
  v_fmac_f32 v77, v71, v61
  v_lshlrev_b32 v70, 16, v46
  v_and_b32 v71, 0xffff0000, v46
  v_fmac_f32 v77, v70, v62
  v_fmac_f32 v77, v71, v63
  v_lshlrev_b32 v70, 16, v47
  v_and_b32 v71, 0xffff0000, v47
  v_fmac_f32 v77, v70, v64
  v_fmac_f32 v77, v71, v65
  v_lshlrev_b32 v70, 16, v48
  v_and_b32 v71, 0xffff0000, v48
  v_fmac_f32 v77, v70, v66
  v_fmac_f32 v77, v71, v67
  v_lshlrev_b32 v70, 16, v49
  v_and_b32 v71, 0xffff0000, v49
  v_fmac_f32 v77, v70, v68
  v_fmac_f32 v77, v71, v69
  v_lshlrev_b32 v70, 16, v50
  v_and_b32 v71, 0xffff0000, v50
  v_mul_f32 v78, v70, v60
  v_fmac_f32 v78, v71, v61
  v_lshlrev_b32 v70, 16, v51
  v_and_b32 v71, 0xffff0000, v51
  v_fmac_f32 v78, v70, v62
  v_fmac_f32 v78, v71, v63
  v_lshlrev_b32 v70, 16, v52
  v_and_b32 v71, 0xffff0000, v52
  v_fmac_f32 v78, v70, v64
  v_fmac_f32 v78, v71, v65
  v_lshlrev_b32 v70, 16, v53
  v_and_b32 v71, 0xffff0000, v53
  v_fmac_f32 v78, v70, v66
  v_fmac_f32 v78, v71, v67
  v_lshlrev_b32 v70, 16, v54
  v_and_b32 v71, 0xffff0000, v54
  v_fmac_f32 v78, v70, v68
  v_fmac_f32 v78, v71, v69
  v_lshlrev_b32 v70, 16, v55
  v_and_b32 v71, 0xffff0000, v55
  v_mul_f32 v79, v70, v60
  v_fmac_f32 v79, v71, v61
  v_lshlrev_b32 v70, 16, v56
  v_and_b32 v71, 0xffff0000, v56
  v_fmac_f32 v79, v70, v62
  v_fmac_f32 v79, v71, v63
  v_lshlrev_b32 v70, 16, v57
  v_and_b32 v71, 0xffff0000, v57
  v_fmac_f32 v79, v70, v64
  v_fmac_f32 v79, v71, v65
  v_lshlrev_b32 v70, 16, v58
  v_and_b32 v71, 0xffff0000, v58
  v_fmac_f32 v79, v70, v66
  v_fmac_f32 v79, v71, v67
  v_lshlrev_b32 v70, 16, v59
  v_and_b32 v71, 0xffff0000, v59
  v_fmac_f32 v79, v70, v68
  v_fmac_f32 v79, v71, v69
  s_nop 1
  v_add_f32_dpp v72, v72, v72 row_ror:1 row_mask:0xf bank_mask:0xf
  v_add_f32_dpp v73, v73, v73 row_ror:1 row_mask:0xf bank_mask:0xf
  v_add_f32_dpp v74, v74, v74 row_ror:1 row_mask:0xf bank_mask:0xf
  v_add_f32_dpp v75, v75, v75 row_ror:1 row_mask:0xf bank_mask:0xf
  v_add_f32_dpp v76, v76, v76 row_ror:1 row_mask:0xf bank_mask:0xf
  v_add_f32_dpp v77, v77, v77 row_ror:1 row_mask:0xf bank_mask:0xf
  v_add_f32_dpp v78, v78, v78 row_ror:1 row_mask:0xf bank_mask:0xf
  v_add_f32_dpp v79, v79, v79 row_ror:1 row_mask:0xf bank_mask:0xf
  s_nop 1
  v_add_f32_dpp v72, v72, v72 row_ror:2 row_mask:0xf bank_mask:0xf
  v_add_f32_dpp v73, v73, v73 row_ror:2 row_mask:0xf bank_mask:0xf
  v_add_f32_dpp v74, v74, v74 row_ror:2 row_mask:0xf bank_mask:0xf
  v_add_f32_dpp v75, v75, v75 row_ror:2 row_mask:0xf bank_mask:0xf
  v_add_f32_dpp v76, v76, v76 row_ror:2 row_mask:0xf bank_mask:0xf
  v_add_f32_dpp v77, v77, v77 row_ror:2 row_mask:0xf bank_mask:0xf
  v_add_f32_dpp v78, v78, v78 row_ror:2 row_mask:0xf bank_mask:0xf
  v_add_f32_dpp v79, v79, v79 row_ror:2 row_mask:0xf bank_mask:0xf
  s_nop 1
  v_add_f32_dpp v72, v72, v72 row_ror:4 row_mask:0xf bank_mask:0xf
  v_add_f32_dpp v73, v73, v73 row_ror:4 row_mask:0xf bank_mask:0xf
  v_add_f32_dpp v74, v74, v74 row_ror:4 row_mask:0xf bank_mask:0xf
  v_add_f32_dpp v75, v75, v75 row_ror:4 row_mask:0xf bank_mask:0xf
  v_add_f32_dpp v76, v76, v76 row_ror:4 row_mask:0xf bank_mask:0xf
  v_add_f32_dpp v77, v77, v77 row_ror:4 row_mask:0xf bank_mask:0xf
  v_add_f32_dpp v78, v78, v78 row_ror:4 row_mask:0xf bank_mask:0xf
  v_add_f32_dpp v79, v79, v79 row_ror:4 row_mask:0xf bank_mask:0xf
  s_nop 1
  v_add_f32_dpp v72, v72, v72 row_ror:8 row_mask:0xf bank_mask:0xf
  v_add_f32_dpp v73, v73, v73 row_ror:8 row_mask:0xf bank_mask:0xf
  v_add_f32_dpp v74, v74, v74 row_ror:8 row_mask:0xf bank_mask:0xf
  v_add_f32_dpp v75, v75, v75 row_ror:8 row_mask:0xf bank_mask:0xf
  v_add_f32_dpp v76, v76, v76 row_ror:8 row_mask:0xf bank_mask:0xf
  v_add_f32_dpp v77, v77, v77 row_ror:8 row_mask:0xf bank_mask:0xf
  v_add_f32_dpp v78, v78, v78 row_ror:8 row_mask:0xf bank_mask:0xf
  v_add_f32_dpp v79, v79, v79 row_ror:8 row_mask:0xf bank_mask:0xf
  v_mov_b32 v70, v72
  s_nop 1
  v_permlane16_swap_b32 v72, v70
  v_add_f32 v72, v72, v70
  v_mov_b32 v70, v73
  s_nop 1
  v_permlane16_swap_b32 v73, v70
  v_add_f32 v73, v73, v70
  v_mov_b32 v70, v74
  s_nop 1
  v_permlane16_swap_b32 v74, v70
  v_add_f32 v74, v74, v70
  v_mov_b32 v70, v75
  s_nop 1
  v_permlane16_swap_b32 v75, v70
  v_add_f32 v75, v75, v70
  v_mov_b32 v70, v76
  s_nop 1
  v_permlane16_swap_b32 v76, v70
  v_add_f32 v76, v76, v70
  v_mov_b32 v70, v77
  s_nop 1
  v_permlane16_swap_b32 v77, v70
  v_add_f32 v77, v77, v70
  v_mov_b32 v70, v78
  s_nop 1
  v_permlane16_swap_b32 v78, v70
  v_add_f32 v78, v78, v70
  v_mov_b32 v70, v79
  s_nop 1
  v_permlane16_swap_b32 v79, v70
  v_add_f32 v79, v79, v70
  v_mov_b32 v70, v72
  s_nop 1
  v_permlane32_swap_b32 v72, v70
  v_add_f32 v72, v72, v70
  v_mov_b32 v70, v73
  s_nop 1
  v_permlane32_swap_b32 v73, v70
  v_add_f32 v73, v73, v70
  v_mov_b32 v70, v74
  s_nop 1
  v_permlane32_swap_b32 v74, v70
  v_add_f32 v74, v74, v70
  v_mov_b32 v70, v75
  s_nop 1
  v_permlane32_swap_b32 v75, v70
  v_add_f32 v75, v75, v70
  v_mov_b32 v70, v76
  s_nop 1
  v_permlane32_swap_b32 v76, v70
  v_add_f32 v76, v76, v70
  v_mov_b32 v70, v77
  s_nop 1
  v_permlane32_swap_b32 v77, v70
  v_add_f32 v77, v77, v70
  v_mov_b32 v70, v78
  s_nop 1
  v_permlane32_swap_b32 v78, v70
  v_add_f32 v78, v78, v70
  v_mov_b32 v70, v79
  s_nop 1
  v_permlane32_swap_b32 v79, v70
  v_add_f32 v79, v79, v70
  v_mov_b32 v80, v72
  v_cmp_eq_u32 vcc, 1, v0
  s_nop 1
  v_cndmask_b32 v80, v80, v73, vcc
  v_cmp_eq_u32 vcc, 2, v0
  s_nop 1
  v_cndmask_b32 v80, v80, v74, vcc
  v_cmp_eq_u32 vcc, 3, v0
  s_nop 1
  v_cndmask_b32 v80, v80, v75, vcc
  v_cmp_eq_u32 vcc, 4, v0
  s_nop 1
  v_cndmask_b32 v80, v80, v76, vcc
  v_cmp_eq_u32 vcc, 5, v0
  s_nop 1
  v_cndmask_b32 v80, v80, v77, vcc
  v_cmp_eq_u32 vcc, 6, v0
  s_nop 1
  v_cndmask_b32 v80, v80, v78, vcc
  v_cmp_eq_u32 vcc, 7, v0
  s_nop 1
  v_cndmask_b32 v80, v80, v79, vcc
  v_mul_f32 v80, 0xbfb8aa3b, v80
  v_exp_f32 v80, v80
  s_nop 0
  v_add_f32 v80, 1.0, v80
  v_rcp_f32 v80, v80
  s_lshl_b32 s24, s24, 2
  s_add_u32 s24, s24, 102760448
  v_lshlrev_b32 v2, 2, v0
  s_mov_b64 exec, 0xff
  buffer_store_dword v80, v2, s[8:11], s24 offen sc1
  s_mov_b64 exec, -1
  s_branch L_jobdone
JA1:
  s_lshr_b32 s24, s23, 3
  s_and_b32 s25, s23, 7
  s_mov_b32 s60, 0x3fb8aa3b
  s_mov_b32 s12, s72
  s_and_b32 s13, s73, 0xffff
  s_mov_b32 s14, 2621440
  s_mov_b32 s15, 0x20000
  s_mul_i32 s26, s25, 160
  s_cmp_lt_u32 s22, 2
  s_cbranch_scc0 JA1_wv
  s_add_u32 s28, s4, 100663296
  s_addc_u32 s29, s5, 0
  s_mov_b32 s16, s28
  s_and_b32 s17, s29, 0xffff
  s_mov_b32 s18, 1638400
  s_mov_b32 s19, 0x20000
  s_add_u32 s31, s26, 1280
  s_mov_b32 s61, 163840
  s_branch JA1_wd
JA1_wv:
  s_mov_b32 s16, s74
  s_and_b32 s17, s75, 0xffff
  s_mov_b32 s18, 2457600
  s_mov_b32 s19, 0x20000
  s_add_u32 s31, s26, 2560
  s_mov_b32 s61, 245760
JA1_wd:
  v_lshrrev_b32 v14, 3, v0
  v_mul_u32_u24 v14, 1280, v14
  v_and_b32 v15, 7, v0
  v_lshrrev_b32 v16, 4, v0
  v_xor_b32 v17, v15, v16
  v_lshl_add_u32 v2, v17, 4, v14
  v_xor_b32 v17, 4, v17
  v_lshl_add_u32 v3, v17, 4, v14
  s_lshl_b32 s41, s22, 12
  v_and_b32 v14, 15, v0
  v_lshlrev_b32 v15, 7, v14
  v_add_u32 v15, s41, v15
  v_lshrrev_b32 v16, 1, v14
  v_lshrrev_b32 v17, 4, v0
  v_xor_b32 v16, v16, v17
  v_lshl_add_u32 v10, v16, 4, v15
  v_xor_b32 v16, 4, v16
  v_lshl_add_u32 v11, v16, 4, v15
  v_bfe_u32 v14, v0, 2, 2
  v_lshl_add_u32 v14, v17, 3, v14
  v_mul_u32_u24 v14, 160, v14
  v_and_b32 v15, 3, v0
  v_mul_u32_u24 v15, 40, v15
  v_add_u32 v14, v14, v15
  v_add_u32 v12, 49152, v14
  s_and_b32 s42, s22, 1
  s_mul_i32 s42, s42, 5
  s_lshr_b32 s43, s22, 1
  s_mul_i32 s43, s43, 1280
  s_add_u32 s43, s43, 2560
  s_add_u32 s44, s42, 0
  s_lshl_b32 s44, s44, 6
  v_add_u32 v14, s44, v0
  v_mul_u32_u24 v15, 6554, v14
  v_lshrrev_b32 v15, 16, v15
  v_mul_u32_u24 v16, 10, v15
  v_sub_u32 v16, v14, v16
  v_mul_lo_u32 v15, v15, s43
  v_lshl_add_u32 v4, v16, 4, v15
  s_add_u32 s44, s42, 1
  s_lshl_b32 s44, s44, 6
  v_add_u32 v14, s44, v0
  v_mul_u32_u24 v15, 6554, v14
  v_lshrrev_b32 v15, 16, v15
  v_mul_u32_u24 v16, 10, v15
  v_sub_u32 v16, v14, v16
  v_mul_lo_u32 v15, v15, s43
  v_lshl_add_u32 v5, v16, 4, v15
  s_add_u32 s44, s42, 2
  s_lshl_b32 s44, s44, 6
  v_add_u32 v14, s44, v0
  v_mul_u32_u24 v15, 6554, v14
  v_lshrrev_b32 v15, 16, v15
  v_mul_u32_u24 v16, 10, v15
  v_sub_u32 v16, v14, v16
  v_mul_lo_u32 v15, v15, s43
  v_lshl_add_u32 v6, v16, 4, v15
  s_add_u32 s44, s42, 3
  s_lshl_b32 s44, s44, 6
  v_add_u32 v14, s44, v0
  v_mul_u32_u24 v15, 6554, v14
  v_lshrrev_b32 v15, 16, v15
  v_mul_u32_u24 v16, 10, v15
  v_sub_u32 v16, v14, v16
  v_mul_lo_u32 v15, v15, s43
  v_lshl_add_u32 v7, v16, 4, v15
  s_add_u32 s44, s42, 4
  s_lshl_b32 s44, s44, 6
  v_add_u32 v14, s44, v0
  v_mul_u32_u24 v15, 6554, v14
  v_lshrrev_b32 v15, 16, v15
  v_mul_u32_u24 v16, 10, v15
  v_sub_u32 v16, v14, v16
  v_mul_lo_u32 v15, v15, s43
  v_lshl_add_u32 v8, v16, 4, v15
  s_mul_i32 s45, s22, 40960
  s_add_u32 s46, s45, 0
  s_add_u32 s47, s45, 10240
  s_add_u32 s48, s45, 20480
  s_add_u32 s49, s45, 30720
  s_lshl_b32 s50, s22, 12
  s_lshr_b32 s51, s22, 1
  s_mul_i32 s51, s51, 10240
  s_lshl_b32 s44, s42, 10
  s_add_u32 s51, s51, s44
  s_mul_i32 s30, s24, 163840
  s_add_u32 s44, s30, s46
  s_add_u32 m0, s50, 0
  buffer_load_dwordx4 v2, s[12:15], s44 offen lds
  s_add_u32 s44, s30, s47
  s_add_u32 m0, s50, 1024
  buffer_load_dwordx4 v3, s[12:15], s44 offen lds
  s_add_u32 s44, s30, s48
  s_add_u32 m0, s50, 2048
  buffer_load_dwordx4 v2, s[12:15], s44 offen lds
  s_add_u32 s44, s30, s49
  s_add_u32 m0, s50, 3072
  buffer_load_dwordx4 v3, s[12:15], s44 offen lds
  s_add_u32 m0, s51, 49152
  buffer_load_dwordx4 v4, s[16:19], s31 offen sc1 lds
  s_add_u32 m0, s51, 50176
  buffer_load_dwordx4 v5, s[16:19], s31 offen sc1 lds
  s_add_u32 m0, s51, 51200
  buffer_load_dwordx4 v6, s[16:19], s31 offen sc1 lds
  s_add_u32 m0, s51, 52224
  buffer_load_dwordx4 v7, s[16:19], s31 offen sc1 lds
  s_add_u32 m0, s51, 53248
  buffer_load_dwordx4 v8, s[16:19], s31 offen sc1 lds
  s_add_u32 s30, s30, 128
  s_add_u32 s31, s31, s61
  s_add_u32 s44, s30, s46
  s_add_u32 m0, s50, 16384
  buffer_load_dwordx4 v2, s[12:15], s44 offen lds
  s_add_u32 s44, s30, s47
  s_add_u32 m0, s50, 17408
  buffer_load_dwordx4 v3, s[12:15], s44 offen lds
  s_add_u32 s44, s30, s48
  s_add_u32 m0, s50, 18432
  buffer_load_dwordx4 v2, s[12:15], s44 offen lds
  s_add_u32 s44, s30, s49
  s_add_u32 m0, s50, 19456
  buffer_load_dwordx4 v3, s[12:15], s44 offen lds
  s_add_u32 m0, s51, 69632
  buffer_load_dwordx4 v4, s[16:19], s31 offen sc1 lds
  s_add_u32 m0, s51, 70656
  buffer_load_dwordx4 v5, s[16:19], s31 offen sc1 lds
  s_add_u32 m0, s51, 71680
  buffer_load_dwordx4 v6, s[16:19], s31 offen sc1 lds
  s_add_u32 m0, s51, 72704
  buffer_load_dwordx4 v7, s[16:19], s31 offen sc1 lds
  s_add_u32 m0, s51, 73728
  buffer_load_dwordx4 v8, s[16:19], s31 offen sc1 lds
  s_add_u32 s30, s30, 128
  s_add_u32 s31, s31, s61
  s_waitcnt vmcnt(9)
  s_barrier
  ds_read_b128 v[16:19], v10 offset:0
  ds_read_b128 v[20:23], v10 offset:2048
  ds_read_b128 v[24:27], v11 offset:0
  ds_read_b128 v[28:31], v11 offset:2048
  ds_read_b64_tr_b16 v[32:33], v12 offset:0
  ds_read_b64_tr_b16 v[34:35], v12 offset:640
  ds_read_b64_tr_b16 v[36:37], v12 offset:8
  ds_read_b64_tr_b16 v[38:39], v12 offset:648
  ds_read_b64_tr_b16 v[40:41], v12 offset:16
  ds_read_b64_tr_b16 v[42:43], v12 offset:656
  ds_read_b64_tr_b16 v[44:45], v12 offset:24
  ds_read_b64_tr_b16 v[46:47], v12 offset:664
  s_waitcnt lgkmcnt(10)
  s_waitcnt lgkmcnt(6)
  v_mfma_f32_16x16x32_bf16 v[64:67], v[32:35], v[16:19], 0
  v_mfma_f32_16x16x32_bf16 v[104:107], v[32:35], v[20:23], 0
  ds_read_b64_tr_b16 v[32:33], v12 offset:32
  ds_read_b64_tr_b16 v[34:35], v12 offset:672
  s_waitcnt lgkmcnt(6)
  v_mfma_f32_16x16x32_bf16 v[68:71], v[36:39], v[16:19], 0
  v_mfma_f32_16x16x32_bf16 v[108:111], v[36:39], v[20:23], 0
  s_add_u32 s44, s30, s46
  s_add_u32 m0, s50, 32768
  buffer_load_dwordx4 v2, s[12:15], s44 offen lds
  ds_read_b64_tr_b16 v[36:37], v12 offset:10240
  ds_read_b64_tr_b16 v[38:39], v12 offset:10880
  s_waitcnt lgkmcnt(6)
  v_mfma_f32_16x16x32_bf16 v[72:75], v[40:43], v[16:19], 0
  v_mfma_f32_16x16x32_bf16 v[112:115], v[40:43], v[20:23], 0
  ds_read_b64_tr_b16 v[40:41], v12 offset:10248
  ds_read_b64_tr_b16 v[42:43], v12 offset:10888
  s_waitcnt lgkmcnt(6)
  v_mfma_f32_16x16x32_bf16 v[76:79], v[44:47], v[16:19], 0
  v_mfma_f32_16x16x32_bf16 v[116:119], v[44:47], v[20:23], 0
  s_add_u32 s44, s30, s47
  s_add_u32 m0, s50, 33792
  buffer_load_dwordx4 v3, s[12:15], s44 offen lds
  ds_read_b64_tr_b16 v[44:45], v12 offset:10256
  ds_read_b64_tr_b16 v[46:47], v12 offset:10896
  s_waitcnt lgkmcnt(6)
  v_mfma_f32_16x16x32_bf16 v[80:83], v[32:35], v[16:19], 0
  v_mfma_f32_16x16x32_bf16 v[120:123], v[32:35], v[20:23], 0
  ds_read_b64_tr_b16 v[32:33], v12 offset:10264
  ds_read_b64_tr_b16 v[34:35], v12 offset:10904
  s_waitcnt lgkmcnt(6)
  v_mfma_f32_16x16x32_bf16 v[84:87], v[36:39], v[16:19], 0
  v_mfma_f32_16x16x32_bf16 v[124:127], v[36:39], v[20:23], 0
  s_add_u32 s44, s30, s48
  s_add_u32 m0, s50, 34816
  buffer_load_dwordx4 v2, s[12:15], s44 offen lds
  ds_read_b64_tr_b16 v[36:37], v12 offset:10272
  ds_read_b64_tr_b16 v[38:39], v12 offset:10912
  s_waitcnt lgkmcnt(6)
  v_mfma_f32_16x16x32_bf16 v[88:91], v[40:43], v[16:19], 0
  v_mfma_f32_16x16x32_bf16 v[128:131], v[40:43], v[20:23], 0
  ds_read_b64_tr_b16 v[40:41], v12 offset:5120
  ds_read_b64_tr_b16 v[42:43], v12 offset:5760
  s_waitcnt lgkmcnt(6)
  v_mfma_f32_16x16x32_bf16 v[92:95], v[44:47], v[16:19], 0
  v_mfma_f32_16x16x32_bf16 v[132:135], v[44:47], v[20:23], 0
  s_add_u32 s44, s30, s49
  s_add_u32 m0, s50, 35840
  buffer_load_dwordx4 v3, s[12:15], s44 offen lds
  ds_read_b64_tr_b16 v[44:45], v12 offset:5128
  ds_read_b64_tr_b16 v[46:47], v12 offset:5768
  s_waitcnt lgkmcnt(6)
  v_mfma_f32_16x16x32_bf16 v[96:99], v[32:35], v[16:19], 0
  v_mfma_f32_16x16x32_bf16 v[136:139], v[32:35], v[20:23], 0
  ds_read_b64_tr_b16 v[32:33], v12 offset:5136
  ds_read_b64_tr_b16 v[34:35], v12 offset:5776
  s_waitcnt lgkmcnt(6)
  v_mfma_f32_16x16x32_bf16 v[100:103], v[36:39], v[16:19], 0
  v_mfma_f32_16x16x32_bf16 v[140:143], v[36:39], v[20:23], 0
  s_add_u32 m0, s51, 90112
  buffer_load_dwordx4 v4, s[16:19], s31 offen sc1 lds
  ds_read_b64_tr_b16 v[36:37], v12 offset:5144
  ds_read_b64_tr_b16 v[38:39], v12 offset:5784
  s_waitcnt lgkmcnt(6)
  v_mfma_f32_16x16x32_bf16 v[64:67], v[40:43], v[24:27], v[64:67]
  v_mfma_f32_16x16x32_bf16 v[104:107], v[40:43], v[28:31], v[104:107]
  ds_read_b64_tr_b16 v[40:41], v12 offset:5152
  ds_read_b64_tr_b16 v[42:43], v12 offset:5792
  s_waitcnt lgkmcnt(6)
  v_mfma_f32_16x16x32_bf16 v[68:71], v[44:47], v[24:27], v[68:71]
  v_mfma_f32_16x16x32_bf16 v[108:111], v[44:47], v[28:31], v[108:111]
  s_add_u32 m0, s51, 91136
  buffer_load_dwordx4 v5, s[16:19], s31 offen sc1 lds
  ds_read_b64_tr_b16 v[44:45], v12 offset:15360
  ds_read_b64_tr_b16 v[46:47], v12 offset:16000
  s_waitcnt lgkmcnt(6)
  v_mfma_f32_16x16x32_bf16 v[72:75], v[32:35], v[24:27], v[72:75]
  v_mfma_f32_16x16x32_bf16 v[112:115], v[32:35], v[28:31], v[112:115]
  ds_read_b64_tr_b16 v[32:33], v12 offset:15368
  ds_read_b64_tr_b16 v[34:35], v12 offset:16008
  s_waitcnt lgkmcnt(6)
  v_mfma_f32_16x16x32_bf16 v[76:79], v[36:39], v[24:27], v[76:79]
  v_mfma_f32_16x16x32_bf16 v[116:119], v[36:39], v[28:31], v[116:119]
  s_add_u32 m0, s51, 92160
  buffer_load_dwordx4 v6, s[16:19], s31 offen sc1 lds
  ds_read_b64_tr_b16 v[36:37], v12 offset:15376
  ds_read_b64_tr_b16 v[38:39], v12 offset:16016
  s_waitcnt lgkmcnt(6)
  v_mfma_f32_16x16x32_bf16 v[80:83], v[40:43], v[24:27], v[80:83]
  v_mfma_f32_16x16x32_bf16 v[120:123], v[40:43], v[28:31], v[120:123]
  ds_read_b64_tr_b16 v[40:41], v12 offset:15384
  ds_read_b64_tr_b16 v[42:43], v12 offset:16024
  s_waitcnt lgkmcnt(6)
  v_mfma_f32_16x16x32_bf16 v[84:87], v[44:47], v[24:27], v[84:87]
  v_mfma_f32_16x16x32_bf16 v[124:127], v[44:47], v[28:31], v[124:127]
  s_add_u32 m0, s51, 93184
  buffer_load_dwordx4 v7, s[16:19], s31 offen sc1 lds
  ds_read_b64_tr_b16 v[44:45], v12 offset:15392
  ds_read_b64_tr_b16 v[46:47], v12 offset:16032
  s_waitcnt lgkmcnt(6)
  v_mfma_f32_16x16x32_bf16 v[88:91], v[32:35], v[24:27], v[88:91]
  v_mfma_f32_16x16x32_bf16 v[128:131], v[32:35], v[28:31], v[128:131]
  s_waitcnt lgkmcnt(4)
  v_mfma_f32_16x16x32_bf16 v[92:95], v[36:39], v[24:27], v[92:95]
  v_mfma_f32_16x16x32_bf16 v[132:135], v[36:39], v[28:31], v[132:135]
  s_add_u32 m0, s51, 94208
  buffer_load_dwordx4 v8, s[16:19], s31 offen sc1 lds
  s_waitcnt lgkmcnt(2)
  v_mfma_f32_16x16x32_bf16 v[96:99], v[40:43], v[24:27], v[96:99]
  v_mfma_f32_16x16x32_bf16 v[136:139], v[40:43], v[28:31], v[136:139]
  s_waitcnt lgkmcnt(0)
  v_mfma_f32_16x16x32_bf16 v[100:103], v[44:47], v[24:27], v[100:103]
  v_mfma_f32_16x16x32_bf16 v[140:143], v[44:47], v[28:31], v[140:143]
  s_add_u32 s30, s30, 128
  s_add_u32 s31, s31, s61
  s_waitcnt vmcnt(9)
  s_barrier
  ds_read_b128 v[16:19], v10 offset:16384
  ds_read_b128 v[20:23], v10 offset:18432
  ds_read_b128 v[24:27], v11 offset:16384
  ds_read_b128 v[28:31], v11 offset:18432
  ds_read_b64_tr_b16 v[32:33], v12 offset:20480
  ds_read_b64_tr_b16 v[34:35], v12 offset:21120
  ds_read_b64_tr_b16 v[36:37], v12 offset:20488
  ds_read_b64_tr_b16 v[38:39], v12 offset:21128
  ds_read_b64_tr_b16 v[40:41], v12 offset:20496
  ds_read_b64_tr_b16 v[42:43], v12 offset:21136
  ds_read_b64_tr_b16 v[44:45], v12 offset:20504
  ds_read_b64_tr_b16 v[46:47], v12 offset:21144
  s_waitcnt lgkmcnt(10)
  s_waitcnt lgkmcnt(6)
  v_mfma_f32_16x16x32_bf16 v[64:67], v[32:35], v[16:19], v[64:67]
  v_mfma_f32_16x16x32_bf16 v[104:107], v[32:35], v[20:23], v[104:107]
  ds_read_b64_tr_b16 v[32:33], v12 offset:20512
  ds_read_b64_tr_b16 v[34:35], v12 offset:21152
  s_waitcnt lgkmcnt(6)
  v_mfma_f32_16x16x32_bf16 v[68:71], v[36:39], v[16:19], v[68:71]
  v_mfma_f32_16x16x32_bf16 v[108:111], v[36:39], v[20:23], v[108:111]
  s_add_u32 s44, s30, s46
  s_add_u32 m0, s50, 0
  buffer_load_dwordx4 v2, s[12:15], s44 offen lds
  ds_read_b64_tr_b16 v[36:37], v12 offset:30720
  ds_read_b64_tr_b16 v[38:39], v12 offset:31360
  s_waitcnt lgkmcnt(6)
  v_mfma_f32_16x16x32_bf16 v[72:75], v[40:43], v[16:19], v[72:75]
  v_mfma_f32_16x16x32_bf16 v[112:115], v[40:43], v[20:23], v[112:115]
  ds_read_b64_tr_b16 v[40:41], v12 offset:30728
  ds_read_b64_tr_b16 v[42:43], v12 offset:31368
  s_waitcnt lgkmcnt(6)
  v_mfma_f32_16x16x32_bf16 v[76:79], v[44:47], v[16:19], v[76:79]
  v_mfma_f32_16x16x32_bf16 v[116:119], v[44:47], v[20:23], v[116:119]
  s_add_u32 s44, s30, s47
  s_add_u32 m0, s50, 1024
  buffer_load_dwordx4 v3, s[12:15], s44 offen lds
  ds_read_b64_tr_b16 v[44:45], v12 offset:30736
  ds_read_b64_tr_b16 v[46:47], v12 offset:31376
  s_waitcnt lgkmcnt(6)
  v_mfma_f32_16x16x32_bf16 v[80:83], v[32:35], v[16:19], v[80:83]
  v_mfma_f32_16x16x32_bf16 v[120:123], v[32:35], v[20:23], v[120:123]
  ds_read_b64_tr_b16 v[32:33], v12 offset:30744
  ds_read_b64_tr_b16 v[34:35], v12 offset:31384
  s_waitcnt lgkmcnt(6)
  v_mfma_f32_16x16x32_bf16 v[84:87], v[36:39], v[16:19], v[84:87]
  v_mfma_f32_16x16x32_bf16 v[124:127], v[36:39], v[20:23], v[124:127]
  s_add_u32 s44, s30, s48
  s_add_u32 m0, s50, 2048
  buffer_load_dwordx4 v2, s[12:15], s44 offen lds
  ds_read_b64_tr_b16 v[36:37], v12 offset:30752
  ds_read_b64_tr_b16 v[38:39], v12 offset:31392
  s_waitcnt lgkmcnt(6)
  v_mfma_f32_16x16x32_bf16 v[88:91], v[40:43], v[16:19], v[88:91]
  v_mfma_f32_16x16x32_bf16 v[128:131], v[40:43], v[20:23], v[128:131]
  ds_read_b64_tr_b16 v[40:41], v12 offset:25600
  ds_read_b64_tr_b16 v[42:43], v12 offset:26240
  s_waitcnt lgkmcnt(6)
  v_mfma_f32_16x16x32_bf16 v[92:95], v[44:47], v[16:19], v[92:95]
  v_mfma_f32_16x16x32_bf16 v[132:135], v[44:47], v[20:23], v[132:135]
  s_add_u32 s44, s30, s49
  s_add_u32 m0, s50, 3072
  buffer_load_dwordx4 v3, s[12:15], s44 offen lds
  ds_read_b64_tr_b16 v[44:45], v12 offset:25608
  ds_read_b64_tr_b16 v[46:47], v12 offset:26248
  s_waitcnt lgkmcnt(6)
  v_mfma_f32_16x16x32_bf16 v[96:99], v[32:35], v[16:19], v[96:99]
  v_mfma_f32_16x16x32_bf16 v[136:139], v[32:35], v[20:23], v[136:139]
  ds_read_b64_tr_b16 v[32:33], v12 offset:25616
  ds_read_b64_tr_b16 v[34:35], v12 offset:26256
  s_waitcnt lgkmcnt(6)
  v_mfma_f32_16x16x32_bf16 v[100:103], v[36:39], v[16:19], v[100:103]
  v_mfma_f32_16x16x32_bf16 v[140:143], v[36:39], v[20:23], v[140:143]
  s_add_u32 m0, s51, 49152
  buffer_load_dwordx4 v4, s[16:19], s31 offen sc1 lds
  ds_read_b64_tr_b16 v[36:37], v12 offset:25624
  ds_read_b64_tr_b16 v[38:39], v12 offset:26264
  s_waitcnt lgkmcnt(6)
  v_mfma_f32_16x16x32_bf16 v[64:67], v[40:43], v[24:27], v[64:67]
  v_mfma_f32_16x16x32_bf16 v[104:107], v[40:43], v[28:31], v[104:107]
  ds_read_b64_tr_b16 v[40:41], v12 offset:25632
  ds_read_b64_tr_b16 v[42:43], v12 offset:26272
  s_waitcnt lgkmcnt(6)
  v_mfma_f32_16x16x32_bf16 v[68:71], v[44:47], v[24:27], v[68:71]
  v_mfma_f32_16x16x32_bf16 v[108:111], v[44:47], v[28:31], v[108:111]
  s_add_u32 m0, s51, 50176
  buffer_load_dwordx4 v5, s[16:19], s31 offen sc1 lds
  ds_read_b64_tr_b16 v[44:45], v12 offset:35840
  ds_read_b64_tr_b16 v[46:47], v12 offset:36480
  s_waitcnt lgkmcnt(6)
  v_mfma_f32_16x16x32_bf16 v[72:75], v[32:35], v[24:27], v[72:75]
  v_mfma_f32_16x16x32_bf16 v[112:115], v[32:35], v[28:31], v[112:115]
  ds_read_b64_tr_b16 v[32:33], v12 offset:35848
  ds_read_b64_tr_b16 v[34:35], v12 offset:36488
  s_waitcnt lgkmcnt(6)
  v_mfma_f32_16x16x32_bf16 v[76:79], v[36:39], v[24:27], v[76:79]
  v_mfma_f32_16x16x32_bf16 v[116:119], v[36:39], v[28:31], v[116:119]
  s_add_u32 m0, s51, 51200
  buffer_load_dwordx4 v6, s[16:19], s31 offen sc1 lds
  ds_read_b64_tr_b16 v[36:37], v12 offset:35856
  ds_read_b64_tr_b16 v[38:39], v12 offset:36496
  s_waitcnt lgkmcnt(6)
  v_mfma_f32_16x16x32_bf16 v[80:83], v[40:43], v[24:27], v[80:83]
  v_mfma_f32_16x16x32_bf16 v[120:123], v[40:43], v[28:31], v[120:123]
  ds_read_b64_tr_b16 v[40:41], v12 offset:35864
  ds_read_b64_tr_b16 v[42:43], v12 offset:36504
  s_waitcnt lgkmcnt(6)
  v_mfma_f32_16x16x32_bf16 v[84:87], v[44:47], v[24:27], v[84:87]
  v_mfma_f32_16x16x32_bf16 v[124:127], v[44:47], v[28:31], v[124:127]
  s_add_u32 m0, s51, 52224
  buffer_load_dwordx4 v7, s[16:19], s31 offen sc1 lds
  ds_read_b64_tr_b16 v[44:45], v12 offset:35872
  ds_read_b64_tr_b16 v[46:47], v12 offset:36512
  s_waitcnt lgkmcnt(6)
  v_mfma_f32_16x16x32_bf16 v[88:91], v[32:35], v[24:27], v[88:91]
  v_mfma_f32_16x16x32_bf16 v[128:131], v[32:35], v[28:31], v[128:131]
  s_waitcnt lgkmcnt(4)
  v_mfma_f32_16x16x32_bf16 v[92:95], v[36:39], v[24:27], v[92:95]
  v_mfma_f32_16x16x32_bf16 v[132:135], v[36:39], v[28:31], v[132:135]
  s_add_u32 m0, s51, 53248
  buffer_load_dwordx4 v8, s[16:19], s31 offen sc1 lds
  s_waitcnt lgkmcnt(2)
  v_mfma_f32_16x16x32_bf16 v[96:99], v[40:43], v[24:27], v[96:99]
  v_mfma_f32_16x16x32_bf16 v[136:139], v[40:43], v[28:31], v[136:139]
  s_waitcnt lgkmcnt(0)
  v_mfma_f32_16x16x32_bf16 v[100:103], v[44:47], v[24:27], v[100:103]
  v_mfma_f32_16x16x32_bf16 v[140:143], v[44:47], v[28:31], v[140:143]
  s_add_u32 s30, s30, 128
  s_add_u32 s31, s31, s61
  s_waitcnt vmcnt(9)
  s_barrier
  ds_read_b128 v[16:19], v10 offset:32768
  ds_read_b128 v[20:23], v10 offset:34816
  ds_read_b128 v[24:27], v11 offset:32768
  ds_read_b128 v[28:31], v11 offset:34816
  ds_read_b64_tr_b16 v[32:33], v12 offset:40960
  ds_read_b64_tr_b16 v[34:35], v12 offset:41600
  ds_read_b64_tr_b16 v[36:37], v12 offset:40968
  ds_read_b64_tr_b16 v[38:39], v12 offset:41608
  ds_read_b64_tr_b16 v[40:41], v12 offset:40976
  ds_read_b64_tr_b16 v[42:43], v12 offset:41616
  ds_read_b64_tr_b16 v[44:45], v12 offset:40984
  ds_read_b64_tr_b16 v[46:47], v12 offset:41624
  s_waitcnt lgkmcnt(10)
  s_waitcnt lgkmcnt(6)
  v_mfma_f32_16x16x32_bf16 v[64:67], v[32:35], v[16:19], v[64:67]
  v_mfma_f32_16x16x32_bf16 v[104:107], v[32:35], v[20:23], v[104:107]
  ds_read_b64_tr_b16 v[32:33], v12 offset:40992
  ds_read_b64_tr_b16 v[34:35], v12 offset:41632
  s_waitcnt lgkmcnt(6)
  v_mfma_f32_16x16x32_bf16 v[68:71], v[36:39], v[16:19], v[68:71]
  v_mfma_f32_16x16x32_bf16 v[108:111], v[36:39], v[20:23], v[108:111]
  s_add_u32 s44, s30, s46
  s_add_u32 m0, s50, 16384
  buffer_load_dwordx4 v2, s[12:15], s44 offen lds
  ds_read_b64_tr_b16 v[36:37], v12 offset:51200
  ds_read_b64_tr_b16 v[38:39], v12 offset:51840
  s_waitcnt lgkmcnt(6)
  v_mfma_f32_16x16x32_bf16 v[72:75], v[40:43], v[16:19], v[72:75]
  v_mfma_f32_16x16x32_bf16 v[112:115], v[40:43], v[20:23], v[112:115]
  ds_read_b64_tr_b16 v[40:41], v12 offset:51208
  ds_read_b64_tr_b16 v[42:43], v12 offset:51848
  s_waitcnt lgkmcnt(6)
  v_mfma_f32_16x16x32_bf16 v[76:79], v[44:47], v[16:19], v[76:79]
  v_mfma_f32_16x16x32_bf16 v[116:119], v[44:47], v[20:23], v[116:119]
  s_add_u32 s44, s30, s47
  s_add_u32 m0, s50, 17408
  buffer_load_dwordx4 v3, s[12:15], s44 offen lds
  ds_read_b64_tr_b16 v[44:45], v12 offset:51216
  ds_read_b64_tr_b16 v[46:47], v12 offset:51856
  s_waitcnt lgkmcnt(6)
  v_mfma_f32_16x16x32_bf16 v[80:83], v[32:35], v[16:19], v[80:83]
  v_mfma_f32_16x16x32_bf16 v[120:123], v[32:35], v[20:23], v[120:123]
  ds_read_b64_tr_b16 v[32:33], v12 offset:51224
  ds_read_b64_tr_b16 v[34:35], v12 offset:51864
  s_waitcnt lgkmcnt(6)
  v_mfma_f32_16x16x32_bf16 v[84:87], v[36:39], v[16:19], v[84:87]
  v_mfma_f32_16x16x32_bf16 v[124:127], v[36:39], v[20:23], v[124:127]
  s_add_u32 s44, s30, s48
  s_add_u32 m0, s50, 18432
  buffer_load_dwordx4 v2, s[12:15], s44 offen lds
  ds_read_b64_tr_b16 v[36:37], v12 offset:51232
  ds_read_b64_tr_b16 v[38:39], v12 offset:51872
  s_waitcnt lgkmcnt(6)
  v_mfma_f32_16x16x32_bf16 v[88:91], v[40:43], v[16:19], v[88:91]
  v_mfma_f32_16x16x32_bf16 v[128:131], v[40:43], v[20:23], v[128:131]
  ds_read_b64_tr_b16 v[40:41], v12 offset:46080
  ds_read_b64_tr_b16 v[42:43], v12 offset:46720
  s_waitcnt lgkmcnt(6)
  v_mfma_f32_16x16x32_bf16 v[92:95], v[44:47], v[16:19], v[92:95]
  v_mfma_f32_16x16x32_bf16 v[132:135], v[44:47], v[20:23], v[132:135]
  s_add_u32 s44, s30, s49
  s_add_u32 m0, s50, 19456
  buffer_load_dwordx4 v3, s[12:15], s44 offen lds
  ds_read_b64_tr_b16 v[44:45], v12 offset:46088
  ds_read_b64_tr_b16 v[46:47], v12 offset:46728
  s_waitcnt lgkmcnt(6)
  v_mfma_f32_16x16x32_bf16 v[96:99], v[32:35], v[16:19], v[96:99]
  v_mfma_f32_16x16x32_bf16 v[136:139], v[32:35], v[20:23], v[136:139]
  ds_read_b64_tr_b16 v[32:33], v12 offset:46096
  ds_read_b64_tr_b16 v[34:35], v12 offset:46736
  s_waitcnt lgkmcnt(6)
  v_mfma_f32_16x16x32_bf16 v[100:103], v[36:39], v[16:19], v[100:103]
  v_mfma_f32_16x16x32_bf16 v[140:143], v[36:39], v[20:23], v[140:143]
  s_add_u32 m0, s51, 69632
  buffer_load_dwordx4 v4, s[16:19], s31 offen sc1 lds
  ds_read_b64_tr_b16 v[36:37], v12 offset:46104
  ds_read_b64_tr_b16 v[38:39], v12 offset:46744
  s_waitcnt lgkmcnt(6)
  v_mfma_f32_16x16x32_bf16 v[64:67], v[40:43], v[24:27], v[64:67]
  v_mfma_f32_16x16x32_bf16 v[104:107], v[40:43], v[28:31], v[104:107]
  ds_read_b64_tr_b16 v[40:41], v12 offset:46112
  ds_read_b64_tr_b16 v[42:43], v12 offset:46752
  s_waitcnt lgkmcnt(6)
  v_mfma_f32_16x16x32_bf16 v[68:71], v[44:47], v[24:27], v[68:71]
  v_mfma_f32_16x16x32_bf16 v[108:111], v[44:47], v[28:31], v[108:111]
  s_add_u32 m0, s51, 70656
  buffer_load_dwordx4 v5, s[16:19], s31 offen sc1 lds
  ds_read_b64_tr_b16 v[44:45], v12 offset:56320
  ds_read_b64_tr_b16 v[46:47], v12 offset:56960
  s_waitcnt lgkmcnt(6)
  v_mfma_f32_16x16x32_bf16 v[72:75], v[32:35], v[24:27], v[72:75]
  v_mfma_f32_16x16x32_bf16 v[112:115], v[32:35], v[28:31], v[112:115]
  ds_read_b64_tr_b16 v[32:33], v12 offset:56328
  ds_read_b64_tr_b16 v[34:35], v12 offset:56968
  s_waitcnt lgkmcnt(6)
  v_mfma_f32_16x16x32_bf16 v[76:79], v[36:39], v[24:27], v[76:79]
  v_mfma_f32_16x16x32_bf16 v[116:119], v[36:39], v[28:31], v[116:119]
  s_add_u32 m0, s51, 71680
  buffer_load_dwordx4 v6, s[16:19], s31 offen sc1 lds
  ds_read_b64_tr_b16 v[36:37], v12 offset:56336
  ds_read_b64_tr_b16 v[38:39], v12 offset:56976
  s_waitcnt lgkmcnt(6)
  v_mfma_f32_16x16x32_bf16 v[80:83], v[40:43], v[24:27], v[80:83]
  v_mfma_f32_16x16x32_bf16 v[120:123], v[40:43], v[28:31], v[120:123]
  ds_read_b64_tr_b16 v[40:41], v12 offset:56344
  ds_read_b64_tr_b16 v[42:43], v12 offset:56984
  s_waitcnt lgkmcnt(6)
  v_mfma_f32_16x16x32_bf16 v[84:87], v[44:47], v[24:27], v[84:87]
  v_mfma_f32_16x16x32_bf16 v[124:127], v[44:47], v[28:31], v[124:127]
  s_add_u32 m0, s51, 72704
  buffer_load_dwordx4 v7, s[16:19], s31 offen sc1 lds
  ds_read_b64_tr_b16 v[44:45], v12 offset:56352
  ds_read_b64_tr_b16 v[46:47], v12 offset:56992
  s_waitcnt lgkmcnt(6)
  v_mfma_f32_16x16x32_bf16 v[88:91], v[32:35], v[24:27], v[88:91]
  v_mfma_f32_16x16x32_bf16 v[128:131], v[32:35], v[28:31], v[128:131]
  s_waitcnt lgkmcnt(4)
  v_mfma_f32_16x16x32_bf16 v[92:95], v[36:39], v[24:27], v[92:95]
  v_mfma_f32_16x16x32_bf16 v[132:135], v[36:39], v[28:31], v[132:135]
  s_add_u32 m0, s51, 73728
  buffer_load_dwordx4 v8, s[16:19], s31 offen sc1 lds
  s_waitcnt lgkmcnt(2)
  v_mfma_f32_16x16x32_bf16 v[96:99], v[40:43], v[24:27], v[96:99]
  v_mfma_f32_16x16x32_bf16 v[136:139], v[40:43], v[28:31], v[136:139]
  s_waitcnt lgkmcnt(0)
  v_mfma_f32_16x16x32_bf16 v[100:103], v[44:47], v[24:27], v[100:103]
  v_mfma_f32_16x16x32_bf16 v[140:143], v[44:47], v[28:31], v[140:143]
  s_add_u32 s30, s30, 128
  s_add_u32 s31, s31, s61
  s_waitcnt vmcnt(9)
  s_barrier
  ds_read_b128 v[16:19], v10 offset:0
  ds_read_b128 v[20:23], v10 offset:2048
  ds_read_b128 v[24:27], v11 offset:0
  ds_read_b128 v[28:31], v11 offset:2048
  ds_read_b64_tr_b16 v[32:33], v12 offset:0
  ds_read_b64_tr_b16 v[34:35], v12 offset:640
  ds_read_b64_tr_b16 v[36:37], v12 offset:8
  ds_read_b64_tr_b16 v[38:39], v12 offset:648
  ds_read_b64_tr_b16 v[40:41], v12 offset:16
  ds_read_b64_tr_b16 v[42:43], v12 offset:656
  ds_read_b64_tr_b16 v[44:45], v12 offset:24
  ds_read_b64_tr_b16 v[46:47], v12 offset:664
  s_waitcnt lgkmcnt(10)
  s_waitcnt lgkmcnt(6)
  v_mfma_f32_16x16x32_bf16 v[64:67], v[32:35], v[16:19], v[64:67]
  v_mfma_f32_16x16x32_bf16 v[104:107], v[32:35], v[20:23], v[104:107]
  ds_read_b64_tr_b16 v[32:33], v12 offset:32
  ds_read_b64_tr_b16 v[34:35], v12 offset:672
  s_waitcnt lgkmcnt(6)
  v_mfma_f32_16x16x32_bf16 v[68:71], v[36:39], v[16:19], v[68:71]
  v_mfma_f32_16x16x32_bf16 v[108:111], v[36:39], v[20:23], v[108:111]
  s_add_u32 s44, s30, s46
  s_add_u32 m0, s50, 32768
  buffer_load_dwordx4 v2, s[12:15], s44 offen lds
  ds_read_b64_tr_b16 v[36:37], v12 offset:10240
  ds_read_b64_tr_b16 v[38:39], v12 offset:10880
  s_waitcnt lgkmcnt(6)
  v_mfma_f32_16x16x32_bf16 v[72:75], v[40:43], v[16:19], v[72:75]
  v_mfma_f32_16x16x32_bf16 v[112:115], v[40:43], v[20:23], v[112:115]
  ds_read_b64_tr_b16 v[40:41], v12 offset:10248
  ds_read_b64_tr_b16 v[42:43], v12 offset:10888
  s_waitcnt lgkmcnt(6)
  v_mfma_f32_16x16x32_bf16 v[76:79], v[44:47], v[16:19], v[76:79]
  v_mfma_f32_16x16x32_bf16 v[116:119], v[44:47], v[20:23], v[116:119]
  s_add_u32 s44, s30, s47
  s_add_u32 m0, s50, 33792
  buffer_load_dwordx4 v3, s[12:15], s44 offen lds
  ds_read_b64_tr_b16 v[44:45], v12 offset:10256
  ds_read_b64_tr_b16 v[46:47], v12 offset:10896
  s_waitcnt lgkmcnt(6)
  v_mfma_f32_16x16x32_bf16 v[80:83], v[32:35], v[16:19], v[80:83]
  v_mfma_f32_16x16x32_bf16 v[120:123], v[32:35], v[20:23], v[120:123]
  ds_read_b64_tr_b16 v[32:33], v12 offset:10264
  ds_read_b64_tr_b16 v[34:35], v12 offset:10904
  s_waitcnt lgkmcnt(6)
  v_mfma_f32_16x16x32_bf16 v[84:87], v[36:39], v[16:19], v[84:87]
  v_mfma_f32_16x16x32_bf16 v[124:127], v[36:39], v[20:23], v[124:127]
  s_add_u32 s44, s30, s48
  s_add_u32 m0, s50, 34816
  buffer_load_dwordx4 v2, s[12:15], s44 offen lds
  ds_read_b64_tr_b16 v[36:37], v12 offset:10272
  ds_read_b64_tr_b16 v[38:39], v12 offset:10912
  s_waitcnt lgkmcnt(6)
  v_mfma_f32_16x16x32_bf16 v[88:91], v[40:43], v[16:19], v[88:91]
  v_mfma_f32_16x16x32_bf16 v[128:131], v[40:43], v[20:23], v[128:131]
  ds_read_b64_tr_b16 v[40:41], v12 offset:5120
  ds_read_b64_tr_b16 v[42:43], v12 offset:5760
  s_waitcnt lgkmcnt(6)
  v_mfma_f32_16x16x32_bf16 v[92:95], v[44:47], v[16:19], v[92:95]
  v_mfma_f32_16x16x32_bf16 v[132:135], v[44:47], v[20:23], v[132:135]
  s_add_u32 s44, s30, s49
  s_add_u32 m0, s50, 35840
  buffer_load_dwordx4 v3, s[12:15], s44 offen lds
  ds_read_b64_tr_b16 v[44:45], v12 offset:5128
  ds_read_b64_tr_b16 v[46:47], v12 offset:5768
  s_waitcnt lgkmcnt(6)
  v_mfma_f32_16x16x32_bf16 v[96:99], v[32:35], v[16:19], v[96:99]
  v_mfma_f32_16x16x32_bf16 v[136:139], v[32:35], v[20:23], v[136:139]
  ds_read_b64_tr_b16 v[32:33], v12 offset:5136
  ds_read_b64_tr_b16 v[34:35], v12 offset:5776
  s_waitcnt lgkmcnt(6)
  v_mfma_f32_16x16x32_bf16 v[100:103], v[36:39], v[16:19], v[100:103]
  v_mfma_f32_16x16x32_bf16 v[140:143], v[36:39], v[20:23], v[140:143]
  s_add_u32 m0, s51, 90112
  buffer_load_dwordx4 v4, s[16:19], s31 offen sc1 lds
  ds_read_b64_tr_b16 v[36:37], v12 offset:5144
  ds_read_b64_tr_b16 v[38:39], v12 offset:5784
  s_waitcnt lgkmcnt(6)
  v_mfma_f32_16x16x32_bf16 v[64:67], v[40:43], v[24:27], v[64:67]
  v_mfma_f32_16x16x32_bf16 v[104:107], v[40:43], v[28:31], v[104:107]
  ds_read_b64_tr_b16 v[40:41], v12 offset:5152
  ds_read_b64_tr_b16 v[42:43], v12 offset:5792
  s_waitcnt lgkmcnt(6)
  v_mfma_f32_16x16x32_bf16 v[68:71], v[44:47], v[24:27], v[68:71]
  v_mfma_f32_16x16x32_bf16 v[108:111], v[44:47], v[28:31], v[108:111]
  s_add_u32 m0, s51, 91136
  buffer_load_dwordx4 v5, s[16:19], s31 offen sc1 lds
  ds_read_b64_tr_b16 v[44:45], v12 offset:15360
  ds_read_b64_tr_b16 v[46:47], v12 offset:16000
  s_waitcnt lgkmcnt(6)
  v_mfma_f32_16x16x32_bf16 v[72:75], v[32:35], v[24:27], v[72:75]
  v_mfma_f32_16x16x32_bf16 v[112:115], v[32:35], v[28:31], v[112:115]
  ds_read_b64_tr_b16 v[32:33], v12 offset:15368
  ds_read_b64_tr_b16 v[34:35], v12 offset:16008
  s_waitcnt lgkmcnt(6)
  v_mfma_f32_16x16x32_bf16 v[76:79], v[36:39], v[24:27], v[76:79]
  v_mfma_f32_16x16x32_bf16 v[116:119], v[36:39], v[28:31], v[116:119]
  s_add_u32 m0, s51, 92160
  buffer_load_dwordx4 v6, s[16:19], s31 offen sc1 lds
  ds_read_b64_tr_b16 v[36:37], v12 offset:15376
  ds_read_b64_tr_b16 v[38:39], v12 offset:16016
  s_waitcnt lgkmcnt(6)
  v_mfma_f32_16x16x32_bf16 v[80:83], v[40:43], v[24:27], v[80:83]
  v_mfma_f32_16x16x32_bf16 v[120:123], v[40:43], v[28:31], v[120:123]
  ds_read_b64_tr_b16 v[40:41], v12 offset:15384
  ds_read_b64_tr_b16 v[42:43], v12 offset:16024
  s_waitcnt lgkmcnt(6)
  v_mfma_f32_16x16x32_bf16 v[84:87], v[44:47], v[24:27], v[84:87]
  v_mfma_f32_16x16x32_bf16 v[124:127], v[44:47], v[28:31], v[124:127]
  s_add_u32 m0, s51, 93184
  buffer_load_dwordx4 v7, s[16:19], s31 offen sc1 lds
  ds_read_b64_tr_b16 v[44:45], v12 offset:15392
  ds_read_b64_tr_b16 v[46:47], v12 offset:16032
  s_waitcnt lgkmcnt(6)
  v_mfma_f32_16x16x32_bf16 v[88:91], v[32:35], v[24:27], v[88:91]
  v_mfma_f32_16x16x32_bf16 v[128:131], v[32:35], v[28:31], v[128:131]
  s_waitcnt lgkmcnt(4)
  v_mfma_f32_16x16x32_bf16 v[92:95], v[36:39], v[24:27], v[92:95]
  v_mfma_f32_16x16x32_bf16 v[132:135], v[36:39], v[28:31], v[132:135]
  s_add_u32 m0, s51, 94208
  buffer_load_dwordx4 v8, s[16:19], s31 offen sc1 lds
  s_waitcnt lgkmcnt(2)
  v_mfma_f32_16x16x32_bf16 v[96:99], v[40:43], v[24:27], v[96:99]
  v_mfma_f32_16x16x32_bf16 v[136:139], v[40:43], v[28:31], v[136:139]
  s_waitcnt lgkmcnt(0)
  v_mfma_f32_16x16x32_bf16 v[100:103], v[44:47], v[24:27], v[100:103]
  v_mfma_f32_16x16x32_bf16 v[140:143], v[44:47], v[28:31], v[140:143]
  s_add_u32 s30, s30, 128
  s_add_u32 s31, s31, s61
  s_waitcnt vmcnt(9)
  s_barrier
  ds_read_b128 v[16:19], v10 offset:16384
  ds_read_b128 v[20:23], v10 offset:18432
  ds_read_b128 v[24:27], v11 offset:16384
  ds_read_b128 v[28:31], v11 offset:18432
  ds_read_b64_tr_b16 v[32:33], v12 offset:20480
  ds_read_b64_tr_b16 v[34:35], v12 offset:21120
  ds_read_b64_tr_b16 v[36:37], v12 offset:20488
  ds_read_b64_tr_b16 v[38:39], v12 offset:21128
  ds_read_b64_tr_b16 v[40:41], v12 offset:20496
  ds_read_b64_tr_b16 v[42:43], v12 offset:21136
  ds_read_b64_tr_b16 v[44:45], v12 offset:20504
  ds_read_b64_tr_b16 v[46:47], v12 offset:21144
  s_waitcnt lgkmcnt(10)
  s_waitcnt lgkmcnt(6)
  v_mfma_f32_16x16x32_bf16 v[64:67], v[32:35], v[16:19], v[64:67]
  v_mfma_f32_16x16x32_bf16 v[104:107], v[32:35], v[20:23], v[104:107]
  ds_read_b64_tr_b16 v[32:33], v12 offset:20512
  ds_read_b64_tr_b16 v[34:35], v12 offset:21152
  s_waitcnt lgkmcnt(6)
  v_mfma_f32_16x16x32_bf16 v[68:71], v[36:39], v[16:19], v[68:71]
  v_mfma_f32_16x16x32_bf16 v[108:111], v[36:39], v[20:23], v[108:111]
  s_add_u32 s44, s30, s46
  s_add_u32 m0, s50, 0
  buffer_load_dwordx4 v2, s[12:15], s44 offen lds
  ds_read_b64_tr_b16 v[36:37], v12 offset:30720
  ds_read_b64_tr_b16 v[38:39], v12 offset:31360
  s_waitcnt lgkmcnt(6)
  v_mfma_f32_16x16x32_bf16 v[72:75], v[40:43], v[16:19], v[72:75]
  v_mfma_f32_16x16x32_bf16 v[112:115], v[40:43], v[20:23], v[112:115]
  ds_read_b64_tr_b16 v[40:41], v12 offset:30728
  ds_read_b64_tr_b16 v[42:43], v12 offset:31368
  s_waitcnt lgkmcnt(6)
  v_mfma_f32_16x16x32_bf16 v[76:79], v[44:47], v[16:19], v[76:79]
  v_mfma_f32_16x16x32_bf16 v[116:119], v[44:47], v[20:23], v[116:119]
  s_add_u32 s44, s30, s47
  s_add_u32 m0, s50, 1024
  buffer_load_dwordx4 v3, s[12:15], s44 offen lds
  ds_read_b64_tr_b16 v[44:45], v12 offset:30736
  ds_read_b64_tr_b16 v[46:47], v12 offset:31376
  s_waitcnt lgkmcnt(6)
  v_mfma_f32_16x16x32_bf16 v[80:83], v[32:35], v[16:19], v[80:83]
  v_mfma_f32_16x16x32_bf16 v[120:123], v[32:35], v[20:23], v[120:123]
  ds_read_b64_tr_b16 v[32:33], v12 offset:30744
  ds_read_b64_tr_b16 v[34:35], v12 offset:31384
  s_waitcnt lgkmcnt(6)
  v_mfma_f32_16x16x32_bf16 v[84:87], v[36:39], v[16:19], v[84:87]
  v_mfma_f32_16x16x32_bf16 v[124:127], v[36:39], v[20:23], v[124:127]
  s_add_u32 s44, s30, s48
  s_add_u32 m0, s50, 2048
  buffer_load_dwordx4 v2, s[12:15], s44 offen lds
  ds_read_b64_tr_b16 v[36:37], v12 offset:30752
  ds_read_b64_tr_b16 v[38:39], v12 offset:31392
  s_waitcnt lgkmcnt(6)
  v_mfma_f32_16x16x32_bf16 v[88:91], v[40:43], v[16:19], v[88:91]
  v_mfma_f32_16x16x32_bf16 v[128:131], v[40:43], v[20:23], v[128:131]
  ds_read_b64_tr_b16 v[40:41], v12 offset:25600
  ds_read_b64_tr_b16 v[42:43], v12 offset:26240
  s_waitcnt lgkmcnt(6)
  v_mfma_f32_16x16x32_bf16 v[92:95], v[44:47], v[16:19], v[92:95]
  v_mfma_f32_16x16x32_bf16 v[132:135], v[44:47], v[20:23], v[132:135]
  s_add_u32 s44, s30, s49
  s_add_u32 m0, s50, 3072
  buffer_load_dwordx4 v3, s[12:15], s44 offen lds
  ds_read_b64_tr_b16 v[44:45], v12 offset:25608
  ds_read_b64_tr_b16 v[46:47], v12 offset:26248
  s_waitcnt lgkmcnt(6)
  v_mfma_f32_16x16x32_bf16 v[96:99], v[32:35], v[16:19], v[96:99]
  v_mfma_f32_16x16x32_bf16 v[136:139], v[32:35], v[20:23], v[136:139]
  ds_read_b64_tr_b16 v[32:33], v12 offset:25616
  ds_read_b64_tr_b16 v[34:35], v12 offset:26256
  s_waitcnt lgkmcnt(6)
  v_mfma_f32_16x16x32_bf16 v[100:103], v[36:39], v[16:19], v[100:103]
  v_mfma_f32_16x16x32_bf16 v[140:143], v[36:39], v[20:23], v[140:143]
  s_add_u32 m0, s51, 49152
  buffer_load_dwordx4 v4, s[16:19], s31 offen sc1 lds
  ds_read_b64_tr_b16 v[36:37], v12 offset:25624
  ds_read_b64_tr_b16 v[38:39], v12 offset:26264
  s_waitcnt lgkmcnt(6)
  v_mfma_f32_16x16x32_bf16 v[64:67], v[40:43], v[24:27], v[64:67]
  v_mfma_f32_16x16x32_bf16 v[104:107], v[40:43], v[28:31], v[104:107]
  ds_read_b64_tr_b16 v[40:41], v12 offset:25632
  ds_read_b64_tr_b16 v[42:43], v12 offset:26272
  s_waitcnt lgkmcnt(6)
  v_mfma_f32_16x16x32_bf16 v[68:71], v[44:47], v[24:27], v[68:71]
  v_mfma_f32_16x16x32_bf16 v[108:111], v[44:47], v[28:31], v[108:111]
  s_add_u32 m0, s51, 50176
  buffer_load_dwordx4 v5, s[16:19], s31 offen sc1 lds
  ds_read_b64_tr_b16 v[44:45], v12 offset:35840
  ds_read_b64_tr_b16 v[46:47], v12 offset:36480
  s_waitcnt lgkmcnt(6)
  v_mfma_f32_16x16x32_bf16 v[72:75], v[32:35], v[24:27], v[72:75]
  v_mfma_f32_16x16x32_bf16 v[112:115], v[32:35], v[28:31], v[112:115]
  ds_read_b64_tr_b16 v[32:33], v12 offset:35848
  ds_read_b64_tr_b16 v[34:35], v12 offset:36488
  s_waitcnt lgkmcnt(6)
  v_mfma_f32_16x16x32_bf16 v[76:79], v[36:39], v[24:27], v[76:79]
  v_mfma_f32_16x16x32_bf16 v[116:119], v[36:39], v[28:31], v[116:119]
  s_add_u32 m0, s51, 51200
  buffer_load_dwordx4 v6, s[16:19], s31 offen sc1 lds
  ds_read_b64_tr_b16 v[36:37], v12 offset:35856
  ds_read_b64_tr_b16 v[38:39], v12 offset:36496
  s_waitcnt lgkmcnt(6)
  v_mfma_f32_16x16x32_bf16 v[80:83], v[40:43], v[24:27], v[80:83]
  v_mfma_f32_16x16x32_bf16 v[120:123], v[40:43], v[28:31], v[120:123]
  ds_read_b64_tr_b16 v[40:41], v12 offset:35864
  ds_read_b64_tr_b16 v[42:43], v12 offset:36504
  s_waitcnt lgkmcnt(6)
  v_mfma_f32_16x16x32_bf16 v[84:87], v[44:47], v[24:27], v[84:87]
  v_mfma_f32_16x16x32_bf16 v[124:127], v[44:47], v[28:31], v[124:127]
  s_add_u32 m0, s51, 52224
  buffer_load_dwordx4 v7, s[16:19], s31 offen sc1 lds
  ds_read_b64_tr_b16 v[44:45], v12 offset:35872
  ds_read_b64_tr_b16 v[46:47], v12 offset:36512
  s_waitcnt lgkmcnt(6)
  v_mfma_f32_16x16x32_bf16 v[88:91], v[32:35], v[24:27], v[88:91]
  v_mfma_f32_16x16x32_bf16 v[128:131], v[32:35], v[28:31], v[128:131]
  s_waitcnt lgkmcnt(4)
  v_mfma_f32_16x16x32_bf16 v[92:95], v[36:39], v[24:27], v[92:95]
  v_mfma_f32_16x16x32_bf16 v[132:135], v[36:39], v[28:31], v[132:135]
  s_add_u32 m0, s51, 53248
  buffer_load_dwordx4 v8, s[16:19], s31 offen sc1 lds
  s_waitcnt lgkmcnt(2)
  v_mfma_f32_16x16x32_bf16 v[96:99], v[40:43], v[24:27], v[96:99]
  v_mfma_f32_16x16x32_bf16 v[136:139], v[40:43], v[28:31], v[136:139]
  s_waitcnt lgkmcnt(0)
  v_mfma_f32_16x16x32_bf16 v[100:103], v[44:47], v[24:27], v[100:103]
  v_mfma_f32_16x16x32_bf16 v[140:143], v[44:47], v[28:31], v[140:143]
  s_add_u32 s30, s30, 128
  s_add_u32 s31, s31, s61
  s_waitcnt vmcnt(9)
  s_barrier
  ds_read_b128 v[16:19], v10 offset:32768
  ds_read_b128 v[20:23], v10 offset:34816
  ds_read_b128 v[24:27], v11 offset:32768
  ds_read_b128 v[28:31], v11 offset:34816
  ds_read_b64_tr_b16 v[32:33], v12 offset:40960
  ds_read_b64_tr_b16 v[34:35], v12 offset:41600
  ds_read_b64_tr_b16 v[36:37], v12 offset:40968
  ds_read_b64_tr_b16 v[38:39], v12 offset:41608
  ds_read_b64_tr_b16 v[40:41], v12 offset:40976
  ds_read_b64_tr_b16 v[42:43], v12 offset:41616
  ds_read_b64_tr_b16 v[44:45], v12 offset:40984
  ds_read_b64_tr_b16 v[46:47], v12 offset:41624
  s_waitcnt lgkmcnt(10)
  s_waitcnt lgkmcnt(6)
  v_mfma_f32_16x16x32_bf16 v[64:67], v[32:35], v[16:19], v[64:67]
  v_mfma_f32_16x16x32_bf16 v[104:107], v[32:35], v[20:23], v[104:107]
  ds_read_b64_tr_b16 v[32:33], v12 offset:40992
  ds_read_b64_tr_b16 v[34:35], v12 offset:41632
  s_waitcnt lgkmcnt(6)
  v_mfma_f32_16x16x32_bf16 v[68:71], v[36:39], v[16:19], v[68:71]
  v_mfma_f32_16x16x32_bf16 v[108:111], v[36:39], v[20:23], v[108:111]
  s_add_u32 s44, s30, s46
  s_add_u32 m0, s50, 16384
  buffer_load_dwordx4 v2, s[12:15], s44 offen lds
  ds_read_b64_tr_b16 v[36:37], v12 offset:51200
  ds_read_b64_tr_b16 v[38:39], v12 offset:51840
  s_waitcnt lgkmcnt(6)
  v_mfma_f32_16x16x32_bf16 v[72:75], v[40:43], v[16:19], v[72:75]
  v_mfma_f32_16x16x32_bf16 v[112:115], v[40:43], v[20:23], v[112:115]
  ds_read_b64_tr_b16 v[40:41], v12 offset:51208
  ds_read_b64_tr_b16 v[42:43], v12 offset:51848
  s_waitcnt lgkmcnt(6)
  v_mfma_f32_16x16x32_bf16 v[76:79], v[44:47], v[16:19], v[76:79]
  v_mfma_f32_16x16x32_bf16 v[116:119], v[44:47], v[20:23], v[116:119]
  s_add_u32 s44, s30, s47
  s_add_u32 m0, s50, 17408
  buffer_load_dwordx4 v3, s[12:15], s44 offen lds
  ds_read_b64_tr_b16 v[44:45], v12 offset:51216
  ds_read_b64_tr_b16 v[46:47], v12 offset:51856
  s_waitcnt lgkmcnt(6)
  v_mfma_f32_16x16x32_bf16 v[80:83], v[32:35], v[16:19], v[80:83]
  v_mfma_f32_16x16x32_bf16 v[120:123], v[32:35], v[20:23], v[120:123]
  ds_read_b64_tr_b16 v[32:33], v12 offset:51224
  ds_read_b64_tr_b16 v[34:35], v12 offset:51864
  s_waitcnt lgkmcnt(6)
  v_mfma_f32_16x16x32_bf16 v[84:87], v[36:39], v[16:19], v[84:87]
  v_mfma_f32_16x16x32_bf16 v[124:127], v[36:39], v[20:23], v[124:127]
  s_add_u32 s44, s30, s48
  s_add_u32 m0, s50, 18432
  buffer_load_dwordx4 v2, s[12:15], s44 offen lds
  ds_read_b64_tr_b16 v[36:37], v12 offset:51232
  ds_read_b64_tr_b16 v[38:39], v12 offset:51872
  s_waitcnt lgkmcnt(6)
  v_mfma_f32_16x16x32_bf16 v[88:91], v[40:43], v[16:19], v[88:91]
  v_mfma_f32_16x16x32_bf16 v[128:131], v[40:43], v[20:23], v[128:131]
  ds_read_b64_tr_b16 v[40:41], v12 offset:46080
  ds_read_b64_tr_b16 v[42:43], v12 offset:46720
  s_waitcnt lgkmcnt(6)
  v_mfma_f32_16x16x32_bf16 v[92:95], v[44:47], v[16:19], v[92:95]
  v_mfma_f32_16x16x32_bf16 v[132:135], v[44:47], v[20:23], v[132:135]
  s_add_u32 s44, s30, s49
  s_add_u32 m0, s50, 19456
  buffer_load_dwordx4 v3, s[12:15], s44 offen lds
  ds_read_b64_tr_b16 v[44:45], v12 offset:46088
  ds_read_b64_tr_b16 v[46:47], v12 offset:46728
  s_waitcnt lgkmcnt(6)
  v_mfma_f32_16x16x32_bf16 v[96:99], v[32:35], v[16:19], v[96:99]
  v_mfma_f32_16x16x32_bf16 v[136:139], v[32:35], v[20:23], v[136:139]
  ds_read_b64_tr_b16 v[32:33], v12 offset:46096
  ds_read_b64_tr_b16 v[34:35], v12 offset:46736
  s_waitcnt lgkmcnt(6)
  v_mfma_f32_16x16x32_bf16 v[100:103], v[36:39], v[16:19], v[100:103]
  v_mfma_f32_16x16x32_bf16 v[140:143], v[36:39], v[20:23], v[140:143]
  s_add_u32 m0, s51, 69632
  buffer_load_dwordx4 v4, s[16:19], s31 offen sc1 lds
  ds_read_b64_tr_b16 v[36:37], v12 offset:46104
  ds_read_b64_tr_b16 v[38:39], v12 offset:46744
  s_waitcnt lgkmcnt(6)
  v_mfma_f32_16x16x32_bf16 v[64:67], v[40:43], v[24:27], v[64:67]
  v_mfma_f32_16x16x32_bf16 v[104:107], v[40:43], v[28:31], v[104:107]
  ds_read_b64_tr_b16 v[40:41], v12 offset:46112
  ds_read_b64_tr_b16 v[42:43], v12 offset:46752
  s_waitcnt lgkmcnt(6)
  v_mfma_f32_16x16x32_bf16 v[68:71], v[44:47], v[24:27], v[68:71]
  v_mfma_f32_16x16x32_bf16 v[108:111], v[44:47], v[28:31], v[108:111]
  s_add_u32 m0, s51, 70656
  buffer_load_dwordx4 v5, s[16:19], s31 offen sc1 lds
  ds_read_b64_tr_b16 v[44:45], v12 offset:56320
  ds_read_b64_tr_b16 v[46:47], v12 offset:56960
  s_waitcnt lgkmcnt(6)
  v_mfma_f32_16x16x32_bf16 v[72:75], v[32:35], v[24:27], v[72:75]
  v_mfma_f32_16x16x32_bf16 v[112:115], v[32:35], v[28:31], v[112:115]
  ds_read_b64_tr_b16 v[32:33], v12 offset:56328
  ds_read_b64_tr_b16 v[34:35], v12 offset:56968
  s_waitcnt lgkmcnt(6)
  v_mfma_f32_16x16x32_bf16 v[76:79], v[36:39], v[24:27], v[76:79]
  v_mfma_f32_16x16x32_bf16 v[116:119], v[36:39], v[28:31], v[116:119]
  s_add_u32 m0, s51, 71680
  buffer_load_dwordx4 v6, s[16:19], s31 offen sc1 lds
  ds_read_b64_tr_b16 v[36:37], v12 offset:56336
  ds_read_b64_tr_b16 v[38:39], v12 offset:56976
  s_waitcnt lgkmcnt(6)
  v_mfma_f32_16x16x32_bf16 v[80:83], v[40:43], v[24:27], v[80:83]
  v_mfma_f32_16x16x32_bf16 v[120:123], v[40:43], v[28:31], v[120:123]
  ds_read_b64_tr_b16 v[40:41], v12 offset:56344
  ds_read_b64_tr_b16 v[42:43], v12 offset:56984
  s_waitcnt lgkmcnt(6)
  v_mfma_f32_16x16x32_bf16 v[84:87], v[44:47], v[24:27], v[84:87]
  v_mfma_f32_16x16x32_bf16 v[124:127], v[44:47], v[28:31], v[124:127]
  s_add_u32 m0, s51, 72704
  buffer_load_dwordx4 v7, s[16:19], s31 offen sc1 lds
  ds_read_b64_tr_b16 v[44:45], v12 offset:56352
  ds_read_b64_tr_b16 v[46:47], v12 offset:56992
  s_waitcnt lgkmcnt(6)
  v_mfma_f32_16x16x32_bf16 v[88:91], v[32:35], v[24:27], v[88:91]
  v_mfma_f32_16x16x32_bf16 v[128:131], v[32:35], v[28:31], v[128:131]
  s_waitcnt lgkmcnt(4)
  v_mfma_f32_16x16x32_bf16 v[92:95], v[36:39], v[24:27], v[92:95]
  v_mfma_f32_16x16x32_bf16 v[132:135], v[36:39], v[28:31], v[132:135]
  s_add_u32 m0, s51, 73728
  buffer_load_dwordx4 v8, s[16:19], s31 offen sc1 lds
  s_waitcnt lgkmcnt(2)
  v_mfma_f32_16x16x32_bf16 v[96:99], v[40:43], v[24:27], v[96:99]
  v_mfma_f32_16x16x32_bf16 v[136:139], v[40:43], v[28:31], v[136:139]
  s_waitcnt lgkmcnt(0)
  v_mfma_f32_16x16x32_bf16 v[100:103], v[44:47], v[24:27], v[100:103]
  v_mfma_f32_16x16x32_bf16 v[140:143], v[44:47], v[28:31], v[140:143]
  s_add_u32 s30, s30, 128
  s_add_u32 s31, s31, s61
  s_waitcnt vmcnt(9)
  s_barrier
  ds_read_b128 v[16:19], v10 offset:0
  ds_read_b128 v[20:23], v10 offset:2048
  ds_read_b128 v[24:27], v11 offset:0
  ds_read_b128 v[28:31], v11 offset:2048
  ds_read_b64_tr_b16 v[32:33], v12 offset:0
  ds_read_b64_tr_b16 v[34:35], v12 offset:640
  ds_read_b64_tr_b16 v[36:37], v12 offset:8
  ds_read_b64_tr_b16 v[38:39], v12 offset:648
  ds_read_b64_tr_b16 v[40:41], v12 offset:16
  ds_read_b64_tr_b16 v[42:43], v12 offset:656
  ds_read_b64_tr_b16 v[44:45], v12 offset:24
  ds_read_b64_tr_b16 v[46:47], v12 offset:664
  s_waitcnt lgkmcnt(10)
  s_waitcnt lgkmcnt(6)
  v_mfma_f32_16x16x32_bf16 v[64:67], v[32:35], v[16:19], v[64:67]
  v_mfma_f32_16x16x32_bf16 v[104:107], v[32:35], v[20:23], v[104:107]
  ds_read_b64_tr_b16 v[32:33], v12 offset:32
  ds_read_b64_tr_b16 v[34:35], v12 offset:672
  s_waitcnt lgkmcnt(6)
  v_mfma_f32_16x16x32_bf16 v[68:71], v[36:39], v[16:19], v[68:71]
  v_mfma_f32_16x16x32_bf16 v[108:111], v[36:39], v[20:23], v[108:111]
  s_add_u32 s44, s30, s46
  s_add_u32 m0, s50, 32768
  buffer_load_dwordx4 v2, s[12:15], s44 offen lds
  ds_read_b64_tr_b16 v[36:37], v12 offset:10240
  ds_read_b64_tr_b16 v[38:39], v12 offset:10880
  s_waitcnt lgkmcnt(6)
  v_mfma_f32_16x16x32_bf16 v[72:75], v[40:43], v[16:19], v[72:75]
  v_mfma_f32_16x16x32_bf16 v[112:115], v[40:43], v[20:23], v[112:115]
  ds_read_b64_tr_b16 v[40:41], v12 offset:10248
  ds_read_b64_tr_b16 v[42:43], v12 offset:10888
  s_waitcnt lgkmcnt(6)
  v_mfma_f32_16x16x32_bf16 v[76:79], v[44:47], v[16:19], v[76:79]
  v_mfma_f32_16x16x32_bf16 v[116:119], v[44:47], v[20:23], v[116:119]
  s_add_u32 s44, s30, s47
  s_add_u32 m0, s50, 33792
  buffer_load_dwordx4 v3, s[12:15], s44 offen lds
  ds_read_b64_tr_b16 v[44:45], v12 offset:10256
  ds_read_b64_tr_b16 v[46:47], v12 offset:10896
  s_waitcnt lgkmcnt(6)
  v_mfma_f32_16x16x32_bf16 v[80:83], v[32:35], v[16:19], v[80:83]
  v_mfma_f32_16x16x32_bf16 v[120:123], v[32:35], v[20:23], v[120:123]
  ds_read_b64_tr_b16 v[32:33], v12 offset:10264
  ds_read_b64_tr_b16 v[34:35], v12 offset:10904
  s_waitcnt lgkmcnt(6)
  v_mfma_f32_16x16x32_bf16 v[84:87], v[36:39], v[16:19], v[84:87]
  v_mfma_f32_16x16x32_bf16 v[124:127], v[36:39], v[20:23], v[124:127]
  s_add_u32 s44, s30, s48
  s_add_u32 m0, s50, 34816
  buffer_load_dwordx4 v2, s[12:15], s44 offen lds
  ds_read_b64_tr_b16 v[36:37], v12 offset:10272
  ds_read_b64_tr_b16 v[38:39], v12 offset:10912
  s_waitcnt lgkmcnt(6)
  v_mfma_f32_16x16x32_bf16 v[88:91], v[40:43], v[16:19], v[88:91]
  v_mfma_f32_16x16x32_bf16 v[128:131], v[40:43], v[20:23], v[128:131]
  ds_read_b64_tr_b16 v[40:41], v12 offset:5120
  ds_read_b64_tr_b16 v[42:43], v12 offset:5760
  s_waitcnt lgkmcnt(6)
  v_mfma_f32_16x16x32_bf16 v[92:95], v[44:47], v[16:19], v[92:95]
  v_mfma_f32_16x16x32_bf16 v[132:135], v[44:47], v[20:23], v[132:135]
  s_add_u32 s44, s30, s49
  s_add_u32 m0, s50, 35840
  buffer_load_dwordx4 v3, s[12:15], s44 offen lds
  ds_read_b64_tr_b16 v[44:45], v12 offset:5128
  ds_read_b64_tr_b16 v[46:47], v12 offset:5768
  s_waitcnt lgkmcnt(6)
  v_mfma_f32_16x16x32_bf16 v[96:99], v[32:35], v[16:19], v[96:99]
  v_mfma_f32_16x16x32_bf16 v[136:139], v[32:35], v[20:23], v[136:139]
  ds_read_b64_tr_b16 v[32:33], v12 offset:5136
  ds_read_b64_tr_b16 v[34:35], v12 offset:5776
  s_waitcnt lgkmcnt(6)
  v_mfma_f32_16x16x32_bf16 v[100:103], v[36:39], v[16:19], v[100:103]
  v_mfma_f32_16x16x32_bf16 v[140:143], v[36:39], v[20:23], v[140:143]
  s_add_u32 m0, s51, 90112
  buffer_load_dwordx4 v4, s[16:19], s31 offen sc1 lds
  ds_read_b64_tr_b16 v[36:37], v12 offset:5144
  ds_read_b64_tr_b16 v[38:39], v12 offset:5784
  s_waitcnt lgkmcnt(6)
  v_mfma_f32_16x16x32_bf16 v[64:67], v[40:43], v[24:27], v[64:67]
  v_mfma_f32_16x16x32_bf16 v[104:107], v[40:43], v[28:31], v[104:107]
  ds_read_b64_tr_b16 v[40:41], v12 offset:5152
  ds_read_b64_tr_b16 v[42:43], v12 offset:5792
  s_waitcnt lgkmcnt(6)
  v_mfma_f32_16x16x32_bf16 v[68:71], v[44:47], v[24:27], v[68:71]
  v_mfma_f32_16x16x32_bf16 v[108:111], v[44:47], v[28:31], v[108:111]
  s_add_u32 m0, s51, 91136
  buffer_load_dwordx4 v5, s[16:19], s31 offen sc1 lds
  ds_read_b64_tr_b16 v[44:45], v12 offset:15360
  ds_read_b64_tr_b16 v[46:47], v12 offset:16000
  s_waitcnt lgkmcnt(6)
  v_mfma_f32_16x16x32_bf16 v[72:75], v[32:35], v[24:27], v[72:75]
  v_mfma_f32_16x16x32_bf16 v[112:115], v[32:35], v[28:31], v[112:115]
  ds_read_b64_tr_b16 v[32:33], v12 offset:15368
  ds_read_b64_tr_b16 v[34:35], v12 offset:16008
  s_waitcnt lgkmcnt(6)
  v_mfma_f32_16x16x32_bf16 v[76:79], v[36:39], v[24:27], v[76:79]
  v_mfma_f32_16x16x32_bf16 v[116:119], v[36:39], v[28:31], v[116:119]
  s_add_u32 m0, s51, 92160
  buffer_load_dwordx4 v6, s[16:19], s31 offen sc1 lds
  ds_read_b64_tr_b16 v[36:37], v12 offset:15376
  ds_read_b64_tr_b16 v[38:39], v12 offset:16016
  s_waitcnt lgkmcnt(6)
  v_mfma_f32_16x16x32_bf16 v[80:83], v[40:43], v[24:27], v[80:83]
  v_mfma_f32_16x16x32_bf16 v[120:123], v[40:43], v[28:31], v[120:123]
  ds_read_b64_tr_b16 v[40:41], v12 offset:15384
  ds_read_b64_tr_b16 v[42:43], v12 offset:16024
  s_waitcnt lgkmcnt(6)
  v_mfma_f32_16x16x32_bf16 v[84:87], v[44:47], v[24:27], v[84:87]
  v_mfma_f32_16x16x32_bf16 v[124:127], v[44:47], v[28:31], v[124:127]
  s_add_u32 m0, s51, 93184
  buffer_load_dwordx4 v7, s[16:19], s31 offen sc1 lds
  ds_read_b64_tr_b16 v[44:45], v12 offset:15392
  ds_read_b64_tr_b16 v[46:47], v12 offset:16032
  s_waitcnt lgkmcnt(6)
  v_mfma_f32_16x16x32_bf16 v[88:91], v[32:35], v[24:27], v[88:91]
  v_mfma_f32_16x16x32_bf16 v[128:131], v[32:35], v[28:31], v[128:131]
  s_waitcnt lgkmcnt(4)
  v_mfma_f32_16x16x32_bf16 v[92:95], v[36:39], v[24:27], v[92:95]
  v_mfma_f32_16x16x32_bf16 v[132:135], v[36:39], v[28:31], v[132:135]
  s_add_u32 m0, s51, 94208
  buffer_load_dwordx4 v8, s[16:19], s31 offen sc1 lds
  s_waitcnt lgkmcnt(2)
  v_mfma_f32_16x16x32_bf16 v[96:99], v[40:43], v[24:27], v[96:99]
  v_mfma_f32_16x16x32_bf16 v[136:139], v[40:43], v[28:31], v[136:139]
  s_waitcnt lgkmcnt(0)
  v_mfma_f32_16x16x32_bf16 v[100:103], v[44:47], v[24:27], v[100:103]
  v_mfma_f32_16x16x32_bf16 v[140:143], v[44:47], v[28:31], v[140:143]
  s_add_u32 s30, s30, 128
  s_add_u32 s31, s31, s61
  s_waitcnt vmcnt(9)
  s_barrier
  ds_read_b128 v[16:19], v10 offset:16384
  ds_read_b128 v[20:23], v10 offset:18432
  ds_read_b128 v[24:27], v11 offset:16384
  ds_read_b128 v[28:31], v11 offset:18432
  ds_read_b64_tr_b16 v[32:33], v12 offset:20480
  ds_read_b64_tr_b16 v[34:35], v12 offset:21120
  ds_read_b64_tr_b16 v[36:37], v12 offset:20488
  ds_read_b64_tr_b16 v[38:39], v12 offset:21128
  ds_read_b64_tr_b16 v[40:41], v12 offset:20496
  ds_read_b64_tr_b16 v[42:43], v12 offset:21136
  ds_read_b64_tr_b16 v[44:45], v12 offset:20504
  ds_read_b64_tr_b16 v[46:47], v12 offset:21144
  s_waitcnt lgkmcnt(10)
  s_waitcnt lgkmcnt(6)
  v_mfma_f32_16x16x32_bf16 v[64:67], v[32:35], v[16:19], v[64:67]
  v_mfma_f32_16x16x32_bf16 v[104:107], v[32:35], v[20:23], v[104:107]
  ds_read_b64_tr_b16 v[32:33], v12 offset:20512
  ds_read_b64_tr_b16 v[34:35], v12 offset:21152
  s_waitcnt lgkmcnt(6)
  v_mfma_f32_16x16x32_bf16 v[68:71], v[36:39], v[16:19], v[68:71]
  v_mfma_f32_16x16x32_bf16 v[108:111], v[36:39], v[20:23], v[108:111]
  s_add_u32 s44, s30, s46
  s_add_u32 m0, s50, 0
  buffer_load_dwordx4 v2, s[12:15], s44 offen lds
  ds_read_b64_tr_b16 v[36:37], v12 offset:30720
  ds_read_b64_tr_b16 v[38:39], v12 offset:31360
  s_waitcnt lgkmcnt(6)
  v_mfma_f32_16x16x32_bf16 v[72:75], v[40:43], v[16:19], v[72:75]
  v_mfma_f32_16x16x32_bf16 v[112:115], v[40:43], v[20:23], v[112:115]
  ds_read_b64_tr_b16 v[40:41], v12 offset:30728
  ds_read_b64_tr_b16 v[42:43], v12 offset:31368
  s_waitcnt lgkmcnt(6)
  v_mfma_f32_16x16x32_bf16 v[76:79], v[44:47], v[16:19], v[76:79]
  v_mfma_f32_16x16x32_bf16 v[116:119], v[44:47], v[20:23], v[116:119]
  s_add_u32 s44, s30, s47
  s_add_u32 m0, s50, 1024
  buffer_load_dwordx4 v3, s[12:15], s44 offen lds
  ds_read_b64_tr_b16 v[44:45], v12 offset:30736
  ds_read_b64_tr_b16 v[46:47], v12 offset:31376
  s_waitcnt lgkmcnt(6)
  v_mfma_f32_16x16x32_bf16 v[80:83], v[32:35], v[16:19], v[80:83]
  v_mfma_f32_16x16x32_bf16 v[120:123], v[32:35], v[20:23], v[120:123]
  ds_read_b64_tr_b16 v[32:33], v12 offset:30744
  ds_read_b64_tr_b16 v[34:35], v12 offset:31384
  s_waitcnt lgkmcnt(6)
  v_mfma_f32_16x16x32_bf16 v[84:87], v[36:39], v[16:19], v[84:87]
  v_mfma_f32_16x16x32_bf16 v[124:127], v[36:39], v[20:23], v[124:127]
  s_add_u32 s44, s30, s48
  s_add_u32 m0, s50, 2048
  buffer_load_dwordx4 v2, s[12:15], s44 offen lds
  ds_read_b64_tr_b16 v[36:37], v12 offset:30752
  ds_read_b64_tr_b16 v[38:39], v12 offset:31392
  s_waitcnt lgkmcnt(6)
  v_mfma_f32_16x16x32_bf16 v[88:91], v[40:43], v[16:19], v[88:91]
  v_mfma_f32_16x16x32_bf16 v[128:131], v[40:43], v[20:23], v[128:131]
  ds_read_b64_tr_b16 v[40:41], v12 offset:25600
  ds_read_b64_tr_b16 v[42:43], v12 offset:26240
  s_waitcnt lgkmcnt(6)
  v_mfma_f32_16x16x32_bf16 v[92:95], v[44:47], v[16:19], v[92:95]
  v_mfma_f32_16x16x32_bf16 v[132:135], v[44:47], v[20:23], v[132:135]
  s_add_u32 s44, s30, s49
  s_add_u32 m0, s50, 3072
  buffer_load_dwordx4 v3, s[12:15], s44 offen lds
  ds_read_b64_tr_b16 v[44:45], v12 offset:25608
  ds_read_b64_tr_b16 v[46:47], v12 offset:26248
  s_waitcnt lgkmcnt(6)
  v_mfma_f32_16x16x32_bf16 v[96:99], v[32:35], v[16:19], v[96:99]
  v_mfma_f32_16x16x32_bf16 v[136:139], v[32:35], v[20:23], v[136:139]
  ds_read_b64_tr_b16 v[32:33], v12 offset:25616
  ds_read_b64_tr_b16 v[34:35], v12 offset:26256
  s_waitcnt lgkmcnt(6)
  v_mfma_f32_16x16x32_bf16 v[100:103], v[36:39], v[16:19], v[100:103]
  v_mfma_f32_16x16x32_bf16 v[140:143], v[36:39], v[20:23], v[140:143]
  s_add_u32 m0, s51, 49152
  buffer_load_dwordx4 v4, s[16:19], s31 offen sc1 lds
  ds_read_b64_tr_b16 v[36:37], v12 offset:25624
  ds_read_b64_tr_b16 v[38:39], v12 offset:26264
  s_waitcnt lgkmcnt(6)
  v_mfma_f32_16x16x32_bf16 v[64:67], v[40:43], v[24:27], v[64:67]
  v_mfma_f32_16x16x32_bf16 v[104:107], v[40:43], v[28:31], v[104:107]
  ds_read_b64_tr_b16 v[40:41], v12 offset:25632
  ds_read_b64_tr_b16 v[42:43], v12 offset:26272
  s_waitcnt lgkmcnt(6)
  v_mfma_f32_16x16x32_bf16 v[68:71], v[44:47], v[24:27], v[68:71]
  v_mfma_f32_16x16x32_bf16 v[108:111], v[44:47], v[28:31], v[108:111]
  s_add_u32 m0, s51, 50176
  buffer_load_dwordx4 v5, s[16:19], s31 offen sc1 lds
  ds_read_b64_tr_b16 v[44:45], v12 offset:35840
  ds_read_b64_tr_b16 v[46:47], v12 offset:36480
  s_waitcnt lgkmcnt(6)
  v_mfma_f32_16x16x32_bf16 v[72:75], v[32:35], v[24:27], v[72:75]
  v_mfma_f32_16x16x32_bf16 v[112:115], v[32:35], v[28:31], v[112:115]
  ds_read_b64_tr_b16 v[32:33], v12 offset:35848
  ds_read_b64_tr_b16 v[34:35], v12 offset:36488
  s_waitcnt lgkmcnt(6)
  v_mfma_f32_16x16x32_bf16 v[76:79], v[36:39], v[24:27], v[76:79]
  v_mfma_f32_16x16x32_bf16 v[116:119], v[36:39], v[28:31], v[116:119]
  s_add_u32 m0, s51, 51200
  buffer_load_dwordx4 v6, s[16:19], s31 offen sc1 lds
  ds_read_b64_tr_b16 v[36:37], v12 offset:35856
  ds_read_b64_tr_b16 v[38:39], v12 offset:36496
  s_waitcnt lgkmcnt(6)
  v_mfma_f32_16x16x32_bf16 v[80:83], v[40:43], v[24:27], v[80:83]
  v_mfma_f32_16x16x32_bf16 v[120:123], v[40:43], v[28:31], v[120:123]
  ds_read_b64_tr_b16 v[40:41], v12 offset:35864
  ds_read_b64_tr_b16 v[42:43], v12 offset:36504
  s_waitcnt lgkmcnt(6)
  v_mfma_f32_16x16x32_bf16 v[84:87], v[44:47], v[24:27], v[84:87]
  v_mfma_f32_16x16x32_bf16 v[124:127], v[44:47], v[28:31], v[124:127]
  s_add_u32 m0, s51, 52224
  buffer_load_dwordx4 v7, s[16:19], s31 offen sc1 lds
  ds_read_b64_tr_b16 v[44:45], v12 offset:35872
  ds_read_b64_tr_b16 v[46:47], v12 offset:36512
  s_waitcnt lgkmcnt(6)
  v_mfma_f32_16x16x32_bf16 v[88:91], v[32:35], v[24:27], v[88:91]
  v_mfma_f32_16x16x32_bf16 v[128:131], v[32:35], v[28:31], v[128:131]
  s_waitcnt lgkmcnt(4)
  v_mfma_f32_16x16x32_bf16 v[92:95], v[36:39], v[24:27], v[92:95]
  v_mfma_f32_16x16x32_bf16 v[132:135], v[36:39], v[28:31], v[132:135]
  s_add_u32 m0, s51, 53248
  buffer_load_dwordx4 v8, s[16:19], s31 offen sc1 lds
  s_waitcnt lgkmcnt(2)
  v_mfma_f32_16x16x32_bf16 v[96:99], v[40:43], v[24:27], v[96:99]
  v_mfma_f32_16x16x32_bf16 v[136:139], v[40:43], v[28:31], v[136:139]
  s_waitcnt lgkmcnt(0)
  v_mfma_f32_16x16x32_bf16 v[100:103], v[44:47], v[24:27], v[100:103]
  v_mfma_f32_16x16x32_bf16 v[140:143], v[44:47], v[28:31], v[140:143]
  s_add_u32 s30, s30, 128
  s_add_u32 s31, s31, s61
  s_waitcnt vmcnt(9)
  s_barrier
  ds_read_b128 v[16:19], v10 offset:32768
  ds_read_b128 v[20:23], v10 offset:34816
  ds_read_b128 v[24:27], v11 offset:32768
  ds_read_b128 v[28:31], v11 offset:34816
  ds_read_b64_tr_b16 v[32:33], v12 offset:40960
  ds_read_b64_tr_b16 v[34:35], v12 offset:41600
  ds_read_b64_tr_b16 v[36:37], v12 offset:40968
  ds_read_b64_tr_b16 v[38:39], v12 offset:41608
  ds_read_b64_tr_b16 v[40:41], v12 offset:40976
  ds_read_b64_tr_b16 v[42:43], v12 offset:41616
  ds_read_b64_tr_b16 v[44:45], v12 offset:40984
  ds_read_b64_tr_b16 v[46:47], v12 offset:41624
  s_waitcnt lgkmcnt(10)
  s_waitcnt lgkmcnt(6)
  v_mfma_f32_16x16x32_bf16 v[64:67], v[32:35], v[16:19], v[64:67]
  v_mfma_f32_16x16x32_bf16 v[104:107], v[32:35], v[20:23], v[104:107]
  ds_read_b64_tr_b16 v[32:33], v12 offset:40992
  ds_read_b64_tr_b16 v[34:35], v12 offset:41632
  s_waitcnt lgkmcnt(6)
  v_mfma_f32_16x16x32_bf16 v[68:71], v[36:39], v[16:19], v[68:71]
  v_mfma_f32_16x16x32_bf16 v[108:111], v[36:39], v[20:23], v[108:111]
  ds_read_b64_tr_b16 v[36:37], v12 offset:51200
  ds_read_b64_tr_b16 v[38:39], v12 offset:51840
  s_waitcnt lgkmcnt(6)
  v_mfma_f32_16x16x32_bf16 v[72:75], v[40:43], v[16:19], v[72:75]
  v_mfma_f32_16x16x32_bf16 v[112:115], v[40:43], v[20:23], v[112:115]
  ds_read_b64_tr_b16 v[40:41], v12 offset:51208
  ds_read_b64_tr_b16 v[42:43], v12 offset:51848
  s_waitcnt lgkmcnt(6)
  v_mfma_f32_16x16x32_bf16 v[76:79], v[44:47], v[16:19], v[76:79]
  v_mfma_f32_16x16x32_bf16 v[116:119], v[44:47], v[20:23], v[116:119]
  ds_read_b64_tr_b16 v[44:45], v12 offset:51216
  ds_read_b64_tr_b16 v[46:47], v12 offset:51856
  s_waitcnt lgkmcnt(6)
  v_mfma_f32_16x16x32_bf16 v[80:83], v[32:35], v[16:19], v[80:83]
  v_mfma_f32_16x16x32_bf16 v[120:123], v[32:35], v[20:23], v[120:123]
  ds_read_b64_tr_b16 v[32:33], v12 offset:51224
  ds_read_b64_tr_b16 v[34:35], v12 offset:51864
  s_waitcnt lgkmcnt(6)
  v_mfma_f32_16x16x32_bf16 v[84:87], v[36:39], v[16:19], v[84:87]
  v_mfma_f32_16x16x32_bf16 v[124:127], v[36:39], v[20:23], v[124:127]
  ds_read_b64_tr_b16 v[36:37], v12 offset:51232
  ds_read_b64_tr_b16 v[38:39], v12 offset:51872
  s_waitcnt lgkmcnt(6)
  v_mfma_f32_16x16x32_bf16 v[88:91], v[40:43], v[16:19], v[88:91]
  v_mfma_f32_16x16x32_bf16 v[128:131], v[40:43], v[20:23], v[128:131]
  ds_read_b64_tr_b16 v[40:41], v12 offset:46080
  ds_read_b64_tr_b16 v[42:43], v12 offset:46720
  s_waitcnt lgkmcnt(6)
  v_mfma_f32_16x16x32_bf16 v[92:95], v[44:47], v[16:19], v[92:95]
  v_mfma_f32_16x16x32_bf16 v[132:135], v[44:47], v[20:23], v[132:135]
  ds_read_b64_tr_b16 v[44:45], v12 offset:46088
  ds_read_b64_tr_b16 v[46:47], v12 offset:46728
  s_waitcnt lgkmcnt(6)
  v_mfma_f32_16x16x32_bf16 v[96:99], v[32:35], v[16:19], v[96:99]
  v_mfma_f32_16x16x32_bf16 v[136:139], v[32:35], v[20:23], v[136:139]
  ds_read_b64_tr_b16 v[32:33], v12 offset:46096
  ds_read_b64_tr_b16 v[34:35], v12 offset:46736
  s_waitcnt lgkmcnt(6)
  v_mfma_f32_16x16x32_bf16 v[100:103], v[36:39], v[16:19], v[100:103]
  v_mfma_f32_16x16x32_bf16 v[140:143], v[36:39], v[20:23], v[140:143]
  ds_read_b64_tr_b16 v[36:37], v12 offset:46104
  ds_read_b64_tr_b16 v[38:39], v12 offset:46744
  s_waitcnt lgkmcnt(6)
  v_mfma_f32_16x16x32_bf16 v[64:67], v[40:43], v[24:27], v[64:67]
  v_mfma_f32_16x16x32_bf16 v[104:107], v[40:43], v[28:31], v[104:107]
  ds_read_b64_tr_b16 v[40:41], v12 offset:46112
  ds_read_b64_tr_b16 v[42:43], v12 offset:46752
  s_waitcnt lgkmcnt(6)
  v_mfma_f32_16x16x32_bf16 v[68:71], v[44:47], v[24:27], v[68:71]
  v_mfma_f32_16x16x32_bf16 v[108:111], v[44:47], v[28:31], v[108:111]
  ds_read_b64_tr_b16 v[44:45], v12 offset:56320
  ds_read_b64_tr_b16 v[46:47], v12 offset:56960
  s_waitcnt lgkmcnt(6)
  v_mfma_f32_16x16x32_bf16 v[72:75], v[32:35], v[24:27], v[72:75]
  v_mfma_f32_16x16x32_bf16 v[112:115], v[32:35], v[28:31], v[112:115]
  ds_read_b64_tr_b16 v[32:33], v12 offset:56328
  ds_read_b64_tr_b16 v[34:35], v12 offset:56968
  s_waitcnt lgkmcnt(6)
  v_mfma_f32_16x16x32_bf16 v[76:79], v[36:39], v[24:27], v[76:79]
  v_mfma_f32_16x16x32_bf16 v[116:119], v[36:39], v[28:31], v[116:119]
  ds_read_b64_tr_b16 v[36:37], v12 offset:56336
  ds_read_b64_tr_b16 v[38:39], v12 offset:56976
  s_waitcnt lgkmcnt(6)
  v_mfma_f32_16x16x32_bf16 v[80:83], v[40:43], v[24:27], v[80:83]
  v_mfma_f32_16x16x32_bf16 v[120:123], v[40:43], v[28:31], v[120:123]
  ds_read_b64_tr_b16 v[40:41], v12 offset:56344
  ds_read_b64_tr_b16 v[42:43], v12 offset:56984
  s_waitcnt lgkmcnt(6)
  v_mfma_f32_16x16x32_bf16 v[84:87], v[44:47], v[24:27], v[84:87]
  v_mfma_f32_16x16x32_bf16 v[124:127], v[44:47], v[28:31], v[124:127]
  ds_read_b64_tr_b16 v[44:45], v12 offset:56352
  ds_read_b64_tr_b16 v[46:47], v12 offset:56992
  s_waitcnt lgkmcnt(6)
  v_mfma_f32_16x16x32_bf16 v[88:91], v[32:35], v[24:27], v[88:91]
  v_mfma_f32_16x16x32_bf16 v[128:131], v[32:35], v[28:31], v[128:131]
  s_waitcnt lgkmcnt(4)
  v_mfma_f32_16x16x32_bf16 v[92:95], v[36:39], v[24:27], v[92:95]
  v_mfma_f32_16x16x32_bf16 v[132:135], v[36:39], v[28:31], v[132:135]
  s_waitcnt lgkmcnt(2)
  v_mfma_f32_16x16x32_bf16 v[96:99], v[40:43], v[24:27], v[96:99]
  v_mfma_f32_16x16x32_bf16 v[136:139], v[40:43], v[28:31], v[136:139]
  s_waitcnt lgkmcnt(0)
  v_mfma_f32_16x16x32_bf16 v[100:103], v[44:47], v[24:27], v[100:103]
  v_mfma_f32_16x16x32_bf16 v[140:143], v[44:47], v[28:31], v[140:143]
  s_waitcnt vmcnt(0)
  s_barrier
  ds_read_b128 v[16:19], v10 offset:0
  ds_read_b128 v[20:23], v10 offset:2048
  ds_read_b128 v[24:27], v11 offset:0
  ds_read_b128 v[28:31], v11 offset:2048
  ds_read_b64_tr_b16 v[32:33], v12 offset:0
  ds_read_b64_tr_b16 v[34:35], v12 offset:640
  ds_read_b64_tr_b16 v[36:37], v12 offset:8
  ds_read_b64_tr_b16 v[38:39], v12 offset:648
  ds_read_b64_tr_b16 v[40:41], v12 offset:16
  ds_read_b64_tr_b16 v[42:43], v12 offset:656
  ds_read_b64_tr_b16 v[44:45], v12 offset:24
  ds_read_b64_tr_b16 v[46:47], v12 offset:664
  s_waitcnt lgkmcnt(10)
  s_waitcnt lgkmcnt(6)
  v_mfma_f32_16x16x32_bf16 v[64:67], v[32:35], v[16:19], v[64:67]
  v_mfma_f32_16x16x32_bf16 v[104:107], v[32:35], v[20:23], v[104:107]
  ds_read_b64_tr_b16 v[32:33], v12 offset:32
  ds_read_b64_tr_b16 v[34:35], v12 offset:672
  s_waitcnt lgkmcnt(6)
  v_mfma_f32_16x16x32_bf16 v[68:71], v[36:39], v[16:19], v[68:71]
  v_mfma_f32_16x16x32_bf16 v[108:111], v[36:39], v[20:23], v[108:111]
  ds_read_b64_tr_b16 v[36:37], v12 offset:10240
  ds_read_b64_tr_b16 v[38:39], v12 offset:10880
  s_waitcnt lgkmcnt(6)
  v_mfma_f32_16x16x32_bf16 v[72:75], v[40:43], v[16:19], v[72:75]
  v_mfma_f32_16x16x32_bf16 v[112:115], v[40:43], v[20:23], v[112:115]
  ds_read_b64_tr_b16 v[40:41], v12 offset:10248
  ds_read_b64_tr_b16 v[42:43], v12 offset:10888
  s_waitcnt lgkmcnt(6)
  v_mfma_f32_16x16x32_bf16 v[76:79], v[44:47], v[16:19], v[76:79]
  v_mfma_f32_16x16x32_bf16 v[116:119], v[44:47], v[20:23], v[116:119]
  ds_read_b64_tr_b16 v[44:45], v12 offset:10256
  ds_read_b64_tr_b16 v[46:47], v12 offset:10896
  s_waitcnt lgkmcnt(6)
  v_mfma_f32_16x16x32_bf16 v[80:83], v[32:35], v[16:19], v[80:83]
  v_mfma_f32_16x16x32_bf16 v[120:123], v[32:35], v[20:23], v[120:123]
  ds_read_b64_tr_b16 v[32:33], v12 offset:10264
  ds_read_b64_tr_b16 v[34:35], v12 offset:10904
  s_waitcnt lgkmcnt(6)
  v_mfma_f32_16x16x32_bf16 v[84:87], v[36:39], v[16:19], v[84:87]
  v_mfma_f32_16x16x32_bf16 v[124:127], v[36:39], v[20:23], v[124:127]
  ds_read_b64_tr_b16 v[36:37], v12 offset:10272
  ds_read_b64_tr_b16 v[38:39], v12 offset:10912
  s_waitcnt lgkmcnt(6)
  v_mfma_f32_16x16x32_bf16 v[88:91], v[40:43], v[16:19], v[88:91]
  v_mfma_f32_16x16x32_bf16 v[128:131], v[40:43], v[20:23], v[128:131]
  ds_read_b64_tr_b16 v[40:41], v12 offset:5120
  ds_read_b64_tr_b16 v[42:43], v12 offset:5760
  s_waitcnt lgkmcnt(6)
  v_mfma_f32_16x16x32_bf16 v[92:95], v[44:47], v[16:19], v[92:95]
  v_mfma_f32_16x16x32_bf16 v[132:135], v[44:47], v[20:23], v[132:135]
  ds_read_b64_tr_b16 v[44:45], v12 offset:5128
  ds_read_b64_tr_b16 v[46:47], v12 offset:5768
  s_waitcnt lgkmcnt(6)
  v_mfma_f32_16x16x32_bf16 v[96:99], v[32:35], v[16:19], v[96:99]
  v_mfma_f32_16x16x32_bf16 v[136:139], v[32:35], v[20:23], v[136:139]
  ds_read_b64_tr_b16 v[32:33], v12 offset:5136
  ds_read_b64_tr_b16 v[34:35], v12 offset:5776
  s_waitcnt lgkmcnt(6)
  v_mfma_f32_16x16x32_bf16 v[100:103], v[36:39], v[16:19], v[100:103]
  v_mfma_f32_16x16x32_bf16 v[140:143], v[36:39], v[20:23], v[140:143]
  ds_read_b64_tr_b16 v[36:37], v12 offset:5144
  ds_read_b64_tr_b16 v[38:39], v12 offset:5784
  s_waitcnt lgkmcnt(6)
  v_mfma_f32_16x16x32_bf16 v[64:67], v[40:43], v[24:27], v[64:67]
  v_mfma_f32_16x16x32_bf16 v[104:107], v[40:43], v[28:31], v[104:107]
  ds_read_b64_tr_b16 v[40:41], v12 offset:5152
  ds_read_b64_tr_b16 v[42:43], v12 offset:5792
  s_waitcnt lgkmcnt(6)
  v_mfma_f32_16x16x32_bf16 v[68:71], v[44:47], v[24:27], v[68:71]
  v_mfma_f32_16x16x32_bf16 v[108:111], v[44:47], v[28:31], v[108:111]
  ds_read_b64_tr_b16 v[44:45], v12 offset:15360
  ds_read_b64_tr_b16 v[46:47], v12 offset:16000
  s_waitcnt lgkmcnt(6)
  v_mfma_f32_16x16x32_bf16 v[72:75], v[32:35], v[24:27], v[72:75]
  v_mfma_f32_16x16x32_bf16 v[112:115], v[32:35], v[28:31], v[112:115]
  ds_read_b64_tr_b16 v[32:33], v12 offset:15368
  ds_read_b64_tr_b16 v[34:35], v12 offset:16008
  s_waitcnt lgkmcnt(6)
  v_mfma_f32_16x16x32_bf16 v[76:79], v[36:39], v[24:27], v[76:79]
  v_mfma_f32_16x16x32_bf16 v[116:119], v[36:39], v[28:31], v[116:119]
  ds_read_b64_tr_b16 v[36:37], v12 offset:15376
  ds_read_b64_tr_b16 v[38:39], v12 offset:16016
  s_waitcnt lgkmcnt(6)
  v_mfma_f32_16x16x32_bf16 v[80:83], v[40:43], v[24:27], v[80:83]
  v_mfma_f32_16x16x32_bf16 v[120:123], v[40:43], v[28:31], v[120:123]
  ds_read_b64_tr_b16 v[40:41], v12 offset:15384
  ds_read_b64_tr_b16 v[42:43], v12 offset:16024
  s_waitcnt lgkmcnt(6)
  v_mfma_f32_16x16x32_bf16 v[84:87], v[44:47], v[24:27], v[84:87]
  v_mfma_f32_16x16x32_bf16 v[124:127], v[44:47], v[28:31], v[124:127]
  ds_read_b64_tr_b16 v[44:45], v12 offset:15392
  ds_read_b64_tr_b16 v[46:47], v12 offset:16032
  s_waitcnt lgkmcnt(6)
  v_mfma_f32_16x16x32_bf16 v[88:91], v[32:35], v[24:27], v[88:91]
  v_mfma_f32_16x16x32_bf16 v[128:131], v[32:35], v[28:31], v[128:131]
  s_waitcnt lgkmcnt(4)
  v_mfma_f32_16x16x32_bf16 v[92:95], v[36:39], v[24:27], v[92:95]
  v_mfma_f32_16x16x32_bf16 v[132:135], v[36:39], v[28:31], v[132:135]
  s_waitcnt lgkmcnt(2)
  v_mfma_f32_16x16x32_bf16 v[96:99], v[40:43], v[24:27], v[96:99]
  v_mfma_f32_16x16x32_bf16 v[136:139], v[40:43], v[28:31], v[136:139]
  s_waitcnt lgkmcnt(0)
  v_mfma_f32_16x16x32_bf16 v[100:103], v[44:47], v[24:27], v[100:103]
  v_mfma_f32_16x16x32_bf16 v[140:143], v[44:47], v[28:31], v[140:143]
  s_nop 7
  s_barrier
  v_and_b32 v14, 15, v0
  v_lshrrev_b32 v15, 4, v0
  s_lshl_b32 s26, s22, 5
  v_add_u32 v14, s26, v14
  v_mul_u32_u24 v16, 384, v14
  v_mul_u32_u24 v17, 96, v15
  v_add_u32 v2, v16, v17
  v_lshlrev_b32 v16, 8, v14
  v_lshl_add_u32 v3, v15, 6, v16
  v_mov_b32 v4, 0x3f80
  v_max3_f32 v5, v64, v65, v66
  v_max3_f32 v7, v67, v68, v69
  v_max3_f32 v5, v5, v70, v71
  v_max3_f32 v7, v7, v72, v73
  v_max3_f32 v5, v5, v74, v75
  v_max3_f32 v7, v7, v76, v77
  v_max3_f32 v5, v5, v78, v79
  v_max3_f32 v7, v7, v80, v81
  v_max3_f32 v5, v5, v82, v83
  v_max_f32 v5, v5, v7
  v_mul_f32 v5, s60, v5
  v_fma_f32 v20, v64, s60, -v5
  v_fma_f32 v21, v65, s60, -v5
  v_fma_f32 v22, v66, s60, -v5
  v_fma_f32 v23, v67, s60, -v5
  v_fma_f32 v24, v68, s60, -v5
  v_fma_f32 v25, v69, s60, -v5
  v_fma_f32 v26, v70, s60, -v5
  v_fma_f32 v27, v71, s60, -v5
  v_fma_f32 v28, v72, s60, -v5
  v_fma_f32 v29, v73, s60, -v5
  v_fma_f32 v30, v74, s60, -v5
  v_fma_f32 v31, v75, s60, -v5
  v_fma_f32 v32, v76, s60, -v5
  v_fma_f32 v33, v77, s60, -v5
  v_fma_f32 v34, v78, s60, -v5
  v_fma_f32 v35, v79, s60, -v5
  v_fma_f32 v36, v80, s60, -v5
  v_fma_f32 v37, v81, s60, -v5
  v_fma_f32 v38, v82, s60, -v5
  v_fma_f32 v39, v83, s60, -v5
  v_exp_f32 v20, v20
  v_exp_f32 v21, v21
  v_exp_f32 v22, v22
  v_exp_f32 v23, v23
  v_exp_f32 v24, v24
  v_exp_f32 v25, v25
  v_exp_f32 v26, v26
  v_exp_f32 v27, v27
  v_exp_f32 v28, v28
  v_exp_f32 v29, v29
  v_exp_f32 v30, v30
  v_exp_f32 v31, v31
  v_exp_f32 v32, v32
  v_exp_f32 v33, v33
  v_exp_f32 v34, v34
  v_exp_f32 v35, v35
  v_exp_f32 v36, v36
  v_exp_f32 v37, v37
  v_exp_f32 v38, v38
  v_exp_f32 v39, v39
  s_nop 0
  v_add_f32 v6, v20, v21
  v_add_f32 v7, v22, v23
  v_add_f32 v6, v6, v24
  v_add_f32 v7, v7, v25
  v_add_f32 v6, v6, v26
  v_add_f32 v7, v7, v27
  v_add_f32 v6, v6, v28
  v_add_f32 v7, v7, v29
  v_add_f32 v6, v6, v30
  v_add_f32 v7, v7, v31
  v_add_f32 v6, v6, v32
  v_add_f32 v7, v7, v33
  v_add_f32 v6, v6, v34
  v_add_f32 v7, v7, v35
  v_add_f32 v6, v6, v36
  v_add_f32 v7, v7, v37
  v_add_f32 v6, v6, v38
  v_add_f32 v7, v7, v39
  v_add_f32 v6, v6, v7
  v_rcp_f32 v6, v6
  s_nop 0
  v_mul_f32 v20, v20, v6
  v_mul_f32 v21, v21, v6
  v_mul_f32 v22, v22, v6
  v_mul_f32 v23, v23, v6
  v_mul_f32 v24, v24, v6
  v_mul_f32 v25, v25, v6
  v_mul_f32 v26, v26, v6
  v_mul_f32 v27, v27, v6
  v_mul_f32 v28, v28, v6
  v_mul_f32 v29, v29, v6
  v_mul_f32 v30, v30, v6
  v_mul_f32 v31, v31, v6
  v_mul_f32 v32, v32, v6
  v_mul_f32 v33, v33, v6
  v_mul_f32 v34, v34, v6
  v_mul_f32 v35, v35, v6
  v_mul_f32 v36, v36, v6
  v_mul_f32 v37, v37, v6
  v_mul_f32 v38, v38, v6
  v_mul_f32 v39, v39, v6
  v_cvt_pk_bf16_f32 v40, v20, v21
  v_cvt_pk_bf16_f32 v41, v22, v23
  v_cvt_pk_bf16_f32 v42, v24, v25
  v_cvt_pk_bf16_f32 v43, v26, v27
  v_cvt_pk_bf16_f32 v44, v28, v29
  v_cvt_pk_bf16_f32 v45, v30, v31
  v_cvt_pk_bf16_f32 v46, v32, v33
  v_cvt_pk_bf16_f32 v47, v34, v35
  v_cvt_pk_bf16_f32 v48, v36, v37
  v_cvt_pk_bf16_f32 v49, v38, v39
  ds_write_b64 v2, v[40:41] offset:0
  ds_write_b64 v2, v[42:43] offset:8
  ds_write_b64 v2, v[44:45] offset:16
  ds_write_b64 v2, v[46:47] offset:24
  ds_write_b64 v2, v[48:49] offset:32
  v_min3_f32 v5, v64, v65, v66
  v_min3_f32 v7, v67, v68, v69
  v_min3_f32 v5, v5, v70, v71
  v_min3_f32 v7, v7, v72, v73
  v_min3_f32 v5, v5, v74, v75
  v_min3_f32 v7, v7, v76, v77
  v_min3_f32 v5, v5, v78, v79
  v_min3_f32 v7, v7, v80, v81
  v_min3_f32 v5, v5, v82, v83
  v_min_f32 v5, v5, v7
  v_mul_f32 v5, s60, v5
  v_fma_f32 v20, -v64, s60, v5
  v_fma_f32 v21, -v65, s60, v5
  v_fma_f32 v22, -v66, s60, v5
  v_fma_f32 v23, -v67, s60, v5
  v_fma_f32 v24, -v68, s60, v5
  v_fma_f32 v25, -v69, s60, v5
  v_fma_f32 v26, -v70, s60, v5
  v_fma_f32 v27, -v71, s60, v5
  v_fma_f32 v28, -v72, s60, v5
  v_fma_f32 v29, -v73, s60, v5
  v_fma_f32 v30, -v74, s60, v5
  v_fma_f32 v31, -v75, s60, v5
  v_fma_f32 v32, -v76, s60, v5
  v_fma_f32 v33, -v77, s60, v5
  v_fma_f32 v34, -v78, s60, v5
  v_fma_f32 v35, -v79, s60, v5
  v_fma_f32 v36, -v80, s60, v5
  v_fma_f32 v37, -v81, s60, v5
  v_fma_f32 v38, -v82, s60, v5
  v_fma_f32 v39, -v83, s60, v5
  v_exp_f32 v20, v20
  v_exp_f32 v21, v21
  v_exp_f32 v22, v22
  v_exp_f32 v23, v23
  v_exp_f32 v24, v24
  v_exp_f32 v25, v25
  v_exp_f32 v26, v26
  v_exp_f32 v27, v27
  v_exp_f32 v28, v28
  v_exp_f32 v29, v29
  v_exp_f32 v30, v30
  v_exp_f32 v31, v31
  v_exp_f32 v32, v32
  v_exp_f32 v33, v33
  v_exp_f32 v34, v34
  v_exp_f32 v35, v35
  v_exp_f32 v36, v36
  v_exp_f32 v37, v37
  v_exp_f32 v38, v38
  v_exp_f32 v39, v39
  s_nop 0
  v_add_f32 v6, v20, v21
  v_add_f32 v7, v22, v23
  v_add_f32 v6, v6, v24
  v_add_f32 v7, v7, v25
  v_add_f32 v6, v6, v26
  v_add_f32 v7, v7, v27
  v_add_f32 v6, v6, v28
  v_add_f32 v7, v7, v29
  v_add_f32 v6, v6, v30
  v_add_f32 v7, v7, v31
  v_add_f32 v6, v6, v32
  v_add_f32 v7, v7, v33
  v_add_f32 v6, v6, v34
  v_add_f32 v7, v7, v35
  v_add_f32 v6, v6, v36
  v_add_f32 v7, v7, v37
  v_add_f32 v6, v6, v38
  v_add_f32 v7, v7, v39
  v_add_f32 v6, v6, v7
  v_rcp_f32 v6, v6
  s_nop 0
  v_mul_f32 v20, v20, v6
  v_mul_f32 v21, v21, v6
  v_mul_f32 v22, v22, v6
  v_mul_f32 v23, v23, v6
  v_mul_f32 v24, v24, v6
  v_mul_f32 v25, v25, v6
  v_mul_f32 v26, v26, v6
  v_mul_f32 v27, v27, v6
  v_mul_f32 v28, v28, v6
  v_mul_f32 v29, v29, v6
  v_mul_f32 v30, v30, v6
  v_mul_f32 v31, v31, v6
  v_mul_f32 v32, v32, v6
  v_mul_f32 v33, v33, v6
  v_mul_f32 v34, v34, v6
  v_mul_f32 v35, v35, v6
  v_mul_f32 v36, v36, v6
  v_mul_f32 v37, v37, v6
  v_mul_f32 v38, v38, v6
  v_mul_f32 v39, v39, v6
  v_cvt_pk_bf16_f32 v40, v20, v21
  v_cvt_pk_bf16_f32 v41, v22, v23
  v_cvt_pk_bf16_f32 v42, v24, v25
  v_cvt_pk_bf16_f32 v43, v26, v27
  v_cvt_pk_bf16_f32 v44, v28, v29
  v_cvt_pk_bf16_f32 v45, v30, v31
  v_cvt_pk_bf16_f32 v46, v32, v33
  v_cvt_pk_bf16_f32 v47, v34, v35
  v_cvt_pk_bf16_f32 v48, v36, v37
  v_cvt_pk_bf16_f32 v49, v38, v39
  ds_write_b64 v2, v[40:41] offset:40
  ds_write_b64 v2, v[42:43] offset:48
  ds_write_b64 v2, v[44:45] offset:56
  ds_write_b64 v2, v[46:47] offset:64
  ds_write_b64 v2, v[48:49] offset:72
  v_cvt_pk_bf16_f32 v50, v84, v85
  v_cvt_pk_bf16_f32 v51, v86, v87
  v_cvt_pk_bf16_f32 v52, v88, v89
  v_cvt_pk_bf16_f32 v53, v90, v91
  v_cvt_pk_bf16_f32 v54, v92, v93
  v_cvt_pk_bf16_f32 v55, v94, v95
  v_cvt_pk_bf16_f32 v56, v96, v97
  v_cvt_pk_bf16_f32 v57, v98, v99
  v_cvt_pk_bf16_f32 v58, v100, v101
  v_cvt_pk_bf16_f32 v59, v102, v103
  ds_write_b64 v3, v[50:51] offset:49152
  ds_write_b64 v3, v[52:53] offset:49160
  ds_write_b64 v3, v[54:55] offset:49168
  ds_write_b64 v3, v[56:57] offset:49176
  ds_write_b64 v3, v[58:59] offset:49184
  ds_write_b32 v3, v4 offset:49192
  v_max3_f32 v5, v104, v105, v106
  v_max3_f32 v7, v107, v108, v109
  v_max3_f32 v5, v5, v110, v111
  v_max3_f32 v7, v7, v112, v113
  v_max3_f32 v5, v5, v114, v115
  v_max3_f32 v7, v7, v116, v117
  v_max3_f32 v5, v5, v118, v119
  v_max3_f32 v7, v7, v120, v121
  v_max3_f32 v5, v5, v122, v123
  v_max_f32 v5, v5, v7
  v_mul_f32 v5, s60, v5
  v_fma_f32 v20, v104, s60, -v5
  v_fma_f32 v21, v105, s60, -v5
  v_fma_f32 v22, v106, s60, -v5
  v_fma_f32 v23, v107, s60, -v5
  v_fma_f32 v24, v108, s60, -v5
  v_fma_f32 v25, v109, s60, -v5
  v_fma_f32 v26, v110, s60, -v5
  v_fma_f32 v27, v111, s60, -v5
  v_fma_f32 v28, v112, s60, -v5
  v_fma_f32 v29, v113, s60, -v5
  v_fma_f32 v30, v114, s60, -v5
  v_fma_f32 v31, v115, s60, -v5
  v_fma_f32 v32, v116, s60, -v5
  v_fma_f32 v33, v117, s60, -v5
  v_fma_f32 v34, v118, s60, -v5
  v_fma_f32 v35, v119, s60, -v5
  v_fma_f32 v36, v120, s60, -v5
  v_fma_f32 v37, v121, s60, -v5
  v_fma_f32 v38, v122, s60, -v5
  v_fma_f32 v39, v123, s60, -v5
  v_exp_f32 v20, v20
  v_exp_f32 v21, v21
  v_exp_f32 v22, v22
  v_exp_f32 v23, v23
  v_exp_f32 v24, v24
  v_exp_f32 v25, v25
  v_exp_f32 v26, v26
  v_exp_f32 v27, v27
  v_exp_f32 v28, v28
  v_exp_f32 v29, v29
  v_exp_f32 v30, v30
  v_exp_f32 v31, v31
  v_exp_f32 v32, v32
  v_exp_f32 v33, v33
  v_exp_f32 v34, v34
  v_exp_f32 v35, v35
  v_exp_f32 v36, v36
  v_exp_f32 v37, v37
  v_exp_f32 v38, v38
  v_exp_f32 v39, v39
  s_nop 0
  v_add_f32 v6, v20, v21
  v_add_f32 v7, v22, v23
  v_add_f32 v6, v6, v24
  v_add_f32 v7, v7, v25
  v_add_f32 v6, v6, v26
  v_add_f32 v7, v7, v27
  v_add_f32 v6, v6, v28
  v_add_f32 v7, v7, v29
  v_add_f32 v6, v6, v30
  v_add_f32 v7, v7, v31
  v_add_f32 v6, v6, v32
  v_add_f32 v7, v7, v33
  v_add_f32 v6, v6, v34
  v_add_f32 v7, v7, v35
  v_add_f32 v6, v6, v36
  v_add_f32 v7, v7, v37
  v_add_f32 v6, v6, v38
  v_add_f32 v7, v7, v39
  v_add_f32 v6, v6, v7
  v_rcp_f32 v6, v6
  s_nop 0
  v_mul_f32 v20, v20, v6
  v_mul_f32 v21, v21, v6
  v_mul_f32 v22, v22, v6
  v_mul_f32 v23, v23, v6
  v_mul_f32 v24, v24, v6
  v_mul_f32 v25, v25, v6
  v_mul_f32 v26, v26, v6
  v_mul_f32 v27, v27, v6
  v_mul_f32 v28, v28, v6
  v_mul_f32 v29, v29, v6
  v_mul_f32 v30, v30, v6
  v_mul_f32 v31, v31, v6
  v_mul_f32 v32, v32, v6
  v_mul_f32 v33, v33, v6
  v_mul_f32 v34, v34, v6
  v_mul_f32 v35, v35, v6
  v_mul_f32 v36, v36, v6
  v_mul_f32 v37, v37, v6
  v_mul_f32 v38, v38, v6
  v_mul_f32 v39, v39, v6
  v_cvt_pk_bf16_f32 v40, v20, v21
  v_cvt_pk_bf16_f32 v41, v22, v23
  v_cvt_pk_bf16_f32 v42, v24, v25
  v_cvt_pk_bf16_f32 v43, v26, v27
  v_cvt_pk_bf16_f32 v44, v28, v29
  v_cvt_pk_bf16_f32 v45, v30, v31
  v_cvt_pk_bf16_f32 v46, v32, v33
  v_cvt_pk_bf16_f32 v47, v34, v35
  v_cvt_pk_bf16_f32 v48, v36, v37
  v_cvt_pk_bf16_f32 v49, v38, v39
  ds_write_b64 v2, v[40:41] offset:6144
  ds_write_b64 v2, v[42:43] offset:6152
  ds_write_b64 v2, v[44:45] offset:6160
  ds_write_b64 v2, v[46:47] offset:6168
  ds_write_b64 v2, v[48:49] offset:6176
  v_min3_f32 v5, v104, v105, v106
  v_min3_f32 v7, v107, v108, v109
  v_min3_f32 v5, v5, v110, v111
  v_min3_f32 v7, v7, v112, v113
  v_min3_f32 v5, v5, v114, v115
  v_min3_f32 v7, v7, v116, v117
  v_min3_f32 v5, v5, v118, v119
  v_min3_f32 v7, v7, v120, v121
  v_min3_f32 v5, v5, v122, v123
  v_min_f32 v5, v5, v7
  v_mul_f32 v5, s60, v5
  v_fma_f32 v20, -v104, s60, v5
  v_fma_f32 v21, -v105, s60, v5
  v_fma_f32 v22, -v106, s60, v5
  v_fma_f32 v23, -v107, s60, v5
  v_fma_f32 v24, -v108, s60, v5
  v_fma_f32 v25, -v109, s60, v5
  v_fma_f32 v26, -v110, s60, v5
  v_fma_f32 v27, -v111, s60, v5
  v_fma_f32 v28, -v112, s60, v5
  v_fma_f32 v29, -v113, s60, v5
  v_fma_f32 v30, -v114, s60, v5
  v_fma_f32 v31, -v115, s60, v5
  v_fma_f32 v32, -v116, s60, v5
  v_fma_f32 v33, -v117, s60, v5
  v_fma_f32 v34, -v118, s60, v5
  v_fma_f32 v35, -v119, s60, v5
  v_fma_f32 v36, -v120, s60, v5
  v_fma_f32 v37, -v121, s60, v5
  v_fma_f32 v38, -v122, s60, v5
  v_fma_f32 v39, -v123, s60, v5
  v_exp_f32 v20, v20
  v_exp_f32 v21, v21
  v_exp_f32 v22, v22
  v_exp_f32 v23, v23
  v_exp_f32 v24, v24
  v_exp_f32 v25, v25
  v_exp_f32 v26, v26
  v_exp_f32 v27, v27
  v_exp_f32 v28, v28
  v_exp_f32 v29, v29
  v_exp_f32 v30, v30
  v_exp_f32 v31, v31
  v_exp_f32 v32, v32
  v_exp_f32 v33, v33
  v_exp_f32 v34, v34
  v_exp_f32 v35, v35
  v_exp_f32 v36, v36
  v_exp_f32 v37, v37
  v_exp_f32 v38, v38
  v_exp_f32 v39, v39
  s_nop 0
  v_add_f32 v6, v20, v21
  v_add_f32 v7, v22, v23
  v_add_f32 v6, v6, v24
  v_add_f32 v7, v7, v25
  v_add_f32 v6, v6, v26
  v_add_f32 v7, v7, v27
  v_add_f32 v6, v6, v28
  v_add_f32 v7, v7, v29
  v_add_f32 v6, v6, v30
  v_add_f32 v7, v7, v31
  v_add_f32 v6, v6, v32
  v_add_f32 v7, v7, v33
  v_add_f32 v6, v6, v34
  v_add_f32 v7, v7, v35
  v_add_f32 v6, v6, v36
  v_add_f32 v7, v7, v37
  v_add_f32 v6, v6, v38
  v_add_f32 v7, v7, v39
  v_add_f32 v6, v6, v7
  v_rcp_f32 v6, v6
  s_nop 0
  v_mul_f32 v20, v20, v6
  v_mul_f32 v21, v21, v6
  v_mul_f32 v22, v22, v6
  v_mul_f32 v23, v23, v6
  v_mul_f32 v24, v24, v6
  v_mul_f32 v25, v25, v6
  v_mul_f32 v26, v26, v6
  v_mul_f32 v27, v27, v6
  v_mul_f32 v28, v28, v6
  v_mul_f32 v29, v29, v6
  v_mul_f32 v30, v30, v6
  v_mul_f32 v31, v31, v6
  v_mul_f32 v32, v32, v6
  v_mul_f32 v33, v33, v6
  v_mul_f32 v34, v34, v6
  v_mul_f32 v35, v35, v6
  v_mul_f32 v36, v36, v6
  v_mul_f32 v37, v37, v6
  v_mul_f32 v38, v38, v6
  v_mul_f32 v39, v39, v6
  v_cvt_pk_bf16_f32 v40, v20, v21
  v_cvt_pk_bf16_f32 v41, v22, v23
  v_cvt_pk_bf16_f32 v42, v24, v25
  v_cvt_pk_bf16_f32 v43, v26, v27
  v_cvt_pk_bf16_f32 v44, v28, v29
  v_cvt_pk_bf16_f32 v45, v30, v31
  v_cvt_pk_bf16_f32 v46, v32, v33
  v_cvt_pk_bf16_f32 v47, v34, v35
  v_cvt_pk_bf16_f32 v48, v36, v37
  v_cvt_pk_bf16_f32 v49, v38, v39
  ds_write_b64 v2, v[40:41] offset:6184
  ds_write_b64 v2, v[42:43] offset:6192
  ds_write_b64 v2, v[44:45] offset:6200
  ds_write_b64 v2, v[46:47] offset:6208
  ds_write_b64 v2, v[48:49] offset:6216
  v_cvt_pk_bf16_f32 v50, v124, v125
  v_cvt_pk_bf16_f32 v51, v126, v127
  v_cvt_pk_bf16_f32 v52, v128, v129
  v_cvt_pk_bf16_f32 v53, v130, v131
  v_cvt_pk_bf16_f32 v54, v132, v133
  v_cvt_pk_bf16_f32 v55, v134, v135
  v_cvt_pk_bf16_f32 v56, v136, v137
  v_cvt_pk_bf16_f32 v57, v138, v139
  v_cvt_pk_bf16_f32 v58, v140, v141
  v_cvt_pk_bf16_f32 v59, v142, v143
  ds_write_b64 v3, v[50:51] offset:53248
  ds_write_b64 v3, v[52:53] offset:53256
  ds_write_b64 v3, v[54:55] offset:53264
  ds_write_b64 v3, v[56:57] offset:53272
  ds_write_b64 v3, v[58:59] offset:53280
  ds_write_b32 v3, v4 offset:53288
  s_waitcnt lgkmcnt(0)
  s_barrier
  v_lshrrev_b32 v14, 4, v0
  v_bfe_u32 v15, v0, 2, 2
  v_lshl_add_u32 v14, v14, 3, v15
  v_and_b32 v15, 3, v0
  v_mul_u32_u24 v16, 384, v14
  s_mul_i32 s26, s22, 96
  v_lshl_add_u32 v16, v15, 3, v16
  v_add_u32 v5, s26, v16
  v_lshlrev_b32 v16, 8, v14
  s_lshl_b32 s26, s22, 6
  v_lshl_add_u32 v16, v15, 3, v16
  v_add_u32 v6, s26, v16
  v_add_u32 v6, 49152, v6
  ds_read_b64_tr_b16 v[20:21], v5 offset:0
  ds_read_b64_tr_b16 v[22:23], v5 offset:1536
  ds_read_b64_tr_b16 v[24:25], v5 offset:32
  ds_read_b64_tr_b16 v[26:27], v5 offset:1568
  ds_read_b64_tr_b16 v[28:29], v5 offset:64
  ds_read_b64_tr_b16 v[30:31], v5 offset:1600
  ds_read_b64_tr_b16 v[32:33], v6 offset:0
  ds_read_b64_tr_b16 v[34:35], v6 offset:1024
  ds_read_b64_tr_b16 v[36:37], v6 offset:32
  ds_read_b64_tr_b16 v[38:39], v6 offset:1056
  s_waitcnt lgkmcnt(0)
  v_mfma_f32_16x16x32_bf16 v[64:67], v[20:23], v[32:35], 0
  v_mfma_f32_16x16x32_bf16 v[68:71], v[20:23], v[36:39], 0
  v_mfma_f32_16x16x32_bf16 v[72:75], v[24:27], v[32:35], 0
  v_mfma_f32_16x16x32_bf16 v[76:79], v[24:27], v[36:39], 0
  v_mfma_f32_16x16x32_bf16 v[80:83], v[28:31], v[32:35], 0
  v_mfma_f32_16x16x32_bf16 v[84:87], v[28:31], v[36:39], 0
  ds_read_b64_tr_b16 v[20:21], v5 offset:12288
  ds_read_b64_tr_b16 v[22:23], v5 offset:13824
  ds_read_b64_tr_b16 v[24:25], v5 offset:12320
  ds_read_b64_tr_b16 v[26:27], v5 offset:13856
  ds_read_b64_tr_b16 v[28:29], v5 offset:12352
  ds_read_b64_tr_b16 v[30:31], v5 offset:13888
  ds_read_b64_tr_b16 v[32:33], v6 offset:8192
  ds_read_b64_tr_b16 v[34:35], v6 offset:9216
  ds_read_b64_tr_b16 v[36:37], v6 offset:8224
  ds_read_b64_tr_b16 v[38:39], v6 offset:9248
  s_waitcnt lgkmcnt(0)
  v_mfma_f32_16x16x32_bf16 v[64:67], v[20:23], v[32:35], v[64:67]
  v_mfma_f32_16x16x32_bf16 v[68:71], v[20:23], v[36:39], v[68:71]
  v_mfma_f32_16x16x32_bf16 v[72:75], v[24:27], v[32:35], v[72:75]
  v_mfma_f32_16x16x32_bf16 v[76:79], v[24:27], v[36:39], v[76:79]
  v_mfma_f32_16x16x32_bf16 v[80:83], v[28:31], v[32:35], v[80:83]
  v_mfma_f32_16x16x32_bf16 v[84:87], v[28:31], v[36:39], v[84:87]
  ds_read_b64_tr_b16 v[20:21], v5 offset:24576
  ds_read_b64_tr_b16 v[22:23], v5 offset:26112
  ds_read_b64_tr_b16 v[24:25], v5 offset:24608
  ds_read_b64_tr_b16 v[26:27], v5 offset:26144
  ds_read_b64_tr_b16 v[28:29], v5 offset:24640
  ds_read_b64_tr_b16 v[30:31], v5 offset:26176
  ds_read_b64_tr_b16 v[32:33], v6 offset:16384
  ds_read_b64_tr_b16 v[34:35], v6 offset:17408
  ds_read_b64_tr_b16 v[36:37], v6 offset:16416
  ds_read_b64_tr_b16 v[38:39], v6 offset:17440
  s_waitcnt lgkmcnt(0)
  v_mfma_f32_16x16x32_bf16 v[64:67], v[20:23], v[32:35], v[64:67]
  v_mfma_f32_16x16x32_bf16 v[68:71], v[20:23], v[36:39], v[68:71]
  v_mfma_f32_16x16x32_bf16 v[72:75], v[24:27], v[32:35], v[72:75]
  v_mfma_f32_16x16x32_bf16 v[76:79], v[24:27], v[36:39], v[76:79]
  v_mfma_f32_16x16x32_bf16 v[80:83], v[28:31], v[32:35], v[80:83]
  v_mfma_f32_16x16x32_bf16 v[84:87], v[28:31], v[36:39], v[84:87]
  ds_read_b64_tr_b16 v[20:21], v5 offset:36864
  ds_read_b64_tr_b16 v[22:23], v5 offset:38400
  ds_read_b64_tr_b16 v[24:25], v5 offset:36896
  ds_read_b64_tr_b16 v[26:27], v5 offset:38432
  ds_read_b64_tr_b16 v[28:29], v5 offset:36928
  ds_read_b64_tr_b16 v[30:31], v5 offset:38464
  ds_read_b64_tr_b16 v[32:33], v6 offset:24576
  ds_read_b64_tr_b16 v[34:35], v6 offset:25600
  ds_read_b64_tr_b16 v[36:37], v6 offset:24608
  ds_read_b64_tr_b16 v[38:39], v6 offset:25632
  s_waitcnt lgkmcnt(0)
  v_mfma_f32_16x16x32_bf16 v[64:67], v[20:23], v[32:35], v[64:67]
  v_mfma_f32_16x16x32_bf16 v[68:71], v[20:23], v[36:39], v[68:71]
  v_mfma_f32_16x16x32_bf16 v[72:75], v[24:27], v[32:35], v[72:75]
  v_mfma_f32_16x16x32_bf16 v[76:79], v[24:27], v[36:39], v[76:79]
  v_mfma_f32_16x16x32_bf16 v[80:83], v[28:31], v[32:35], v[80:83]
  v_mfma_f32_16x16x32_bf16 v[84:87], v[28:31], v[36:39], v[84:87]
  s_nop 7
  s_lshl_b32 s26, s24, 5
  s_lshl_b32 s27, s25, 2
  s_add_u32 s26, s26, s27
  s_add_u32 s26, s26, s22
  s_mul_i32 s26, s26, 6144
  s_add_u32 s26, s26, 103809024
  v_lshrrev_b32 v14, 4, v0
  v_lshlrev_b32 v14, 9, v14
  v_and_b32 v15, 15, v0
  v_lshl_add_u32 v14, v15, 2, v14
  buffer_store_dword v64, v14, s[8:11], s26 offen offset:0 sc1
  buffer_store_dword v65, v14, s[8:11], s26 offen offset:128 sc1
  buffer_store_dword v66, v14, s[8:11], s26 offen offset:256 sc1
  buffer_store_dword v67, v14, s[8:11], s26 offen offset:384 sc1
  buffer_store_dword v68, v14, s[8:11], s26 offen offset:64 sc1
  buffer_store_dword v69, v14, s[8:11], s26 offen offset:192 sc1
  buffer_store_dword v70, v14, s[8:11], s26 offen offset:320 sc1
  buffer_store_dword v71, v14, s[8:11], s26 offen offset:448 sc1
  buffer_store_dword v72, v14, s[8:11], s26 offen offset:2048 sc1
  buffer_store_dword v73, v14, s[8:11], s26 offen offset:2176 sc1
  buffer_store_dword v74, v14, s[8:11], s26 offen offset:2304 sc1
  buffer_store_dword v75, v14, s[8:11], s26 offen offset:2432 sc1
  buffer_store_dword v76, v14, s[8:11], s26 offen offset:2112 sc1
  buffer_store_dword v77, v14, s[8:11], s26 offen offset:2240 sc1
  buffer_store_dword v78, v14, s[8:11], s26 offen offset:2368 sc1
  buffer_store_dword v79, v14, s[8:11], s26 offen offset:2496 sc1
  s_add_u32 s27, s26, 4096
  buffer_store_dword v80, v14, s[8:11], s27 offen offset:0 sc1
  s_add_u32 s27, s26, 4096
  buffer_store_dword v81, v14, s[8:11], s27 offen offset:128 sc1
  s_add_u32 s27, s26, 4096
  buffer_store_dword v82, v14, s[8:11], s27 offen offset:256 sc1
  s_add_u32 s27, s26, 4096
  buffer_store_dword v83, v14, s[8:11], s27 offen offset:384 sc1
  s_add_u32 s27, s26, 4096
  buffer_store_dword v84, v14, s[8:11], s27 offen offset:64 sc1
  s_add_u32 s27, s26, 4096
  buffer_store_dword v85, v14, s[8:11], s27 offen offset:192 sc1
  s_add_u32 s27, s26, 4096
  buffer_store_dword v86, v14, s[8:11], s27 offen offset:320 sc1
  s_add_u32 s27, s26, 4096
  buffer_store_dword v87, v14, s[8:11], s27 offen offset:448 sc1
  s_branch L_jobdone
JKVR:
  s_lshl_b32 s26, s22, 6
  v_add_u32 v1, s26, v0
  v_mul_u32_u24 v2, 10923, v1
  v_lshrrev_b32 v2, 16, v2
  v_mul_u32_u24 v3, 6, v2
  v_sub_u32 v3, v1, v3
  v_lshlrev_b32 v4, 7, v2
  v_lshl_add_u32 v4, v3, 4, v4
  s_mul_i32 s27, s23, 6144
  s_add_u32 s27, s27, 103809024
  v_cmp_gt_u32 vcc, 240, v1
  s_and_saveexec_b64 s[28:29], vcc
  s_cbranch_execz JKVR_done
  buffer_load_dwordx4 v[10:13], v4, s[8:11], s27 offen sc1
  s_add_u32 s27, s27, 196608
  buffer_load_dwordx4 v[14:17], v4, s[8:11], s27 offen sc1
  s_add_u32 s27, s27, 196608
  buffer_load_dwordx4 v[18:21], v4, s[8:11], s27 offen sc1
  s_add_u32 s27, s27, 196608
  buffer_load_dwordx4 v[22:25], v4, s[8:11], s27 offen sc1
  s_add_u32 s27, s27, 196608
  buffer_load_dwordx4 v[26:29], v4, s[8:11], s27 offen sc1
  s_add_u32 s27, s27, 196608
  buffer_load_dwordx4 v[30:33], v4, s[8:11], s27 offen sc1
  s_add_u32 s27, s27, 196608
  buffer_load_dwordx4 v[34:37], v4, s[8:11], s27 offen sc1
  s_add_u32 s27, s27, 196608
  buffer_load_dwordx4 v[38:41], v4, s[8:11], s27 offen sc1
  s_add_u32 s27, s27, 196608
  buffer_load_dwordx4 v[42:45], v4, s[8:11], s27 offen sc1
  s_add_u32 s27, s27, 196608
  buffer_load_dwordx4 v[46:49], v4, s[8:11], s27 offen sc1
  s_add_u32 s27, s27, 196608
  buffer_load_dwordx4 v[50:53], v4, s[8:11], s27 offen sc1
  s_add_u32 s27, s27, 196608
  buffer_load_dwordx4 v[54:57], v4, s[8:11], s27 offen sc1
  s_add_u32 s27, s27, 196608
  buffer_load_dwordx4 v[58:61], v4, s[8:11], s27 offen sc1
  s_add_u32 s27, s27, 196608
  buffer_load_dwordx4 v[62:65], v4, s[8:11], s27 offen sc1
  s_add_u32 s27, s27, 196608
  buffer_load_dwordx4 v[66:69], v4, s[8:11], s27 offen sc1
  s_add_u32 s27, s27, 196608
  buffer_load_dwordx4 v[70:73], v4, s[8:11], s27 offen sc1
  s_add_u32 s27, s27, 196608
  s_waitcnt vmcnt(0)
  v_add_f32 v10, v10, v14
  v_add_f32 v11, v11, v15
  v_add_f32 v12, v12, v16
  v_add_f32 v13, v13, v17
  v_add_f32 v10, v10, v18
  v_add_f32 v11, v11, v19
  v_add_f32 v12, v12, v20
  v_add_f32 v13, v13, v21
  v_add_f32 v10, v10, v22
  v_add_f32 v11, v11, v23
  v_add_f32 v12, v12, v24
  v_add_f32 v13, v13, v25
  v_add_f32 v10, v10, v26
  v_add_f32 v11, v11, v27
  v_add_f32 v12, v12, v28
  v_add_f32 v13, v13, v29
  v_add_f32 v10, v10, v30
  v_add_f32 v11, v11, v31
  v_add_f32 v12, v12, v32
  v_add_f32 v13, v13, v33
  v_add_f32 v10, v10, v34
  v_add_f32 v11, v11, v35
  v_add_f32 v12, v12, v36
  v_add_f32 v13, v13, v37
  v_add_f32 v10, v10, v38
  v_add_f32 v11, v11, v39
  v_add_f32 v12, v12, v40
  v_add_f32 v13, v13, v41
  v_add_f32 v10, v10, v42
  v_add_f32 v11, v11, v43
  v_add_f32 v12, v12, v44
  v_add_f32 v13, v13, v45
  v_add_f32 v10, v10, v46
  v_add_f32 v11, v11, v47
  v_add_f32 v12, v12, v48
  v_add_f32 v13, v13, v49
  v_add_f32 v10, v10, v50
  v_add_f32 v11, v11, v51
  v_add_f32 v12, v12, v52
  v_add_f32 v13, v13, v53
  v_add_f32 v10, v10, v54
  v_add_f32 v11, v11, v55
  v_add_f32 v12, v12, v56
  v_add_f32 v13, v13, v57
  v_add_f32 v10, v10, v58
  v_add_f32 v11, v11, v59
  v_add_f32 v12, v12, v60
  v_add_f32 v13, v13, v61
  v_add_f32 v10, v10, v62
  v_add_f32 v11, v11, v63
  v_add_f32 v12, v12, v64
  v_add_f32 v13, v13, v65
  v_add_f32 v10, v10, v66
  v_add_f32 v11, v11, v67
  v_add_f32 v12, v12, v68
  v_add_f32 v13, v13, v69
  v_add_f32 v10, v10, v70
  v_add_f32 v11, v11, v71
  v_add_f32 v12, v12, v72
  v_add_f32 v13, v13, v73
  v_cvt_pk_bf16_f32 v10, v10, v11
  v_cvt_pk_bf16_f32 v11, v12, v13
  v_mul_u32_u24 v5, 320, v3
  v_lshl_add_u32 v5, v2, 1, v5
  s_lshl_b32 s27, s23, 11
  s_add_u32 s27, s27, 108003328
  buffer_store_short v10, v5, s[8:11], s27 offen sc1
  buffer_store_short_d16_hi v10, v5, s[8:11], s27 offen offset:80 sc1
  buffer_store_short v11, v5, s[8:11], s27 offen offset:160 sc1
  buffer_store_short_d16_hi v11, v5, s[8:11], s27 offen offset:240 sc1
JKVR_done:
  s_mov_b64 exec, s[28:29]
  s_branch L_jobdone
JA2:
  s_lshr_b32 s24, s23, 3
  s_and_b32 s25, s23, 7
  s_mov_b32 s60, 0x3fb8aa3b
  s_add_u32 s28, s4, 100663296
  s_addc_u32 s29, s5, 0
  s_mov_b32 s16, s28
  s_and_b32 s17, s29, 0xffff
  s_mov_b32 s18, 1638400
  s_mov_b32 s19, 0x20000
  s_mul_i32 s31, s25, 160
  s_mov_b32 s61, 163840
  s_mov_b32 s12, s72
  s_and_b32 s13, s73, 0xffff
  s_mov_b32 s14, 2621440
  s_mov_b32 s15, 0x20000
  v_lshrrev_b32 v14, 3, v0
  v_mul_u32_u24 v14, 1280, v14
  v_and_b32 v15, 7, v0
  v_lshrrev_b32 v16, 4, v0
  v_xor_b32 v17, v15, v16
  v_lshl_add_u32 v2, v17, 4, v14
  v_xor_b32 v17, 4, v17
  v_lshl_add_u32 v3, v17, 4, v14
  s_lshl_b32 s41, s22, 12
  v_and_b32 v14, 15, v0
  v_lshlrev_b32 v15, 7, v14
  v_add_u32 v15, s41, v15
  v_lshrrev_b32 v16, 1, v14
  v_lshrrev_b32 v17, 4, v0
  v_xor_b32 v16, v16, v17
  v_lshl_add_u32 v10, v16, 4, v15
  v_xor_b32 v16, 4, v16
  v_lshl_add_u32 v11, v16, 4, v15
  v_bfe_u32 v14, v0, 2, 2
  v_lshl_add_u32 v14, v17, 3, v14
  v_mul_u32_u24 v14, 160, v14
  v_and_b32 v15, 3, v0
  v_mul_u32_u24 v15, 40, v15
  v_add_u32 v14, v14, v15
  v_add_u32 v12, 49152, v14
  s_mul_i32 s42, s22, 3
  s_mov_b32 s43, 2560
  s_add_u32 s44, s42, 0
  s_lshl_b32 s44, s44, 6
  v_add_u32 v14, s44, v0
  v_mul_u32_u24 v15, 6554, v14
  v_lshrrev_b32 v15, 16, v15
  v_mul_u32_u24 v16, 10, v15
  v_sub_u32 v16, v14, v16
  v_mul_lo_u32 v15, v15, s43
  v_lshl_add_u32 v4, v16, 4, v15
  s_add_u32 s44, s42, 1
  s_lshl_b32 s44, s44, 6
  v_add_u32 v14, s44, v0
  v_mul_u32_u24 v15, 6554, v14
  v_lshrrev_b32 v15, 16, v15
  v_mul_u32_u24 v16, 10, v15
  v_sub_u32 v16, v14, v16
  v_mul_lo_u32 v15, v15, s43
  v_lshl_add_u32 v5, v16, 4, v15
  s_add_u32 s44, s42, 2
  s_lshl_b32 s44, s44, 6
  v_add_u32 v14, s44, v0
  v_mul_u32_u24 v15, 6554, v14
  v_lshrrev_b32 v15, 16, v15
  v_mul_u32_u24 v16, 10, v15
  v_sub_u32 v16, v14, v16
  v_mul_lo_u32 v15, v15, s43
  v_lshl_add_u32 v6, v16, 4, v15
  s_mul_i32 s45, s22, 40960
  s_add_u32 s46, s45, 0
  s_add_u32 s47, s45, 10240
  s_add_u32 s48, s45, 20480
  s_add_u32 s49, s45, 30720
  s_lshl_b32 s50, s22, 12
  s_lshl_b32 s51, s42, 10
  s_mul_i32 s30, s24, 163840
  s_add_u32 s44, s30, s46
  s_add_u32 m0, s50, 0
  buffer_load_dwordx4 v2, s[12:15], s44 offen lds
  s_add_u32 s44, s30, s47
  s_add_u32 m0, s50, 1024
  buffer_load_dwordx4 v3, s[12:15], s44 offen lds
  s_add_u32 s44, s30, s48
  s_add_u32 m0, s50, 2048
  buffer_load_dwordx4 v2, s[12:15], s44 offen lds
  s_add_u32 s44, s30, s49
  s_add_u32 m0, s50, 3072
  buffer_load_dwordx4 v3, s[12:15], s44 offen lds
  s_add_u32 m0, s51, 49152
  buffer_load_dwordx4 v4, s[16:19], s31 offen sc1 lds
  s_add_u32 m0, s51, 50176
  buffer_load_dwordx4 v5, s[16:19], s31 offen sc1 lds
  s_add_u32 m0, s51, 51200
  buffer_load_dwordx4 v6, s[16:19], s31 offen sc1 lds
  s_add_u32 s30, s30, 128
  s_add_u32 s31, s31, s61
  s_add_u32 s44, s30, s46
  s_add_u32 m0, s50, 16384
  buffer_load_dwordx4 v2, s[12:15], s44 offen lds
  s_add_u32 s44, s30, s47
  s_add_u32 m0, s50, 17408
  buffer_load_dwordx4 v3, s[12:15], s44 offen lds
  s_add_u32 s44, s30, s48
  s_add_u32 m0, s50, 18432
  buffer_load_dwordx4 v2, s[12:15], s44 offen lds
  s_add_u32 s44, s30, s49
  s_add_u32 m0, s50, 19456
  buffer_load_dwordx4 v3, s[12:15], s44 offen lds
  s_add_u32 m0, s51, 61440
  buffer_load_dwordx4 v4, s[16:19], s31 offen sc1 lds
  s_add_u32 m0, s51, 62464
  buffer_load_dwordx4 v5, s[16:19], s31 offen sc1 lds
  s_add_u32 m0, s51, 63488
  buffer_load_dwordx4 v6, s[16:19], s31 offen sc1 lds
  s_add_u32 s30, s30, 128
  s_add_u32 s31, s31, s61
  s_waitcnt vmcnt(7)
  s_barrier
  ds_read_b128 v[16:19], v10 offset:0
  ds_read_b128 v[20:23], v10 offset:2048
  ds_read_b128 v[24:27], v11 offset:0
  ds_read_b128 v[28:31], v11 offset:2048
  ds_read_b64_tr_b16 v[32:33], v12 offset:0
  ds_read_b64_tr_b16 v[34:35], v12 offset:640
  ds_read_b64_tr_b16 v[36:37], v12 offset:8
  ds_read_b64_tr_b16 v[38:39], v12 offset:648
  ds_read_b64_tr_b16 v[40:41], v12 offset:16
  ds_read_b64_tr_b16 v[42:43], v12 offset:656
  ds_read_b64_tr_b16 v[44:45], v12 offset:24
  ds_read_b64_tr_b16 v[46:47], v12 offset:664
  s_waitcnt lgkmcnt(10)
  s_waitcnt lgkmcnt(6)
  v_mfma_f32_16x16x32_bf16 v[64:67], v[32:35], v[16:19], 0
  v_mfma_f32_16x16x32_bf16 v[84:87], v[32:35], v[20:23], 0
  ds_read_b64_tr_b16 v[32:33], v12 offset:32
  ds_read_b64_tr_b16 v[34:35], v12 offset:672
  s_waitcnt lgkmcnt(6)
  v_mfma_f32_16x16x32_bf16 v[68:71], v[36:39], v[16:19], 0
  v_mfma_f32_16x16x32_bf16 v[88:91], v[36:39], v[20:23], 0
  s_add_u32 s44, s30, s46
  s_add_u32 m0, s50, 32768
  buffer_load_dwordx4 v2, s[12:15], s44 offen lds
  ds_read_b64_tr_b16 v[36:37], v12 offset:5120
  ds_read_b64_tr_b16 v[38:39], v12 offset:5760
  s_waitcnt lgkmcnt(6)
  v_mfma_f32_16x16x32_bf16 v[72:75], v[40:43], v[16:19], 0
  v_mfma_f32_16x16x32_bf16 v[92:95], v[40:43], v[20:23], 0
  ds_read_b64_tr_b16 v[40:41], v12 offset:5128
  ds_read_b64_tr_b16 v[42:43], v12 offset:5768
  s_waitcnt lgkmcnt(6)
  v_mfma_f32_16x16x32_bf16 v[76:79], v[44:47], v[16:19], 0
  v_mfma_f32_16x16x32_bf16 v[96:99], v[44:47], v[20:23], 0
  s_add_u32 s44, s30, s47
  s_add_u32 m0, s50, 33792
  buffer_load_dwordx4 v3, s[12:15], s44 offen lds
  ds_read_b64_tr_b16 v[44:45], v12 offset:5136
  ds_read_b64_tr_b16 v[46:47], v12 offset:5776
  s_waitcnt lgkmcnt(6)
  v_mfma_f32_16x16x32_bf16 v[80:83], v[32:35], v[16:19], 0
  v_mfma_f32_16x16x32_bf16 v[100:103], v[32:35], v[20:23], 0
  ds_read_b64_tr_b16 v[32:33], v12 offset:5144
  ds_read_b64_tr_b16 v[34:35], v12 offset:5784
  s_waitcnt lgkmcnt(6)
  v_mfma_f32_16x16x32_bf16 v[64:67], v[36:39], v[24:27], v[64:67]
  v_mfma_f32_16x16x32_bf16 v[84:87], v[36:39], v[28:31], v[84:87]
  s_add_u32 s44, s30, s48
  s_add_u32 m0, s50, 34816
  buffer_load_dwordx4 v2, s[12:15], s44 offen lds
  ds_read_b64_tr_b16 v[36:37], v12 offset:5152
  ds_read_b64_tr_b16 v[38:39], v12 offset:5792
  s_waitcnt lgkmcnt(6)
  v_mfma_f32_16x16x32_bf16 v[68:71], v[40:43], v[24:27], v[68:71]
  v_mfma_f32_16x16x32_bf16 v[88:91], v[40:43], v[28:31], v[88:91]
  s_waitcnt lgkmcnt(4)
  v_mfma_f32_16x16x32_bf16 v[72:75], v[44:47], v[24:27], v[72:75]
  v_mfma_f32_16x16x32_bf16 v[92:95], v[44:47], v[28:31], v[92:95]
  s_add_u32 s44, s30, s49
  s_add_u32 m0, s50, 35840
  buffer_load_dwordx4 v3, s[12:15], s44 offen lds
  s_waitcnt lgkmcnt(2)
  v_mfma_f32_16x16x32_bf16 v[76:79], v[32:35], v[24:27], v[76:79]
  v_mfma_f32_16x16x32_bf16 v[96:99], v[32:35], v[28:31], v[96:99]
  s_waitcnt lgkmcnt(0)
  v_mfma_f32_16x16x32_bf16 v[80:83], v[36:39], v[24:27], v[80:83]
  v_mfma_f32_16x16x32_bf16 v[100:103], v[36:39], v[28:31], v[100:103]
  s_add_u32 m0, s51, 73728
  buffer_load_dwordx4 v4, s[16:19], s31 offen sc1 lds
  s_add_u32 m0, s51, 74752
  buffer_load_dwordx4 v5, s[16:19], s31 offen sc1 lds
  s_add_u32 m0, s51, 75776
  buffer_load_dwordx4 v6, s[16:19], s31 offen sc1 lds
  s_add_u32 s30, s30, 128
  s_add_u32 s31, s31, s61
  s_waitcnt vmcnt(7)
  s_barrier
  ds_read_b128 v[16:19], v10 offset:16384
  ds_read_b128 v[20:23], v10 offset:18432
  ds_read_b128 v[24:27], v11 offset:16384
  ds_read_b128 v[28:31], v11 offset:18432
  ds_read_b64_tr_b16 v[32:33], v12 offset:12288
  ds_read_b64_tr_b16 v[34:35], v12 offset:12928
  ds_read_b64_tr_b16 v[36:37], v12 offset:12296
  ds_read_b64_tr_b16 v[38:39], v12 offset:12936
  ds_read_b64_tr_b16 v[40:41], v12 offset:12304
  ds_read_b64_tr_b16 v[42:43], v12 offset:12944
  ds_read_b64_tr_b16 v[44:45], v12 offset:12312
  ds_read_b64_tr_b16 v[46:47], v12 offset:12952
  s_waitcnt lgkmcnt(10)
  s_waitcnt lgkmcnt(6)
  v_mfma_f32_16x16x32_bf16 v[64:67], v[32:35], v[16:19], v[64:67]
  v_mfma_f32_16x16x32_bf16 v[84:87], v[32:35], v[20:23], v[84:87]
  ds_read_b64_tr_b16 v[32:33], v12 offset:12320
  ds_read_b64_tr_b16 v[34:35], v12 offset:12960
  s_waitcnt lgkmcnt(6)
  v_mfma_f32_16x16x32_bf16 v[68:71], v[36:39], v[16:19], v[68:71]
  v_mfma_f32_16x16x32_bf16 v[88:91], v[36:39], v[20:23], v[88:91]
  s_add_u32 s44, s30, s46
  s_add_u32 m0, s50, 0
  buffer_load_dwordx4 v2, s[12:15], s44 offen lds
  ds_read_b64_tr_b16 v[36:37], v12 offset:17408
  ds_read_b64_tr_b16 v[38:39], v12 offset:18048
  s_waitcnt lgkmcnt(6)
  v_mfma_f32_16x16x32_bf16 v[72:75], v[40:43], v[16:19], v[72:75]
  v_mfma_f32_16x16x32_bf16 v[92:95], v[40:43], v[20:23], v[92:95]
  ds_read_b64_tr_b16 v[40:41], v12 offset:17416
  ds_read_b64_tr_b16 v[42:43], v12 offset:18056
  s_waitcnt lgkmcnt(6)
  v_mfma_f32_16x16x32_bf16 v[76:79], v[44:47], v[16:19], v[76:79]
  v_mfma_f32_16x16x32_bf16 v[96:99], v[44:47], v[20:23], v[96:99]
  s_add_u32 s44, s30, s47
  s_add_u32 m0, s50, 1024
  buffer_load_dwordx4 v3, s[12:15], s44 offen lds
  ds_read_b64_tr_b16 v[44:45], v12 offset:17424
  ds_read_b64_tr_b16 v[46:47], v12 offset:18064
  s_waitcnt lgkmcnt(6)
  v_mfma_f32_16x16x32_bf16 v[80:83], v[32:35], v[16:19], v[80:83]
  v_mfma_f32_16x16x32_bf16 v[100:103], v[32:35], v[20:23], v[100:103]
  ds_read_b64_tr_b16 v[32:33], v12 offset:17432
  ds_read_b64_tr_b16 v[34:35], v12 offset:18072
  s_waitcnt lgkmcnt(6)
  v_mfma_f32_16x16x32_bf16 v[64:67], v[36:39], v[24:27], v[64:67]
  v_mfma_f32_16x16x32_bf16 v[84:87], v[36:39], v[28:31], v[84:87]
  s_add_u32 s44, s30, s48
  s_add_u32 m0, s50, 2048
  buffer_load_dwordx4 v2, s[12:15], s44 offen lds
  ds_read_b64_tr_b16 v[36:37], v12 offset:17440
  ds_read_b64_tr_b16 v[38:39], v12 offset:18080
  s_waitcnt lgkmcnt(6)
  v_mfma_f32_16x16x32_bf16 v[68:71], v[40:43], v[24:27], v[68:71]
  v_mfma_f32_16x16x32_bf16 v[88:91], v[40:43], v[28:31], v[88:91]
  s_waitcnt lgkmcnt(4)
  v_mfma_f32_16x16x32_bf16 v[72:75], v[44:47], v[24:27], v[72:75]
  v_mfma_f32_16x16x32_bf16 v[92:95], v[44:47], v[28:31], v[92:95]
  s_add_u32 s44, s30, s49
  s_add_u32 m0, s50, 3072
  buffer_load_dwordx4 v3, s[12:15], s44 offen lds
  s_waitcnt lgkmcnt(2)
  v_mfma_f32_16x16x32_bf16 v[76:79], v[32:35], v[24:27], v[76:79]
  v_mfma_f32_16x16x32_bf16 v[96:99], v[32:35], v[28:31], v[96:99]
  s_waitcnt lgkmcnt(0)
  v_mfma_f32_16x16x32_bf16 v[80:83], v[36:39], v[24:27], v[80:83]
  v_mfma_f32_16x16x32_bf16 v[100:103], v[36:39], v[28:31], v[100:103]
  s_add_u32 m0, s51, 49152
  buffer_load_dwordx4 v4, s[16:19], s31 offen sc1 lds
  s_add_u32 m0, s51, 50176
  buffer_load_dwordx4 v5, s[16:19], s31 offen sc1 lds
  s_add_u32 m0, s51, 51200
  buffer_load_dwordx4 v6, s[16:19], s31 offen sc1 lds
  s_add_u32 s30, s30, 128
  s_add_u32 s31, s31, s61
  s_waitcnt vmcnt(7)
  s_barrier
  ds_read_b128 v[16:19], v10 offset:32768
  ds_read_b128 v[20:23], v10 offset:34816
  ds_read_b128 v[24:27], v11 offset:32768
  ds_read_b128 v[28:31], v11 offset:34816
  ds_read_b64_tr_b16 v[32:33], v12 offset:24576
  ds_read_b64_tr_b16 v[34:35], v12 offset:25216
  ds_read_b64_tr_b16 v[36:37], v12 offset:24584
  ds_read_b64_tr_b16 v[38:39], v12 offset:25224
  ds_read_b64_tr_b16 v[40:41], v12 offset:24592
  ds_read_b64_tr_b16 v[42:43], v12 offset:25232
  ds_read_b64_tr_b16 v[44:45], v12 offset:24600
  ds_read_b64_tr_b16 v[46:47], v12 offset:25240
  s_waitcnt lgkmcnt(10)
  s_waitcnt lgkmcnt(6)
  v_mfma_f32_16x16x32_bf16 v[64:67], v[32:35], v[16:19], v[64:67]
  v_mfma_f32_16x16x32_bf16 v[84:87], v[32:35], v[20:23], v[84:87]
  ds_read_b64_tr_b16 v[32:33], v12 offset:24608
  ds_read_b64_tr_b16 v[34:35], v12 offset:25248
  s_waitcnt lgkmcnt(6)
  v_mfma_f32_16x16x32_bf16 v[68:71], v[36:39], v[16:19], v[68:71]
  v_mfma_f32_16x16x32_bf16 v[88:91], v[36:39], v[20:23], v[88:91]
  s_add_u32 s44, s30, s46
  s_add_u32 m0, s50, 16384
  buffer_load_dwordx4 v2, s[12:15], s44 offen lds
  ds_read_b64_tr_b16 v[36:37], v12 offset:29696
  ds_read_b64_tr_b16 v[38:39], v12 offset:30336
  s_waitcnt lgkmcnt(6)
  v_mfma_f32_16x16x32_bf16 v[72:75], v[40:43], v[16:19], v[72:75]
  v_mfma_f32_16x16x32_bf16 v[92:95], v[40:43], v[20:23], v[92:95]
  ds_read_b64_tr_b16 v[40:41], v12 offset:29704
  ds_read_b64_tr_b16 v[42:43], v12 offset:30344
  s_waitcnt lgkmcnt(6)
  v_mfma_f32_16x16x32_bf16 v[76:79], v[44:47], v[16:19], v[76:79]
  v_mfma_f32_16x16x32_bf16 v[96:99], v[44:47], v[20:23], v[96:99]
  s_add_u32 s44, s30, s47
  s_add_u32 m0, s50, 17408
  buffer_load_dwordx4 v3, s[12:15], s44 offen lds
  ds_read_b64_tr_b16 v[44:45], v12 offset:29712
  ds_read_b64_tr_b16 v[46:47], v12 offset:30352
  s_waitcnt lgkmcnt(6)
  v_mfma_f32_16x16x32_bf16 v[80:83], v[32:35], v[16:19], v[80:83]
  v_mfma_f32_16x16x32_bf16 v[100:103], v[32:35], v[20:23], v[100:103]
  ds_read_b64_tr_b16 v[32:33], v12 offset:29720
  ds_read_b64_tr_b16 v[34:35], v12 offset:30360
  s_waitcnt lgkmcnt(6)
  v_mfma_f32_16x16x32_bf16 v[64:67], v[36:39], v[24:27], v[64:67]
  v_mfma_f32_16x16x32_bf16 v[84:87], v[36:39], v[28:31], v[84:87]
  s_add_u32 s44, s30, s48
  s_add_u32 m0, s50, 18432
  buffer_load_dwordx4 v2, s[12:15], s44 offen lds
  ds_read_b64_tr_b16 v[36:37], v12 offset:29728
  ds_read_b64_tr_b16 v[38:39], v12 offset:30368
  s_waitcnt lgkmcnt(6)
  v_mfma_f32_16x16x32_bf16 v[68:71], v[40:43], v[24:27], v[68:71]
  v_mfma_f32_16x16x32_bf16 v[88:91], v[40:43], v[28:31], v[88:91]
  s_waitcnt lgkmcnt(4)
  v_mfma_f32_16x16x32_bf16 v[72:75], v[44:47], v[24:27], v[72:75]
  v_mfma_f32_16x16x32_bf16 v[92:95], v[44:47], v[28:31], v[92:95]
  s_add_u32 s44, s30, s49
  s_add_u32 m0, s50, 19456
  buffer_load_dwordx4 v3, s[12:15], s44 offen lds
  s_waitcnt lgkmcnt(2)
  v_mfma_f32_16x16x32_bf16 v[76:79], v[32:35], v[24:27], v[76:79]
  v_mfma_f32_16x16x32_bf16 v[96:99], v[32:35], v[28:31], v[96:99]
  s_waitcnt lgkmcnt(0)
  v_mfma_f32_16x16x32_bf16 v[80:83], v[36:39], v[24:27], v[80:83]
  v_mfma_f32_16x16x32_bf16 v[100:103], v[36:39], v[28:31], v[100:103]
  s_add_u32 m0, s51, 61440
  buffer_load_dwordx4 v4, s[16:19], s31 offen sc1 lds
  s_add_u32 m0, s51, 62464
  buffer_load_dwordx4 v5, s[16:19], s31 offen sc1 lds
  s_add_u32 m0, s51, 63488
  buffer_load_dwordx4 v6, s[16:19], s31 offen sc1 lds
  s_add_u32 s30, s30, 128
  s_add_u32 s31, s31, s61
  s_waitcnt vmcnt(7)
  s_barrier
  ds_read_b128 v[16:19], v10 offset:0
  ds_read_b128 v[20:23], v10 offset:2048
  ds_read_b128 v[24:27], v11 offset:0
  ds_read_b128 v[28:31], v11 offset:2048
  ds_read_b64_tr_b16 v[32:33], v12 offset:0
  ds_read_b64_tr_b16 v[34:35], v12 offset:640
  ds_read_b64_tr_b16 v[36:37], v12 offset:8
  ds_read_b64_tr_b16 v[38:39], v12 offset:648
  ds_read_b64_tr_b16 v[40:41], v12 offset:16
  ds_read_b64_tr_b16 v[42:43], v12 offset:656
  ds_read_b64_tr_b16 v[44:45], v12 offset:24
  ds_read_b64_tr_b16 v[46:47], v12 offset:664
  s_waitcnt lgkmcnt(10)
  s_waitcnt lgkmcnt(6)
  v_mfma_f32_16x16x32_bf16 v[64:67], v[32:35], v[16:19], v[64:67]
  v_mfma_f32_16x16x32_bf16 v[84:87], v[32:35], v[20:23], v[84:87]
  ds_read_b64_tr_b16 v[32:33], v12 offset:32
  ds_read_b64_tr_b16 v[34:35], v12 offset:672
  s_waitcnt lgkmcnt(6)
  v_mfma_f32_16x16x32_bf16 v[68:71], v[36:39], v[16:19], v[68:71]
  v_mfma_f32_16x16x32_bf16 v[88:91], v[36:39], v[20:23], v[88:91]
  s_add_u32 s44, s30, s46
  s_add_u32 m0, s50, 32768
  buffer_load_dwordx4 v2, s[12:15], s44 offen lds
  ds_read_b64_tr_b16 v[36:37], v12 offset:5120
  ds_read_b64_tr_b16 v[38:39], v12 offset:5760
  s_waitcnt lgkmcnt(6)
  v_mfma_f32_16x16x32_bf16 v[72:75], v[40:43], v[16:19], v[72:75]
  v_mfma_f32_16x16x32_bf16 v[92:95], v[40:43], v[20:23], v[92:95]
  ds_read_b64_tr_b16 v[40:41], v12 offset:5128
  ds_read_b64_tr_b16 v[42:43], v12 offset:5768
  s_waitcnt lgkmcnt(6)
  v_mfma_f32_16x16x32_bf16 v[76:79], v[44:47], v[16:19], v[76:79]
  v_mfma_f32_16x16x32_bf16 v[96:99], v[44:47], v[20:23], v[96:99]
  s_add_u32 s44, s30, s47
  s_add_u32 m0, s50, 33792
  buffer_load_dwordx4 v3, s[12:15], s44 offen lds
  ds_read_b64_tr_b16 v[44:45], v12 offset:5136
  ds_read_b64_tr_b16 v[46:47], v12 offset:5776
  s_waitcnt lgkmcnt(6)
  v_mfma_f32_16x16x32_bf16 v[80:83], v[32:35], v[16:19], v[80:83]
  v_mfma_f32_16x16x32_bf16 v[100:103], v[32:35], v[20:23], v[100:103]
  ds_read_b64_tr_b16 v[32:33], v12 offset:5144
  ds_read_b64_tr_b16 v[34:35], v12 offset:5784
  s_waitcnt lgkmcnt(6)
  v_mfma_f32_16x16x32_bf16 v[64:67], v[36:39], v[24:27], v[64:67]
  v_mfma_f32_16x16x32_bf16 v[84:87], v[36:39], v[28:31], v[84:87]
  s_add_u32 s44, s30, s48
  s_add_u32 m0, s50, 34816
  buffer_load_dwordx4 v2, s[12:15], s44 offen lds
  ds_read_b64_tr_b16 v[36:37], v12 offset:5152
  ds_read_b64_tr_b16 v[38:39], v12 offset:5792
  s_waitcnt lgkmcnt(6)
  v_mfma_f32_16x16x32_bf16 v[68:71], v[40:43], v[24:27], v[68:71]
  v_mfma_f32_16x16x32_bf16 v[88:91], v[40:43], v[28:31], v[88:91]
  s_waitcnt lgkmcnt(4)
  v_mfma_f32_16x16x32_bf16 v[72:75], v[44:47], v[24:27], v[72:75]
  v_mfma_f32_16x16x32_bf16 v[92:95], v[44:47], v[28:31], v[92:95]
  s_add_u32 s44, s30, s49
  s_add_u32 m0, s50, 35840
  buffer_load_dwordx4 v3, s[12:15], s44 offen lds
  s_waitcnt lgkmcnt(2)
  v_mfma_f32_16x16x32_bf16 v[76:79], v[32:35], v[24:27], v[76:79]
  v_mfma_f32_16x16x32_bf16 v[96:99], v[32:35], v[28:31], v[96:99]
  s_waitcnt lgkmcnt(0)
  v_mfma_f32_16x16x32_bf16 v[80:83], v[36:39], v[24:27], v[80:83]
  v_mfma_f32_16x16x32_bf16 v[100:103], v[36:39], v[28:31], v[100:103]
  s_add_u32 m0, s51, 73728
  buffer_load_dwordx4 v4, s[16:19], s31 offen sc1 lds
  s_add_u32 m0, s51, 74752
  buffer_load_dwordx4 v5, s[16:19], s31 offen sc1 lds
  s_add_u32 m0, s51, 75776
  buffer_load_dwordx4 v6, s[16:19], s31 offen sc1 lds
  s_add_u32 s30, s30, 128
  s_add_u32 s31, s31, s61
  s_waitcnt vmcnt(7)
  s_barrier
  ds_read_b128 v[16:19], v10 offset:16384
  ds_read_b128 v[20:23], v10 offset:18432
  ds_read_b128 v[24:27], v11 offset:16384
  ds_read_b128 v[28:31], v11 offset:18432
  ds_read_b64_tr_b16 v[32:33], v12 offset:12288
  ds_read_b64_tr_b16 v[34:35], v12 offset:12928
  ds_read_b64_tr_b16 v[36:37], v12 offset:12296
  ds_read_b64_tr_b16 v[38:39], v12 offset:12936
  ds_read_b64_tr_b16 v[40:41], v12 offset:12304
  ds_read_b64_tr_b16 v[42:43], v12 offset:12944
  ds_read_b64_tr_b16 v[44:45], v12 offset:12312
  ds_read_b64_tr_b16 v[46:47], v12 offset:12952
  s_waitcnt lgkmcnt(10)
  s_waitcnt lgkmcnt(6)
  v_mfma_f32_16x16x32_bf16 v[64:67], v[32:35], v[16:19], v[64:67]
  v_mfma_f32_16x16x32_bf16 v[84:87], v[32:35], v[20:23], v[84:87]
  ds_read_b64_tr_b16 v[32:33], v12 offset:12320
  ds_read_b64_tr_b16 v[34:35], v12 offset:12960
  s_waitcnt lgkmcnt(6)
  v_mfma_f32_16x16x32_bf16 v[68:71], v[36:39], v[16:19], v[68:71]
  v_mfma_f32_16x16x32_bf16 v[88:91], v[36:39], v[20:23], v[88:91]
  s_add_u32 s44, s30, s46
  s_add_u32 m0, s50, 0
  buffer_load_dwordx4 v2, s[12:15], s44 offen lds
  ds_read_b64_tr_b16 v[36:37], v12 offset:17408
  ds_read_b64_tr_b16 v[38:39], v12 offset:18048
  s_waitcnt lgkmcnt(6)
  v_mfma_f32_16x16x32_bf16 v[72:75], v[40:43], v[16:19], v[72:75]
  v_mfma_f32_16x16x32_bf16 v[92:95], v[40:43], v[20:23], v[92:95]
  ds_read_b64_tr_b16 v[40:41], v12 offset:17416
  ds_read_b64_tr_b16 v[42:43], v12 offset:18056
  s_waitcnt lgkmcnt(6)
  v_mfma_f32_16x16x32_bf16 v[76:79], v[44:47], v[16:19], v[76:79]
  v_mfma_f32_16x16x32_bf16 v[96:99], v[44:47], v[20:23], v[96:99]
  s_add_u32 s44, s30, s47
  s_add_u32 m0, s50, 1024
  buffer_load_dwordx4 v3, s[12:15], s44 offen lds
  ds_read_b64_tr_b16 v[44:45], v12 offset:17424
  ds_read_b64_tr_b16 v[46:47], v12 offset:18064
  s_waitcnt lgkmcnt(6)
  v_mfma_f32_16x16x32_bf16 v[80:83], v[32:35], v[16:19], v[80:83]
  v_mfma_f32_16x16x32_bf16 v[100:103], v[32:35], v[20:23], v[100:103]
  ds_read_b64_tr_b16 v[32:33], v12 offset:17432
  ds_read_b64_tr_b16 v[34:35], v12 offset:18072
  s_waitcnt lgkmcnt(6)
  v_mfma_f32_16x16x32_bf16 v[64:67], v[36:39], v[24:27], v[64:67]
  v_mfma_f32_16x16x32_bf16 v[84:87], v[36:39], v[28:31], v[84:87]
  s_add_u32 s44, s30, s48
  s_add_u32 m0, s50, 2048
  buffer_load_dwordx4 v2, s[12:15], s44 offen lds
  ds_read_b64_tr_b16 v[36:37], v12 offset:17440
  ds_read_b64_tr_b16 v[38:39], v12 offset:18080
  s_waitcnt lgkmcnt(6)
  v_mfma_f32_16x16x32_bf16 v[68:71], v[40:43], v[24:27], v[68:71]
  v_mfma_f32_16x16x32_bf16 v[88:91], v[40:43], v[28:31], v[88:91]
  s_waitcnt lgkmcnt(4)
  v_mfma_f32_16x16x32_bf16 v[72:75], v[44:47], v[24:27], v[72:75]
  v_mfma_f32_16x16x32_bf16 v[92:95], v[44:47], v[28:31], v[92:95]
  s_add_u32 s44, s30, s49
  s_add_u32 m0, s50, 3072
  buffer_load_dwordx4 v3, s[12:15], s44 offen lds
  s_waitcnt lgkmcnt(2)
  v_mfma_f32_16x16x32_bf16 v[76:79], v[32:35], v[24:27], v[76:79]
  v_mfma_f32_16x16x32_bf16 v[96:99], v[32:35], v[28:31], v[96:99]
  s_waitcnt lgkmcnt(0)
  v_mfma_f32_16x16x32_bf16 v[80:83], v[36:39], v[24:27], v[80:83]
  v_mfma_f32_16x16x32_bf16 v[100:103], v[36:39], v[28:31], v[100:103]
  s_add_u32 m0, s51, 49152
  buffer_load_dwordx4 v4, s[16:19], s31 offen sc1 lds
  s_add_u32 m0, s51, 50176
  buffer_load_dwordx4 v5, s[16:19], s31 offen sc1 lds
  s_add_u32 m0, s51, 51200
  buffer_load_dwordx4 v6, s[16:19], s31 offen sc1 lds
  s_add_u32 s30, s30, 128
  s_add_u32 s31, s31, s61
  s_waitcnt vmcnt(7)
  s_barrier
  ds_read_b128 v[16:19], v10 offset:32768
  ds_read_b128 v[20:23], v10 offset:34816
  ds_read_b128 v[24:27], v11 offset:32768
  ds_read_b128 v[28:31], v11 offset:34816
  ds_read_b64_tr_b16 v[32:33], v12 offset:24576
  ds_read_b64_tr_b16 v[34:35], v12 offset:25216
  ds_read_b64_tr_b16 v[36:37], v12 offset:24584
  ds_read_b64_tr_b16 v[38:39], v12 offset:25224
  ds_read_b64_tr_b16 v[40:41], v12 offset:24592
  ds_read_b64_tr_b16 v[42:43], v12 offset:25232
  ds_read_b64_tr_b16 v[44:45], v12 offset:24600
  ds_read_b64_tr_b16 v[46:47], v12 offset:25240
  s_waitcnt lgkmcnt(10)
  s_waitcnt lgkmcnt(6)
  v_mfma_f32_16x16x32_bf16 v[64:67], v[32:35], v[16:19], v[64:67]
  v_mfma_f32_16x16x32_bf16 v[84:87], v[32:35], v[20:23], v[84:87]
  ds_read_b64_tr_b16 v[32:33], v12 offset:24608
  ds_read_b64_tr_b16 v[34:35], v12 offset:25248
  s_waitcnt lgkmcnt(6)
  v_mfma_f32_16x16x32_bf16 v[68:71], v[36:39], v[16:19], v[68:71]
  v_mfma_f32_16x16x32_bf16 v[88:91], v[36:39], v[20:23], v[88:91]
  s_add_u32 s44, s30, s46
  s_add_u32 m0, s50, 16384
  buffer_load_dwordx4 v2, s[12:15], s44 offen lds
  ds_read_b64_tr_b16 v[36:37], v12 offset:29696
  ds_read_b64_tr_b16 v[38:39], v12 offset:30336
  s_waitcnt lgkmcnt(6)
  v_mfma_f32_16x16x32_bf16 v[72:75], v[40:43], v[16:19], v[72:75]
  v_mfma_f32_16x16x32_bf16 v[92:95], v[40:43], v[20:23], v[92:95]
  ds_read_b64_tr_b16 v[40:41], v12 offset:29704
  ds_read_b64_tr_b16 v[42:43], v12 offset:30344
  s_waitcnt lgkmcnt(6)
  v_mfma_f32_16x16x32_bf16 v[76:79], v[44:47], v[16:19], v[76:79]
  v_mfma_f32_16x16x32_bf16 v[96:99], v[44:47], v[20:23], v[96:99]
  s_add_u32 s44, s30, s47
  s_add_u32 m0, s50, 17408
  buffer_load_dwordx4 v3, s[12:15], s44 offen lds
  ds_read_b64_tr_b16 v[44:45], v12 offset:29712
  ds_read_b64_tr_b16 v[46:47], v12 offset:30352
  s_waitcnt lgkmcnt(6)
  v_mfma_f32_16x16x32_bf16 v[80:83], v[32:35], v[16:19], v[80:83]
  v_mfma_f32_16x16x32_bf16 v[100:103], v[32:35], v[20:23], v[100:103]
  ds_read_b64_tr_b16 v[32:33], v12 offset:29720
  ds_read_b64_tr_b16 v[34:35], v12 offset:30360
  s_waitcnt lgkmcnt(6)
  v_mfma_f32_16x16x32_bf16 v[64:67], v[36:39], v[24:27], v[64:67]
  v_mfma_f32_16x16x32_bf16 v[84:87], v[36:39], v[28:31], v[84:87]
  s_add_u32 s44, s30, s48
  s_add_u32 m0, s50, 18432
  buffer_load_dwordx4 v2, s[12:15], s44 offen lds
  ds_read_b64_tr_b16 v[36:37], v12 offset:29728
  ds_read_b64_tr_b16 v[38:39], v12 offset:30368
  s_waitcnt lgkmcnt(6)
  v_mfma_f32_16x16x32_bf16 v[68:71], v[40:43], v[24:27], v[68:71]
  v_mfma_f32_16x16x32_bf16 v[88:91], v[40:43], v[28:31], v[88:91]
  s_waitcnt lgkmcnt(4)
  v_mfma_f32_16x16x32_bf16 v[72:75], v[44:47], v[24:27], v[72:75]
  v_mfma_f32_16x16x32_bf16 v[92:95], v[44:47], v[28:31], v[92:95]
  s_add_u32 s44, s30, s49
  s_add_u32 m0, s50, 19456
  buffer_load_dwordx4 v3, s[12:15], s44 offen lds
  s_waitcnt lgkmcnt(2)
  v_mfma_f32_16x16x32_bf16 v[76:79], v[32:35], v[24:27], v[76:79]
  v_mfma_f32_16x16x32_bf16 v[96:99], v[32:35], v[28:31], v[96:99]
  s_waitcnt lgkmcnt(0)
  v_mfma_f32_16x16x32_bf16 v[80:83], v[36:39], v[24:27], v[80:83]
  v_mfma_f32_16x16x32_bf16 v[100:103], v[36:39], v[28:31], v[100:103]
  s_add_u32 m0, s51, 61440
  buffer_load_dwordx4 v4, s[16:19], s31 offen sc1 lds
  s_add_u32 m0, s51, 62464
  buffer_load_dwordx4 v5, s[16:19], s31 offen sc1 lds
  s_add_u32 m0, s51, 63488
  buffer_load_dwordx4 v6, s[16:19], s31 offen sc1 lds
  s_add_u32 s30, s30, 128
  s_add_u32 s31, s31, s61
  s_waitcnt vmcnt(7)
  s_barrier
  ds_read_b128 v[16:19], v10 offset:0
  ds_read_b128 v[20:23], v10 offset:2048
  ds_read_b128 v[24:27], v11 offset:0
  ds_read_b128 v[28:31], v11 offset:2048
  ds_read_b64_tr_b16 v[32:33], v12 offset:0
  ds_read_b64_tr_b16 v[34:35], v12 offset:640
  ds_read_b64_tr_b16 v[36:37], v12 offset:8
  ds_read_b64_tr_b16 v[38:39], v12 offset:648
  ds_read_b64_tr_b16 v[40:41], v12 offset:16
  ds_read_b64_tr_b16 v[42:43], v12 offset:656
  ds_read_b64_tr_b16 v[44:45], v12 offset:24
  ds_read_b64_tr_b16 v[46:47], v12 offset:664
  s_waitcnt lgkmcnt(10)
  s_waitcnt lgkmcnt(6)
  v_mfma_f32_16x16x32_bf16 v[64:67], v[32:35], v[16:19], v[64:67]
  v_mfma_f32_16x16x32_bf16 v[84:87], v[32:35], v[20:23], v[84:87]
  ds_read_b64_tr_b16 v[32:33], v12 offset:32
  ds_read_b64_tr_b16 v[34:35], v12 offset:672
  s_waitcnt lgkmcnt(6)
  v_mfma_f32_16x16x32_bf16 v[68:71], v[36:39], v[16:19], v[68:71]
  v_mfma_f32_16x16x32_bf16 v[88:91], v[36:39], v[20:23], v[88:91]
  s_add_u32 s44, s30, s46
  s_add_u32 m0, s50, 32768
  buffer_load_dwordx4 v2, s[12:15], s44 offen lds
  ds_read_b64_tr_b16 v[36:37], v12 offset:5120
  ds_read_b64_tr_b16 v[38:39], v12 offset:5760
  s_waitcnt lgkmcnt(6)
  v_mfma_f32_16x16x32_bf16 v[72:75], v[40:43], v[16:19], v[72:75]
  v_mfma_f32_16x16x32_bf16 v[92:95], v[40:43], v[20:23], v[92:95]
  ds_read_b64_tr_b16 v[40:41], v12 offset:5128
  ds_read_b64_tr_b16 v[42:43], v12 offset:5768
  s_waitcnt lgkmcnt(6)
  v_mfma_f32_16x16x32_bf16 v[76:79], v[44:47], v[16:19], v[76:79]
  v_mfma_f32_16x16x32_bf16 v[96:99], v[44:47], v[20:23], v[96:99]
  s_add_u32 s44, s30, s47
  s_add_u32 m0, s50, 33792
  buffer_load_dwordx4 v3, s[12:15], s44 offen lds
  ds_read_b64_tr_b16 v[44:45], v12 offset:5136
  ds_read_b64_tr_b16 v[46:47], v12 offset:5776
  s_waitcnt lgkmcnt(6)
  v_mfma_f32_16x16x32_bf16 v[80:83], v[32:35], v[16:19], v[80:83]
  v_mfma_f32_16x16x32_bf16 v[100:103], v[32:35], v[20:23], v[100:103]
  ds_read_b64_tr_b16 v[32:33], v12 offset:5144
  ds_read_b64_tr_b16 v[34:35], v12 offset:5784
  s_waitcnt lgkmcnt(6)
  v_mfma_f32_16x16x32_bf16 v[64:67], v[36:39], v[24:27], v[64:67]
  v_mfma_f32_16x16x32_bf16 v[84:87], v[36:39], v[28:31], v[84:87]
  s_add_u32 s44, s30, s48
  s_add_u32 m0, s50, 34816
  buffer_load_dwordx4 v2, s[12:15], s44 offen lds
  ds_read_b64_tr_b16 v[36:37], v12 offset:5152
  ds_read_b64_tr_b16 v[38:39], v12 offset:5792
  s_waitcnt lgkmcnt(6)
  v_mfma_f32_16x16x32_bf16 v[68:71], v[40:43], v[24:27], v[68:71]
  v_mfma_f32_16x16x32_bf16 v[88:91], v[40:43], v[28:31], v[88:91]
  s_waitcnt lgkmcnt(4)
  v_mfma_f32_16x16x32_bf16 v[72:75], v[44:47], v[24:27], v[72:75]
  v_mfma_f32_16x16x32_bf16 v[92:95], v[44:47], v[28:31], v[92:95]
  s_add_u32 s44, s30, s49
  s_add_u32 m0, s50, 35840
  buffer_load_dwordx4 v3, s[12:15], s44 offen lds
  s_waitcnt lgkmcnt(2)
  v_mfma_f32_16x16x32_bf16 v[76:79], v[32:35], v[24:27], v[76:79]
  v_mfma_f32_16x16x32_bf16 v[96:99], v[32:35], v[28:31], v[96:99]
  s_waitcnt lgkmcnt(0)
  v_mfma_f32_16x16x32_bf16 v[80:83], v[36:39], v[24:27], v[80:83]
  v_mfma_f32_16x16x32_bf16 v[100:103], v[36:39], v[28:31], v[100:103]
  s_add_u32 m0, s51, 73728
  buffer_load_dwordx4 v4, s[16:19], s31 offen sc1 lds
  s_add_u32 m0, s51, 74752
  buffer_load_dwordx4 v5, s[16:19], s31 offen sc1 lds
  s_add_u32 m0, s51, 75776
  buffer_load_dwordx4 v6, s[16:19], s31 offen sc1 lds
  s_add_u32 s30, s30, 128
  s_add_u32 s31, s31, s61
  s_waitcnt vmcnt(7)
  s_barrier
  ds_read_b128 v[16:19], v10 offset:16384
  ds_read_b128 v[20:23], v10 offset:18432
  ds_read_b128 v[24:27], v11 offset:16384
  ds_read_b128 v[28:31], v11 offset:18432
  ds_read_b64_tr_b16 v[32:33], v12 offset:12288
  ds_read_b64_tr_b16 v[34:35], v12 offset:12928
  ds_read_b64_tr_b16 v[36:37], v12 offset:12296
  ds_read_b64_tr_b16 v[38:39], v12 offset:12936
  ds_read_b64_tr_b16 v[40:41], v12 offset:12304
  ds_read_b64_tr_b16 v[42:43], v12 offset:12944
  ds_read_b64_tr_b16 v[44:45], v12 offset:12312
  ds_read_b64_tr_b16 v[46:47], v12 offset:12952
  s_waitcnt lgkmcnt(10)
  s_waitcnt lgkmcnt(6)
  v_mfma_f32_16x16x32_bf16 v[64:67], v[32:35], v[16:19], v[64:67]
  v_mfma_f32_16x16x32_bf16 v[84:87], v[32:35], v[20:23], v[84:87]
  ds_read_b64_tr_b16 v[32:33], v12 offset:12320
  ds_read_b64_tr_b16 v[34:35], v12 offset:12960
  s_waitcnt lgkmcnt(6)
  v_mfma_f32_16x16x32_bf16 v[68:71], v[36:39], v[16:19], v[68:71]
  v_mfma_f32_16x16x32_bf16 v[88:91], v[36:39], v[20:23], v[88:91]
  s_add_u32 s44, s30, s46
  s_add_u32 m0, s50, 0
  buffer_load_dwordx4 v2, s[12:15], s44 offen lds
  ds_read_b64_tr_b16 v[36:37], v12 offset:17408
  ds_read_b64_tr_b16 v[38:39], v12 offset:18048
  s_waitcnt lgkmcnt(6)
  v_mfma_f32_16x16x32_bf16 v[72:75], v[40:43], v[16:19], v[72:75]
  v_mfma_f32_16x16x32_bf16 v[92:95], v[40:43], v[20:23], v[92:95]
  ds_read_b64_tr_b16 v[40:41], v12 offset:17416
  ds_read_b64_tr_b16 v[42:43], v12 offset:18056
  s_waitcnt lgkmcnt(6)
  v_mfma_f32_16x16x32_bf16 v[76:79], v[44:47], v[16:19], v[76:79]
  v_mfma_f32_16x16x32_bf16 v[96:99], v[44:47], v[20:23], v[96:99]
  s_add_u32 s44, s30, s47
  s_add_u32 m0, s50, 1024
  buffer_load_dwordx4 v3, s[12:15], s44 offen lds
  ds_read_b64_tr_b16 v[44:45], v12 offset:17424
  ds_read_b64_tr_b16 v[46:47], v12 offset:18064
  s_waitcnt lgkmcnt(6)
  v_mfma_f32_16x16x32_bf16 v[80:83], v[32:35], v[16:19], v[80:83]
  v_mfma_f32_16x16x32_bf16 v[100:103], v[32:35], v[20:23], v[100:103]
  ds_read_b64_tr_b16 v[32:33], v12 offset:17432
  ds_read_b64_tr_b16 v[34:35], v12 offset:18072
  s_waitcnt lgkmcnt(6)
  v_mfma_f32_16x16x32_bf16 v[64:67], v[36:39], v[24:27], v[64:67]
  v_mfma_f32_16x16x32_bf16 v[84:87], v[36:39], v[28:31], v[84:87]
  s_add_u32 s44, s30, s48
  s_add_u32 m0, s50, 2048
  buffer_load_dwordx4 v2, s[12:15], s44 offen lds
  ds_read_b64_tr_b16 v[36:37], v12 offset:17440
  ds_read_b64_tr_b16 v[38:39], v12 offset:18080
  s_waitcnt lgkmcnt(6)
  v_mfma_f32_16x16x32_bf16 v[68:71], v[40:43], v[24:27], v[68:71]
  v_mfma_f32_16x16x32_bf16 v[88:91], v[40:43], v[28:31], v[88:91]
  s_waitcnt lgkmcnt(4)
  v_mfma_f32_16x16x32_bf16 v[72:75], v[44:47], v[24:27], v[72:75]
  v_mfma_f32_16x16x32_bf16 v[92:95], v[44:47], v[28:31], v[92:95]
  s_add_u32 s44, s30, s49
  s_add_u32 m0, s50, 3072
  buffer_load_dwordx4 v3, s[12:15], s44 offen lds
  s_waitcnt lgkmcnt(2)
  v_mfma_f32_16x16x32_bf16 v[76:79], v[32:35], v[24:27], v[76:79]
  v_mfma_f32_16x16x32_bf16 v[96:99], v[32:35], v[28:31], v[96:99]
  s_waitcnt lgkmcnt(0)
  v_mfma_f32_16x16x32_bf16 v[80:83], v[36:39], v[24:27], v[80:83]
  v_mfma_f32_16x16x32_bf16 v[100:103], v[36:39], v[28:31], v[100:103]
  s_add_u32 m0, s51, 49152
  buffer_load_dwordx4 v4, s[16:19], s31 offen sc1 lds
  s_add_u32 m0, s51, 50176
  buffer_load_dwordx4 v5, s[16:19], s31 offen sc1 lds
  s_add_u32 m0, s51, 51200
  buffer_load_dwordx4 v6, s[16:19], s31 offen sc1 lds
  s_add_u32 s30, s30, 128
  s_add_u32 s31, s31, s61
  s_waitcnt vmcnt(7)
  s_barrier
  ds_read_b128 v[16:19], v10 offset:32768
  ds_read_b128 v[20:23], v10 offset:34816
  ds_read_b128 v[24:27], v11 offset:32768
  ds_read_b128 v[28:31], v11 offset:34816
  ds_read_b64_tr_b16 v[32:33], v12 offset:24576
  ds_read_b64_tr_b16 v[34:35], v12 offset:25216
  ds_read_b64_tr_b16 v[36:37], v12 offset:24584
  ds_read_b64_tr_b16 v[38:39], v12 offset:25224
  ds_read_b64_tr_b16 v[40:41], v12 offset:24592
  ds_read_b64_tr_b16 v[42:43], v12 offset:25232
  ds_read_b64_tr_b16 v[44:45], v12 offset:24600
  ds_read_b64_tr_b16 v[46:47], v12 offset:25240
  s_waitcnt lgkmcnt(10)
  s_waitcnt lgkmcnt(6)
  v_mfma_f32_16x16x32_bf16 v[64:67], v[32:35], v[16:19], v[64:67]
  v_mfma_f32_16x16x32_bf16 v[84:87], v[32:35], v[20:23], v[84:87]
  ds_read_b64_tr_b16 v[32:33], v12 offset:24608
  ds_read_b64_tr_b16 v[34:35], v12 offset:25248
  s_waitcnt lgkmcnt(6)
  v_mfma_f32_16x16x32_bf16 v[68:71], v[36:39], v[16:19], v[68:71]
  v_mfma_f32_16x16x32_bf16 v[88:91], v[36:39], v[20:23], v[88:91]
  ds_read_b64_tr_b16 v[36:37], v12 offset:29696
  ds_read_b64_tr_b16 v[38:39], v12 offset:30336
  s_waitcnt lgkmcnt(6)
  v_mfma_f32_16x16x32_bf16 v[72:75], v[40:43], v[16:19], v[72:75]
  v_mfma_f32_16x16x32_bf16 v[92:95], v[40:43], v[20:23], v[92:95]
  ds_read_b64_tr_b16 v[40:41], v12 offset:29704
  ds_read_b64_tr_b16 v[42:43], v12 offset:30344
  s_waitcnt lgkmcnt(6)
  v_mfma_f32_16x16x32_bf16 v[76:79], v[44:47], v[16:19], v[76:79]
  v_mfma_f32_16x16x32_bf16 v[96:99], v[44:47], v[20:23], v[96:99]
  ds_read_b64_tr_b16 v[44:45], v12 offset:29712
  ds_read_b64_tr_b16 v[46:47], v12 offset:30352
  s_waitcnt lgkmcnt(6)
  v_mfma_f32_16x16x32_bf16 v[80:83], v[32:35], v[16:19], v[80:83]
  v_mfma_f32_16x16x32_bf16 v[100:103], v[32:35], v[20:23], v[100:103]
  ds_read_b64_tr_b16 v[32:33], v12 offset:29720
  ds_read_b64_tr_b16 v[34:35], v12 offset:30360
  s_waitcnt lgkmcnt(6)
  v_mfma_f32_16x16x32_bf16 v[64:67], v[36:39], v[24:27], v[64:67]
  v_mfma_f32_16x16x32_bf16 v[84:87], v[36:39], v[28:31], v[84:87]
  ds_read_b64_tr_b16 v[36:37], v12 offset:29728
  ds_read_b64_tr_b16 v[38:39], v12 offset:30368
  s_waitcnt lgkmcnt(6)
  v_mfma_f32_16x16x32_bf16 v[68:71], v[40:43], v[24:27], v[68:71]
  v_mfma_f32_16x16x32_bf16 v[88:91], v[40:43], v[28:31], v[88:91]
  s_waitcnt lgkmcnt(4)
  v_mfma_f32_16x16x32_bf16 v[72:75], v[44:47], v[24:27], v[72:75]
  v_mfma_f32_16x16x32_bf16 v[92:95], v[44:47], v[28:31], v[92:95]
  s_waitcnt lgkmcnt(2)
  v_mfma_f32_16x16x32_bf16 v[76:79], v[32:35], v[24:27], v[76:79]
  v_mfma_f32_16x16x32_bf16 v[96:99], v[32:35], v[28:31], v[96:99]
  s_waitcnt lgkmcnt(0)
  v_mfma_f32_16x16x32_bf16 v[80:83], v[36:39], v[24:27], v[80:83]
  v_mfma_f32_16x16x32_bf16 v[100:103], v[36:39], v[28:31], v[100:103]
  s_waitcnt vmcnt(0)
  s_barrier
  ds_read_b128 v[16:19], v10 offset:0
  ds_read_b128 v[20:23], v10 offset:2048
  ds_read_b128 v[24:27], v11 offset:0
  ds_read_b128 v[28:31], v11 offset:2048
  ds_read_b64_tr_b16 v[32:33], v12 offset:0
  ds_read_b64_tr_b16 v[34:35], v12 offset:640
  ds_read_b64_tr_b16 v[36:37], v12 offset:8
  ds_read_b64_tr_b16 v[38:39], v12 offset:648
  ds_read_b64_tr_b16 v[40:41], v12 offset:16
  ds_read_b64_tr_b16 v[42:43], v12 offset:656
  ds_read_b64_tr_b16 v[44:45], v12 offset:24
  ds_read_b64_tr_b16 v[46:47], v12 offset:664
  s_waitcnt lgkmcnt(10)
  s_waitcnt lgkmcnt(6)
  v_mfma_f32_16x16x32_bf16 v[64:67], v[32:35], v[16:19], v[64:67]
  v_mfma_f32_16x16x32_bf16 v[84:87], v[32:35], v[20:23], v[84:87]
  ds_read_b64_tr_b16 v[32:33], v12 offset:32
  ds_read_b64_tr_b16 v[34:35], v12 offset:672
  s_waitcnt lgkmcnt(6)
  v_mfma_f32_16x16x32_bf16 v[68:71], v[36:39], v[16:19], v[68:71]
  v_mfma_f32_16x16x32_bf16 v[88:91], v[36:39], v[20:23], v[88:91]
  ds_read_b64_tr_b16 v[36:37], v12 offset:5120
  ds_read_b64_tr_b16 v[38:39], v12 offset:5760
  s_waitcnt lgkmcnt(6)
  v_mfma_f32_16x16x32_bf16 v[72:75], v[40:43], v[16:19], v[72:75]
  v_mfma_f32_16x16x32_bf16 v[92:95], v[40:43], v[20:23], v[92:95]
  ds_read_b64_tr_b16 v[40:41], v12 offset:5128
  ds_read_b64_tr_b16 v[42:43], v12 offset:5768
  s_waitcnt lgkmcnt(6)
  v_mfma_f32_16x16x32_bf16 v[76:79], v[44:47], v[16:19], v[76:79]
  v_mfma_f32_16x16x32_bf16 v[96:99], v[44:47], v[20:23], v[96:99]
  ds_read_b64_tr_b16 v[44:45], v12 offset:5136
  ds_read_b64_tr_b16 v[46:47], v12 offset:5776
  s_waitcnt lgkmcnt(6)
  v_mfma_f32_16x16x32_bf16 v[80:83], v[32:35], v[16:19], v[80:83]
  v_mfma_f32_16x16x32_bf16 v[100:103], v[32:35], v[20:23], v[100:103]
  ds_read_b64_tr_b16 v[32:33], v12 offset:5144
  ds_read_b64_tr_b16 v[34:35], v12 offset:5784
  s_waitcnt lgkmcnt(6)
  v_mfma_f32_16x16x32_bf16 v[64:67], v[36:39], v[24:27], v[64:67]
  v_mfma_f32_16x16x32_bf16 v[84:87], v[36:39], v[28:31], v[84:87]
  ds_read_b64_tr_b16 v[36:37], v12 offset:5152
  ds_read_b64_tr_b16 v[38:39], v12 offset:5792
  s_waitcnt lgkmcnt(6)
  v_mfma_f32_16x16x32_bf16 v[68:71], v[40:43], v[24:27], v[68:71]
  v_mfma_f32_16x16x32_bf16 v[88:91], v[40:43], v[28:31], v[88:91]
  s_waitcnt lgkmcnt(4)
  v_mfma_f32_16x16x32_bf16 v[72:75], v[44:47], v[24:27], v[72:75]
  v_mfma_f32_16x16x32_bf16 v[92:95], v[44:47], v[28:31], v[92:95]
  s_waitcnt lgkmcnt(2)
  v_mfma_f32_16x16x32_bf16 v[76:79], v[32:35], v[24:27], v[76:79]
  v_mfma_f32_16x16x32_bf16 v[96:99], v[32:35], v[28:31], v[96:99]
  s_waitcnt lgkmcnt(0)
  v_mfma_f32_16x16x32_bf16 v[80:83], v[36:39], v[24:27], v[80:83]
  v_mfma_f32_16x16x32_bf16 v[100:103], v[36:39], v[28:31], v[100:103]
  s_nop 7
  v_lshrrev_b32 v14, 4, v0
  v_bfe_u32 v15, v0, 2, 2
  v_cmp_eq_u32 vcc, v14, v15
  s_nop 4
  s_mov_b64 s[62:63], vcc
  v_and_b32 v16, 3, v0
  v_mul_u32_u24 v16, 80, v16
  v_lshl_add_u32 v2, v14, 11, v16
  s_lshl_b32 s26, s25, 13
  s_add_u32 s26, s26, 108003328
  v_and_b32 v15, 15, v0
  s_lshl_b32 s27, s24, 7
  s_lshl_b32 s28, s22, 5
  s_add_u32 s27, s27, s28
  v_add_u32 v15, s27, v15
  v_lshlrev_b32 v3, 2, v15
  s_mov_b32 s28, 102760448
  buffer_load_dword v8, v3, s[8:11], s28 offen sc1
  buffer_load_dword v9, v3, s[8:11], s28 offen offset:64 sc1
  s_mov_b32 s29, 9472
  v_mul_lo_u32 v4, v15, s29
  v_mul_u32_u24 v16, 40, v14
  v_add_u32 v4, v4, v16
  s_mul_i32 s29, s25, 160
  s_add_u32 s29, s29, 67108864
  v_max3_f32 v5, v64, v65, v66
  v_max3_f32 v7, v67, v68, v69
  v_max3_f32 v5, v5, v70, v71
  v_max3_f32 v7, v7, v72, v73
  v_max3_f32 v5, v5, v74, v75
  v_max3_f32 v7, v7, v76, v77
  v_max3_f32 v5, v5, v78, v79
  v_max3_f32 v7, v7, v80, v81
  v_max3_f32 v5, v5, v82, v83
  v_max_f32 v5, v5, v7
  v_mul_f32 v5, s60, v5
  v_fma_f32 v20, v64, s60, -v5
  v_fma_f32 v21, v65, s60, -v5
  v_fma_f32 v22, v66, s60, -v5
  v_fma_f32 v23, v67, s60, -v5
  v_fma_f32 v24, v68, s60, -v5
  v_fma_f32 v25, v69, s60, -v5
  v_fma_f32 v26, v70, s60, -v5
  v_fma_f32 v27, v71, s60, -v5
  v_fma_f32 v28, v72, s60, -v5
  v_fma_f32 v29, v73, s60, -v5
  v_fma_f32 v30, v74, s60, -v5
  v_fma_f32 v31, v75, s60, -v5
  v_fma_f32 v32, v76, s60, -v5
  v_fma_f32 v33, v77, s60, -v5
  v_fma_f32 v34, v78, s60, -v5
  v_fma_f32 v35, v79, s60, -v5
  v_fma_f32 v36, v80, s60, -v5
  v_fma_f32 v37, v81, s60, -v5
  v_fma_f32 v38, v82, s60, -v5
  v_fma_f32 v39, v83, s60, -v5
  v_exp_f32 v20, v20
  v_exp_f32 v21, v21
  v_exp_f32 v22, v22
  v_exp_f32 v23, v23
  v_exp_f32 v24, v24
  v_exp_f32 v25, v25
  v_exp_f32 v26, v26
  v_exp_f32 v27, v27
  v_exp_f32 v28, v28
  v_exp_f32 v29, v29
  v_exp_f32 v30, v30
  v_exp_f32 v31, v31
  v_exp_f32 v32, v32
  v_exp_f32 v33, v33
  v_exp_f32 v34, v34
  v_exp_f32 v35, v35
  v_exp_f32 v36, v36
  v_exp_f32 v37, v37
  v_exp_f32 v38, v38
  v_exp_f32 v39, v39
  s_nop 0
  v_add_f32 v6, v20, v21
  v_add_f32 v7, v22, v23
  v_add_f32 v6, v6, v24
  v_add_f32 v7, v7, v25
  v_add_f32 v6, v6, v26
  v_add_f32 v7, v7, v27
  v_add_f32 v6, v6, v28
  v_add_f32 v7, v7, v29
  v_add_f32 v6, v6, v30
  v_add_f32 v7, v7, v31
  v_add_f32 v6, v6, v32
  v_add_f32 v7, v7, v33
  v_add_f32 v6, v6, v34
  v_add_f32 v7, v7, v35
  v_add_f32 v6, v6, v36
  v_add_f32 v7, v7, v37
  v_add_f32 v6, v6, v38
  v_add_f32 v7, v7, v39
  v_add_f32 v6, v6, v7
  v_rcp_f32 v6, v6
  s_nop 0
  v_mul_f32 v20, v20, v6
  v_mul_f32 v21, v21, v6
  v_mul_f32 v22, v22, v6
  v_mul_f32 v23, v23, v6
  v_mul_f32 v24, v24, v6
  v_mul_f32 v25, v25, v6
  v_mul_f32 v26, v26, v6
  v_mul_f32 v27, v27, v6
  v_mul_f32 v28, v28, v6
  v_mul_f32 v29, v29, v6
  v_mul_f32 v30, v30, v6
  v_mul_f32 v31, v31, v6
  v_mul_f32 v32, v32, v6
  v_mul_f32 v33, v33, v6
  v_mul_f32 v34, v34, v6
  v_mul_f32 v35, v35, v6
  v_mul_f32 v36, v36, v6
  v_mul_f32 v37, v37, v6
  v_mul_f32 v38, v38, v6
  v_mul_f32 v39, v39, v6
  v_cvt_pk_bf16_f32 v104, v20, v21
  v_cvt_pk_bf16_f32 v105, v22, v23
  v_cvt_pk_bf16_f32 v106, v24, v25
  v_cvt_pk_bf16_f32 v107, v26, v27
  v_cvt_pk_bf16_f32 v108, v28, v29
  v_cvt_pk_bf16_f32 v109, v30, v31
  v_cvt_pk_bf16_f32 v110, v32, v33
  v_cvt_pk_bf16_f32 v111, v34, v35
  v_cvt_pk_bf16_f32 v112, v36, v37
  v_cvt_pk_bf16_f32 v113, v38, v39
  v_min3_f32 v5, v64, v65, v66
  v_min3_f32 v7, v67, v68, v69
  v_min3_f32 v5, v5, v70, v71
  v_min3_f32 v7, v7, v72, v73
  v_min3_f32 v5, v5, v74, v75
  v_min3_f32 v7, v7, v76, v77
  v_min3_f32 v5, v5, v78, v79
  v_min3_f32 v7, v7, v80, v81
  v_min3_f32 v5, v5, v82, v83
  v_min_f32 v5, v5, v7
  v_mul_f32 v5, s60, v5
  v_fma_f32 v20, -v64, s60, v5
  v_fma_f32 v21, -v65, s60, v5
  v_fma_f32 v22, -v66, s60, v5
  v_fma_f32 v23, -v67, s60, v5
  v_fma_f32 v24, -v68, s60, v5
  v_fma_f32 v25, -v69, s60, v5
  v_fma_f32 v26, -v70, s60, v5
  v_fma_f32 v27, -v71, s60, v5
  v_fma_f32 v28, -v72, s60, v5
  v_fma_f32 v29, -v73, s60, v5
  v_fma_f32 v30, -v74, s60, v5
  v_fma_f32 v31, -v75, s60, v5
  v_fma_f32 v32, -v76, s60, v5
  v_fma_f32 v33, -v77, s60, v5
  v_fma_f32 v34, -v78, s60, v5
  v_fma_f32 v35, -v79, s60, v5
  v_fma_f32 v36, -v80, s60, v5
  v_fma_f32 v37, -v81, s60, v5
  v_fma_f32 v38, -v82, s60, v5
  v_fma_f32 v39, -v83, s60, v5
  v_exp_f32 v20, v20
  v_exp_f32 v21, v21
  v_exp_f32 v22, v22
  v_exp_f32 v23, v23
  v_exp_f32 v24, v24
  v_exp_f32 v25, v25
  v_exp_f32 v26, v26
  v_exp_f32 v27, v27
  v_exp_f32 v28, v28
  v_exp_f32 v29, v29
  v_exp_f32 v30, v30
  v_exp_f32 v31, v31
  v_exp_f32 v32, v32
  v_exp_f32 v33, v33
  v_exp_f32 v34, v34
  v_exp_f32 v35, v35
  v_exp_f32 v36, v36
  v_exp_f32 v37, v37
  v_exp_f32 v38, v38
  v_exp_f32 v39, v39
  s_nop 0
  v_add_f32 v6, v20, v21
  v_add_f32 v7, v22, v23
  v_add_f32 v6, v6, v24
  v_add_f32 v7, v7, v25
  v_add_f32 v6, v6, v26
  v_add_f32 v7, v7, v27
  v_add_f32 v6, v6, v28
  v_add_f32 v7, v7, v29
  v_add_f32 v6, v6, v30
  v_add_f32 v7, v7, v31
  v_add_f32 v6, v6, v32
  v_add_f32 v7, v7, v33
  v_add_f32 v6, v6, v34
  v_add_f32 v7, v7, v35
  v_add_f32 v6, v6, v36
  v_add_f32 v7, v7, v37
  v_add_f32 v6, v6, v38
  v_add_f32 v7, v7, v39
  v_add_f32 v6, v6, v7
  v_rcp_f32 v6, v6
  s_nop 0
  v_mul_f32 v20, v20, v6
  v_mul_f32 v21, v21, v6
  v_mul_f32 v22, v22, v6
  v_mul_f32 v23, v23, v6
  v_mul_f32 v24, v24, v6
  v_mul_f32 v25, v25, v6
  v_mul_f32 v26, v26, v6
  v_mul_f32 v27, v27, v6
  v_mul_f32 v28, v28, v6
  v_mul_f32 v29, v29, v6
  v_mul_f32 v30, v30, v6
  v_mul_f32 v31, v31, v6
  v_mul_f32 v32, v32, v6
  v_mul_f32 v33, v33, v6
  v_mul_f32 v34, v34, v6
  v_mul_f32 v35, v35, v6
  v_mul_f32 v36, v36, v6
  v_mul_f32 v37, v37, v6
  v_mul_f32 v38, v38, v6
  v_mul_f32 v39, v39, v6
  v_cvt_pk_bf16_f32 v114, v20, v21
  v_cvt_pk_bf16_f32 v115, v22, v23
  v_cvt_pk_bf16_f32 v116, v24, v25
  v_cvt_pk_bf16_f32 v117, v26, v27
  v_cvt_pk_bf16_f32 v118, v28, v29
  v_cvt_pk_bf16_f32 v119, v30, v31
  v_cvt_pk_bf16_f32 v120, v32, v33
  v_cvt_pk_bf16_f32 v121, v34, v35
  v_cvt_pk_bf16_f32 v122, v36, v37
  v_cvt_pk_bf16_f32 v123, v38, v39
  v_max3_f32 v5, v84, v85, v86
  v_max3_f32 v7, v87, v88, v89
  v_max3_f32 v5, v5, v90, v91
  v_max3_f32 v7, v7, v92, v93
  v_max3_f32 v5, v5, v94, v95
  v_max3_f32 v7, v7, v96, v97
  v_max3_f32 v5, v5, v98, v99
  v_max3_f32 v7, v7, v100, v101
  v_max3_f32 v5, v5, v102, v103
  v_max_f32 v5, v5, v7
  v_mul_f32 v5, s60, v5
  v_fma_f32 v20, v84, s60, -v5
  v_fma_f32 v21, v85, s60, -v5
  v_fma_f32 v22, v86, s60, -v5
  v_fma_f32 v23, v87, s60, -v5
  v_fma_f32 v24, v88, s60, -v5
  v_fma_f32 v25, v89, s60, -v5
  v_fma_f32 v26, v90, s60, -v5
  v_fma_f32 v27, v91, s60, -v5
  v_fma_f32 v28, v92, s60, -v5
  v_fma_f32 v29, v93, s60, -v5
  v_fma_f32 v30, v94, s60, -v5
  v_fma_f32 v31, v95, s60, -v5
  v_fma_f32 v32, v96, s60, -v5
  v_fma_f32 v33, v97, s60, -v5
  v_fma_f32 v34, v98, s60, -v5
  v_fma_f32 v35, v99, s60, -v5
  v_fma_f32 v36, v100, s60, -v5
  v_fma_f32 v37, v101, s60, -v5
  v_fma_f32 v38, v102, s60, -v5
  v_fma_f32 v39, v103, s60, -v5
  v_exp_f32 v20, v20
  v_exp_f32 v21, v21
  v_exp_f32 v22, v22
  v_exp_f32 v23, v23
  v_exp_f32 v24, v24
  v_exp_f32 v25, v25
  v_exp_f32 v26, v26
  v_exp_f32 v27, v27
  v_exp_f32 v28, v28
  v_exp_f32 v29, v29
  v_exp_f32 v30, v30
  v_exp_f32 v31, v31
  v_exp_f32 v32, v32
  v_exp_f32 v33, v33
  v_exp_f32 v34, v34
  v_exp_f32 v35, v35
  v_exp_f32 v36, v36
  v_exp_f32 v37, v37
  v_exp_f32 v38, v38
  v_exp_f32 v39, v39
  s_nop 0
  v_add_f32 v6, v20, v21
  v_add_f32 v7, v22, v23
  v_add_f32 v6, v6, v24
  v_add_f32 v7, v7, v25
  v_add_f32 v6, v6, v26
  v_add_f32 v7, v7, v27
  v_add_f32 v6, v6, v28
  v_add_f32 v7, v7, v29
  v_add_f32 v6, v6, v30
  v_add_f32 v7, v7, v31
  v_add_f32 v6, v6, v32
  v_add_f32 v7, v7, v33
  v_add_f32 v6, v6, v34
  v_add_f32 v7, v7, v35
  v_add_f32 v6, v6, v36
  v_add_f32 v7, v7, v37
  v_add_f32 v6, v6, v38
  v_add_f32 v7, v7, v39
  v_add_f32 v6, v6, v7
  v_rcp_f32 v6, v6
  s_nop 0
  v_mul_f32 v20, v20, v6
  v_mul_f32 v21, v21, v6
  v_mul_f32 v22, v22, v6
  v_mul_f32 v23, v23, v6
  v_mul_f32 v24, v24, v6
  v_mul_f32 v25, v25, v6
  v_mul_f32 v26, v26, v6
  v_mul_f32 v27, v27, v6
  v_mul_f32 v28, v28, v6
  v_mul_f32 v29, v29, v6
  v_mul_f32 v30, v30, v6
  v_mul_f32 v31, v31, v6
  v_mul_f32 v32, v32, v6
  v_mul_f32 v33, v33, v6
  v_mul_f32 v34, v34, v6
  v_mul_f32 v35, v35, v6
  v_mul_f32 v36, v36, v6
  v_mul_f32 v37, v37, v6
  v_mul_f32 v38, v38, v6
  v_mul_f32 v39, v39, v6
  v_cvt_pk_bf16_f32 v124, v20, v21
  v_cvt_pk_bf16_f32 v125, v22, v23
  v_cvt_pk_bf16_f32 v126, v24, v25
  v_cvt_pk_bf16_f32 v127, v26, v27
  v_cvt_pk_bf16_f32 v128, v28, v29
  v_cvt_pk_bf16_f32 v129, v30, v31
  v_cvt_pk_bf16_f32 v130, v32, v33
  v_cvt_pk_bf16_f32 v131, v34, v35
  v_cvt_pk_bf16_f32 v132, v36, v37
  v_cvt_pk_bf16_f32 v133, v38, v39
  v_min3_f32 v5, v84, v85, v86
  v_min3_f32 v7, v87, v88, v89
  v_min3_f32 v5, v5, v90, v91
  v_min3_f32 v7, v7, v92, v93
  v_min3_f32 v5, v5, v94, v95
  v_min3_f32 v7, v7, v96, v97
  v_min3_f32 v5, v5, v98, v99
  v_min3_f32 v7, v7, v100, v101
  v_min3_f32 v5, v5, v102, v103
  v_min_f32 v5, v5, v7
  v_mul_f32 v5, s60, v5
  v_fma_f32 v20, -v84, s60, v5
  v_fma_f32 v21, -v85, s60, v5
  v_fma_f32 v22, -v86, s60, v5
  v_fma_f32 v23, -v87, s60, v5
  v_fma_f32 v24, -v88, s60, v5
  v_fma_f32 v25, -v89, s60, v5
  v_fma_f32 v26, -v90, s60, v5
  v_fma_f32 v27, -v91, s60, v5
  v_fma_f32 v28, -v92, s60, v5
  v_fma_f32 v29, -v93, s60, v5
  v_fma_f32 v30, -v94, s60, v5
  v_fma_f32 v31, -v95, s60, v5
  v_fma_f32 v32, -v96, s60, v5
  v_fma_f32 v33, -v97, s60, v5
  v_fma_f32 v34, -v98, s60, v5
  v_fma_f32 v35, -v99, s60, v5
  v_fma_f32 v36, -v100, s60, v5
  v_fma_f32 v37, -v101, s60, v5
  v_fma_f32 v38, -v102, s60, v5
  v_fma_f32 v39, -v103, s60, v5
  v_exp_f32 v20, v20
  v_exp_f32 v21, v21
  v_exp_f32 v22, v22
  v_exp_f32 v23, v23
  v_exp_f32 v24, v24
  v_exp_f32 v25, v25
  v_exp_f32 v26, v26
  v_exp_f32 v27, v27
  v_exp_f32 v28, v28
  v_exp_f32 v29, v29
  v_exp_f32 v30, v30
  v_exp_f32 v31, v31
  v_exp_f32 v32, v32
  v_exp_f32 v33, v33
  v_exp_f32 v34, v34
  v_exp_f32 v35, v35
  v_exp_f32 v36, v36
  v_exp_f32 v37, v37
  v_exp_f32 v38, v38
  v_exp_f32 v39, v39
  s_nop 0
  v_add_f32 v6, v20, v21
  v_add_f32 v7, v22, v23
  v_add_f32 v6, v6, v24
  v_add_f32 v7, v7, v25
  v_add_f32 v6, v6, v26
  v_add_f32 v7, v7, v27
  v_add_f32 v6, v6, v28
  v_add_f32 v7, v7, v29
  v_add_f32 v6, v6, v30
  v_add_f32 v7, v7, v31
  v_add_f32 v6, v6, v32
  v_add_f32 v7, v7, v33
  v_add_f32 v6, v6, v34
  v_add_f32 v7, v7, v35
  v_add_f32 v6, v6, v36
  v_add_f32 v7, v7, v37
  v_add_f32 v6, v6, v38
  v_add_f32 v7, v7, v39
  v_add_f32 v6, v6, v7
  v_rcp_f32 v6, v6
  s_nop 0
  v_mul_f32 v20, v20, v6
  v_mul_f32 v21, v21, v6
  v_mul_f32 v22, v22, v6
  v_mul_f32 v23, v23, v6
  v_mul_f32 v24, v24, v6
  v_mul_f32 v25, v25, v6
  v_mul_f32 v26, v26, v6
  v_mul_f32 v27, v27, v6
  v_mul_f32 v28, v28, v6
  v_mul_f32 v29, v29, v6
  v_mul_f32 v30, v30, v6
  v_mul_f32 v31, v31, v6
  v_mul_f32 v32, v32, v6
  v_mul_f32 v33, v33, v6
  v_mul_f32 v34, v34, v6
  v_mul_f32 v35, v35, v6
  v_mul_f32 v36, v36, v6
  v_mul_f32 v37, v37, v6
  v_mul_f32 v38, v38, v6
  v_mul_f32 v39, v39, v6
  v_cvt_pk_bf16_f32 v134, v20, v21
  v_cvt_pk_bf16_f32 v135, v22, v23
  v_cvt_pk_bf16_f32 v136, v24, v25
  v_cvt_pk_bf16_f32 v137, v26, v27
  v_cvt_pk_bf16_f32 v138, v28, v29
  v_cvt_pk_bf16_f32 v139, v30, v31
  v_cvt_pk_bf16_f32 v140, v32, v33
  v_cvt_pk_bf16_f32 v141, v34, v35
  v_cvt_pk_bf16_f32 v142, v36, v37
  v_cvt_pk_bf16_f32 v143, v38, v39
  v_mov_b32 v20, 0
  v_mov_b32 v21, 0
  v_mov_b32 v22, 0
  v_mov_b32 v23, 0
  v_mov_b32 v24, 0
  v_mov_b32 v25, 0
  v_mov_b32 v26, 0
  v_mov_b32 v27, 0
  v_mov_b32 v28, 0
  v_mov_b32 v29, 0
  v_mov_b32 v30, 0
  v_mov_b32 v31, 0
  v_mov_b32 v32, 0
  v_mov_b32 v33, 0
  v_mov_b32 v34, 0
  v_mov_b32 v35, 0
  v_mov_b32 v36, 0
  v_mov_b32 v37, 0
  v_mov_b32 v38, 0
  v_mov_b32 v39, 0
  s_mov_b64 exec, s[62:63]
  buffer_load_dwordx4 v[20:23], v2, s[8:11], s26 offen offset:0 sc1
  buffer_load_dwordx4 v[24:27], v2, s[8:11], s26 offen offset:16 sc1
  buffer_load_dwordx4 v[28:31], v2, s[8:11], s26 offen offset:32 sc1
  buffer_load_dwordx4 v[32:35], v2, s[8:11], s26 offen offset:48 sc1
  buffer_load_dwordx4 v[36:39], v2, s[8:11], s26 offen offset:64 sc1
  s_mov_b64 exec, -1
  s_waitcnt vmcnt(0)
  v_mfma_f32_16x16x32_bf16 v[144:147], v[20:23], v[104:107], 0
  v_mfma_f32_16x16x32_bf16 v[144:147], v[24:27], v[108:111], v[144:147]
  v_mfma_f32_16x16x32_bf16 v[144:147], v[28:31], v[112:115], v[144:147]
  v_mfma_f32_16x16x32_bf16 v[144:147], v[32:35], v[116:119], v[144:147]
  v_mfma_f32_16x16x32_bf16 v[144:147], v[36:39], v[120:123], v[144:147]
  v_mfma_f32_16x16x32_bf16 v[168:171], v[20:23], v[124:127], 0
  v_mfma_f32_16x16x32_bf16 v[168:171], v[24:27], v[128:131], v[168:171]
  v_mfma_f32_16x16x32_bf16 v[168:171], v[28:31], v[132:135], v[168:171]
  v_mfma_f32_16x16x32_bf16 v[168:171], v[32:35], v[136:139], v[168:171]
  v_mfma_f32_16x16x32_bf16 v[168:171], v[36:39], v[140:143], v[168:171]
  s_nop 3
  v_mov_b32 v20, 0
  v_mov_b32 v21, 0
  v_mov_b32 v22, 0
  v_mov_b32 v23, 0
  v_mov_b32 v24, 0
  v_mov_b32 v25, 0
  v_mov_b32 v26, 0
  v_mov_b32 v27, 0
  v_mov_b32 v28, 0
  v_mov_b32 v29, 0
  v_mov_b32 v30, 0
  v_mov_b32 v31, 0
  v_mov_b32 v32, 0
  v_mov_b32 v33, 0
  v_mov_b32 v34, 0
  v_mov_b32 v35, 0
  v_mov_b32 v36, 0
  v_mov_b32 v37, 0
  v_mov_b32 v38, 0
  v_mov_b32 v39, 0
  s_mov_b64 exec, s[62:63]
  buffer_load_dwordx4 v[20:23], v2, s[8:11], s26 offen offset:320 sc1
  buffer_load_dwordx4 v[24:27], v2, s[8:11], s26 offen offset:336 sc1
  buffer_load_dwordx4 v[28:31], v2, s[8:11], s26 offen offset:352 sc1
  buffer_load_dwordx4 v[32:35], v2, s[8:11], s26 offen offset:368 sc1
  buffer_load_dwordx4 v[36:39], v2, s[8:11], s26 offen offset:384 sc1
  s_mov_b64 exec, -1
  s_waitcnt vmcnt(0)
  v_mfma_f32_16x16x32_bf16 v[148:151], v[20:23], v[104:107], 0
  v_mfma_f32_16x16x32_bf16 v[148:151], v[24:27], v[108:111], v[148:151]
  v_mfma_f32_16x16x32_bf16 v[148:151], v[28:31], v[112:115], v[148:151]
  v_mfma_f32_16x16x32_bf16 v[148:151], v[32:35], v[116:119], v[148:151]
  v_mfma_f32_16x16x32_bf16 v[148:151], v[36:39], v[120:123], v[148:151]
  v_mfma_f32_16x16x32_bf16 v[172:175], v[20:23], v[124:127], 0
  v_mfma_f32_16x16x32_bf16 v[172:175], v[24:27], v[128:131], v[172:175]
  v_mfma_f32_16x16x32_bf16 v[172:175], v[28:31], v[132:135], v[172:175]
  v_mfma_f32_16x16x32_bf16 v[172:175], v[32:35], v[136:139], v[172:175]
  v_mfma_f32_16x16x32_bf16 v[172:175], v[36:39], v[140:143], v[172:175]
  s_nop 3
  v_mov_b32 v20, 0
  v_mov_b32 v21, 0
  v_mov_b32 v22, 0
  v_mov_b32 v23, 0
  v_mov_b32 v24, 0
  v_mov_b32 v25, 0
  v_mov_b32 v26, 0
  v_mov_b32 v27, 0
  v_mov_b32 v28, 0
  v_mov_b32 v29, 0
  v_mov_b32 v30, 0
  v_mov_b32 v31, 0
  v_mov_b32 v32, 0
  v_mov_b32 v33, 0
  v_mov_b32 v34, 0
  v_mov_b32 v35, 0
  v_mov_b32 v36, 0
  v_mov_b32 v37, 0
  v_mov_b32 v38, 0
  v_mov_b32 v39, 0
  s_mov_b64 exec, s[62:63]
  buffer_load_dwordx4 v[20:23], v2, s[8:11], s26 offen offset:640 sc1
  buffer_load_dwordx4 v[24:27], v2, s[8:11], s26 offen offset:656 sc1
  buffer_load_dwordx4 v[28:31], v2, s[8:11], s26 offen offset:672 sc1
  buffer_load_dwordx4 v[32:35], v2, s[8:11], s26 offen offset:688 sc1
  buffer_load_dwordx4 v[36:39], v2, s[8:11], s26 offen offset:704 sc1
  s_mov_b64 exec, -1
  s_waitcnt vmcnt(0)
  v_mfma_f32_16x16x32_bf16 v[152:155], v[20:23], v[104:107], 0
  v_mfma_f32_16x16x32_bf16 v[152:155], v[24:27], v[108:111], v[152:155]
  v_mfma_f32_16x16x32_bf16 v[152:155], v[28:31], v[112:115], v[152:155]
  v_mfma_f32_16x16x32_bf16 v[152:155], v[32:35], v[116:119], v[152:155]
  v_mfma_f32_16x16x32_bf16 v[152:155], v[36:39], v[120:123], v[152:155]
  v_mfma_f32_16x16x32_bf16 v[176:179], v[20:23], v[124:127], 0
  v_mfma_f32_16x16x32_bf16 v[176:179], v[24:27], v[128:131], v[176:179]
  v_mfma_f32_16x16x32_bf16 v[176:179], v[28:31], v[132:135], v[176:179]
  v_mfma_f32_16x16x32_bf16 v[176:179], v[32:35], v[136:139], v[176:179]
  v_mfma_f32_16x16x32_bf16 v[176:179], v[36:39], v[140:143], v[176:179]
  s_nop 3
  v_mov_b32 v20, 0
  v_mov_b32 v21, 0
  v_mov_b32 v22, 0
  v_mov_b32 v23, 0
  v_mov_b32 v24, 0
  v_mov_b32 v25, 0
  v_mov_b32 v26, 0
  v_mov_b32 v27, 0
  v_mov_b32 v28, 0
  v_mov_b32 v29, 0
  v_mov_b32 v30, 0
  v_mov_b32 v31, 0
  v_mov_b32 v32, 0
  v_mov_b32 v33, 0
  v_mov_b32 v34, 0
  v_mov_b32 v35, 0
  v_mov_b32 v36, 0
  v_mov_b32 v37, 0
  v_mov_b32 v38, 0
  v_mov_b32 v39, 0
  s_mov_b64 exec, s[62:63]
  buffer_load_dwordx4 v[20:23], v2, s[8:11], s26 offen offset:960 sc1
  buffer_load_dwordx4 v[24:27], v2, s[8:11], s26 offen offset:976 sc1
  buffer_load_dwordx4 v[28:31], v2, s[8:11], s26 offen offset:992 sc1
  buffer_load_dwordx4 v[32:35], v2, s[8:11], s26 offen offset:1008 sc1
  buffer_load_dwordx4 v[36:39], v2, s[8:11], s26 offen offset:1024 sc1
  s_mov_b64 exec, -1
  s_waitcnt vmcnt(0)
  v_mfma_f32_16x16x32_bf16 v[156:159], v[20:23], v[104:107], 0
  v_mfma_f32_16x16x32_bf16 v[156:159], v[24:27], v[108:111], v[156:159]
  v_mfma_f32_16x16x32_bf16 v[156:159], v[28:31], v[112:115], v[156:159]
  v_mfma_f32_16x16x32_bf16 v[156:159], v[32:35], v[116:119], v[156:159]
  v_mfma_f32_16x16x32_bf16 v[156:159], v[36:39], v[120:123], v[156:159]
  v_mfma_f32_16x16x32_bf16 v[180:183], v[20:23], v[124:127], 0
  v_mfma_f32_16x16x32_bf16 v[180:183], v[24:27], v[128:131], v[180:183]
  v_mfma_f32_16x16x32_bf16 v[180:183], v[28:31], v[132:135], v[180:183]
  v_mfma_f32_16x16x32_bf16 v[180:183], v[32:35], v[136:139], v[180:183]
  v_mfma_f32_16x16x32_bf16 v[180:183], v[36:39], v[140:143], v[180:183]
  s_nop 3
  v_mov_b32 v20, 0
  v_mov_b32 v21, 0
  v_mov_b32 v22, 0
  v_mov_b32 v23, 0
  v_mov_b32 v24, 0
  v_mov_b32 v25, 0
  v_mov_b32 v26, 0
  v_mov_b32 v27, 0
  v_mov_b32 v28, 0
  v_mov_b32 v29, 0
  v_mov_b32 v30, 0
  v_mov_b32 v31, 0
  v_mov_b32 v32, 0
  v_mov_b32 v33, 0
  v_mov_b32 v34, 0
  v_mov_b32 v35, 0
  v_mov_b32 v36, 0
  v_mov_b32 v37, 0
  v_mov_b32 v38, 0
  v_mov_b32 v39, 0
  s_mov_b64 exec, s[62:63]
  buffer_load_dwordx4 v[20:23], v2, s[8:11], s26 offen offset:1280 sc1
  buffer_load_dwordx4 v[24:27], v2, s[8:11], s26 offen offset:1296 sc1
  buffer_load_dwordx4 v[28:31], v2, s[8:11], s26 offen offset:1312 sc1
  buffer_load_dwordx4 v[32:35], v2, s[8:11], s26 offen offset:1328 sc1
  buffer_load_dwordx4 v[36:39], v2, s[8:11], s26 offen offset:1344 sc1
  s_mov_b64 exec, -1
  s_waitcnt vmcnt(0)
  v_mfma_f32_16x16x32_bf16 v[160:163], v[20:23], v[104:107], 0
  v_mfma_f32_16x16x32_bf16 v[160:163], v[24:27], v[108:111], v[160:163]
  v_mfma_f32_16x16x32_bf16 v[160:163], v[28:31], v[112:115], v[160:163]
  v_mfma_f32_16x16x32_bf16 v[160:163], v[32:35], v[116:119], v[160:163]
  v_mfma_f32_16x16x32_bf16 v[160:163], v[36:39], v[120:123], v[160:163]
  v_mfma_f32_16x16x32_bf16 v[184:187], v[20:23], v[124:127], 0
  v_mfma_f32_16x16x32_bf16 v[184:187], v[24:27], v[128:131], v[184:187]
  v_mfma_f32_16x16x32_bf16 v[184:187], v[28:31], v[132:135], v[184:187]
  v_mfma_f32_16x16x32_bf16 v[184:187], v[32:35], v[136:139], v[184:187]
  v_mfma_f32_16x16x32_bf16 v[184:187], v[36:39], v[140:143], v[184:187]
  s_nop 3
  v_mov_b32 v20, 0
  v_mov_b32 v21, 0
  v_mov_b32 v22, 0
  v_mov_b32 v23, 0
  v_mov_b32 v24, 0
  v_mov_b32 v25, 0
  v_mov_b32 v26, 0
  v_mov_b32 v27, 0
  v_mov_b32 v28, 0
  v_mov_b32 v29, 0
  v_mov_b32 v30, 0
  v_mov_b32 v31, 0
  v_mov_b32 v32, 0
  v_mov_b32 v33, 0
  v_mov_b32 v34, 0
  v_mov_b32 v35, 0
  v_mov_b32 v36, 0
  v_mov_b32 v37, 0
  v_mov_b32 v38, 0
  v_mov_b32 v39, 0
  s_mov_b64 exec, s[62:63]
  buffer_load_dwordx4 v[20:23], v2, s[8:11], s26 offen offset:1600 sc1
  buffer_load_dwordx4 v[24:27], v2, s[8:11], s26 offen offset:1616 sc1
  buffer_load_dwordx4 v[28:31], v2, s[8:11], s26 offen offset:1632 sc1
  buffer_load_dwordx4 v[32:35], v2, s[8:11], s26 offen offset:1648 sc1
  buffer_load_dwordx4 v[36:39], v2, s[8:11], s26 offen offset:1664 sc1
  s_mov_b64 exec, -1
  s_waitcnt vmcnt(0)
  v_mfma_f32_16x16x32_bf16 v[164:167], v[20:23], v[104:107], 0
  v_mfma_f32_16x16x32_bf16 v[164:167], v[24:27], v[108:111], v[164:167]
  v_mfma_f32_16x16x32_bf16 v[164:167], v[28:31], v[112:115], v[164:167]
  v_mfma_f32_16x16x32_bf16 v[164:167], v[32:35], v[116:119], v[164:167]
  v_mfma_f32_16x16x32_bf16 v[164:167], v[36:39], v[120:123], v[164:167]
  v_mfma_f32_16x16x32_bf16 v[188:191], v[20:23], v[124:127], 0
  v_mfma_f32_16x16x32_bf16 v[188:191], v[24:27], v[128:131], v[188:191]
  v_mfma_f32_16x16x32_bf16 v[188:191], v[28:31], v[132:135], v[188:191]
  v_mfma_f32_16x16x32_bf16 v[188:191], v[32:35], v[136:139], v[188:191]
  v_mfma_f32_16x16x32_bf16 v[188:191], v[36:39], v[140:143], v[188:191]
  s_nop 3
  s_nop 7
  v_add_f32 v5, 0x358637bd, v164
  v_rcp_f32 v5, v5
  s_nop 0
  v_mul_f32 v5, v5, v8
  v_mul_f32 v144, v144, v5
  v_mul_f32 v145, v145, v5
  v_mul_f32 v146, v146, v5
  v_mul_f32 v147, v147, v5
  v_mul_f32 v148, v148, v5
  v_mul_f32 v149, v149, v5
  v_mul_f32 v150, v150, v5
  v_mul_f32 v151, v151, v5
  v_mul_f32 v152, v152, v5
  v_mul_f32 v153, v153, v5
  v_mul_f32 v154, v154, v5
  v_mul_f32 v155, v155, v5
  v_mul_f32 v156, v156, v5
  v_mul_f32 v157, v157, v5
  v_mul_f32 v158, v158, v5
  v_mul_f32 v159, v159, v5
  v_mul_f32 v160, v160, v5
  v_mul_f32 v161, v161, v5
  v_mul_f32 v162, v162, v5
  v_mul_f32 v163, v163, v5
  v_cvt_pk_bf16_f32 v40, v144, v145
  v_cvt_pk_bf16_f32 v41, v146, v147
  v_cvt_pk_bf16_f32 v42, v148, v149
  v_cvt_pk_bf16_f32 v43, v150, v151
  v_cvt_pk_bf16_f32 v44, v152, v153
  v_cvt_pk_bf16_f32 v45, v154, v155
  v_cvt_pk_bf16_f32 v46, v156, v157
  v_cvt_pk_bf16_f32 v47, v158, v159
  v_cvt_pk_bf16_f32 v48, v160, v161
  v_cvt_pk_bf16_f32 v49, v162, v163
  buffer_store_dwordx2 v[40:41], v4, s[8:11], s29 offen offset:0 sc1
  buffer_store_dwordx2 v[42:43], v4, s[8:11], s29 offen offset:8 sc1
  buffer_store_dwordx2 v[44:45], v4, s[8:11], s29 offen offset:16 sc1
  buffer_store_dwordx2 v[46:47], v4, s[8:11], s29 offen offset:24 sc1
  buffer_store_dwordx2 v[48:49], v4, s[8:11], s29 offen offset:32 sc1
  s_nop 1
  v_add_f32 v5, 0x358637bd, v188
  v_rcp_f32 v5, v5
  s_nop 0
  v_mul_f32 v5, v5, v9
  v_mul_f32 v168, v168, v5
  v_mul_f32 v169, v169, v5
  v_mul_f32 v170, v170, v5
  v_mul_f32 v171, v171, v5
  v_mul_f32 v172, v172, v5
  v_mul_f32 v173, v173, v5
  v_mul_f32 v174, v174, v5
  v_mul_f32 v175, v175, v5
  v_mul_f32 v176, v176, v5
  v_mul_f32 v177, v177, v5
  v_mul_f32 v178, v178, v5
  v_mul_f32 v179, v179, v5
  v_mul_f32 v180, v180, v5
  v_mul_f32 v181, v181, v5
  v_mul_f32 v182, v182, v5
  v_mul_f32 v183, v183, v5
  v_mul_f32 v184, v184, v5
  v_mul_f32 v185, v185, v5
  v_mul_f32 v186, v186, v5
  v_mul_f32 v187, v187, v5
  v_cvt_pk_bf16_f32 v40, v168, v169
  v_cvt_pk_bf16_f32 v41, v170, v171
  v_cvt_pk_bf16_f32 v42, v172, v173
  v_cvt_pk_bf16_f32 v43, v174, v175
  v_cvt_pk_bf16_f32 v44, v176, v177
  v_cvt_pk_bf16_f32 v45, v178, v179
  v_cvt_pk_bf16_f32 v46, v180, v181
  v_cvt_pk_bf16_f32 v47, v182, v183
  v_cvt_pk_bf16_f32 v48, v184, v185
  v_cvt_pk_bf16_f32 v49, v186, v187
  s_add_u32 s29, s29, 151552
  buffer_store_dwordx2 v[40:41], v4, s[8:11], s29 offen offset:0 sc1
  buffer_store_dwordx2 v[42:43], v4, s[8:11], s29 offen offset:8 sc1
  buffer_store_dwordx2 v[44:45], v4, s[8:11], s29 offen offset:16 sc1
  buffer_store_dwordx2 v[46:47], v4, s[8:11], s29 offen offset:24 sc1
  buffer_store_dwordx2 v[48:49], v4, s[8:11], s29 offen offset:32 sc1
  s_nop 1
  s_branch L_jobdone
JC:
  s_lshl_b32 s24, s23, 2
  s_add_u32 s24, s24, s22
  s_lshr_b32 s25, s24, 5
  s_and_b32 s26, s24, 31
  s_lshl_b32 s27, s24, 13
  s_lshl_b32 s28, s24, 11
  s_add_u32 s29, s27, 33554432
  s_add_u32 s30, s27, 0
  s_add_u32 s31, s27, 16777216
  s_add_u32 s32, s28, 50331648
  s_add_u32 s33, s28, 54525952
  v_lshlrev_b32 v1, 4, v0
  v_lshrrev_b32 v2, 4, v0
  v_and_b32 v3, 15, v0
  s_add_u32 s34, s29, 0
  buffer_load_dwordx4 v[16:19], v1, s[8:11], s34 offen offset:0 sc1
  buffer_load_dwordx4 v[20:23], v1, s[8:11], s34 offen offset:1024 sc1
  buffer_load_dwordx4 v[24:27], v1, s[8:11], s34 offen offset:2048 sc1
  buffer_load_dwordx4 v[28:31], v1, s[8:11], s34 offen offset:3072 sc1
  s_add_u32 s34, s29, 4096
  buffer_load_dwordx4 v[32:35], v1, s[8:11], s34 offen offset:0 sc1
  buffer_load_dwordx4 v[36:39], v1, s[8:11], s34 offen offset:1024 sc1
  buffer_load_dwordx4 v[40:43], v1, s[8:11], s34 offen offset:2048 sc1
  buffer_load_dwordx4 v[44:47], v1, s[8:11], s34 offen offset:3072 sc1
  s_add_u32 s34, s30, 0
  buffer_load_dwordx4 v[48:51], v1, s[8:11], s34 offen offset:0 sc1
  buffer_load_dwordx4 v[52:55], v1, s[8:11], s34 offen offset:1024 sc1
  buffer_load_dwordx4 v[56:59], v1, s[8:11], s34 offen offset:2048 sc1
  buffer_load_dwordx4 v[60:63], v1, s[8:11], s34 offen offset:3072 sc1
  s_add_u32 s34, s30, 4096
  buffer_load_dwordx4 v[64:67], v1, s[8:11], s34 offen offset:0 sc1
  buffer_load_dwordx4 v[68:71], v1, s[8:11], s34 offen offset:1024 sc1
  buffer_load_dwordx4 v[72:75], v1, s[8:11], s34 offen offset:2048 sc1
  buffer_load_dwordx4 v[76:79], v1, s[8:11], s34 offen offset:3072 sc1
  s_add_u32 s34, s31, 0
  buffer_load_dwordx4 v[96:99], v1, s[8:11], s34 offen offset:0 sc1
  buffer_load_dwordx4 v[100:103], v1, s[8:11], s34 offen offset:1024 sc1
  buffer_load_dwordx4 v[104:107], v1, s[8:11], s34 offen offset:2048 sc1
  buffer_load_dwordx4 v[108:111], v1, s[8:11], s34 offen offset:3072 sc1
  s_add_u32 s34, s31, 4096
  buffer_load_dwordx4 v[112:115], v1, s[8:11], s34 offen offset:0 sc1
  buffer_load_dwordx4 v[116:119], v1, s[8:11], s34 offen offset:1024 sc1
  buffer_load_dwordx4 v[120:123], v1, s[8:11], s34 offen offset:2048 sc1
  buffer_load_dwordx4 v[124:127], v1, s[8:11], s34 offen offset:3072 sc1
  v_mov_b64 v[128:129], 0
  v_mov_b64 v[130:131], 0
  v_mov_b64 v[132:133], 0
  v_mov_b64 v[134:135], 0
  v_mov_b64 v[136:137], 0
  v_mov_b64 v[138:139], 0
  v_mov_b64 v[140:141], 0
  v_mov_b64 v[142:143], 0
  v_mov_b64 v[144:145], 0
  v_mov_b64 v[146:147], 0
  v_mov_b64 v[148:149], 0
  v_mov_b64 v[150:151], 0
  v_mov_b64 v[152:153], 0
  v_mov_b64 v[154:155], 0
  v_mov_b64 v[156:157], 0
  v_mov_b64 v[158:159], 0
  s_lshl_b32 s36, s26, 10
  s_lshl_b32 s37, s25, 4
  s_add_u32 s36, s36, s37
  s_add_u32 s36, s36, 109068288
  s_add_u32 s37, s36, 32768
  s_mov_b32 s38, 0
  v_mov_b32 v4, 0
JC_pw:
  buffer_load_dword v5, v4, s[8:11], s36 offen sc1
  buffer_load_dword v6, v4, s[8:11], s37 offen sc1
  s_waitcnt vmcnt(0)
  v_and_b32 v5, v5, v6
  s_nop 0
  v_readfirstlane_b32 s39, v5
  s_add_u32 s38, s38, 1
  s_cmp_ge_u32 s38, 4000000
  s_cbranch_scc1 JC_pd
  s_cmp_lg_u32 s39, 0
  s_cbranch_scc1 JC_pd
  s_sleep 2
  s_branch JC_pw
JC_pd:
  buffer_load_dwordx4 v[80:83], v1, s[8:11], s32 offen sc1
  buffer_load_dwordx4 v[84:87], v1, s[8:11], s32 offen offset:1024 sc1
  s_lshl_b32 s38, s22, 11
  v_add_u32 v4, s38, v1
  s_waitcnt vmcnt(0)
  ds_write_b128 v4, v[80:83]
  ds_write_b128 v4, v[84:87] offset:1024
  v_lshrrev_b32 v13, 1, v2
  v_lshlrev_b32 v13, 4, v13
  v_and_b32 v14, 1, v2
  v_lshl_add_u32 v13, v14, 2, v13
  v_bfe_u32 v14, v0, 2, 2
  v_add_u32 v13, v13, v14
  v_lshlrev_b32 v13, 4, v13
  v_and_b32 v14, 1, v0
  v_lshl_add_u32 v13, v14, 3, v13
  v_add_u32 v13, s38, v13
  s_waitcnt lgkmcnt(0)
  ds_read_b64_tr_b16 v[80:81], v13 offset:0
  ds_read_b64_tr_b16 v[82:83], v13 offset:128
  ds_read_b64_tr_b16 v[84:85], v13 offset:512
  ds_read_b64_tr_b16 v[86:87], v13 offset:640
  ds_read_b64_tr_b16 v[88:89], v13 offset:1024
  ds_read_b64_tr_b16 v[90:91], v13 offset:1152
  ds_read_b64_tr_b16 v[92:93], v13 offset:1536
  ds_read_b64_tr_b16 v[94:95], v13 offset:1664
  s_waitcnt lgkmcnt(0)
  v_lshlrev_b32 v5, 4, v3
  v_lshl_add_u32 v5, v2, 3, v5
  s_mov_b32 exec_hi, 0
  buffer_load_dwordx2 v[128:129], v5, s[8:11], s33 offen offset:0 sc1
  buffer_load_dwordx2 v[132:133], v5, s[8:11], s33 offen offset:256 sc1
  buffer_load_dwordx2 v[136:137], v5, s[8:11], s33 offen offset:512 sc1
  buffer_load_dwordx2 v[140:141], v5, s[8:11], s33 offen offset:768 sc1
  buffer_load_dwordx2 v[144:145], v5, s[8:11], s33 offen offset:1024 sc1
  buffer_load_dwordx2 v[148:149], v5, s[8:11], s33 offen offset:1280 sc1
  buffer_load_dwordx2 v[152:153], v5, s[8:11], s33 offen offset:1536 sc1
  buffer_load_dwordx2 v[156:157], v5, s[8:11], s33 offen offset:1792 sc1
  s_mov_b64 exec, -1
  v_lshrrev_b32 v6, 1, v2
  v_lshlrev_b32 v6, 4, v6
  v_and_b32 v7, 1, v2
  v_lshl_add_u32 v6, v7, 2, v6
  v_lshrrev_b32 v7, 3, v3
  v_lshlrev_b32 v7, 4, v7
  v_bfe_u32 v8, v3, 2, 1
  v_lshl_add_u32 v7, v8, 2, v7
  v_and_b32 v8, 3, v3
  v_add_u32 v7, v7, v8
  v_sub_u32 v8, v7, v6
  s_lshl_b32 s34, s25, 5
  v_add_u32 v9, s34, v7
  v_lshlrev_b32 v10, 2, v9
  s_mov_b32 s35, 102760448
  buffer_load_dword v11, v10, s[8:11], s35 offen sc1
  buffer_load_dword v12, v10, s[8:11], s35 offen offset:32 sc1
  s_mov_b32 s60, 0x3e0293ee
  s_mov_b32 s61, 0xff800000
  s_waitcnt vmcnt(0)
  v_mfma_f32_16x16x32_bf16 v[160:163], v[48:51], v[16:19], 0
  v_mfma_f32_16x16x32_bf16 v[160:163], v[52:55], v[20:23], v[160:163]
  v_mfma_f32_16x16x32_bf16 v[160:163], v[56:59], v[24:27], v[160:163]
  v_mfma_f32_16x16x32_bf16 v[160:163], v[60:63], v[28:31], v[160:163]
  v_mfma_f32_16x16x32_bf16 v[164:167], v[64:67], v[16:19], 0
  v_mfma_f32_16x16x32_bf16 v[164:167], v[68:71], v[20:23], v[164:167]
  v_mfma_f32_16x16x32_bf16 v[164:167], v[72:75], v[24:27], v[164:167]
  v_mfma_f32_16x16x32_bf16 v[164:167], v[76:79], v[28:31], v[164:167]
  v_mfma_f32_16x16x32_bf16 v[168:171], v[80:83], v[16:19], 0
  v_mfma_f32_16x16x32_bf16 v[168:171], v[84:87], v[20:23], v[168:171]
  v_mfma_f32_16x16x32_bf16 v[168:171], v[88:91], v[24:27], v[168:171]
  v_mfma_f32_16x16x32_bf16 v[168:171], v[92:95], v[28:31], v[168:171]
  v_mfma_f32_16x16x32_bf16 v[172:175], v[48:51], v[32:35], 0
  v_mfma_f32_16x16x32_bf16 v[172:175], v[52:55], v[36:39], v[172:175]
  v_mfma_f32_16x16x32_bf16 v[172:175], v[56:59], v[40:43], v[172:175]
  v_mfma_f32_16x16x32_bf16 v[172:175], v[60:63], v[44:47], v[172:175]
  v_mfma_f32_16x16x32_bf16 v[176:179], v[64:67], v[32:35], 0
  v_mfma_f32_16x16x32_bf16 v[176:179], v[68:71], v[36:39], v[176:179]
  v_mfma_f32_16x16x32_bf16 v[176:179], v[72:75], v[40:43], v[176:179]
  v_mfma_f32_16x16x32_bf16 v[176:179], v[76:79], v[44:47], v[176:179]
  v_mfma_f32_16x16x32_bf16 v[180:183], v[80:83], v[32:35], 0
  v_mfma_f32_16x16x32_bf16 v[180:183], v[84:87], v[36:39], v[180:183]
  v_mfma_f32_16x16x32_bf16 v[180:183], v[88:91], v[40:43], v[180:183]
  v_mfma_f32_16x16x32_bf16 v[180:183], v[92:95], v[44:47], v[180:183]
  s_nop 7
  v_cmp_gt_u32 s[62:63], 2, v2
  v_mov_b32 v200, 0x3f803f80
  v_mov_b32 v201, 0x3f803f80
  v_mov_b32 v202, 0x3f803f80
  v_mov_b32 v203, 0x3f803f80
  v_cmp_le_i32 vcc, 0, v8
  v_mov_b32 v13, s61
  s_nop 0
  v_cndmask_b32 v160, v13, v160, vcc
  v_cmp_le_i32 vcc, 1, v8
  v_mov_b32 v13, s61
  s_nop 0
  v_cndmask_b32 v161, v13, v161, vcc
  v_cmp_le_i32 vcc, 2, v8
  v_mov_b32 v13, s61
  s_nop 0
  v_cndmask_b32 v162, v13, v162, vcc
  v_cmp_le_i32 vcc, 3, v8
  v_mov_b32 v13, s61
  s_nop 0
  v_cndmask_b32 v163, v13, v163, vcc
  v_cmp_le_i32 vcc, 8, v8
  v_mov_b32 v13, s61
  s_nop 0
  v_cndmask_b32 v164, v13, v164, vcc
  v_cmp_le_i32 vcc, 9, v8
  v_mov_b32 v13, s61
  s_nop 0
  v_cndmask_b32 v165, v13, v165, vcc
  v_cmp_le_i32 vcc, 10, v8
  v_mov_b32 v13, s61
  s_nop 0
  v_cndmask_b32 v166, v13, v166, vcc
  v_cmp_le_i32 vcc, 11, v8
  v_mov_b32 v13, s61
  s_nop 0
  v_cndmask_b32 v167, v13, v167, vcc
  v_mov_b32 v13, s61
  v_cndmask_b32_e64 v168, v13, v168, s[62:63]
  v_mov_b32 v13, s61
  v_cndmask_b32_e64 v169, v13, v169, s[62:63]
  v_mov_b32 v13, s61
  v_cndmask_b32_e64 v170, v13, v170, s[62:63]
  v_mov_b32 v13, s61
  v_cndmask_b32_e64 v171, v13, v171, s[62:63]
  v_max3_f32 v13, v160, v161, v162
  v_max3_f32 v14, v163, v164, v165
  v_max3_f32 v13, v13, v166, v167
  v_max3_f32 v14, v14, v168, v169
  v_max3_f32 v13, v13, v170, v171
  v_max_f32 v13, v13, v14
  v_mov_b32 v14, v13
  s_nop 1
  v_permlane32_swap_b32 v13, v14
  v_max_f32 v13, v13, v14
  v_mov_b32 v14, v13
  s_nop 1
  v_permlane16_swap_b32 v13, v14
  v_max_f32 v13, v13, v14
  v_mul_f32 v13, s60, v13
  v_fma_f32 v160, v160, s60, -v13
  v_fma_f32 v161, v161, s60, -v13
  v_fma_f32 v162, v162, s60, -v13
  v_fma_f32 v163, v163, s60, -v13
  v_fma_f32 v164, v164, s60, -v13
  v_fma_f32 v165, v165, s60, -v13
  v_fma_f32 v166, v166, s60, -v13
  v_fma_f32 v167, v167, s60, -v13
  v_fma_f32 v168, v168, s60, -v13
  v_fma_f32 v169, v169, s60, -v13
  v_fma_f32 v170, v170, s60, -v13
  v_fma_f32 v171, v171, s60, -v13
  v_exp_f32 v160, v160
  v_exp_f32 v161, v161
  v_exp_f32 v162, v162
  v_exp_f32 v163, v163
  v_exp_f32 v164, v164
  v_exp_f32 v165, v165
  v_exp_f32 v166, v166
  v_exp_f32 v167, v167
  v_exp_f32 v168, v168
  v_exp_f32 v169, v169
  v_exp_f32 v170, v170
  v_exp_f32 v171, v171
  s_nop 0
  v_cvt_pk_bf16_f32 v184, v160, v161
  v_cvt_pk_bf16_f32 v185, v162, v163
  v_cvt_pk_bf16_f32 v186, v164, v165
  v_cvt_pk_bf16_f32 v187, v166, v167
  v_cvt_pk_bf16_f32 v188, v168, v169
  v_cvt_pk_bf16_f32 v189, v170, v171
  v_mov_b64 v[190:191], 0
  v_cmp_le_i32 vcc, -8, v8
  v_mov_b32 v13, s61
  s_nop 0
  v_cndmask_b32 v172, v13, v172, vcc
  v_cmp_le_i32 vcc, -7, v8
  v_mov_b32 v13, s61
  s_nop 0
  v_cndmask_b32 v173, v13, v173, vcc
  v_cmp_le_i32 vcc, -6, v8
  v_mov_b32 v13, s61
  s_nop 0
  v_cndmask_b32 v174, v13, v174, vcc
  v_cmp_le_i32 vcc, -5, v8
  v_mov_b32 v13, s61
  s_nop 0
  v_cndmask_b32 v175, v13, v175, vcc
  v_cmp_le_i32 vcc, 0, v8
  v_mov_b32 v13, s61
  s_nop 0
  v_cndmask_b32 v176, v13, v176, vcc
  v_cmp_le_i32 vcc, 1, v8
  v_mov_b32 v13, s61
  s_nop 0
  v_cndmask_b32 v177, v13, v177, vcc
  v_cmp_le_i32 vcc, 2, v8
  v_mov_b32 v13, s61
  s_nop 0
  v_cndmask_b32 v178, v13, v178, vcc
  v_cmp_le_i32 vcc, 3, v8
  v_mov_b32 v13, s61
  s_nop 0
  v_cndmask_b32 v179, v13, v179, vcc
  v_mov_b32 v13, s61
  v_cndmask_b32_e64 v180, v13, v180, s[62:63]
  v_mov_b32 v13, s61
  v_cndmask_b32_e64 v181, v13, v181, s[62:63]
  v_mov_b32 v13, s61
  v_cndmask_b32_e64 v182, v13, v182, s[62:63]
  v_mov_b32 v13, s61
  v_cndmask_b32_e64 v183, v13, v183, s[62:63]
  v_max3_f32 v13, v172, v173, v174
  v_max3_f32 v14, v175, v176, v177
  v_max3_f32 v13, v13, v178, v179
  v_max3_f32 v14, v14, v180, v181
  v_max3_f32 v13, v13, v182, v183
  v_max_f32 v13, v13, v14
  v_mov_b32 v14, v13
  s_nop 1
  v_permlane32_swap_b32 v13, v14
  v_max_f32 v13, v13, v14
  v_mov_b32 v14, v13
  s_nop 1
  v_permlane16_swap_b32 v13, v14
  v_max_f32 v13, v13, v14
  v_mul_f32 v13, s60, v13
  v_fma_f32 v172, v172, s60, -v13
  v_fma_f32 v173, v173, s60, -v13
  v_fma_f32 v174, v174, s60, -v13
  v_fma_f32 v175, v175, s60, -v13
  v_fma_f32 v176, v176, s60, -v13
  v_fma_f32 v177, v177, s60, -v13
  v_fma_f32 v178, v178, s60, -v13
  v_fma_f32 v179, v179, s60, -v13
  v_fma_f32 v180, v180, s60, -v13
  v_fma_f32 v181, v181, s60, -v13
  v_fma_f32 v182, v182, s60, -v13
  v_fma_f32 v183, v183, s60, -v13
  v_exp_f32 v172, v172
  v_exp_f32 v173, v173
  v_exp_f32 v174, v174
  v_exp_f32 v175, v175
  v_exp_f32 v176, v176
  v_exp_f32 v177, v177
  v_exp_f32 v178, v178
  v_exp_f32 v179, v179
  v_exp_f32 v180, v180
  v_exp_f32 v181, v181
  v_exp_f32 v182, v182
  v_exp_f32 v183, v183
  s_nop 0
  v_cvt_pk_bf16_f32 v192, v172, v173
  v_cvt_pk_bf16_f32 v193, v174, v175
  v_cvt_pk_bf16_f32 v194, v176, v177
  v_cvt_pk_bf16_f32 v195, v178, v179
  v_cvt_pk_bf16_f32 v196, v180, v181
  v_cvt_pk_bf16_f32 v197, v182, v183
  v_mov_b64 v[198:199], 0
  s_nop 1
  v_mfma_f32_16x16x32_bf16 v[160:163], v[200:203], v[184:187], 0
  v_mfma_f32_16x16x32_bf16 v[160:163], v[200:203], v[188:191], v[160:163]
  v_mfma_f32_16x16x32_bf16 v[164:167], v[200:203], v[192:195], 0
  v_mfma_f32_16x16x32_bf16 v[164:167], v[200:203], v[196:199], v[164:167]
  s_mov_b32 s34, 9472
  v_mul_lo_u32 v10, v9, s34
  v_lshl_add_u32 v10, v2, 4, v10
  s_lshl_b32 s35, s26, 8
  s_add_u32 s35, s35, 67110144
  v_mfma_f32_16x16x32_bf16 v[16:19], v[96:99], v[184:187], 0
  v_mfma_f32_16x16x32_bf16 v[20:23], v[100:103], v[184:187], 0
  v_mfma_f32_16x16x32_bf16 v[24:27], v[104:107], v[184:187], 0
  v_mfma_f32_16x16x32_bf16 v[28:31], v[108:111], v[184:187], 0
  v_mfma_f32_16x16x32_bf16 v[32:35], v[112:115], v[184:187], 0
  v_mfma_f32_16x16x32_bf16 v[36:39], v[116:119], v[184:187], 0
  v_mfma_f32_16x16x32_bf16 v[40:43], v[120:123], v[184:187], 0
  v_mfma_f32_16x16x32_bf16 v[44:47], v[124:127], v[184:187], 0
  v_mfma_f32_16x16x32_bf16 v[16:19], v[128:131], v[188:191], v[16:19]
  v_mfma_f32_16x16x32_bf16 v[20:23], v[132:135], v[188:191], v[20:23]
  v_mfma_f32_16x16x32_bf16 v[24:27], v[136:139], v[188:191], v[24:27]
  v_mfma_f32_16x16x32_bf16 v[28:31], v[140:143], v[188:191], v[28:31]
  v_mfma_f32_16x16x32_bf16 v[32:35], v[144:147], v[188:191], v[32:35]
  v_mfma_f32_16x16x32_bf16 v[36:39], v[148:151], v[188:191], v[36:39]
  v_mfma_f32_16x16x32_bf16 v[40:43], v[152:155], v[188:191], v[40:43]
  v_mfma_f32_16x16x32_bf16 v[44:47], v[156:159], v[188:191], v[44:47]
  v_mfma_f32_16x16x32_bf16 v[208:211], v[96:99], v[192:195], 0
  v_mfma_f32_16x16x32_bf16 v[212:215], v[100:103], v[192:195], 0
  v_mfma_f32_16x16x32_bf16 v[216:219], v[104:107], v[192:195], 0
  v_mfma_f32_16x16x32_bf16 v[220:223], v[108:111], v[192:195], 0
  v_mfma_f32_16x16x32_bf16 v[224:227], v[112:115], v[192:195], 0
  v_mfma_f32_16x16x32_bf16 v[228:231], v[116:119], v[192:195], 0
  v_mfma_f32_16x16x32_bf16 v[232:235], v[120:123], v[192:195], 0
  v_mfma_f32_16x16x32_bf16 v[236:239], v[124:127], v[192:195], 0
  v_mfma_f32_16x16x32_bf16 v[208:211], v[128:131], v[196:199], v[208:211]
  v_mfma_f32_16x16x32_bf16 v[212:215], v[132:135], v[196:199], v[212:215]
  v_mfma_f32_16x16x32_bf16 v[216:219], v[136:139], v[196:199], v[216:219]
  v_mfma_f32_16x16x32_bf16 v[220:223], v[140:143], v[196:199], v[220:223]
  v_mfma_f32_16x16x32_bf16 v[224:227], v[144:147], v[196:199], v[224:227]
  v_mfma_f32_16x16x32_bf16 v[228:231], v[148:151], v[196:199], v[228:231]
  v_mfma_f32_16x16x32_bf16 v[232:235], v[152:155], v[196:199], v[232:235]
  v_mfma_f32_16x16x32_bf16 v[236:239], v[156:159], v[196:199], v[236:239]
  s_nop 7
  v_rcp_f32 v13, v160
  v_sub_f32 v14, 1.0, v11
  v_mul_f32 v13, v13, v14
  v_mul_f32 v16, v16, v13
  v_mul_f32 v17, v17, v13
  v_mul_f32 v18, v18, v13
  v_mul_f32 v19, v19, v13
  v_mul_f32 v20, v20, v13
  v_mul_f32 v21, v21, v13
  v_mul_f32 v22, v22, v13
  v_mul_f32 v23, v23, v13
  v_mul_f32 v24, v24, v13
  v_mul_f32 v25, v25, v13
  v_mul_f32 v26, v26, v13
  v_mul_f32 v27, v27, v13
  v_mul_f32 v28, v28, v13
  v_mul_f32 v29, v29, v13
  v_mul_f32 v30, v30, v13
  v_mul_f32 v31, v31, v13
  v_mul_f32 v32, v32, v13
  v_mul_f32 v33, v33, v13
  v_mul_f32 v34, v34, v13
  v_mul_f32 v35, v35, v13
  v_mul_f32 v36, v36, v13
  v_mul_f32 v37, v37, v13
  v_mul_f32 v38, v38, v13
  v_mul_f32 v39, v39, v13
  v_mul_f32 v40, v40, v13
  v_mul_f32 v41, v41, v13
  v_mul_f32 v42, v42, v13
  v_mul_f32 v43, v43, v13
  v_mul_f32 v44, v44, v13
  v_mul_f32 v45, v45, v13
  v_mul_f32 v46, v46, v13
  v_mul_f32 v47, v47, v13
  v_cvt_pk_bf16_f32 v48, v16, v17
  v_cvt_pk_bf16_f32 v49, v18, v19
  v_cvt_pk_bf16_f32 v50, v20, v21
  v_cvt_pk_bf16_f32 v51, v22, v23
  buffer_store_dwordx4 v[48:51], v10, s[8:11], s35 offen offset:0 sc1
  v_cvt_pk_bf16_f32 v52, v24, v25
  v_cvt_pk_bf16_f32 v53, v26, v27
  v_cvt_pk_bf16_f32 v54, v28, v29
  v_cvt_pk_bf16_f32 v55, v30, v31
  buffer_store_dwordx4 v[52:55], v10, s[8:11], s35 offen offset:64 sc1
  v_cvt_pk_bf16_f32 v56, v32, v33
  v_cvt_pk_bf16_f32 v57, v34, v35
  v_cvt_pk_bf16_f32 v58, v36, v37
  v_cvt_pk_bf16_f32 v59, v38, v39
  buffer_store_dwordx4 v[56:59], v10, s[8:11], s35 offen offset:128 sc1
  v_cvt_pk_bf16_f32 v60, v40, v41
  v_cvt_pk_bf16_f32 v61, v42, v43
  v_cvt_pk_bf16_f32 v62, v44, v45
  v_cvt_pk_bf16_f32 v63, v46, v47
  buffer_store_dwordx4 v[60:63], v10, s[8:11], s35 offen offset:192 sc1
  s_nop 1
  v_rcp_f32 v13, v164
  v_sub_f32 v14, 1.0, v12
  v_mul_f32 v13, v13, v14
  v_mul_f32 v208, v208, v13
  v_mul_f32 v209, v209, v13
  v_mul_f32 v210, v210, v13
  v_mul_f32 v211, v211, v13
  v_mul_f32 v212, v212, v13
  v_mul_f32 v213, v213, v13
  v_mul_f32 v214, v214, v13
  v_mul_f32 v215, v215, v13
  v_mul_f32 v216, v216, v13
  v_mul_f32 v217, v217, v13
  v_mul_f32 v218, v218, v13
  v_mul_f32 v219, v219, v13
  v_mul_f32 v220, v220, v13
  v_mul_f32 v221, v221, v13
  v_mul_f32 v222, v222, v13
  v_mul_f32 v223, v223, v13
  v_mul_f32 v224, v224, v13
  v_mul_f32 v225, v225, v13
  v_mul_f32 v226, v226, v13
  v_mul_f32 v227, v227, v13
  v_mul_f32 v228, v228, v13
  v_mul_f32 v229, v229, v13
  v_mul_f32 v230, v230, v13
  v_mul_f32 v231, v231, v13
  v_mul_f32 v232, v232, v13
  v_mul_f32 v233, v233, v13
  v_mul_f32 v234, v234, v13
  v_mul_f32 v235, v235, v13
  v_mul_f32 v236, v236, v13
  v_mul_f32 v237, v237, v13
  v_mul_f32 v238, v238, v13
  v_mul_f32 v239, v239, v13
  s_add_u32 s35, s35, 75776
  v_cvt_pk_bf16_f32 v48, v208, v209
  v_cvt_pk_bf16_f32 v49, v210, v211
  v_cvt_pk_bf16_f32 v50, v212, v213
  v_cvt_pk_bf16_f32 v51, v214, v215
  buffer_store_dwordx4 v[48:51], v10, s[8:11], s35 offen offset:0 sc1
  v_cvt_pk_bf16_f32 v52, v216, v217
  v_cvt_pk_bf16_f32 v53, v218, v219
  v_cvt_pk_bf16_f32 v54, v220, v221
  v_cvt_pk_bf16_f32 v55, v222, v223
  buffer_store_dwordx4 v[52:55], v10, s[8:11], s35 offen offset:64 sc1
  v_cvt_pk_bf16_f32 v56, v224, v225
  v_cvt_pk_bf16_f32 v57, v226, v227
  v_cvt_pk_bf16_f32 v58, v228, v229
  v_cvt_pk_bf16_f32 v59, v230, v231
  buffer_store_dwordx4 v[56:59], v10, s[8:11], s35 offen offset:128 sc1
  v_cvt_pk_bf16_f32 v60, v232, v233
  v_cvt_pk_bf16_f32 v61, v234, v235
  v_cvt_pk_bf16_f32 v62, v236, v237
  v_cvt_pk_bf16_f32 v63, v238, v239
  buffer_store_dwordx4 v[60:63], v10, s[8:11], s35 offen offset:192 sc1
  s_nop 1
  s_branch L_jobdone
JO:
  s_mul_i32 s24, s23, 13108
  s_lshr_b32 s24, s24, 16
  s_mul_i32 s25, s24, 5
  s_sub_u32 s25, s23, s25
  v_lshrrev_b32 v40, 3, v0
  s_mov_b32 s40, 9472
  v_mul_lo_u32 v40, v40, s40
  v_and_b32 v41, 7, v0
  v_lshrrev_b32 v42, 4, v0
  v_xor_b32 v43, v41, v42
  v_lshl_add_u32 v2, v43, 4, v40
  v_xor_b32 v43, 4, v43
  v_lshl_add_u32 v3, v43, 4, v40
  v_lshrrev_b32 v40, 4, v0
  v_and_b32 v41, 15, v0
  v_lshlrev_b32 v42, 2, v40
  v_xor_b32 v43, v41, v42
  v_mul_u32_u24 v44, 1280, v40
  v_lshl_add_u32 v4, v43, 4, v44
  s_and_b32 s41, s22, 1
  s_lshl_b32 s41, s41, 12
  s_add_u32 s41, s41, 98304
  v_and_b32 v40, 31, v0
  v_lshlrev_b32 v41, 7, v40
  v_add_u32 v41, s41, v41
  v_lshrrev_b32 v42, 1, v40
  v_and_b32 v42, 7, v42
  v_lshrrev_b32 v43, 5, v0
  v_xor_b32 v42, v42, v43
  v_xor_b32 v43, 0, v42
  v_lshl_add_u32 v8, v43, 4, v41
  v_xor_b32 v43, 2, v42
  v_lshl_add_u32 v9, v43, 4, v41
  v_xor_b32 v43, 4, v42
  v_lshl_add_u32 v10, v43, 4, v41
  v_xor_b32 v43, 6, v42
  v_lshl_add_u32 v11, v43, 4, v41
  v_bfe_u32 v40, v0, 2, 2
  v_lshrrev_b32 v41, 5, v0
  v_lshlrev_b32 v41, 3, v41
  v_add_u32 v41, v41, v40
  v_lshlrev_b32 v41, 8, v41
  v_bfe_u32 v42, v0, 4, 1
  v_lshl_add_u32 v41, v42, 5, v41
  v_and_b32 v42, 3, v0
  v_lshl_add_u32 v41, v42, 3, v41
  s_lshr_b32 s41, s22, 1
  s_lshl_b32 s41, s41, 1
  s_add_u32 s42, s41, 0
  v_xor_b32 v42, s42, v40
  v_lshl_add_u32 v12, v42, 6, v41
  v_add_u32 v14, 0x10000, v12
  s_add_u32 s42, s41, 1
  v_xor_b32 v42, s42, v40
  v_lshl_add_u32 v13, v42, 6, v41
  v_add_u32 v15, 0x10000, v13
  s_mul_i32 s45, s22, 151552
  s_mov_b32 s46, s45
  s_add_u32 s47, s45, 75776
  s_lshl_b32 s50, s22, 11
  s_lshl_b32 s51, s22, 12
  s_mul_i32 s52, s22, 20480
  s_add_u32 s52, s52, 0
  s_lshr_b32 s44, s22, 1
  s_lshl_b32 s44, s44, 5
  s_and_b32 s43, s22, 1
  s_lshl_b32 s43, s43, 3
  s_add_u32 s44, s44, s43
  s_add_u32 s44, s44, 0
  s_mul_i32 s56, s44, 1280
  s_mul_i32 s53, s22, 20480
  s_add_u32 s53, s53, 5120
  s_lshr_b32 s44, s22, 1
  s_lshl_b32 s44, s44, 5
  s_and_b32 s43, s22, 1
  s_lshl_b32 s43, s43, 3
  s_add_u32 s44, s44, s43
  s_add_u32 s44, s44, 16
  s_mul_i32 s57, s44, 1280
  s_mul_i32 s54, s22, 20480
  s_add_u32 s54, s54, 10240
  s_lshr_b32 s44, s22, 1
  s_lshl_b32 s44, s44, 5
  s_and_b32 s43, s22, 1
  s_lshl_b32 s43, s43, 3
  s_add_u32 s44, s44, s43
  s_add_u32 s44, s44, 4
  s_mul_i32 s58, s44, 1280
  s_mul_i32 s55, s22, 20480
  s_add_u32 s55, s55, 15360
  s_lshr_b32 s44, s22, 1
  s_lshl_b32 s44, s44, 5
  s_and_b32 s43, s22, 1
  s_lshl_b32 s43, s43, 3
  s_add_u32 s44, s44, s43
  s_add_u32 s44, s44, 20
  s_mul_i32 s59, s44, 1280
  s_mul_i32 s30, s24, 606208
  s_add_u32 s30, s30, 67108864
  s_lshl_b32 s31, s25, 8
  s_mov_b32 s62, s31
  s_mov_b32 s16, s78
  s_and_b32 s17, s79, 0xffff
  s_mov_b32 s18, 819200
  s_mov_b32 s19, 0x20000
  s_add_u32 s44, s30, s46
  s_add_u32 m0, s50, 98304
  buffer_load_dwordx4 v2, s[8:11], s44 offen sc1 lds
  s_add_u32 s44, s30, s47
  s_add_u32 m0, s50, 99328
  buffer_load_dwordx4 v3, s[8:11], s44 offen sc1 lds
  s_add_u32 s44, s31, s52
  s_add_u32 m0, s51, 0
  buffer_load_dwordx4 v4, s[16:19], s44 offen lds
  s_add_u32 s44, s31, s53
  s_add_u32 m0, s51, 1024
  buffer_load_dwordx4 v4, s[16:19], s44 offen lds
  s_add_u32 s44, s31, s54
  s_add_u32 m0, s51, 2048
  buffer_load_dwordx4 v4, s[16:19], s44 offen lds
  s_add_u32 s44, s31, s55
  s_add_u32 m0, s51, 3072
  buffer_load_dwordx4 v4, s[16:19], s44 offen lds
  s_add_u32 s30, s30, 128
  s_add_u32 s31, s31, 81920
  s_add_u32 s44, s30, s46
  s_add_u32 m0, s50, 106496
  buffer_load_dwordx4 v2, s[8:11], s44 offen sc1 lds
  s_add_u32 s44, s30, s47
  s_add_u32 m0, s50, 107520
  buffer_load_dwordx4 v3, s[8:11], s44 offen sc1 lds
  s_add_u32 s44, s31, s52
  s_add_u32 m0, s51, 16384
  buffer_load_dwordx4 v4, s[16:19], s44 offen lds
  s_add_u32 s44, s31, s53
  s_add_u32 m0, s51, 17408
  buffer_load_dwordx4 v4, s[16:19], s44 offen lds
  s_add_u32 s44, s31, s54
  s_add_u32 m0, s51, 18432
  buffer_load_dwordx4 v4, s[16:19], s44 offen lds
  s_add_u32 s44, s31, s55
  s_add_u32 m0, s51, 19456
  buffer_load_dwordx4 v4, s[16:19], s44 offen lds
  s_add_u32 s30, s30, 128
  s_add_u32 s31, s31, 81920
  s_add_u32 s44, s30, s46
  s_add_u32 m0, s50, 114688
  buffer_load_dwordx4 v2, s[8:11], s44 offen sc1 lds
  s_add_u32 s44, s30, s47
  s_add_u32 m0, s50, 115712
  buffer_load_dwordx4 v3, s[8:11], s44 offen sc1 lds
  s_add_u32 s44, s31, s52
  s_add_u32 m0, s51, 32768
  buffer_load_dwordx4 v4, s[16:19], s44 offen lds
  s_add_u32 s44, s31, s53
  s_add_u32 m0, s51, 33792
  buffer_load_dwordx4 v4, s[16:19], s44 offen lds
  s_add_u32 s44, s31, s54
  s_add_u32 m0, s51, 34816
  buffer_load_dwordx4 v4, s[16:19], s44 offen lds
  s_add_u32 s44, s31, s55
  s_add_u32 m0, s51, 35840
  buffer_load_dwordx4 v4, s[16:19], s44 offen lds
  s_add_u32 s30, s30, 128
  s_add_u32 s31, s31, 81920
  s_add_u32 s44, s30, s46
  s_add_u32 m0, s50, 122880
  buffer_load_dwordx4 v2, s[8:11], s44 offen sc1 lds
  s_add_u32 s44, s30, s47
  s_add_u32 m0, s50, 123904
  buffer_load_dwordx4 v3, s[8:11], s44 offen sc1 lds
  s_add_u32 s44, s31, s52
  s_add_u32 m0, s51, 49152
  buffer_load_dwordx4 v4, s[16:19], s44 offen lds
  s_add_u32 s44, s31, s53
  s_add_u32 m0, s51, 50176
  buffer_load_dwordx4 v4, s[16:19], s44 offen lds
  s_add_u32 s44, s31, s54
  s_add_u32 m0, s51, 51200
  buffer_load_dwordx4 v4, s[16:19], s44 offen lds
  s_add_u32 s44, s31, s55
  s_add_u32 m0, s51, 52224
  buffer_load_dwordx4 v4, s[16:19], s44 offen lds
  s_add_u32 s30, s30, 128
  s_add_u32 s31, s31, 81920
  s_add_u32 s44, s30, s46
  s_add_u32 m0, s50, 131072
  buffer_load_dwordx4 v2, s[8:11], s44 offen sc1 lds
  s_add_u32 s44, s30, s47
  s_add_u32 m0, s50, 132096
  buffer_load_dwordx4 v3, s[8:11], s44 offen sc1 lds
  s_add_u32 s44, s31, s52
  s_add_u32 m0, s51, 65536
  buffer_load_dwordx4 v4, s[16:19], s44 offen lds
  s_add_u32 s44, s31, s53
  s_add_u32 m0, s51, 66560
  buffer_load_dwordx4 v4, s[16:19], s44 offen lds
  s_add_u32 s44, s31, s54
  s_add_u32 m0, s51, 67584
  buffer_load_dwordx4 v4, s[16:19], s44 offen lds
  s_add_u32 s44, s31, s55
  s_add_u32 m0, s51, 68608
  buffer_load_dwordx4 v4, s[16:19], s44 offen lds
  s_add_u32 s30, s30, 128
  s_add_u32 s31, s31, 81920
  s_waitcnt vmcnt(24)
  s_barrier
  ds_read_b128 v[16:19], v8 offset:0
  ds_read_b64_tr_b16 v[24:25], v12 offset:0
  ds_read_b64_tr_b16 v[26:27], v12 offset:1024
  ds_read_b64_tr_b16 v[28:29], v13 offset:0
  ds_read_b64_tr_b16 v[30:31], v13 offset:1024
  ds_read_b128 v[20:23], v9 offset:0
  ds_read_b64_tr_b16 v[32:33], v12 offset:4096
  ds_read_b64_tr_b16 v[34:35], v12 offset:5120
  ds_read_b64_tr_b16 v[36:37], v13 offset:4096
  ds_read_b64_tr_b16 v[38:39], v13 offset:5120
  s_waitcnt lgkmcnt(5)
  v_mfma_f32_32x32x16_bf16 v[64:79], v[16:19], v[24:27], 0
  s_add_u32 s44, s30, s46
  s_add_u32 m0, s50, 139264
  buffer_load_dwordx4 v2, s[8:11], s44 offen sc1 lds
  v_mfma_f32_32x32x16_bf16 v[80:95], v[16:19], v[28:31], 0
  s_add_u32 s44, s30, s47
  s_add_u32 m0, s50, 140288
  buffer_load_dwordx4 v3, s[8:11], s44 offen sc1 lds
  ds_read_b128 v[16:19], v10 offset:0
  ds_read_b64_tr_b16 v[24:25], v12 offset:8192
  ds_read_b64_tr_b16 v[26:27], v12 offset:9216
  ds_read_b64_tr_b16 v[28:29], v13 offset:8192
  ds_read_b64_tr_b16 v[30:31], v13 offset:9216
  s_waitcnt lgkmcnt(5)
  v_mfma_f32_32x32x16_bf16 v[64:79], v[20:23], v[32:35], v[64:79]
  s_add_u32 s44, s31, s52
  s_add_u32 m0, s51, 81920
  buffer_load_dwordx4 v4, s[16:19], s44 offen lds
  v_mfma_f32_32x32x16_bf16 v[80:95], v[20:23], v[36:39], v[80:95]
  s_add_u32 s44, s31, s53
  s_add_u32 m0, s51, 82944
  buffer_load_dwordx4 v4, s[16:19], s44 offen lds
  ds_read_b128 v[20:23], v11 offset:0
  ds_read_b64_tr_b16 v[32:33], v12 offset:12288
  ds_read_b64_tr_b16 v[34:35], v12 offset:13312
  ds_read_b64_tr_b16 v[36:37], v13 offset:12288
  ds_read_b64_tr_b16 v[38:39], v13 offset:13312
  s_waitcnt lgkmcnt(5)
  v_mfma_f32_32x32x16_bf16 v[64:79], v[16:19], v[24:27], v[64:79]
  s_add_u32 s44, s31, s54
  s_add_u32 m0, s51, 83968
  buffer_load_dwordx4 v4, s[16:19], s44 offen lds
  v_mfma_f32_32x32x16_bf16 v[80:95], v[16:19], v[28:31], v[80:95]
  s_add_u32 s44, s31, s55
  s_add_u32 m0, s51, 84992
  buffer_load_dwordx4 v4, s[16:19], s44 offen lds
  s_waitcnt lgkmcnt(0)
  v_mfma_f32_32x32x16_bf16 v[64:79], v[20:23], v[32:35], v[64:79]
  s_add_u32 s30, s30, 128
  s_add_u32 s31, s31, 81920
  v_mfma_f32_32x32x16_bf16 v[80:95], v[20:23], v[36:39], v[80:95]
  s_waitcnt vmcnt(24)
  s_barrier
  ds_read_b128 v[16:19], v8 offset:8192
  ds_read_b64_tr_b16 v[24:25], v12 offset:16384
  ds_read_b64_tr_b16 v[26:27], v12 offset:17408
  ds_read_b64_tr_b16 v[28:29], v13 offset:16384
  ds_read_b64_tr_b16 v[30:31], v13 offset:17408
  ds_read_b128 v[20:23], v9 offset:8192
  ds_read_b64_tr_b16 v[32:33], v12 offset:20480
  ds_read_b64_tr_b16 v[34:35], v12 offset:21504
  ds_read_b64_tr_b16 v[36:37], v13 offset:20480
  ds_read_b64_tr_b16 v[38:39], v13 offset:21504
  s_waitcnt lgkmcnt(5)
  v_mfma_f32_32x32x16_bf16 v[64:79], v[16:19], v[24:27], v[64:79]
  s_add_u32 s44, s30, s46
  s_add_u32 m0, s50, 98304
  buffer_load_dwordx4 v2, s[8:11], s44 offen sc1 lds
  v_mfma_f32_32x32x16_bf16 v[80:95], v[16:19], v[28:31], v[80:95]
  s_add_u32 s44, s30, s47
  s_add_u32 m0, s50, 99328
  buffer_load_dwordx4 v3, s[8:11], s44 offen sc1 lds
  ds_read_b128 v[16:19], v10 offset:8192
  ds_read_b64_tr_b16 v[24:25], v12 offset:24576
  ds_read_b64_tr_b16 v[26:27], v12 offset:25600
  ds_read_b64_tr_b16 v[28:29], v13 offset:24576
  ds_read_b64_tr_b16 v[30:31], v13 offset:25600
  s_waitcnt lgkmcnt(5)
  v_mfma_f32_32x32x16_bf16 v[64:79], v[20:23], v[32:35], v[64:79]
  s_add_u32 s44, s31, s52
  s_add_u32 m0, s51, 0
  buffer_load_dwordx4 v4, s[16:19], s44 offen lds
  v_mfma_f32_32x32x16_bf16 v[80:95], v[20:23], v[36:39], v[80:95]
  s_add_u32 s44, s31, s53
  s_add_u32 m0, s51, 1024
  buffer_load_dwordx4 v4, s[16:19], s44 offen lds
  ds_read_b128 v[20:23], v11 offset:8192
  ds_read_b64_tr_b16 v[32:33], v12 offset:28672
  ds_read_b64_tr_b16 v[34:35], v12 offset:29696
  ds_read_b64_tr_b16 v[36:37], v13 offset:28672
  ds_read_b64_tr_b16 v[38:39], v13 offset:29696
  s_waitcnt lgkmcnt(5)
  v_mfma_f32_32x32x16_bf16 v[64:79], v[16:19], v[24:27], v[64:79]
  s_add_u32 s44, s31, s54
  s_add_u32 m0, s51, 2048
  buffer_load_dwordx4 v4, s[16:19], s44 offen lds
  v_mfma_f32_32x32x16_bf16 v[80:95], v[16:19], v[28:31], v[80:95]
  s_add_u32 s44, s31, s55
  s_add_u32 m0, s51, 3072
  buffer_load_dwordx4 v4, s[16:19], s44 offen lds
  s_waitcnt lgkmcnt(0)
  v_mfma_f32_32x32x16_bf16 v[64:79], v[20:23], v[32:35], v[64:79]
  s_add_u32 s30, s30, 128
  s_add_u32 s31, s31, 81920
  v_mfma_f32_32x32x16_bf16 v[80:95], v[20:23], v[36:39], v[80:95]
  s_waitcnt vmcnt(24)
  s_barrier
  ds_read_b128 v[16:19], v8 offset:16384
  ds_read_b64_tr_b16 v[24:25], v12 offset:32768
  ds_read_b64_tr_b16 v[26:27], v12 offset:33792
  ds_read_b64_tr_b16 v[28:29], v13 offset:32768
  ds_read_b64_tr_b16 v[30:31], v13 offset:33792
  ds_read_b128 v[20:23], v9 offset:16384
  ds_read_b64_tr_b16 v[32:33], v12 offset:36864
  ds_read_b64_tr_b16 v[34:35], v12 offset:37888
  ds_read_b64_tr_b16 v[36:37], v13 offset:36864
  ds_read_b64_tr_b16 v[38:39], v13 offset:37888
  s_waitcnt lgkmcnt(5)
  v_mfma_f32_32x32x16_bf16 v[64:79], v[16:19], v[24:27], v[64:79]
  s_add_u32 s44, s30, s46
  s_add_u32 m0, s50, 106496
  buffer_load_dwordx4 v2, s[8:11], s44 offen sc1 lds
  v_mfma_f32_32x32x16_bf16 v[80:95], v[16:19], v[28:31], v[80:95]
  s_add_u32 s44, s30, s47
  s_add_u32 m0, s50, 107520
  buffer_load_dwordx4 v3, s[8:11], s44 offen sc1 lds
  ds_read_b128 v[16:19], v10 offset:16384
  ds_read_b64_tr_b16 v[24:25], v12 offset:40960
  ds_read_b64_tr_b16 v[26:27], v12 offset:41984
  ds_read_b64_tr_b16 v[28:29], v13 offset:40960
  ds_read_b64_tr_b16 v[30:31], v13 offset:41984
  s_waitcnt lgkmcnt(5)
  v_mfma_f32_32x32x16_bf16 v[64:79], v[20:23], v[32:35], v[64:79]
  s_add_u32 s44, s31, s52
  s_add_u32 m0, s51, 16384
  buffer_load_dwordx4 v4, s[16:19], s44 offen lds
  v_mfma_f32_32x32x16_bf16 v[80:95], v[20:23], v[36:39], v[80:95]
  s_add_u32 s44, s31, s53
  s_add_u32 m0, s51, 17408
  buffer_load_dwordx4 v4, s[16:19], s44 offen lds
  ds_read_b128 v[20:23], v11 offset:16384
  ds_read_b64_tr_b16 v[32:33], v12 offset:45056
  ds_read_b64_tr_b16 v[34:35], v12 offset:46080
  ds_read_b64_tr_b16 v[36:37], v13 offset:45056
  ds_read_b64_tr_b16 v[38:39], v13 offset:46080
  s_waitcnt lgkmcnt(5)
  v_mfma_f32_32x32x16_bf16 v[64:79], v[16:19], v[24:27], v[64:79]
  s_add_u32 s44, s31, s54
  s_add_u32 m0, s51, 18432
  buffer_load_dwordx4 v4, s[16:19], s44 offen lds
  v_mfma_f32_32x32x16_bf16 v[80:95], v[16:19], v[28:31], v[80:95]
  s_add_u32 s44, s31, s55
  s_add_u32 m0, s51, 19456
  buffer_load_dwordx4 v4, s[16:19], s44 offen lds
  s_waitcnt lgkmcnt(0)
  v_mfma_f32_32x32x16_bf16 v[64:79], v[20:23], v[32:35], v[64:79]
  s_add_u32 s30, s30, 128
  s_add_u32 s31, s31, 81920
  v_mfma_f32_32x32x16_bf16 v[80:95], v[20:23], v[36:39], v[80:95]
  s_waitcnt vmcnt(24)
  s_barrier
  ds_read_b128 v[16:19], v8 offset:24576
  ds_read_b64_tr_b16 v[24:25], v12 offset:49152
  ds_read_b64_tr_b16 v[26:27], v12 offset:50176
  ds_read_b64_tr_b16 v[28:29], v13 offset:49152
  ds_read_b64_tr_b16 v[30:31], v13 offset:50176
  ds_read_b128 v[20:23], v9 offset:24576
  ds_read_b64_tr_b16 v[32:33], v12 offset:53248
  ds_read_b64_tr_b16 v[34:35], v12 offset:54272
  ds_read_b64_tr_b16 v[36:37], v13 offset:53248
  ds_read_b64_tr_b16 v[38:39], v13 offset:54272
  s_waitcnt lgkmcnt(5)
  v_mfma_f32_32x32x16_bf16 v[64:79], v[16:19], v[24:27], v[64:79]
  s_add_u32 s44, s30, s46
  s_add_u32 m0, s50, 114688
  buffer_load_dwordx4 v2, s[8:11], s44 offen sc1 lds
  v_mfma_f32_32x32x16_bf16 v[80:95], v[16:19], v[28:31], v[80:95]
  s_add_u32 s44, s30, s47
  s_add_u32 m0, s50, 115712
  buffer_load_dwordx4 v3, s[8:11], s44 offen sc1 lds
  ds_read_b128 v[16:19], v10 offset:24576
  ds_read_b64_tr_b16 v[24:25], v12 offset:57344
  ds_read_b64_tr_b16 v[26:27], v12 offset:58368
  ds_read_b64_tr_b16 v[28:29], v13 offset:57344
  ds_read_b64_tr_b16 v[30:31], v13 offset:58368
  s_waitcnt lgkmcnt(5)
  v_mfma_f32_32x32x16_bf16 v[64:79], v[20:23], v[32:35], v[64:79]
  s_add_u32 s44, s31, s52
  s_add_u32 m0, s51, 32768
  buffer_load_dwordx4 v4, s[16:19], s44 offen lds
  v_mfma_f32_32x32x16_bf16 v[80:95], v[20:23], v[36:39], v[80:95]
  s_add_u32 s44, s31, s53
  s_add_u32 m0, s51, 33792
  buffer_load_dwordx4 v4, s[16:19], s44 offen lds
  ds_read_b128 v[20:23], v11 offset:24576
  ds_read_b64_tr_b16 v[32:33], v12 offset:61440
  ds_read_b64_tr_b16 v[34:35], v12 offset:62464
  ds_read_b64_tr_b16 v[36:37], v13 offset:61440
  ds_read_b64_tr_b16 v[38:39], v13 offset:62464
  s_waitcnt lgkmcnt(5)
  v_mfma_f32_32x32x16_bf16 v[64:79], v[16:19], v[24:27], v[64:79]
  s_add_u32 s44, s31, s54
  s_add_u32 m0, s51, 34816
  buffer_load_dwordx4 v4, s[16:19], s44 offen lds
  v_mfma_f32_32x32x16_bf16 v[80:95], v[16:19], v[28:31], v[80:95]
  s_add_u32 s44, s31, s55
  s_add_u32 m0, s51, 35840
  buffer_load_dwordx4 v4, s[16:19], s44 offen lds
  s_waitcnt lgkmcnt(0)
  v_mfma_f32_32x32x16_bf16 v[64:79], v[20:23], v[32:35], v[64:79]
  s_add_u32 s30, s30, 128
  s_add_u32 s31, s31, 81920
  v_mfma_f32_32x32x16_bf16 v[80:95], v[20:23], v[36:39], v[80:95]
  s_waitcnt vmcnt(24)
  s_barrier
  ds_read_b128 v[16:19], v8 offset:32768
  ds_read_b64_tr_b16 v[24:25], v14 offset:0
  ds_read_b64_tr_b16 v[26:27], v14 offset:1024
  ds_read_b64_tr_b16 v[28:29], v15 offset:0
  ds_read_b64_tr_b16 v[30:31], v15 offset:1024
  ds_read_b128 v[20:23], v9 offset:32768
  ds_read_b64_tr_b16 v[32:33], v14 offset:4096
  ds_read_b64_tr_b16 v[34:35], v14 offset:5120
  ds_read_b64_tr_b16 v[36:37], v15 offset:4096
  ds_read_b64_tr_b16 v[38:39], v15 offset:5120
  s_waitcnt lgkmcnt(5)
  v_mfma_f32_32x32x16_bf16 v[64:79], v[16:19], v[24:27], v[64:79]
  s_add_u32 s44, s30, s46
  s_add_u32 m0, s50, 122880
  buffer_load_dwordx4 v2, s[8:11], s44 offen sc1 lds
  v_mfma_f32_32x32x16_bf16 v[80:95], v[16:19], v[28:31], v[80:95]
  s_add_u32 s44, s30, s47
  s_add_u32 m0, s50, 123904
  buffer_load_dwordx4 v3, s[8:11], s44 offen sc1 lds
  ds_read_b128 v[16:19], v10 offset:32768
  ds_read_b64_tr_b16 v[24:25], v14 offset:8192
  ds_read_b64_tr_b16 v[26:27], v14 offset:9216
  ds_read_b64_tr_b16 v[28:29], v15 offset:8192
  ds_read_b64_tr_b16 v[30:31], v15 offset:9216
  s_waitcnt lgkmcnt(5)
  v_mfma_f32_32x32x16_bf16 v[64:79], v[20:23], v[32:35], v[64:79]
  s_add_u32 s44, s31, s52
  s_add_u32 m0, s51, 49152
  buffer_load_dwordx4 v4, s[16:19], s44 offen lds
  v_mfma_f32_32x32x16_bf16 v[80:95], v[20:23], v[36:39], v[80:95]
  s_add_u32 s44, s31, s53
  s_add_u32 m0, s51, 50176
  buffer_load_dwordx4 v4, s[16:19], s44 offen lds
  ds_read_b128 v[20:23], v11 offset:32768
  ds_read_b64_tr_b16 v[32:33], v14 offset:12288
  ds_read_b64_tr_b16 v[34:35], v14 offset:13312
  ds_read_b64_tr_b16 v[36:37], v15 offset:12288
  ds_read_b64_tr_b16 v[38:39], v15 offset:13312
  s_waitcnt lgkmcnt(5)
  v_mfma_f32_32x32x16_bf16 v[64:79], v[16:19], v[24:27], v[64:79]
  s_add_u32 s44, s31, s54
  s_add_u32 m0, s51, 51200
  buffer_load_dwordx4 v4, s[16:19], s44 offen lds
  v_mfma_f32_32x32x16_bf16 v[80:95], v[16:19], v[28:31], v[80:95]
  s_add_u32 s44, s31, s55
  s_add_u32 m0, s51, 52224
  buffer_load_dwordx4 v4, s[16:19], s44 offen lds
  s_waitcnt lgkmcnt(0)
  v_mfma_f32_32x32x16_bf16 v[64:79], v[20:23], v[32:35], v[64:79]
  s_add_u32 s30, s30, 128
  s_mov_b32 s31, s62
  s_mov_b32 s16, s88
  s_and_b32 s17, s89, 0xffff
  s_mov_b32 s18, 5242880
  v_mfma_f32_32x32x16_bf16 v[80:95], v[20:23], v[36:39], v[80:95]
  s_waitcnt vmcnt(24)
  s_barrier
  ds_read_b128 v[16:19], v8 offset:40960
  ds_read_b64_tr_b16 v[24:25], v14 offset:16384
  ds_read_b64_tr_b16 v[26:27], v14 offset:17408
  ds_read_b64_tr_b16 v[28:29], v15 offset:16384
  ds_read_b64_tr_b16 v[30:31], v15 offset:17408
  ds_read_b128 v[20:23], v9 offset:40960
  ds_read_b64_tr_b16 v[32:33], v14 offset:20480
  ds_read_b64_tr_b16 v[34:35], v14 offset:21504
  ds_read_b64_tr_b16 v[36:37], v15 offset:20480
  ds_read_b64_tr_b16 v[38:39], v15 offset:21504
  s_waitcnt lgkmcnt(5)
  v_mfma_f32_32x32x16_bf16 v[64:79], v[16:19], v[24:27], v[64:79]
  s_add_u32 s44, s30, s46
  s_add_u32 m0, s50, 131072
  buffer_load_dwordx4 v2, s[8:11], s44 offen sc1 lds
  v_mfma_f32_32x32x16_bf16 v[80:95], v[16:19], v[28:31], v[80:95]
  s_add_u32 s44, s30, s47
  s_add_u32 m0, s50, 132096
  buffer_load_dwordx4 v3, s[8:11], s44 offen sc1 lds
  ds_read_b128 v[16:19], v10 offset:40960
  ds_read_b64_tr_b16 v[24:25], v14 offset:24576
  ds_read_b64_tr_b16 v[26:27], v14 offset:25600
  ds_read_b64_tr_b16 v[28:29], v15 offset:24576
  ds_read_b64_tr_b16 v[30:31], v15 offset:25600
  s_waitcnt lgkmcnt(5)
  v_mfma_f32_32x32x16_bf16 v[64:79], v[20:23], v[32:35], v[64:79]
  s_add_u32 s44, s31, s56
  s_add_u32 m0, s51, 65536
  buffer_load_dwordx4 v4, s[16:19], s44 offen lds
  v_mfma_f32_32x32x16_bf16 v[80:95], v[20:23], v[36:39], v[80:95]
  s_add_u32 s44, s31, s57
  s_add_u32 m0, s51, 66560
  buffer_load_dwordx4 v4, s[16:19], s44 offen lds
  ds_read_b128 v[20:23], v11 offset:40960
  ds_read_b64_tr_b16 v[32:33], v14 offset:28672
  ds_read_b64_tr_b16 v[34:35], v14 offset:29696
  ds_read_b64_tr_b16 v[36:37], v15 offset:28672
  ds_read_b64_tr_b16 v[38:39], v15 offset:29696
  s_waitcnt lgkmcnt(5)
  v_mfma_f32_32x32x16_bf16 v[64:79], v[16:19], v[24:27], v[64:79]
  s_add_u32 s44, s31, s58
  s_add_u32 m0, s51, 67584
  buffer_load_dwordx4 v4, s[16:19], s44 offen lds
  v_mfma_f32_32x32x16_bf16 v[80:95], v[16:19], v[28:31], v[80:95]
  s_add_u32 s44, s31, s59
  s_add_u32 m0, s51, 68608
  buffer_load_dwordx4 v4, s[16:19], s44 offen lds
  s_waitcnt lgkmcnt(0)
  v_mfma_f32_32x32x16_bf16 v[64:79], v[20:23], v[32:35], v[64:79]
  s_add_u32 s30, s30, 128
  s_add_u32 s31, s31, 81920
  v_mfma_f32_32x32x16_bf16 v[80:95], v[20:23], v[36:39], v[80:95]
  s_waitcnt vmcnt(24)
  s_barrier
  ds_read_b128 v[16:19], v8 offset:0
  ds_read_b64_tr_b16 v[24:25], v12 offset:0
  ds_read_b64_tr_b16 v[26:27], v12 offset:1024
  ds_read_b64_tr_b16 v[28:29], v13 offset:0
  ds_read_b64_tr_b16 v[30:31], v13 offset:1024
  ds_read_b128 v[20:23], v9 offset:0
  ds_read_b64_tr_b16 v[32:33], v12 offset:4096
  ds_read_b64_tr_b16 v[34:35], v12 offset:5120
  ds_read_b64_tr_b16 v[36:37], v13 offset:4096
  ds_read_b64_tr_b16 v[38:39], v13 offset:5120
  s_waitcnt lgkmcnt(5)
  v_mfma_f32_32x32x16_bf16 v[64:79], v[16:19], v[24:27], v[64:79]
  s_add_u32 s44, s30, s46
  s_add_u32 m0, s50, 139264
  buffer_load_dwordx4 v2, s[8:11], s44 offen sc1 lds
  v_mfma_f32_32x32x16_bf16 v[80:95], v[16:19], v[28:31], v[80:95]
  s_add_u32 s44, s30, s47
  s_add_u32 m0, s50, 140288
  buffer_load_dwordx4 v3, s[8:11], s44 offen sc1 lds
  ds_read_b128 v[16:19], v10 offset:0
  ds_read_b64_tr_b16 v[24:25], v12 offset:8192
  ds_read_b64_tr_b16 v[26:27], v12 offset:9216
  ds_read_b64_tr_b16 v[28:29], v13 offset:8192
  ds_read_b64_tr_b16 v[30:31], v13 offset:9216
  s_waitcnt lgkmcnt(5)
  v_mfma_f32_32x32x16_bf16 v[64:79], v[20:23], v[32:35], v[64:79]
  s_add_u32 s44, s31, s56
  s_add_u32 m0, s51, 81920
  buffer_load_dwordx4 v4, s[16:19], s44 offen lds
  v_mfma_f32_32x32x16_bf16 v[80:95], v[20:23], v[36:39], v[80:95]
  s_add_u32 s44, s31, s57
  s_add_u32 m0, s51, 82944
  buffer_load_dwordx4 v4, s[16:19], s44 offen lds
  ds_read_b128 v[20:23], v11 offset:0
  ds_read_b64_tr_b16 v[32:33], v12 offset:12288
  ds_read_b64_tr_b16 v[34:35], v12 offset:13312
  ds_read_b64_tr_b16 v[36:37], v13 offset:12288
  ds_read_b64_tr_b16 v[38:39], v13 offset:13312
  s_waitcnt lgkmcnt(5)
  v_mfma_f32_32x32x16_bf16 v[64:79], v[16:19], v[24:27], v[64:79]
  s_add_u32 s44, s31, s58
  s_add_u32 m0, s51, 83968
  buffer_load_dwordx4 v4, s[16:19], s44 offen lds
  v_mfma_f32_32x32x16_bf16 v[80:95], v[16:19], v[28:31], v[80:95]
  s_add_u32 s44, s31, s59
  s_add_u32 m0, s51, 84992
  buffer_load_dwordx4 v4, s[16:19], s44 offen lds
  s_waitcnt lgkmcnt(0)
  v_mfma_f32_32x32x16_bf16 v[64:79], v[20:23], v[32:35], v[64:79]
  s_add_u32 s30, s30, 128
  s_add_u32 s31, s31, 81920
  v_mfma_f32_32x32x16_bf16 v[80:95], v[20:23], v[36:39], v[80:95]
  s_waitcnt vmcnt(24)
  s_barrier
  ds_read_b128 v[16:19], v8 offset:8192
  ds_read_b64_tr_b16 v[24:25], v12 offset:16384
  ds_read_b64_tr_b16 v[26:27], v12 offset:17408
  ds_read_b64_tr_b16 v[28:29], v13 offset:16384
  ds_read_b64_tr_b16 v[30:31], v13 offset:17408
  ds_read_b128 v[20:23], v9 offset:8192
  ds_read_b64_tr_b16 v[32:33], v12 offset:20480
  ds_read_b64_tr_b16 v[34:35], v12 offset:21504
  ds_read_b64_tr_b16 v[36:37], v13 offset:20480
  ds_read_b64_tr_b16 v[38:39], v13 offset:21504
  s_waitcnt lgkmcnt(5)
  v_mfma_f32_32x32x16_bf16 v[64:79], v[16:19], v[24:27], v[64:79]
  s_add_u32 s44, s30, s46
  s_add_u32 m0, s50, 98304
  buffer_load_dwordx4 v2, s[8:11], s44 offen sc1 lds
  v_mfma_f32_32x32x16_bf16 v[80:95], v[16:19], v[28:31], v[80:95]
  s_add_u32 s44, s30, s47
  s_add_u32 m0, s50, 99328
  buffer_load_dwordx4 v3, s[8:11], s44 offen sc1 lds
  ds_read_b128 v[16:19], v10 offset:8192
  ds_read_b64_tr_b16 v[24:25], v12 offset:24576
  ds_read_b64_tr_b16 v[26:27], v12 offset:25600
  ds_read_b64_tr_b16 v[28:29], v13 offset:24576
  ds_read_b64_tr_b16 v[30:31], v13 offset:25600
  s_waitcnt lgkmcnt(5)
  v_mfma_f32_32x32x16_bf16 v[64:79], v[20:23], v[32:35], v[64:79]
  s_add_u32 s44, s31, s56
  s_add_u32 m0, s51, 0
  buffer_load_dwordx4 v4, s[16:19], s44 offen lds
  v_mfma_f32_32x32x16_bf16 v[80:95], v[20:23], v[36:39], v[80:95]
  s_add_u32 s44, s31, s57
  s_add_u32 m0, s51, 1024
  buffer_load_dwordx4 v4, s[16:19], s44 offen lds
  ds_read_b128 v[20:23], v11 offset:8192
  ds_read_b64_tr_b16 v[32:33], v12 offset:28672
  ds_read_b64_tr_b16 v[34:35], v12 offset:29696
  ds_read_b64_tr_b16 v[36:37], v13 offset:28672
  ds_read_b64_tr_b16 v[38:39], v13 offset:29696
  s_waitcnt lgkmcnt(5)
  v_mfma_f32_32x32x16_bf16 v[64:79], v[16:19], v[24:27], v[64:79]
  s_add_u32 s44, s31, s58
  s_add_u32 m0, s51, 2048
  buffer_load_dwordx4 v4, s[16:19], s44 offen lds
  v_mfma_f32_32x32x16_bf16 v[80:95], v[16:19], v[28:31], v[80:95]
  s_add_u32 s44, s31, s59
  s_add_u32 m0, s51, 3072
  buffer_load_dwordx4 v4, s[16:19], s44 offen lds
  s_waitcnt lgkmcnt(0)
  v_mfma_f32_32x32x16_bf16 v[64:79], v[20:23], v[32:35], v[64:79]
  s_add_u32 s30, s30, 128
  s_add_u32 s31, s31, 81920
  v_mfma_f32_32x32x16_bf16 v[80:95], v[20:23], v[36:39], v[80:95]
  s_mov_b32 s63, 10
JO_loop:
  s_waitcnt vmcnt(24)
  s_barrier
  ds_read_b128 v[16:19], v8 offset:16384
  ds_read_b64_tr_b16 v[24:25], v12 offset:32768
  ds_read_b64_tr_b16 v[26:27], v12 offset:33792
  ds_read_b64_tr_b16 v[28:29], v13 offset:32768
  ds_read_b64_tr_b16 v[30:31], v13 offset:33792
  ds_read_b128 v[20:23], v9 offset:16384
  ds_read_b64_tr_b16 v[32:33], v12 offset:36864
  ds_read_b64_tr_b16 v[34:35], v12 offset:37888
  ds_read_b64_tr_b16 v[36:37], v13 offset:36864
  ds_read_b64_tr_b16 v[38:39], v13 offset:37888
  s_waitcnt lgkmcnt(5)
  v_mfma_f32_32x32x16_bf16 v[64:79], v[16:19], v[24:27], v[64:79]
  s_add_u32 s44, s30, s46
  s_add_u32 m0, s50, 106496
  buffer_load_dwordx4 v2, s[8:11], s44 offen sc1 lds
  v_mfma_f32_32x32x16_bf16 v[80:95], v[16:19], v[28:31], v[80:95]
  s_add_u32 s44, s30, s47
  s_add_u32 m0, s50, 107520
  buffer_load_dwordx4 v3, s[8:11], s44 offen sc1 lds
  ds_read_b128 v[16:19], v10 offset:16384
  ds_read_b64_tr_b16 v[24:25], v12 offset:40960
  ds_read_b64_tr_b16 v[26:27], v12 offset:41984
  ds_read_b64_tr_b16 v[28:29], v13 offset:40960
  ds_read_b64_tr_b16 v[30:31], v13 offset:41984
  s_waitcnt lgkmcnt(5)
  v_mfma_f32_32x32x16_bf16 v[64:79], v[20:23], v[32:35], v[64:79]
  s_add_u32 s44, s31, s56
  s_add_u32 m0, s51, 16384
  buffer_load_dwordx4 v4, s[16:19], s44 offen lds
  v_mfma_f32_32x32x16_bf16 v[80:95], v[20:23], v[36:39], v[80:95]
  s_add_u32 s44, s31, s57
  s_add_u32 m0, s51, 17408
  buffer_load_dwordx4 v4, s[16:19], s44 offen lds
  ds_read_b128 v[20:23], v11 offset:16384
  ds_read_b64_tr_b16 v[32:33], v12 offset:45056
  ds_read_b64_tr_b16 v[34:35], v12 offset:46080
  ds_read_b64_tr_b16 v[36:37], v13 offset:45056
  ds_read_b64_tr_b16 v[38:39], v13 offset:46080
  s_waitcnt lgkmcnt(5)
  v_mfma_f32_32x32x16_bf16 v[64:79], v[16:19], v[24:27], v[64:79]
  s_add_u32 s44, s31, s58
  s_add_u32 m0, s51, 18432
  buffer_load_dwordx4 v4, s[16:19], s44 offen lds
  v_mfma_f32_32x32x16_bf16 v[80:95], v[16:19], v[28:31], v[80:95]
  s_add_u32 s44, s31, s59
  s_add_u32 m0, s51, 19456
  buffer_load_dwordx4 v4, s[16:19], s44 offen lds
  s_waitcnt lgkmcnt(0)
  v_mfma_f32_32x32x16_bf16 v[64:79], v[20:23], v[32:35], v[64:79]
  s_add_u32 s30, s30, 128
  s_add_u32 s31, s31, 81920
  v_mfma_f32_32x32x16_bf16 v[80:95], v[20:23], v[36:39], v[80:95]
  s_waitcnt vmcnt(24)
  s_barrier
  ds_read_b128 v[16:19], v8 offset:24576
  ds_read_b64_tr_b16 v[24:25], v12 offset:49152
  ds_read_b64_tr_b16 v[26:27], v12 offset:50176
  ds_read_b64_tr_b16 v[28:29], v13 offset:49152
  ds_read_b64_tr_b16 v[30:31], v13 offset:50176
  ds_read_b128 v[20:23], v9 offset:24576
  ds_read_b64_tr_b16 v[32:33], v12 offset:53248
  ds_read_b64_tr_b16 v[34:35], v12 offset:54272
  ds_read_b64_tr_b16 v[36:37], v13 offset:53248
  ds_read_b64_tr_b16 v[38:39], v13 offset:54272
  s_waitcnt lgkmcnt(5)
  v_mfma_f32_32x32x16_bf16 v[64:79], v[16:19], v[24:27], v[64:79]
  s_add_u32 s44, s30, s46
  s_add_u32 m0, s50, 114688
  buffer_load_dwordx4 v2, s[8:11], s44 offen sc1 lds
  v_mfma_f32_32x32x16_bf16 v[80:95], v[16:19], v[28:31], v[80:95]
  s_add_u32 s44, s30, s47
  s_add_u32 m0, s50, 115712
  buffer_load_dwordx4 v3, s[8:11], s44 offen sc1 lds
  ds_read_b128 v[16:19], v10 offset:24576
  ds_read_b64_tr_b16 v[24:25], v12 offset:57344
  ds_read_b64_tr_b16 v[26:27], v12 offset:58368
  ds_read_b64_tr_b16 v[28:29], v13 offset:57344
  ds_read_b64_tr_b16 v[30:31], v13 offset:58368
  s_waitcnt lgkmcnt(5)
  v_mfma_f32_32x32x16_bf16 v[64:79], v[20:23], v[32:35], v[64:79]
  s_add_u32 s44, s31, s56
  s_add_u32 m0, s51, 32768
  buffer_load_dwordx4 v4, s[16:19], s44 offen lds
  v_mfma_f32_32x32x16_bf16 v[80:95], v[20:23], v[36:39], v[80:95]
  s_add_u32 s44, s31, s57
  s_add_u32 m0, s51, 33792
  buffer_load_dwordx4 v4, s[16:19], s44 offen lds
  ds_read_b128 v[20:23], v11 offset:24576
  ds_read_b64_tr_b16 v[32:33], v12 offset:61440
  ds_read_b64_tr_b16 v[34:35], v12 offset:62464
  ds_read_b64_tr_b16 v[36:37], v13 offset:61440
  ds_read_b64_tr_b16 v[38:39], v13 offset:62464
  s_waitcnt lgkmcnt(5)
  v_mfma_f32_32x32x16_bf16 v[64:79], v[16:19], v[24:27], v[64:79]
  s_add_u32 s44, s31, s58
  s_add_u32 m0, s51, 34816
  buffer_load_dwordx4 v4, s[16:19], s44 offen lds
  v_mfma_f32_32x32x16_bf16 v[80:95], v[16:19], v[28:31], v[80:95]
  s_add_u32 s44, s31, s59
  s_add_u32 m0, s51, 35840
  buffer_load_dwordx4 v4, s[16:19], s44 offen lds
  s_waitcnt lgkmcnt(0)
  v_mfma_f32_32x32x16_bf16 v[64:79], v[20:23], v[32:35], v[64:79]
  s_add_u32 s30, s30, 128
  s_add_u32 s31, s31, 81920
  v_mfma_f32_32x32x16_bf16 v[80:95], v[20:23], v[36:39], v[80:95]
  s_waitcnt vmcnt(24)
  s_barrier
  ds_read_b128 v[16:19], v8 offset:32768
  ds_read_b64_tr_b16 v[24:25], v14 offset:0
  ds_read_b64_tr_b16 v[26:27], v14 offset:1024
  ds_read_b64_tr_b16 v[28:29], v15 offset:0
  ds_read_b64_tr_b16 v[30:31], v15 offset:1024
  ds_read_b128 v[20:23], v9 offset:32768
  ds_read_b64_tr_b16 v[32:33], v14 offset:4096
  ds_read_b64_tr_b16 v[34:35], v14 offset:5120
  ds_read_b64_tr_b16 v[36:37], v15 offset:4096
  ds_read_b64_tr_b16 v[38:39], v15 offset:5120
  s_waitcnt lgkmcnt(5)
  v_mfma_f32_32x32x16_bf16 v[64:79], v[16:19], v[24:27], v[64:79]
  s_add_u32 s44, s30, s46
  s_add_u32 m0, s50, 122880
  buffer_load_dwordx4 v2, s[8:11], s44 offen sc1 lds
  v_mfma_f32_32x32x16_bf16 v[80:95], v[16:19], v[28:31], v[80:95]
  s_add_u32 s44, s30, s47
  s_add_u32 m0, s50, 123904
  buffer_load_dwordx4 v3, s[8:11], s44 offen sc1 lds
  ds_read_b128 v[16:19], v10 offset:32768
  ds_read_b64_tr_b16 v[24:25], v14 offset:8192
  ds_read_b64_tr_b16 v[26:27], v14 offset:9216
  ds_read_b64_tr_b16 v[28:29], v15 offset:8192
  ds_read_b64_tr_b16 v[30:31], v15 offset:9216
  s_waitcnt lgkmcnt(5)
  v_mfma_f32_32x32x16_bf16 v[64:79], v[20:23], v[32:35], v[64:79]
  s_add_u32 s44, s31, s56
  s_add_u32 m0, s51, 49152
  buffer_load_dwordx4 v4, s[16:19], s44 offen lds
  v_mfma_f32_32x32x16_bf16 v[80:95], v[20:23], v[36:39], v[80:95]
  s_add_u32 s44, s31, s57
  s_add_u32 m0, s51, 50176
  buffer_load_dwordx4 v4, s[16:19], s44 offen lds
  ds_read_b128 v[20:23], v11 offset:32768
  ds_read_b64_tr_b16 v[32:33], v14 offset:12288
  ds_read_b64_tr_b16 v[34:35], v14 offset:13312
  ds_read_b64_tr_b16 v[36:37], v15 offset:12288
  ds_read_b64_tr_b16 v[38:39], v15 offset:13312
  s_waitcnt lgkmcnt(5)
  v_mfma_f32_32x32x16_bf16 v[64:79], v[16:19], v[24:27], v[64:79]
  s_add_u32 s44, s31, s58
  s_add_u32 m0, s51, 51200
  buffer_load_dwordx4 v4, s[16:19], s44 offen lds
  v_mfma_f32_32x32x16_bf16 v[80:95], v[16:19], v[28:31], v[80:95]
  s_add_u32 s44, s31, s59
  s_add_u32 m0, s51, 52224
  buffer_load_dwordx4 v4, s[16:19], s44 offen lds
  s_waitcnt lgkmcnt(0)
  v_mfma_f32_32x32x16_bf16 v[64:79], v[20:23], v[32:35], v[64:79]
  s_add_u32 s30, s30, 128
  s_add_u32 s31, s31, 81920
  v_mfma_f32_32x32x16_bf16 v[80:95], v[20:23], v[36:39], v[80:95]
  s_waitcnt vmcnt(24)
  s_barrier
  ds_read_b128 v[16:19], v8 offset:40960
  ds_read_b64_tr_b16 v[24:25], v14 offset:16384
  ds_read_b64_tr_b16 v[26:27], v14 offset:17408
  ds_read_b64_tr_b16 v[28:29], v15 offset:16384
  ds_read_b64_tr_b16 v[30:31], v15 offset:17408
  ds_read_b128 v[20:23], v9 offset:40960
  ds_read_b64_tr_b16 v[32:33], v14 offset:20480
  ds_read_b64_tr_b16 v[34:35], v14 offset:21504
  ds_read_b64_tr_b16 v[36:37], v15 offset:20480
  ds_read_b64_tr_b16 v[38:39], v15 offset:21504
  s_waitcnt lgkmcnt(5)
  v_mfma_f32_32x32x16_bf16 v[64:79], v[16:19], v[24:27], v[64:79]
  s_add_u32 s44, s30, s46
  s_add_u32 m0, s50, 131072
  buffer_load_dwordx4 v2, s[8:11], s44 offen sc1 lds
  v_mfma_f32_32x32x16_bf16 v[80:95], v[16:19], v[28:31], v[80:95]
  s_add_u32 s44, s30, s47
  s_add_u32 m0, s50, 132096
  buffer_load_dwordx4 v3, s[8:11], s44 offen sc1 lds
  ds_read_b128 v[16:19], v10 offset:40960
  ds_read_b64_tr_b16 v[24:25], v14 offset:24576
  ds_read_b64_tr_b16 v[26:27], v14 offset:25600
  ds_read_b64_tr_b16 v[28:29], v15 offset:24576
  ds_read_b64_tr_b16 v[30:31], v15 offset:25600
  s_waitcnt lgkmcnt(5)
  v_mfma_f32_32x32x16_bf16 v[64:79], v[20:23], v[32:35], v[64:79]
  s_add_u32 s44, s31, s56
  s_add_u32 m0, s51, 65536
  buffer_load_dwordx4 v4, s[16:19], s44 offen lds
  v_mfma_f32_32x32x16_bf16 v[80:95], v[20:23], v[36:39], v[80:95]
  s_add_u32 s44, s31, s57
  s_add_u32 m0, s51, 66560
  buffer_load_dwordx4 v4, s[16:19], s44 offen lds
  ds_read_b128 v[20:23], v11 offset:40960
  ds_read_b64_tr_b16 v[32:33], v14 offset:28672
  ds_read_b64_tr_b16 v[34:35], v14 offset:29696
  ds_read_b64_tr_b16 v[36:37], v15 offset:28672
  ds_read_b64_tr_b16 v[38:39], v15 offset:29696
  s_waitcnt lgkmcnt(5)
  v_mfma_f32_32x32x16_bf16 v[64:79], v[16:19], v[24:27], v[64:79]
  s_add_u32 s44, s31, s58
  s_add_u32 m0, s51, 67584
  buffer_load_dwordx4 v4, s[16:19], s44 offen lds
  v_mfma_f32_32x32x16_bf16 v[80:95], v[16:19], v[28:31], v[80:95]
  s_add_u32 s44, s31, s59
  s_add_u32 m0, s51, 68608
  buffer_load_dwordx4 v4, s[16:19], s44 offen lds
  s_waitcnt lgkmcnt(0)
  v_mfma_f32_32x32x16_bf16 v[64:79], v[20:23], v[32:35], v[64:79]
  s_add_u32 s30, s30, 128
  s_add_u32 s31, s31, 81920
  v_mfma_f32_32x32x16_bf16 v[80:95], v[20:23], v[36:39], v[80:95]
  s_waitcnt vmcnt(24)
  s_barrier
  ds_read_b128 v[16:19], v8 offset:0
  ds_read_b64_tr_b16 v[24:25], v12 offset:0
  ds_read_b64_tr_b16 v[26:27], v12 offset:1024
  ds_read_b64_tr_b16 v[28:29], v13 offset:0
  ds_read_b64_tr_b16 v[30:31], v13 offset:1024
  ds_read_b128 v[20:23], v9 offset:0
  ds_read_b64_tr_b16 v[32:33], v12 offset:4096
  ds_read_b64_tr_b16 v[34:35], v12 offset:5120
  ds_read_b64_tr_b16 v[36:37], v13 offset:4096
  ds_read_b64_tr_b16 v[38:39], v13 offset:5120
  s_waitcnt lgkmcnt(5)
  v_mfma_f32_32x32x16_bf16 v[64:79], v[16:19], v[24:27], v[64:79]
  s_add_u32 s44, s30, s46
  s_add_u32 m0, s50, 139264
  buffer_load_dwordx4 v2, s[8:11], s44 offen sc1 lds
  v_mfma_f32_32x32x16_bf16 v[80:95], v[16:19], v[28:31], v[80:95]
  s_add_u32 s44, s30, s47
  s_add_u32 m0, s50, 140288
  buffer_load_dwordx4 v3, s[8:11], s44 offen sc1 lds
  ds_read_b128 v[16:19], v10 offset:0
  ds_read_b64_tr_b16 v[24:25], v12 offset:8192
  ds_read_b64_tr_b16 v[26:27], v12 offset:9216
  ds_read_b64_tr_b16 v[28:29], v13 offset:8192
  ds_read_b64_tr_b16 v[30:31], v13 offset:9216
  s_waitcnt lgkmcnt(5)
  v_mfma_f32_32x32x16_bf16 v[64:79], v[20:23], v[32:35], v[64:79]
  s_add_u32 s44, s31, s56
  s_add_u32 m0, s51, 81920
  buffer_load_dwordx4 v4, s[16:19], s44 offen lds
  v_mfma_f32_32x32x16_bf16 v[80:95], v[20:23], v[36:39], v[80:95]
  s_add_u32 s44, s31, s57
  s_add_u32 m0, s51, 82944
  buffer_load_dwordx4 v4, s[16:19], s44 offen lds
  ds_read_b128 v[20:23], v11 offset:0
  ds_read_b64_tr_b16 v[32:33], v12 offset:12288
  ds_read_b64_tr_b16 v[34:35], v12 offset:13312
  ds_read_b64_tr_b16 v[36:37], v13 offset:12288
  ds_read_b64_tr_b16 v[38:39], v13 offset:13312
  s_waitcnt lgkmcnt(5)
  v_mfma_f32_32x32x16_bf16 v[64:79], v[16:19], v[24:27], v[64:79]
  s_add_u32 s44, s31, s58
  s_add_u32 m0, s51, 83968
  buffer_load_dwordx4 v4, s[16:19], s44 offen lds
  v_mfma_f32_32x32x16_bf16 v[80:95], v[16:19], v[28:31], v[80:95]
  s_add_u32 s44, s31, s59
  s_add_u32 m0, s51, 84992
  buffer_load_dwordx4 v4, s[16:19], s44 offen lds
  s_waitcnt lgkmcnt(0)
  v_mfma_f32_32x32x16_bf16 v[64:79], v[20:23], v[32:35], v[64:79]
  s_add_u32 s30, s30, 128
  s_add_u32 s31, s31, 81920
  v_mfma_f32_32x32x16_bf16 v[80:95], v[20:23], v[36:39], v[80:95]
  s_waitcnt vmcnt(24)
  s_barrier
  ds_read_b128 v[16:19], v8 offset:8192
  ds_read_b64_tr_b16 v[24:25], v12 offset:16384
  ds_read_b64_tr_b16 v[26:27], v12 offset:17408
  ds_read_b64_tr_b16 v[28:29], v13 offset:16384
  ds_read_b64_tr_b16 v[30:31], v13 offset:17408
  ds_read_b128 v[20:23], v9 offset:8192
  ds_read_b64_tr_b16 v[32:33], v12 offset:20480
  ds_read_b64_tr_b16 v[34:35], v12 offset:21504
  ds_read_b64_tr_b16 v[36:37], v13 offset:20480
  ds_read_b64_tr_b16 v[38:39], v13 offset:21504
  s_waitcnt lgkmcnt(5)
  v_mfma_f32_32x32x16_bf16 v[64:79], v[16:19], v[24:27], v[64:79]
  s_add_u32 s44, s30, s46
  s_add_u32 m0, s50, 98304
  buffer_load_dwordx4 v2, s[8:11], s44 offen sc1 lds
  v_mfma_f32_32x32x16_bf16 v[80:95], v[16:19], v[28:31], v[80:95]
  s_add_u32 s44, s30, s47
  s_add_u32 m0, s50, 99328
  buffer_load_dwordx4 v3, s[8:11], s44 offen sc1 lds
  ds_read_b128 v[16:19], v10 offset:8192
  ds_read_b64_tr_b16 v[24:25], v12 offset:24576
  ds_read_b64_tr_b16 v[26:27], v12 offset:25600
  ds_read_b64_tr_b16 v[28:29], v13 offset:24576
  ds_read_b64_tr_b16 v[30:31], v13 offset:25600
  s_waitcnt lgkmcnt(5)
  v_mfma_f32_32x32x16_bf16 v[64:79], v[20:23], v[32:35], v[64:79]
  s_add_u32 s44, s31, s56
  s_add_u32 m0, s51, 0
  buffer_load_dwordx4 v4, s[16:19], s44 offen lds
  v_mfma_f32_32x32x16_bf16 v[80:95], v[20:23], v[36:39], v[80:95]
  s_add_u32 s44, s31, s57
  s_add_u32 m0, s51, 1024
  buffer_load_dwordx4 v4, s[16:19], s44 offen lds
  ds_read_b128 v[20:23], v11 offset:8192
  ds_read_b64_tr_b16 v[32:33], v12 offset:28672
  ds_read_b64_tr_b16 v[34:35], v12 offset:29696
  ds_read_b64_tr_b16 v[36:37], v13 offset:28672
  ds_read_b64_tr_b16 v[38:39], v13 offset:29696
  s_waitcnt lgkmcnt(5)
  v_mfma_f32_32x32x16_bf16 v[64:79], v[16:19], v[24:27], v[64:79]
  s_add_u32 s44, s31, s58
  s_add_u32 m0, s51, 2048
  buffer_load_dwordx4 v4, s[16:19], s44 offen lds
  v_mfma_f32_32x32x16_bf16 v[80:95], v[16:19], v[28:31], v[80:95]
  s_add_u32 s44, s31, s59
  s_add_u32 m0, s51, 3072
  buffer_load_dwordx4 v4, s[16:19], s44 offen lds
  s_waitcnt lgkmcnt(0)
  v_mfma_f32_32x32x16_bf16 v[64:79], v[20:23], v[32:35], v[64:79]
  s_add_u32 s30, s30, 128
  s_add_u32 s31, s31, 81920
  v_mfma_f32_32x32x16_bf16 v[80:95], v[20:23], v[36:39], v[80:95]
  s_sub_u32 s63, s63, 1
  s_cmp_lg_u32 s63, 0
  s_cbranch_scc1 JO_loop
  s_waitcnt vmcnt(24)
  s_barrier
  ds_read_b128 v[16:19], v8 offset:16384
  ds_read_b64_tr_b16 v[24:25], v12 offset:32768
  ds_read_b64_tr_b16 v[26:27], v12 offset:33792
  ds_read_b64_tr_b16 v[28:29], v13 offset:32768
  ds_read_b64_tr_b16 v[30:31], v13 offset:33792
  ds_read_b128 v[20:23], v9 offset:16384
  ds_read_b64_tr_b16 v[32:33], v12 offset:36864
  ds_read_b64_tr_b16 v[34:35], v12 offset:37888
  ds_read_b64_tr_b16 v[36:37], v13 offset:36864
  ds_read_b64_tr_b16 v[38:39], v13 offset:37888
  s_waitcnt lgkmcnt(5)
  v_mfma_f32_32x32x16_bf16 v[64:79], v[16:19], v[24:27], v[64:79]
  s_add_u32 s44, s30, s46
  s_add_u32 m0, s50, 106496
  buffer_load_dwordx4 v2, s[8:11], s44 offen sc1 lds
  v_mfma_f32_32x32x16_bf16 v[80:95], v[16:19], v[28:31], v[80:95]
  s_add_u32 s44, s30, s47
  s_add_u32 m0, s50, 107520
  buffer_load_dwordx4 v3, s[8:11], s44 offen sc1 lds
  ds_read_b128 v[16:19], v10 offset:16384
  ds_read_b64_tr_b16 v[24:25], v12 offset:40960
  ds_read_b64_tr_b16 v[26:27], v12 offset:41984
  ds_read_b64_tr_b16 v[28:29], v13 offset:40960
  ds_read_b64_tr_b16 v[30:31], v13 offset:41984
  s_waitcnt lgkmcnt(5)
  v_mfma_f32_32x32x16_bf16 v[64:79], v[20:23], v[32:35], v[64:79]
  s_add_u32 s44, s31, s56
  s_add_u32 m0, s51, 16384
  buffer_load_dwordx4 v4, s[16:19], s44 offen lds
  v_mfma_f32_32x32x16_bf16 v[80:95], v[20:23], v[36:39], v[80:95]
  s_add_u32 s44, s31, s57
  s_add_u32 m0, s51, 17408
  buffer_load_dwordx4 v4, s[16:19], s44 offen lds
  ds_read_b128 v[20:23], v11 offset:16384
  ds_read_b64_tr_b16 v[32:33], v12 offset:45056
  ds_read_b64_tr_b16 v[34:35], v12 offset:46080
  ds_read_b64_tr_b16 v[36:37], v13 offset:45056
  ds_read_b64_tr_b16 v[38:39], v13 offset:46080
  s_waitcnt lgkmcnt(5)
  v_mfma_f32_32x32x16_bf16 v[64:79], v[16:19], v[24:27], v[64:79]
  s_add_u32 s44, s31, s58
  s_add_u32 m0, s51, 18432
  buffer_load_dwordx4 v4, s[16:19], s44 offen lds
  v_mfma_f32_32x32x16_bf16 v[80:95], v[16:19], v[28:31], v[80:95]
  s_add_u32 s44, s31, s59
  s_add_u32 m0, s51, 19456
  buffer_load_dwordx4 v4, s[16:19], s44 offen lds
  s_waitcnt lgkmcnt(0)
  v_mfma_f32_32x32x16_bf16 v[64:79], v[20:23], v[32:35], v[64:79]
  s_add_u32 s30, s30, 128
  s_add_u32 s31, s31, 81920
  v_mfma_f32_32x32x16_bf16 v[80:95], v[20:23], v[36:39], v[80:95]
  s_waitcnt vmcnt(24)
  s_barrier
  ds_read_b128 v[16:19], v8 offset:24576
  ds_read_b64_tr_b16 v[24:25], v12 offset:49152
  ds_read_b64_tr_b16 v[26:27], v12 offset:50176
  ds_read_b64_tr_b16 v[28:29], v13 offset:49152
  ds_read_b64_tr_b16 v[30:31], v13 offset:50176
  ds_read_b128 v[20:23], v9 offset:24576
  ds_read_b64_tr_b16 v[32:33], v12 offset:53248
  ds_read_b64_tr_b16 v[34:35], v12 offset:54272
  ds_read_b64_tr_b16 v[36:37], v13 offset:53248
  ds_read_b64_tr_b16 v[38:39], v13 offset:54272
  s_waitcnt lgkmcnt(5)
  v_mfma_f32_32x32x16_bf16 v[64:79], v[16:19], v[24:27], v[64:79]
  v_mfma_f32_32x32x16_bf16 v[80:95], v[16:19], v[28:31], v[80:95]
  ds_read_b128 v[16:19], v10 offset:24576
  ds_read_b64_tr_b16 v[24:25], v12 offset:57344
  ds_read_b64_tr_b16 v[26:27], v12 offset:58368
  ds_read_b64_tr_b16 v[28:29], v13 offset:57344
  ds_read_b64_tr_b16 v[30:31], v13 offset:58368
  s_waitcnt lgkmcnt(5)
  v_mfma_f32_32x32x16_bf16 v[64:79], v[20:23], v[32:35], v[64:79]
  v_mfma_f32_32x32x16_bf16 v[80:95], v[20:23], v[36:39], v[80:95]
  ds_read_b128 v[20:23], v11 offset:24576
  ds_read_b64_tr_b16 v[32:33], v12 offset:61440
  ds_read_b64_tr_b16 v[34:35], v12 offset:62464
  ds_read_b64_tr_b16 v[36:37], v13 offset:61440
  ds_read_b64_tr_b16 v[38:39], v13 offset:62464
  s_waitcnt lgkmcnt(5)
  v_mfma_f32_32x32x16_bf16 v[64:79], v[16:19], v[24:27], v[64:79]
  v_mfma_f32_32x32x16_bf16 v[80:95], v[16:19], v[28:31], v[80:95]
  s_waitcnt lgkmcnt(0)
  v_mfma_f32_32x32x16_bf16 v[64:79], v[20:23], v[32:35], v[64:79]
  v_mfma_f32_32x32x16_bf16 v[80:95], v[20:23], v[36:39], v[80:95]
  s_waitcnt vmcnt(18)
  s_barrier
  ds_read_b128 v[16:19], v8 offset:32768
  ds_read_b64_tr_b16 v[24:25], v14 offset:0
  ds_read_b64_tr_b16 v[26:27], v14 offset:1024
  ds_read_b64_tr_b16 v[28:29], v15 offset:0
  ds_read_b64_tr_b16 v[30:31], v15 offset:1024
  ds_read_b128 v[20:23], v9 offset:32768
  ds_read_b64_tr_b16 v[32:33], v14 offset:4096
  ds_read_b64_tr_b16 v[34:35], v14 offset:5120
  ds_read_b64_tr_b16 v[36:37], v15 offset:4096
  ds_read_b64_tr_b16 v[38:39], v15 offset:5120
  s_waitcnt lgkmcnt(5)
  v_mfma_f32_32x32x16_bf16 v[64:79], v[16:19], v[24:27], v[64:79]
  v_mfma_f32_32x32x16_bf16 v[80:95], v[16:19], v[28:31], v[80:95]
  ds_read_b128 v[16:19], v10 offset:32768
  ds_read_b64_tr_b16 v[24:25], v14 offset:8192
  ds_read_b64_tr_b16 v[26:27], v14 offset:9216
  ds_read_b64_tr_b16 v[28:29], v15 offset:8192
  ds_read_b64_tr_b16 v[30:31], v15 offset:9216
  s_waitcnt lgkmcnt(5)
  v_mfma_f32_32x32x16_bf16 v[64:79], v[20:23], v[32:35], v[64:79]
  v_mfma_f32_32x32x16_bf16 v[80:95], v[20:23], v[36:39], v[80:95]
  ds_read_b128 v[20:23], v11 offset:32768
  ds_read_b64_tr_b16 v[32:33], v14 offset:12288
  ds_read_b64_tr_b16 v[34:35], v14 offset:13312
  ds_read_b64_tr_b16 v[36:37], v15 offset:12288
  ds_read_b64_tr_b16 v[38:39], v15 offset:13312
  s_waitcnt lgkmcnt(5)
  v_mfma_f32_32x32x16_bf16 v[64:79], v[16:19], v[24:27], v[64:79]
  v_mfma_f32_32x32x16_bf16 v[80:95], v[16:19], v[28:31], v[80:95]
  s_waitcnt lgkmcnt(0)
  v_mfma_f32_32x32x16_bf16 v[64:79], v[20:23], v[32:35], v[64:79]
  v_mfma_f32_32x32x16_bf16 v[80:95], v[20:23], v[36:39], v[80:95]
  s_waitcnt vmcnt(12)
  s_barrier
  ds_read_b128 v[16:19], v8 offset:40960
  ds_read_b64_tr_b16 v[24:25], v14 offset:16384
  ds_read_b64_tr_b16 v[26:27], v14 offset:17408
  ds_read_b64_tr_b16 v[28:29], v15 offset:16384
  ds_read_b64_tr_b16 v[30:31], v15 offset:17408
  ds_read_b128 v[20:23], v9 offset:40960
  ds_read_b64_tr_b16 v[32:33], v14 offset:20480
  ds_read_b64_tr_b16 v[34:35], v14 offset:21504
  ds_read_b64_tr_b16 v[36:37], v15 offset:20480
  ds_read_b64_tr_b16 v[38:39], v15 offset:21504
  s_waitcnt lgkmcnt(5)
  v_mfma_f32_32x32x16_bf16 v[64:79], v[16:19], v[24:27], v[64:79]
  v_mfma_f32_32x32x16_bf16 v[80:95], v[16:19], v[28:31], v[80:95]
  ds_read_b128 v[16:19], v10 offset:40960
  ds_read_b64_tr_b16 v[24:25], v14 offset:24576
  ds_read_b64_tr_b16 v[26:27], v14 offset:25600
  ds_read_b64_tr_b16 v[28:29], v15 offset:24576
  ds_read_b64_tr_b16 v[30:31], v15 offset:25600
  s_waitcnt lgkmcnt(5)
  v_mfma_f32_32x32x16_bf16 v[64:79], v[20:23], v[32:35], v[64:79]
  v_mfma_f32_32x32x16_bf16 v[80:95], v[20:23], v[36:39], v[80:95]
  ds_read_b128 v[20:23], v11 offset:40960
  ds_read_b64_tr_b16 v[32:33], v14 offset:28672
  ds_read_b64_tr_b16 v[34:35], v14 offset:29696
  ds_read_b64_tr_b16 v[36:37], v15 offset:28672
  ds_read_b64_tr_b16 v[38:39], v15 offset:29696
  s_waitcnt lgkmcnt(5)
  v_mfma_f32_32x32x16_bf16 v[64:79], v[16:19], v[24:27], v[64:79]
  v_mfma_f32_32x32x16_bf16 v[80:95], v[16:19], v[28:31], v[80:95]
  s_waitcnt lgkmcnt(0)
  v_mfma_f32_32x32x16_bf16 v[64:79], v[20:23], v[32:35], v[64:79]
  v_mfma_f32_32x32x16_bf16 v[80:95], v[20:23], v[36:39], v[80:95]
  s_waitcnt vmcnt(6)
  s_barrier
  ds_read_b128 v[16:19], v8 offset:0
  ds_read_b64_tr_b16 v[24:25], v12 offset:0
  ds_read_b64_tr_b16 v[26:27], v12 offset:1024
  ds_read_b64_tr_b16 v[28:29], v13 offset:0
  ds_read_b64_tr_b16 v[30:31], v13 offset:1024
  ds_read_b128 v[20:23], v9 offset:0
  ds_read_b64_tr_b16 v[32:33], v12 offset:4096
  ds_read_b64_tr_b16 v[34:35], v12 offset:5120
  ds_read_b64_tr_b16 v[36:37], v13 offset:4096
  ds_read_b64_tr_b16 v[38:39], v13 offset:5120
  s_waitcnt lgkmcnt(5)
  v_mfma_f32_32x32x16_bf16 v[64:79], v[16:19], v[24:27], v[64:79]
  v_mfma_f32_32x32x16_bf16 v[80:95], v[16:19], v[28:31], v[80:95]
  ds_read_b128 v[16:19], v10 offset:0
  ds_read_b64_tr_b16 v[24:25], v12 offset:8192
  ds_read_b64_tr_b16 v[26:27], v12 offset:9216
  ds_read_b64_tr_b16 v[28:29], v13 offset:8192
  ds_read_b64_tr_b16 v[30:31], v13 offset:9216
  s_waitcnt lgkmcnt(5)
  v_mfma_f32_32x32x16_bf16 v[64:79], v[20:23], v[32:35], v[64:79]
  v_mfma_f32_32x32x16_bf16 v[80:95], v[20:23], v[36:39], v[80:95]
  ds_read_b128 v[20:23], v11 offset:0
  ds_read_b64_tr_b16 v[32:33], v12 offset:12288
  ds_read_b64_tr_b16 v[34:35], v12 offset:13312
  ds_read_b64_tr_b16 v[36:37], v13 offset:12288
  ds_read_b64_tr_b16 v[38:39], v13 offset:13312
  s_waitcnt lgkmcnt(5)
  v_mfma_f32_32x32x16_bf16 v[64:79], v[16:19], v[24:27], v[64:79]
  v_mfma_f32_32x32x16_bf16 v[80:95], v[16:19], v[28:31], v[80:95]
  s_waitcnt lgkmcnt(0)
  v_mfma_f32_32x32x16_bf16 v[64:79], v[20:23], v[32:35], v[64:79]
  v_mfma_f32_32x32x16_bf16 v[80:95], v[20:23], v[36:39], v[80:95]
  s_waitcnt vmcnt(0)
  s_barrier
  ds_read_b128 v[16:19], v8 offset:8192
  ds_read_b64_tr_b16 v[24:25], v12 offset:16384
  ds_read_b64_tr_b16 v[26:27], v12 offset:17408
  ds_read_b64_tr_b16 v[28:29], v13 offset:16384
  ds_read_b64_tr_b16 v[30:31], v13 offset:17408
  ds_read_b128 v[20:23], v9 offset:8192
  ds_read_b64_tr_b16 v[32:33], v12 offset:20480
  ds_read_b64_tr_b16 v[34:35], v12 offset:21504
  ds_read_b64_tr_b16 v[36:37], v13 offset:20480
  ds_read_b64_tr_b16 v[38:39], v13 offset:21504
  s_waitcnt lgkmcnt(5)
  v_mfma_f32_32x32x16_bf16 v[64:79], v[16:19], v[24:27], v[64:79]
  v_mfma_f32_32x32x16_bf16 v[80:95], v[16:19], v[28:31], v[80:95]
  ds_read_b128 v[16:19], v10 offset:8192
  ds_read_b64_tr_b16 v[24:25], v12 offset:24576
  ds_read_b64_tr_b16 v[26:27], v12 offset:25600
  ds_read_b64_tr_b16 v[28:29], v13 offset:24576
  ds_read_b64_tr_b16 v[30:31], v13 offset:25600
  s_waitcnt lgkmcnt(5)
  v_mfma_f32_32x32x16_bf16 v[64:79], v[20:23], v[32:35], v[64:79]
  v_mfma_f32_32x32x16_bf16 v[80:95], v[20:23], v[36:39], v[80:95]
  ds_read_b128 v[20:23], v11 offset:8192
  ds_read_b64_tr_b16 v[32:33], v12 offset:28672
  ds_read_b64_tr_b16 v[34:35], v12 offset:29696
  ds_read_b64_tr_b16 v[36:37], v13 offset:28672
  ds_read_b64_tr_b16 v[38:39], v13 offset:29696
  s_waitcnt lgkmcnt(5)
  v_mfma_f32_32x32x16_bf16 v[64:79], v[16:19], v[24:27], v[64:79]
  v_mfma_f32_32x32x16_bf16 v[80:95], v[16:19], v[28:31], v[80:95]
  s_waitcnt lgkmcnt(0)
  v_mfma_f32_32x32x16_bf16 v[64:79], v[20:23], v[32:35], v[64:79]
  v_mfma_f32_32x32x16_bf16 v[80:95], v[20:23], v[36:39], v[80:95]
  s_nop 15
  s_nop 3
  s_mov_b32 s12, s94
  s_and_b32 s13, s95, 0xffff
  s_mov_b32 s14, 2621440
  s_mov_b32 s15, 0x20000
  v_lshrrev_b32 v40, 5, v0
  v_and_b32 v41, 31, v0
  v_mul_u32_u24 v40, 5120, v40
  v_lshl_add_u32 v40, v41, 1, v40
  s_lshl_b32 s26, s24, 6
  s_and_b32 s27, s22, 1
  s_lshl_b32 s27, s27, 5
  s_add_u32 s26, s26, s27
  s_mul_i32 s26, s26, 1280
  s_lshl_b32 s27, s25, 8
  s_add_u32 s26, s26, s27
  s_lshr_b32 s27, s22, 1
  s_lshl_b32 s27, s27, 7
  s_add_u32 s26, s26, s27
  v_cvt_pk_bf16_f32 v44, v64, v65
  s_add_u32 s27, s26, 0
  buffer_store_short v44, v40, s[12:15], s27 offen
  buffer_store_short_d16_hi v44, v40, s[12:15], s27 offen offset:1280
  s_nop 0
  v_cvt_pk_bf16_f32 v44, v66, v67
  s_add_u32 s27, s26, 2560
  buffer_store_short v44, v40, s[12:15], s27 offen
  buffer_store_short_d16_hi v44, v40, s[12:15], s27 offen offset:1280
  s_nop 0
  v_cvt_pk_bf16_f32 v44, v68, v69
  s_add_u32 s27, s26, 10240
  buffer_store_short v44, v40, s[12:15], s27 offen
  buffer_store_short_d16_hi v44, v40, s[12:15], s27 offen offset:1280
  s_nop 0
  v_cvt_pk_bf16_f32 v44, v70, v71
  s_add_u32 s27, s26, 12800
  buffer_store_short v44, v40, s[12:15], s27 offen
  buffer_store_short_d16_hi v44, v40, s[12:15], s27 offen offset:1280
  s_nop 0
  v_cvt_pk_bf16_f32 v44, v72, v73
  s_add_u32 s27, s26, 20480
  buffer_store_short v44, v40, s[12:15], s27 offen
  buffer_store_short_d16_hi v44, v40, s[12:15], s27 offen offset:1280
  s_nop 0
  v_cvt_pk_bf16_f32 v44, v74, v75
  s_add_u32 s27, s26, 23040
  buffer_store_short v44, v40, s[12:15], s27 offen
  buffer_store_short_d16_hi v44, v40, s[12:15], s27 offen offset:1280
  s_nop 0
  v_cvt_pk_bf16_f32 v44, v76, v77
  s_add_u32 s27, s26, 30720
  buffer_store_short v44, v40, s[12:15], s27 offen
  buffer_store_short_d16_hi v44, v40, s[12:15], s27 offen offset:1280
  s_nop 0
  v_cvt_pk_bf16_f32 v44, v78, v79
  s_add_u32 s27, s26, 33280
  buffer_store_short v44, v40, s[12:15], s27 offen
  buffer_store_short_d16_hi v44, v40, s[12:15], s27 offen offset:1280
  s_nop 0
  v_cvt_pk_bf16_f32 v44, v80, v81
  s_add_u32 s27, s26, 64
  buffer_store_short v44, v40, s[12:15], s27 offen
  buffer_store_short_d16_hi v44, v40, s[12:15], s27 offen offset:1280
  s_nop 0
  v_cvt_pk_bf16_f32 v44, v82, v83
  s_add_u32 s27, s26, 2624
  buffer_store_short v44, v40, s[12:15], s27 offen
  buffer_store_short_d16_hi v44, v40, s[12:15], s27 offen offset:1280
  s_nop 0
  v_cvt_pk_bf16_f32 v44, v84, v85
  s_add_u32 s27, s26, 10304
  buffer_store_short v44, v40, s[12:15], s27 offen
  buffer_store_short_d16_hi v44, v40, s[12:15], s27 offen offset:1280
  s_nop 0
  v_cvt_pk_bf16_f32 v44, v86, v87
  s_add_u32 s27, s26, 12864
  buffer_store_short v44, v40, s[12:15], s27 offen
  buffer_store_short_d16_hi v44, v40, s[12:15], s27 offen offset:1280
  s_nop 0
  v_cvt_pk_bf16_f32 v44, v88, v89
  s_add_u32 s27, s26, 20544
  buffer_store_short v44, v40, s[12:15], s27 offen
  buffer_store_short_d16_hi v44, v40, s[12:15], s27 offen offset:1280
  s_nop 0
  v_cvt_pk_bf16_f32 v44, v90, v91
  s_add_u32 s27, s26, 23104
  buffer_store_short v44, v40, s[12:15], s27 offen
  buffer_store_short_d16_hi v44, v40, s[12:15], s27 offen offset:1280
  s_nop 0
  v_cvt_pk_bf16_f32 v44, v92, v93
  s_add_u32 s27, s26, 30784
  buffer_store_short v44, v40, s[12:15], s27 offen
  buffer_store_short_d16_hi v44, v40, s[12:15], s27 offen offset:1280
  s_nop 0
  v_cvt_pk_bf16_f32 v44, v94, v95
  s_add_u32 s27, s26, 33344
  buffer_store_short v44, v40, s[12:15], s27 offen
  buffer_store_short_d16_hi v44, v40, s[12:15], s27 offen offset:1280
  s_nop 0
  s_branch L_jobdone
JOP:
  s_mul_i32 s24, s23, 3277
  s_lshr_b32 s24, s24, 16
  s_mul_i32 s25, s24, 20
  s_sub_u32 s25, s23, s25
  s_mov_b32 s28, s24
  s_mul_i32 s26, s22, 32768
  v_lshrrev_b32 v40, 3, v0
  s_mov_b32 s40, 9472
  v_mul_lo_u32 v40, v40, s40
  v_and_b32 v41, 7, v0
  v_lshrrev_b32 v42, 4, v0
  v_xor_b32 v43, v41, v42
  v_lshl_add_u32 v6, v43, 4, v40
  v_xor_b32 v43, 4, v43
  v_lshl_add_u32 v7, v43, 4, v40
  v_lshrrev_b32 v40, 2, v0
  v_and_b32 v41, 3, v0
  v_mul_u32_u24 v42, 1280, v40
  v_lshl_add_u32 v4, v41, 4, v42
  v_bfe_u32 v42, v40, 2, 1
  v_lshlrev_b32 v42, 4, v42
  v_lshrrev_b32 v43, 3, v40
  v_lshl_add_u32 v42, v43, 2, v42
  v_and_b32 v43, 3, v40
  v_add_u32 v42, v42, v43
  v_mul_u32_u24 v42, 1280, v42
  v_lshl_add_u32 v5, v41, 4, v42
  v_and_b32 v40, 31, v0
  v_lshlrev_b32 v41, 7, v40
  v_add_u32 v41, s26, v41
  v_lshrrev_b32 v42, 1, v40
  v_and_b32 v42, 7, v42
  v_lshrrev_b32 v43, 5, v0
  v_xor_b32 v42, v42, v43
  v_xor_b32 v43, 0, v42
  v_lshl_add_u32 v8, v43, 4, v41
  v_xor_b32 v43, 2, v42
  v_lshl_add_u32 v9, v43, 4, v41
  v_xor_b32 v43, 4, v42
  v_lshl_add_u32 v10, v43, 4, v41
  v_xor_b32 v43, 6, v42
  v_lshl_add_u32 v11, v43, 4, v41
  v_bfe_u32 v40, v0, 2, 2
  v_lshrrev_b32 v41, 5, v0
  v_lshlrev_b32 v41, 3, v41
  v_add_u32 v41, v41, v40
  v_lshlrev_b32 v41, 6, v41
  v_bfe_u32 v42, v0, 4, 1
  v_lshl_add_u32 v41, v42, 5, v41
  v_and_b32 v42, 3, v0
  v_lshl_add_u32 v41, v42, 3, v41
  v_add_u32 v12, s26, v41
  s_lshl_b32 s62, s25, 6
  s_mov_b32 s16, s78
  s_and_b32 s17, s79, 0xffff
  s_mov_b32 s18, 819200
  s_mov_b32 s19, 0x20000
  s_add_u32 s34, s22, 0
  s_mul_i32 s35, s34, 81920
  s_add_u32 s33, s62, s35
  s_add_u32 s44, s33, 0
  s_add_u32 m0, s26, 0
  buffer_load_dwordx4 v4, s[16:19], s44 offen lds
  s_add_u32 s44, s33, 20480
  s_add_u32 m0, s26, 1024
  buffer_load_dwordx4 v4, s[16:19], s44 offen lds
  s_add_u32 s44, s33, 40960
  s_add_u32 m0, s26, 2048
  buffer_load_dwordx4 v4, s[16:19], s44 offen lds
  s_add_u32 s44, s33, 61440
  s_add_u32 m0, s26, 3072
  buffer_load_dwordx4 v4, s[16:19], s44 offen lds
  s_add_u32 s34, s22, 4
  s_mul_i32 s35, s34, 81920
  s_add_u32 s33, s62, s35
  s_add_u32 s44, s33, 0
  s_add_u32 m0, s26, 4096
  buffer_load_dwordx4 v4, s[16:19], s44 offen lds
  s_add_u32 s44, s33, 20480
  s_add_u32 m0, s26, 5120
  buffer_load_dwordx4 v4, s[16:19], s44 offen lds
  s_add_u32 s44, s33, 40960
  s_add_u32 m0, s26, 6144
  buffer_load_dwordx4 v4, s[16:19], s44 offen lds
  s_add_u32 s44, s33, 61440
  s_add_u32 m0, s26, 7168
  buffer_load_dwordx4 v4, s[16:19], s44 offen lds
  s_add_u32 s34, s22, 8
  s_mul_i32 s35, s34, 81920
  s_add_u32 s33, s62, s35
  s_add_u32 s44, s33, 0
  s_add_u32 m0, s26, 8192
  buffer_load_dwordx4 v4, s[16:19], s44 offen lds
  s_add_u32 s44, s33, 20480
  s_add_u32 m0, s26, 9216
  buffer_load_dwordx4 v4, s[16:19], s44 offen lds
  s_add_u32 s44, s33, 40960
  s_add_u32 m0, s26, 10240
  buffer_load_dwordx4 v4, s[16:19], s44 offen lds
  s_add_u32 s44, s33, 61440
  s_add_u32 m0, s26, 11264
  buffer_load_dwordx4 v4, s[16:19], s44 offen lds
  s_waitcnt vmcnt(0)
  ds_read_b64_tr_b16 v[80:81], v12 offset:0
  ds_read_b64_tr_b16 v[82:83], v12 offset:256
  ds_read_b64_tr_b16 v[84:85], v12 offset:1024
  ds_read_b64_tr_b16 v[86:87], v12 offset:1280
  ds_read_b64_tr_b16 v[88:89], v12 offset:2048
  ds_read_b64_tr_b16 v[90:91], v12 offset:2304
  ds_read_b64_tr_b16 v[92:93], v12 offset:3072
  ds_read_b64_tr_b16 v[94:95], v12 offset:3328
  s_waitcnt lgkmcnt(0)
  ds_read_b64_tr_b16 v[96:97], v12 offset:4096
  ds_read_b64_tr_b16 v[98:99], v12 offset:4352
  ds_read_b64_tr_b16 v[100:101], v12 offset:5120
  ds_read_b64_tr_b16 v[102:103], v12 offset:5376
  ds_read_b64_tr_b16 v[104:105], v12 offset:6144
  ds_read_b64_tr_b16 v[106:107], v12 offset:6400
  ds_read_b64_tr_b16 v[108:109], v12 offset:7168
  ds_read_b64_tr_b16 v[110:111], v12 offset:7424
  s_waitcnt lgkmcnt(0)
  ds_read_b64_tr_b16 v[112:113], v12 offset:8192
  ds_read_b64_tr_b16 v[114:115], v12 offset:8448
  ds_read_b64_tr_b16 v[116:117], v12 offset:9216
  ds_read_b64_tr_b16 v[118:119], v12 offset:9472
  ds_read_b64_tr_b16 v[120:121], v12 offset:10240
  ds_read_b64_tr_b16 v[122:123], v12 offset:10496
  ds_read_b64_tr_b16 v[124:125], v12 offset:11264
  ds_read_b64_tr_b16 v[126:127], v12 offset:11520
  s_waitcnt lgkmcnt(0)
  s_mov_b32 s16, s88
  s_and_b32 s17, s89, 0xffff
  s_mov_b32 s18, 5242880
  s_mov_b32 s19, 0x20000
  s_mul_i32 s35, s22, 81920
  s_add_u32 s33, s62, s35
  s_add_u32 s44, s33, 0
  s_add_u32 m0, s26, 0
  buffer_load_dwordx4 v5, s[16:19], s44 offen lds
  s_add_u32 s44, s33, 10240
  s_add_u32 m0, s26, 1024
  buffer_load_dwordx4 v5, s[16:19], s44 offen lds
  s_add_u32 s44, s33, 40960
  s_add_u32 m0, s26, 2048
  buffer_load_dwordx4 v5, s[16:19], s44 offen lds
  s_add_u32 s44, s33, 51200
  s_add_u32 m0, s26, 3072
  buffer_load_dwordx4 v5, s[16:19], s44 offen lds
  s_add_u32 s33, s33, 327680
  s_add_u32 s44, s33, 0
  s_add_u32 m0, s26, 4096
  buffer_load_dwordx4 v5, s[16:19], s44 offen lds
  s_add_u32 s44, s33, 10240
  s_add_u32 m0, s26, 5120
  buffer_load_dwordx4 v5, s[16:19], s44 offen lds
  s_add_u32 s44, s33, 40960
  s_add_u32 m0, s26, 6144
  buffer_load_dwordx4 v5, s[16:19], s44 offen lds
  s_add_u32 s44, s33, 51200
  s_add_u32 m0, s26, 7168
  buffer_load_dwordx4 v5, s[16:19], s44 offen lds
  s_add_u32 s33, s33, 327680
  s_add_u32 s44, s33, 0
  s_add_u32 m0, s26, 8192
  buffer_load_dwordx4 v5, s[16:19], s44 offen lds
  s_add_u32 s44, s33, 10240
  s_add_u32 m0, s26, 9216
  buffer_load_dwordx4 v5, s[16:19], s44 offen lds
  s_add_u32 s44, s33, 40960
  s_add_u32 m0, s26, 10240
  buffer_load_dwordx4 v5, s[16:19], s44 offen lds
  s_add_u32 s44, s33, 51200
  s_add_u32 m0, s26, 11264
  buffer_load_dwordx4 v5, s[16:19], s44 offen lds
  s_add_u32 s33, s33, 327680
  s_add_u32 s44, s33, 0
  s_add_u32 m0, s26, 12288
  buffer_load_dwordx4 v5, s[16:19], s44 offen lds
  s_add_u32 s44, s33, 10240
  s_add_u32 m0, s26, 13312
  buffer_load_dwordx4 v5, s[16:19], s44 offen lds
  s_add_u32 s44, s33, 40960
  s_add_u32 m0, s26, 14336
  buffer_load_dwordx4 v5, s[16:19], s44 offen lds
  s_add_u32 s44, s33, 51200
  s_add_u32 m0, s26, 15360
  buffer_load_dwordx4 v5, s[16:19], s44 offen lds
  s_add_u32 s33, s33, 327680
  s_waitcnt vmcnt(12)
  ds_read_b64_tr_b16 a[0:1], v12 offset:0
  ds_read_b64_tr_b16 a[2:3], v12 offset:256
  ds_read_b64_tr_b16 a[4:5], v12 offset:1024
  ds_read_b64_tr_b16 a[6:7], v12 offset:1280
  ds_read_b64_tr_b16 a[8:9], v12 offset:2048
  ds_read_b64_tr_b16 a[10:11], v12 offset:2304
  ds_read_b64_tr_b16 a[12:13], v12 offset:3072
  ds_read_b64_tr_b16 a[14:15], v12 offset:3328
  s_waitcnt lgkmcnt(0)
  s_add_u32 s44, s33, 0
  s_add_u32 m0, s26, 0
  buffer_load_dwordx4 v5, s[16:19], s44 offen lds
  s_add_u32 s44, s33, 10240
  s_add_u32 m0, s26, 1024
  buffer_load_dwordx4 v5, s[16:19], s44 offen lds
  s_add_u32 s44, s33, 40960
  s_add_u32 m0, s26, 2048
  buffer_load_dwordx4 v5, s[16:19], s44 offen lds
  s_add_u32 s44, s33, 51200
  s_add_u32 m0, s26, 3072
  buffer_load_dwordx4 v5, s[16:19], s44 offen lds
  s_add_u32 s33, s33, 327680
  s_waitcnt vmcnt(12)
  ds_read_b64_tr_b16 a[16:17], v12 offset:4096
  ds_read_b64_tr_b16 a[18:19], v12 offset:4352
  ds_read_b64_tr_b16 a[20:21], v12 offset:5120
  ds_read_b64_tr_b16 a[22:23], v12 offset:5376
  ds_read_b64_tr_b16 a[24:25], v12 offset:6144
  ds_read_b64_tr_b16 a[26:27], v12 offset:6400
  ds_read_b64_tr_b16 a[28:29], v12 offset:7168
  ds_read_b64_tr_b16 a[30:31], v12 offset:7424
  s_waitcnt lgkmcnt(0)
  s_add_u32 s44, s33, 0
  s_add_u32 m0, s26, 4096
  buffer_load_dwordx4 v5, s[16:19], s44 offen lds
  s_add_u32 s44, s33, 10240
  s_add_u32 m0, s26, 5120
  buffer_load_dwordx4 v5, s[16:19], s44 offen lds
  s_add_u32 s44, s33, 40960
  s_add_u32 m0, s26, 6144
  buffer_load_dwordx4 v5, s[16:19], s44 offen lds
  s_add_u32 s44, s33, 51200
  s_add_u32 m0, s26, 7168
  buffer_load_dwordx4 v5, s[16:19], s44 offen lds
  s_add_u32 s33, s33, 327680
  s_waitcnt vmcnt(12)
  ds_read_b64_tr_b16 a[32:33], v12 offset:8192
  ds_read_b64_tr_b16 a[34:35], v12 offset:8448
  ds_read_b64_tr_b16 a[36:37], v12 offset:9216
  ds_read_b64_tr_b16 a[38:39], v12 offset:9472
  ds_read_b64_tr_b16 a[40:41], v12 offset:10240
  ds_read_b64_tr_b16 a[42:43], v12 offset:10496
  ds_read_b64_tr_b16 a[44:45], v12 offset:11264
  ds_read_b64_tr_b16 a[46:47], v12 offset:11520
  s_waitcnt lgkmcnt(0)
  s_add_u32 s44, s33, 0
  s_add_u32 m0, s26, 8192
  buffer_load_dwordx4 v5, s[16:19], s44 offen lds
  s_add_u32 s44, s33, 10240
  s_add_u32 m0, s26, 9216
  buffer_load_dwordx4 v5, s[16:19], s44 offen lds
  s_add_u32 s44, s33, 40960
  s_add_u32 m0, s26, 10240
  buffer_load_dwordx4 v5, s[16:19], s44 offen lds
  s_add_u32 s44, s33, 51200
  s_add_u32 m0, s26, 11264
  buffer_load_dwordx4 v5, s[16:19], s44 offen lds
  s_add_u32 s33, s33, 327680
  s_waitcnt vmcnt(12)
  ds_read_b64_tr_b16 a[48:49], v12 offset:12288
  ds_read_b64_tr_b16 a[50:51], v12 offset:12544
  ds_read_b64_tr_b16 a[52:53], v12 offset:13312
  ds_read_b64_tr_b16 a[54:55], v12 offset:13568
  ds_read_b64_tr_b16 a[56:57], v12 offset:14336
  ds_read_b64_tr_b16 a[58:59], v12 offset:14592
  ds_read_b64_tr_b16 a[60:61], v12 offset:15360
  ds_read_b64_tr_b16 a[62:63], v12 offset:15616
  s_waitcnt lgkmcnt(0)
  s_add_u32 s44, s33, 0
  s_add_u32 m0, s26, 12288
  buffer_load_dwordx4 v5, s[16:19], s44 offen lds
  s_add_u32 s44, s33, 10240
  s_add_u32 m0, s26, 13312
  buffer_load_dwordx4 v5, s[16:19], s44 offen lds
  s_add_u32 s44, s33, 40960
  s_add_u32 m0, s26, 14336
  buffer_load_dwordx4 v5, s[16:19], s44 offen lds
  s_add_u32 s44, s33, 51200
  s_add_u32 m0, s26, 15360
  buffer_load_dwordx4 v5, s[16:19], s44 offen lds
  s_add_u32 s33, s33, 327680
  s_waitcnt vmcnt(12)
  ds_read_b64_tr_b16 a[64:65], v12 offset:0
  ds_read_b64_tr_b16 a[66:67], v12 offset:256
  ds_read_b64_tr_b16 a[68:69], v12 offset:1024
  ds_read_b64_tr_b16 a[70:71], v12 offset:1280
  ds_read_b64_tr_b16 a[72:73], v12 offset:2048
  ds_read_b64_tr_b16 a[74:75], v12 offset:2304
  ds_read_b64_tr_b16 a[76:77], v12 offset:3072
  ds_read_b64_tr_b16 a[78:79], v12 offset:3328
  s_waitcnt lgkmcnt(0)
  s_add_u32 s44, s33, 0
  s_add_u32 m0, s26, 0
  buffer_load_dwordx4 v5, s[16:19], s44 offen lds
  s_add_u32 s44, s33, 10240
  s_add_u32 m0, s26, 1024
  buffer_load_dwordx4 v5, s[16:19], s44 offen lds
  s_add_u32 s44, s33, 40960
  s_add_u32 m0, s26, 2048
  buffer_load_dwordx4 v5, s[16:19], s44 offen lds
  s_add_u32 s44, s33, 51200
  s_add_u32 m0, s26, 3072
  buffer_load_dwordx4 v5, s[16:19], s44 offen lds
  s_add_u32 s33, s33, 327680
  s_waitcnt vmcnt(12)
  ds_read_b64_tr_b16 a[80:81], v12 offset:4096
  ds_read_b64_tr_b16 a[82:83], v12 offset:4352
  ds_read_b64_tr_b16 a[84:85], v12 offset:5120
  ds_read_b64_tr_b16 a[86:87], v12 offset:5376
  ds_read_b64_tr_b16 a[88:89], v12 offset:6144
  ds_read_b64_tr_b16 a[90:91], v12 offset:6400
  ds_read_b64_tr_b16 a[92:93], v12 offset:7168
  ds_read_b64_tr_b16 a[94:95], v12 offset:7424
  s_waitcnt lgkmcnt(0)
  s_add_u32 s44, s33, 0
  s_add_u32 m0, s26, 4096
  buffer_load_dwordx4 v5, s[16:19], s44 offen lds
  s_add_u32 s44, s33, 10240
  s_add_u32 m0, s26, 5120
  buffer_load_dwordx4 v5, s[16:19], s44 offen lds
  s_add_u32 s44, s33, 40960
  s_add_u32 m0, s26, 6144
  buffer_load_dwordx4 v5, s[16:19], s44 offen lds
  s_add_u32 s44, s33, 51200
  s_add_u32 m0, s26, 7168
  buffer_load_dwordx4 v5, s[16:19], s44 offen lds
  s_add_u32 s33, s33, 327680
  s_waitcnt vmcnt(12)
  ds_read_b64_tr_b16 a[96:97], v12 offset:8192
  ds_read_b64_tr_b16 a[98:99], v12 offset:8448
  ds_read_b64_tr_b16 a[100:101], v12 offset:9216
  ds_read_b64_tr_b16 a[102:103], v12 offset:9472
  ds_read_b64_tr_b16 a[104:105], v12 offset:10240
  ds_read_b64_tr_b16 a[106:107], v12 offset:10496
  ds_read_b64_tr_b16 a[108:109], v12 offset:11264
  ds_read_b64_tr_b16 a[110:111], v12 offset:11520
  s_waitcnt lgkmcnt(0)
  s_add_u32 s44, s33, 0
  s_add_u32 m0, s26, 8192
  buffer_load_dwordx4 v5, s[16:19], s44 offen lds
  s_add_u32 s44, s33, 10240
  s_add_u32 m0, s26, 9216
  buffer_load_dwordx4 v5, s[16:19], s44 offen lds
  s_add_u32 s44, s33, 40960
  s_add_u32 m0, s26, 10240
  buffer_load_dwordx4 v5, s[16:19], s44 offen lds
  s_add_u32 s44, s33, 51200
  s_add_u32 m0, s26, 11264
  buffer_load_dwordx4 v5, s[16:19], s44 offen lds
  s_add_u32 s33, s33, 327680
  s_waitcnt vmcnt(12)
  ds_read_b64_tr_b16 a[112:113], v12 offset:12288
  ds_read_b64_tr_b16 a[114:115], v12 offset:12544
  ds_read_b64_tr_b16 a[116:117], v12 offset:13312
  ds_read_b64_tr_b16 a[118:119], v12 offset:13568
  ds_read_b64_tr_b16 a[120:121], v12 offset:14336
  ds_read_b64_tr_b16 a[122:123], v12 offset:14592
  ds_read_b64_tr_b16 a[124:125], v12 offset:15360
  ds_read_b64_tr_b16 a[126:127], v12 offset:15616
  s_waitcnt lgkmcnt(0)
  s_add_u32 s44, s33, 0
  s_add_u32 m0, s26, 12288
  buffer_load_dwordx4 v5, s[16:19], s44 offen lds
  s_add_u32 s44, s33, 10240
  s_add_u32 m0, s26, 13312
  buffer_load_dwordx4 v5, s[16:19], s44 offen lds
  s_add_u32 s44, s33, 40960
  s_add_u32 m0, s26, 14336
  buffer_load_dwordx4 v5, s[16:19], s44 offen lds
  s_add_u32 s44, s33, 51200
  s_add_u32 m0, s26, 15360
  buffer_load_dwordx4 v5, s[16:19], s44 offen lds
  s_add_u32 s33, s33, 327680
  s_waitcnt vmcnt(12)
  ds_read_b64_tr_b16 a[128:129], v12 offset:0
  ds_read_b64_tr_b16 a[130:131], v12 offset:256
  ds_read_b64_tr_b16 a[132:133], v12 offset:1024
  ds_read_b64_tr_b16 a[134:135], v12 offset:1280
  ds_read_b64_tr_b16 a[136:137], v12 offset:2048
  ds_read_b64_tr_b16 a[138:139], v12 offset:2304
  ds_read_b64_tr_b16 a[140:141], v12 offset:3072
  ds_read_b64_tr_b16 a[142:143], v12 offset:3328
  s_waitcnt lgkmcnt(0)
  s_add_u32 s44, s33, 0
  s_add_u32 m0, s26, 0
  buffer_load_dwordx4 v5, s[16:19], s44 offen lds
  s_add_u32 s44, s33, 10240
  s_add_u32 m0, s26, 1024
  buffer_load_dwordx4 v5, s[16:19], s44 offen lds
  s_add_u32 s44, s33, 40960
  s_add_u32 m0, s26, 2048
  buffer_load_dwordx4 v5, s[16:19], s44 offen lds
  s_add_u32 s44, s33, 51200
  s_add_u32 m0, s26, 3072
  buffer_load_dwordx4 v5, s[16:19], s44 offen lds
  s_add_u32 s33, s33, 327680
  s_waitcnt vmcnt(12)
  ds_read_b64_tr_b16 a[144:145], v12 offset:4096
  ds_read_b64_tr_b16 a[146:147], v12 offset:4352
  ds_read_b64_tr_b16 a[148:149], v12 offset:5120
  ds_read_b64_tr_b16 a[150:151], v12 offset:5376
  ds_read_b64_tr_b16 a[152:153], v12 offset:6144
  ds_read_b64_tr_b16 a[154:155], v12 offset:6400
  ds_read_b64_tr_b16 a[156:157], v12 offset:7168
  ds_read_b64_tr_b16 a[158:159], v12 offset:7424
  s_waitcnt lgkmcnt(0)
  s_add_u32 s44, s33, 0
  s_add_u32 m0, s26, 4096
  buffer_load_dwordx4 v5, s[16:19], s44 offen lds
  s_add_u32 s44, s33, 10240
  s_add_u32 m0, s26, 5120
  buffer_load_dwordx4 v5, s[16:19], s44 offen lds
  s_add_u32 s44, s33, 40960
  s_add_u32 m0, s26, 6144
  buffer_load_dwordx4 v5, s[16:19], s44 offen lds
  s_add_u32 s44, s33, 51200
  s_add_u32 m0, s26, 7168
  buffer_load_dwordx4 v5, s[16:19], s44 offen lds
  s_add_u32 s33, s33, 327680
  s_waitcnt vmcnt(12)
  ds_read_b64_tr_b16 a[160:161], v12 offset:8192
  ds_read_b64_tr_b16 a[162:163], v12 offset:8448
  ds_read_b64_tr_b16 a[164:165], v12 offset:9216
  ds_read_b64_tr_b16 a[166:167], v12 offset:9472
  ds_read_b64_tr_b16 a[168:169], v12 offset:10240
  ds_read_b64_tr_b16 a[170:171], v12 offset:10496
  ds_read_b64_tr_b16 a[172:173], v12 offset:11264
  ds_read_b64_tr_b16 a[174:175], v12 offset:11520
  s_waitcnt lgkmcnt(0)
  s_add_u32 s44, s33, 0
  s_add_u32 m0, s26, 8192
  buffer_load_dwordx4 v5, s[16:19], s44 offen lds
  s_add_u32 s44, s33, 10240
  s_add_u32 m0, s26, 9216
  buffer_load_dwordx4 v5, s[16:19], s44 offen lds
  s_add_u32 s44, s33, 40960
  s_add_u32 m0, s26, 10240
  buffer_load_dwordx4 v5, s[16:19], s44 offen lds
  s_add_u32 s44, s33, 51200
  s_add_u32 m0, s26, 11264
  buffer_load_dwordx4 v5, s[16:19], s44 offen lds
  s_add_u32 s33, s33, 327680
  s_waitcnt vmcnt(12)
  ds_read_b64_tr_b16 a[176:177], v12 offset:12288
  ds_read_b64_tr_b16 a[178:179], v12 offset:12544
  ds_read_b64_tr_b16 a[180:181], v12 offset:13312
  ds_read_b64_tr_b16 a[182:183], v12 offset:13568
  ds_read_b64_tr_b16 a[184:185], v12 offset:14336
  ds_read_b64_tr_b16 a[186:187], v12 offset:14592
  ds_read_b64_tr_b16 a[188:189], v12 offset:15360
  ds_read_b64_tr_b16 a[190:191], v12 offset:15616
  s_waitcnt lgkmcnt(0)
  s_add_u32 s44, s33, 0
  s_add_u32 m0, s26, 12288
  buffer_load_dwordx4 v5, s[16:19], s44 offen lds
  s_add_u32 s44, s33, 10240
  s_add_u32 m0, s26, 13312
  buffer_load_dwordx4 v5, s[16:19], s44 offen lds
  s_add_u32 s44, s33, 40960
  s_add_u32 m0, s26, 14336
  buffer_load_dwordx4 v5, s[16:19], s44 offen lds
  s_add_u32 s44, s33, 51200
  s_add_u32 m0, s26, 15360
  buffer_load_dwordx4 v5, s[16:19], s44 offen lds
  s_add_u32 s33, s33, 327680
  s_waitcnt vmcnt(12)
  ds_read_b64_tr_b16 a[192:193], v12 offset:0
  ds_read_b64_tr_b16 a[194:195], v12 offset:256
  ds_read_b64_tr_b16 a[196:197], v12 offset:1024
  ds_read_b64_tr_b16 a[198:199], v12 offset:1280
  ds_read_b64_tr_b16 a[200:201], v12 offset:2048
  ds_read_b64_tr_b16 a[202:203], v12 offset:2304
  ds_read_b64_tr_b16 a[204:205], v12 offset:3072
  ds_read_b64_tr_b16 a[206:207], v12 offset:3328
  s_waitcnt lgkmcnt(0)
  s_waitcnt vmcnt(8)
  ds_read_b64_tr_b16 a[208:209], v12 offset:4096
  ds_read_b64_tr_b16 a[210:211], v12 offset:4352
  ds_read_b64_tr_b16 a[212:213], v12 offset:5120
  ds_read_b64_tr_b16 a[214:215], v12 offset:5376
  ds_read_b64_tr_b16 a[216:217], v12 offset:6144
  ds_read_b64_tr_b16 a[218:219], v12 offset:6400
  ds_read_b64_tr_b16 a[220:221], v12 offset:7168
  ds_read_b64_tr_b16 a[222:223], v12 offset:7424
  s_waitcnt lgkmcnt(0)
  s_waitcnt vmcnt(4)
  ds_read_b64_tr_b16 a[224:225], v12 offset:8192
  ds_read_b64_tr_b16 a[226:227], v12 offset:8448
  ds_read_b64_tr_b16 a[228:229], v12 offset:9216
  ds_read_b64_tr_b16 a[230:231], v12 offset:9472
  ds_read_b64_tr_b16 a[232:233], v12 offset:10240
  ds_read_b64_tr_b16 a[234:235], v12 offset:10496
  ds_read_b64_tr_b16 a[236:237], v12 offset:11264
  ds_read_b64_tr_b16 a[238:239], v12 offset:11520
  s_waitcnt lgkmcnt(0)
  s_waitcnt vmcnt(0)
  ds_read_b64_tr_b16 a[240:241], v12 offset:12288
  ds_read_b64_tr_b16 a[242:243], v12 offset:12544
  ds_read_b64_tr_b16 a[244:245], v12 offset:13312
  ds_read_b64_tr_b16 a[246:247], v12 offset:13568
  ds_read_b64_tr_b16 a[248:249], v12 offset:14336
  ds_read_b64_tr_b16 a[250:251], v12 offset:14592
  ds_read_b64_tr_b16 a[252:253], v12 offset:15360
  ds_read_b64_tr_b16 a[254:255], v12 offset:15616
  s_waitcnt lgkmcnt(0)
  s_mov_b32 s29, 12
JOP_tb:
  s_cmp_lg_u32 s22, 0
  s_cbranch_scc1 L_dpa_e
  s_cmp_lg_u32 s69, 0
  s_cbranch_scc1 L_dpa_fr_d
  s_mov_b32 s71, 0
  v_mov_b32 v2, 40
L_dpa_fr_p:
  buffer_load_dword v1, v2, s[64:67], 0 offen sc1
  s_waitcnt vmcnt(0)
  v_readfirstlane_b32 s96, v1
  s_add_u32 s71, s71, 1
  s_cmp_ge_u32 s71, 2000000
  s_cbranch_scc1 L_dpa_fr_s
  s_cmp_eq_u32 s96, 0
  s_cbranch_scc1 L_dpa_fr_p
L_dpa_fr_s:
  s_mov_b32 s69, 1
L_dpa_fr_d:
L_dpa_e:
  s_lshl_b32 s98, s29, 7
  s_add_u32 s98, s98, 109056384
  s_cmp_lg_u32 s22, 0
  s_cbranch_scc1 L_dpa_b
  s_mov_b32 s71, 0
  v_mov_b32 v2, 0
L_dpa_p:
  buffer_load_dword v1, v2, s[8:11], s98 offen sc1
  s_waitcnt vmcnt(0)
  v_readfirstlane_b32 s96, v1
  s_add_u32 s71, s71, 1
  s_cmp_ge_u32 s71, 2000000
  s_cbranch_scc1 L_dpa_b
  s_cmp_ge_u32 s96, 8
  s_cbranch_scc1 L_dpa_b
  s_sleep 4
  s_branch L_dpa_p
L_dpa_b:
  s_barrier
  s_cmp_lg_u32 s22, 0
  s_cbranch_scc1 L_dpc_e
  s_cmp_lg_u32 s69, 0
  s_cbranch_scc1 L_dpc_fr_d
  s_mov_b32 s71, 0
  v_mov_b32 v2, 40
L_dpc_fr_p:
  buffer_load_dword v1, v2, s[64:67], 0 offen sc1
  s_waitcnt vmcnt(0)
  v_readfirstlane_b32 s96, v1
  s_add_u32 s71, s71, 1
  s_cmp_ge_u32 s71, 2000000
  s_cbranch_scc1 L_dpc_fr_s
  s_cmp_eq_u32 s96, 0
  s_cbranch_scc1 L_dpc_fr_p
L_dpc_fr_s:
  s_mov_b32 s69, 1
L_dpc_fr_d:
L_dpc_e:
  s_lshl_b32 s98, s29, 7
  s_add_u32 s98, s98, 109058432
  s_cmp_lg_u32 s22, 0
  s_cbranch_scc1 L_dpc_b
  s_mov_b32 s71, 0
  v_mov_b32 v2, 0
L_dpc_p:
  buffer_load_dword v1, v2, s[8:11], s98 offen sc1
  s_waitcnt vmcnt(0)
  v_readfirstlane_b32 s96, v1
  s_add_u32 s71, s71, 1
  s_cmp_ge_u32 s71, 2000000
  s_cbranch_scc1 L_dpc_b
  s_cmp_ge_u32 s96, 32
  s_cbranch_scc1 L_dpc_b
  s_sleep 1
  s_branch L_dpc_p
L_dpc_b:
  s_barrier
  s_lshl_b32 s24, s29, 2
  s_add_u32 s24, s24, s28
  s_mul_i32 s30, s24, 303104
  s_add_u32 s30, s30, 67108864
  s_mul_i32 s26, s22, 32768
  s_add_u32 s34, s22, 0
  s_min_u32 s34, s34, 9
  s_lshl_b32 s35, s34, 7
  s_add_u32 s31, s30, s35
  s_add_u32 s44, s31, 0
  s_add_u32 m0, s26, 0
  buffer_load_dwordx4 v6, s[8:11], s44 offen sc1 lds
  s_add_u32 s44, s31, 75776
  s_add_u32 m0, s26, 1024
  buffer_load_dwordx4 v7, s[8:11], s44 offen sc1 lds
  s_add_u32 s44, s31, 151552
  s_add_u32 m0, s26, 2048
  buffer_load_dwordx4 v6, s[8:11], s44 offen sc1 lds
  s_add_u32 s44, s31, 227328
  s_add_u32 m0, s26, 3072
  buffer_load_dwordx4 v7, s[8:11], s44 offen sc1 lds
  s_add_u32 s34, s22, 4
  s_min_u32 s34, s34, 9
  s_lshl_b32 s35, s34, 7
  s_add_u32 s31, s30, s35
  s_add_u32 s44, s31, 0
  s_add_u32 m0, s26, 4096
  buffer_load_dwordx4 v6, s[8:11], s44 offen sc1 lds
  s_add_u32 s44, s31, 75776
  s_add_u32 m0, s26, 5120
  buffer_load_dwordx4 v7, s[8:11], s44 offen sc1 lds
  s_add_u32 s44, s31, 151552
  s_add_u32 m0, s26, 6144
  buffer_load_dwordx4 v6, s[8:11], s44 offen sc1 lds
  s_add_u32 s44, s31, 227328
  s_add_u32 m0, s26, 7168
  buffer_load_dwordx4 v7, s[8:11], s44 offen sc1 lds
  s_add_u32 s34, s22, 8
  s_min_u32 s34, s34, 9
  s_lshl_b32 s35, s34, 7
  s_add_u32 s31, s30, s35
  s_add_u32 s44, s31, 0
  s_add_u32 m0, s26, 8192
  buffer_load_dwordx4 v6, s[8:11], s44 offen sc1 lds
  s_add_u32 s44, s31, 75776
  s_add_u32 m0, s26, 9216
  buffer_load_dwordx4 v7, s[8:11], s44 offen sc1 lds
  s_add_u32 s44, s31, 151552
  s_add_u32 m0, s26, 10240
  buffer_load_dwordx4 v6, s[8:11], s44 offen sc1 lds
  s_add_u32 s44, s31, 227328
  s_add_u32 m0, s26, 11264
  buffer_load_dwordx4 v7, s[8:11], s44 offen sc1 lds
  s_lshl_b32 s35, s22, 7
  s_add_u32 s35, s35, 1280
  s_add_u32 s31, s30, s35
  s_add_u32 s44, s31, 0
  s_add_u32 m0, s26, 12288
  buffer_load_dwordx4 v6, s[8:11], s44 offen sc1 lds
  s_add_u32 s44, s31, 75776
  s_add_u32 m0, s26, 13312
  buffer_load_dwordx4 v7, s[8:11], s44 offen sc1 lds
  s_add_u32 s44, s31, 151552
  s_add_u32 m0, s26, 14336
  buffer_load_dwordx4 v6, s[8:11], s44 offen sc1 lds
  s_add_u32 s44, s31, 227328
  s_add_u32 m0, s26, 15360
  buffer_load_dwordx4 v7, s[8:11], s44 offen sc1 lds
  s_lshl_b32 s35, s22, 7
  s_add_u32 s35, s35, 1792
  s_add_u32 s31, s30, s35
  s_add_u32 s44, s31, 0
  s_add_u32 m0, s26, 16384
  buffer_load_dwordx4 v6, s[8:11], s44 offen sc1 lds
  s_add_u32 s44, s31, 75776
  s_add_u32 m0, s26, 17408
  buffer_load_dwordx4 v7, s[8:11], s44 offen sc1 lds
  s_add_u32 s44, s31, 151552
  s_add_u32 m0, s26, 18432
  buffer_load_dwordx4 v6, s[8:11], s44 offen sc1 lds
  s_add_u32 s44, s31, 227328
  s_add_u32 m0, s26, 19456
  buffer_load_dwordx4 v7, s[8:11], s44 offen sc1 lds
  s_lshl_b32 s35, s22, 7
  s_add_u32 s35, s35, 2304
  s_add_u32 s31, s30, s35
  s_add_u32 s44, s31, 0
  s_add_u32 m0, s26, 20480
  buffer_load_dwordx4 v6, s[8:11], s44 offen sc1 lds
  s_add_u32 s44, s31, 75776
  s_add_u32 m0, s26, 21504
  buffer_load_dwordx4 v7, s[8:11], s44 offen sc1 lds
  s_add_u32 s44, s31, 151552
  s_add_u32 m0, s26, 22528
  buffer_load_dwordx4 v6, s[8:11], s44 offen sc1 lds
  s_add_u32 s44, s31, 227328
  s_add_u32 m0, s26, 23552
  buffer_load_dwordx4 v7, s[8:11], s44 offen sc1 lds
  s_lshl_b32 s35, s22, 7
  s_add_u32 s35, s35, 2816
  s_add_u32 s31, s30, s35
  s_add_u32 s44, s31, 0
  s_add_u32 m0, s26, 24576
  buffer_load_dwordx4 v6, s[8:11], s44 offen sc1 lds
  s_add_u32 s44, s31, 75776
  s_add_u32 m0, s26, 25600
  buffer_load_dwordx4 v7, s[8:11], s44 offen sc1 lds
  s_add_u32 s44, s31, 151552
  s_add_u32 m0, s26, 26624
  buffer_load_dwordx4 v6, s[8:11], s44 offen sc1 lds
  s_add_u32 s44, s31, 227328
  s_add_u32 m0, s26, 27648
  buffer_load_dwordx4 v7, s[8:11], s44 offen sc1 lds
  s_lshl_b32 s35, s22, 7
  s_add_u32 s35, s35, 3328
  s_add_u32 s31, s30, s35
  s_add_u32 s44, s31, 0
  s_add_u32 m0, s26, 28672
  buffer_load_dwordx4 v6, s[8:11], s44 offen sc1 lds
  s_add_u32 s44, s31, 75776
  s_add_u32 m0, s26, 29696
  buffer_load_dwordx4 v7, s[8:11], s44 offen sc1 lds
  s_add_u32 s44, s31, 151552
  s_add_u32 m0, s26, 30720
  buffer_load_dwordx4 v6, s[8:11], s44 offen sc1 lds
  s_add_u32 s44, s31, 227328
  s_add_u32 m0, s26, 31744
  buffer_load_dwordx4 v7, s[8:11], s44 offen sc1 lds
  s_waitcnt vmcnt(28)
  ds_read_b128 v[16:19], v8 offset:0
  ds_read_b128 v[20:23], v9 offset:0
  ds_read_b128 v[24:27], v10 offset:0
  ds_read_b128 v[28:31], v11 offset:0
  s_waitcnt lgkmcnt(3)
  v_mfma_f32_32x32x16_bf16 v[32:47], v[16:19], v[80:83], 0
  s_waitcnt lgkmcnt(2)
  v_mfma_f32_32x32x16_bf16 v[32:47], v[20:23], v[84:87], v[32:47]
  s_waitcnt lgkmcnt(1)
  v_mfma_f32_32x32x16_bf16 v[32:47], v[24:27], v[88:91], v[32:47]
  s_waitcnt lgkmcnt(0)
  v_mfma_f32_32x32x16_bf16 v[32:47], v[28:31], v[92:95], v[32:47]
  s_lshl_b32 s35, s22, 7
  s_add_u32 s35, s35, 3840
  s_add_u32 s31, s30, s35
  s_add_u32 s44, s31, 0
  s_add_u32 m0, s26, 0
  buffer_load_dwordx4 v6, s[8:11], s44 offen sc1 lds
  s_add_u32 s44, s31, 75776
  s_add_u32 m0, s26, 1024
  buffer_load_dwordx4 v7, s[8:11], s44 offen sc1 lds
  s_add_u32 s44, s31, 151552
  s_add_u32 m0, s26, 2048
  buffer_load_dwordx4 v6, s[8:11], s44 offen sc1 lds
  s_add_u32 s44, s31, 227328
  s_add_u32 m0, s26, 3072
  buffer_load_dwordx4 v7, s[8:11], s44 offen sc1 lds
  s_waitcnt vmcnt(28)
  ds_read_b128 v[16:19], v8 offset:4096
  ds_read_b128 v[20:23], v9 offset:4096
  ds_read_b128 v[24:27], v10 offset:4096
  ds_read_b128 v[28:31], v11 offset:4096
  s_waitcnt lgkmcnt(3)
  v_mfma_f32_32x32x16_bf16 v[32:47], v[16:19], v[96:99], v[32:47]
  s_waitcnt lgkmcnt(2)
  v_mfma_f32_32x32x16_bf16 v[32:47], v[20:23], v[100:103], v[32:47]
  s_waitcnt lgkmcnt(1)
  v_mfma_f32_32x32x16_bf16 v[32:47], v[24:27], v[104:107], v[32:47]
  s_waitcnt lgkmcnt(0)
  v_mfma_f32_32x32x16_bf16 v[32:47], v[28:31], v[108:111], v[32:47]
  s_lshl_b32 s35, s22, 7
  s_add_u32 s35, s35, 4352
  s_add_u32 s31, s30, s35
  s_add_u32 s44, s31, 0
  s_add_u32 m0, s26, 4096
  buffer_load_dwordx4 v6, s[8:11], s44 offen sc1 lds
  s_add_u32 s44, s31, 75776
  s_add_u32 m0, s26, 5120
  buffer_load_dwordx4 v7, s[8:11], s44 offen sc1 lds
  s_add_u32 s44, s31, 151552
  s_add_u32 m0, s26, 6144
  buffer_load_dwordx4 v6, s[8:11], s44 offen sc1 lds
  s_add_u32 s44, s31, 227328
  s_add_u32 m0, s26, 7168
  buffer_load_dwordx4 v7, s[8:11], s44 offen sc1 lds
  s_waitcnt vmcnt(28)
  ds_read_b128 v[16:19], v8 offset:8192
  ds_read_b128 v[20:23], v9 offset:8192
  ds_read_b128 v[24:27], v10 offset:8192
  ds_read_b128 v[28:31], v11 offset:8192
  s_waitcnt lgkmcnt(3)
  v_mfma_f32_32x32x16_bf16 v[32:47], v[16:19], v[112:115], v[32:47]
  s_waitcnt lgkmcnt(2)
  v_mfma_f32_32x32x16_bf16 v[32:47], v[20:23], v[116:119], v[32:47]
  s_waitcnt lgkmcnt(1)
  v_mfma_f32_32x32x16_bf16 v[32:47], v[24:27], v[120:123], v[32:47]
  s_waitcnt lgkmcnt(0)
  v_mfma_f32_32x32x16_bf16 v[32:47], v[28:31], v[124:127], v[32:47]
  s_lshl_b32 s35, s22, 7
  s_add_u32 s35, s35, 4864
  s_add_u32 s31, s30, s35
  s_add_u32 s44, s31, 0
  s_add_u32 m0, s26, 8192
  buffer_load_dwordx4 v6, s[8:11], s44 offen sc1 lds
  s_add_u32 s44, s31, 75776
  s_add_u32 m0, s26, 9216
  buffer_load_dwordx4 v7, s[8:11], s44 offen sc1 lds
  s_add_u32 s44, s31, 151552
  s_add_u32 m0, s26, 10240
  buffer_load_dwordx4 v6, s[8:11], s44 offen sc1 lds
  s_add_u32 s44, s31, 227328
  s_add_u32 m0, s26, 11264
  buffer_load_dwordx4 v7, s[8:11], s44 offen sc1 lds
  s_waitcnt vmcnt(28)
  ds_read_b128 v[16:19], v8 offset:12288
  ds_read_b128 v[20:23], v9 offset:12288
  ds_read_b128 v[24:27], v10 offset:12288
  ds_read_b128 v[28:31], v11 offset:12288
  s_waitcnt lgkmcnt(3)
  v_mfma_f32_32x32x16_bf16 v[32:47], v[16:19], a[0:3], v[32:47]
  s_waitcnt lgkmcnt(2)
  v_mfma_f32_32x32x16_bf16 v[32:47], v[20:23], a[4:7], v[32:47]
  s_waitcnt lgkmcnt(1)
  v_mfma_f32_32x32x16_bf16 v[32:47], v[24:27], a[8:11], v[32:47]
  s_waitcnt lgkmcnt(0)
  v_mfma_f32_32x32x16_bf16 v[32:47], v[28:31], a[12:15], v[32:47]
  s_lshl_b32 s35, s22, 7
  s_add_u32 s35, s35, 5376
  s_add_u32 s31, s30, s35
  s_add_u32 s44, s31, 0
  s_add_u32 m0, s26, 12288
  buffer_load_dwordx4 v6, s[8:11], s44 offen sc1 lds
  s_add_u32 s44, s31, 75776
  s_add_u32 m0, s26, 13312
  buffer_load_dwordx4 v7, s[8:11], s44 offen sc1 lds
  s_add_u32 s44, s31, 151552
  s_add_u32 m0, s26, 14336
  buffer_load_dwordx4 v6, s[8:11], s44 offen sc1 lds
  s_add_u32 s44, s31, 227328
  s_add_u32 m0, s26, 15360
  buffer_load_dwordx4 v7, s[8:11], s44 offen sc1 lds
  s_waitcnt vmcnt(28)
  ds_read_b128 v[16:19], v8 offset:16384
  ds_read_b128 v[20:23], v9 offset:16384
  ds_read_b128 v[24:27], v10 offset:16384
  ds_read_b128 v[28:31], v11 offset:16384
  s_waitcnt lgkmcnt(3)
  v_mfma_f32_32x32x16_bf16 v[32:47], v[16:19], a[16:19], v[32:47]
  s_waitcnt lgkmcnt(2)
  v_mfma_f32_32x32x16_bf16 v[32:47], v[20:23], a[20:23], v[32:47]
  s_waitcnt lgkmcnt(1)
  v_mfma_f32_32x32x16_bf16 v[32:47], v[24:27], a[24:27], v[32:47]
  s_waitcnt lgkmcnt(0)
  v_mfma_f32_32x32x16_bf16 v[32:47], v[28:31], a[28:31], v[32:47]
  s_lshl_b32 s35, s22, 7
  s_add_u32 s35, s35, 5888
  s_add_u32 s31, s30, s35
  s_add_u32 s44, s31, 0
  s_add_u32 m0, s26, 16384
  buffer_load_dwordx4 v6, s[8:11], s44 offen sc1 lds
  s_add_u32 s44, s31, 75776
  s_add_u32 m0, s26, 17408
  buffer_load_dwordx4 v7, s[8:11], s44 offen sc1 lds
  s_add_u32 s44, s31, 151552
  s_add_u32 m0, s26, 18432
  buffer_load_dwordx4 v6, s[8:11], s44 offen sc1 lds
  s_add_u32 s44, s31, 227328
  s_add_u32 m0, s26, 19456
  buffer_load_dwordx4 v7, s[8:11], s44 offen sc1 lds
  s_waitcnt vmcnt(28)
  ds_read_b128 v[16:19], v8 offset:20480
  ds_read_b128 v[20:23], v9 offset:20480
  ds_read_b128 v[24:27], v10 offset:20480
  ds_read_b128 v[28:31], v11 offset:20480
  s_waitcnt lgkmcnt(3)
  v_mfma_f32_32x32x16_bf16 v[32:47], v[16:19], a[32:35], v[32:47]
  s_waitcnt lgkmcnt(2)
  v_mfma_f32_32x32x16_bf16 v[32:47], v[20:23], a[36:39], v[32:47]
  s_waitcnt lgkmcnt(1)
  v_mfma_f32_32x32x16_bf16 v[32:47], v[24:27], a[40:43], v[32:47]
  s_waitcnt lgkmcnt(0)
  v_mfma_f32_32x32x16_bf16 v[32:47], v[28:31], a[44:47], v[32:47]
  s_lshl_b32 s35, s22, 7
  s_add_u32 s35, s35, 6400
  s_add_u32 s31, s30, s35
  s_add_u32 s44, s31, 0
  s_add_u32 m0, s26, 20480
  buffer_load_dwordx4 v6, s[8:11], s44 offen sc1 lds
  s_add_u32 s44, s31, 75776
  s_add_u32 m0, s26, 21504
  buffer_load_dwordx4 v7, s[8:11], s44 offen sc1 lds
  s_add_u32 s44, s31, 151552
  s_add_u32 m0, s26, 22528
  buffer_load_dwordx4 v6, s[8:11], s44 offen sc1 lds
  s_add_u32 s44, s31, 227328
  s_add_u32 m0, s26, 23552
  buffer_load_dwordx4 v7, s[8:11], s44 offen sc1 lds
  s_waitcnt vmcnt(28)
  ds_read_b128 v[16:19], v8 offset:24576
  ds_read_b128 v[20:23], v9 offset:24576
  ds_read_b128 v[24:27], v10 offset:24576
  ds_read_b128 v[28:31], v11 offset:24576
  s_waitcnt lgkmcnt(3)
  v_mfma_f32_32x32x16_bf16 v[32:47], v[16:19], a[48:51], v[32:47]
  s_waitcnt lgkmcnt(2)
  v_mfma_f32_32x32x16_bf16 v[32:47], v[20:23], a[52:55], v[32:47]
  s_waitcnt lgkmcnt(1)
  v_mfma_f32_32x32x16_bf16 v[32:47], v[24:27], a[56:59], v[32:47]
  s_waitcnt lgkmcnt(0)
  v_mfma_f32_32x32x16_bf16 v[32:47], v[28:31], a[60:63], v[32:47]
  s_lshl_b32 s35, s22, 7
  s_add_u32 s35, s35, 6912
  s_add_u32 s31, s30, s35
  s_add_u32 s44, s31, 0
  s_add_u32 m0, s26, 24576
  buffer_load_dwordx4 v6, s[8:11], s44 offen sc1 lds
  s_add_u32 s44, s31, 75776
  s_add_u32 m0, s26, 25600
  buffer_load_dwordx4 v7, s[8:11], s44 offen sc1 lds
  s_add_u32 s44, s31, 151552
  s_add_u32 m0, s26, 26624
  buffer_load_dwordx4 v6, s[8:11], s44 offen sc1 lds
  s_add_u32 s44, s31, 227328
  s_add_u32 m0, s26, 27648
  buffer_load_dwordx4 v7, s[8:11], s44 offen sc1 lds
  s_waitcnt vmcnt(28)
  ds_read_b128 v[16:19], v8 offset:28672
  ds_read_b128 v[20:23], v9 offset:28672
  ds_read_b128 v[24:27], v10 offset:28672
  ds_read_b128 v[28:31], v11 offset:28672
  s_waitcnt lgkmcnt(3)
  v_mfma_f32_32x32x16_bf16 v[32:47], v[16:19], a[64:67], v[32:47]
  s_waitcnt lgkmcnt(2)
  v_mfma_f32_32x32x16_bf16 v[32:47], v[20:23], a[68:71], v[32:47]
  s_waitcnt lgkmcnt(1)
  v_mfma_f32_32x32x16_bf16 v[32:47], v[24:27], a[72:75], v[32:47]
  s_waitcnt lgkmcnt(0)
  v_mfma_f32_32x32x16_bf16 v[32:47], v[28:31], a[76:79], v[32:47]
  s_lshl_b32 s35, s22, 7
  s_add_u32 s35, s35, 7424
  s_add_u32 s31, s30, s35
  s_add_u32 s44, s31, 0
  s_add_u32 m0, s26, 28672
  buffer_load_dwordx4 v6, s[8:11], s44 offen sc1 lds
  s_add_u32 s44, s31, 75776
  s_add_u32 m0, s26, 29696
  buffer_load_dwordx4 v7, s[8:11], s44 offen sc1 lds
  s_add_u32 s44, s31, 151552
  s_add_u32 m0, s26, 30720
  buffer_load_dwordx4 v6, s[8:11], s44 offen sc1 lds
  s_add_u32 s44, s31, 227328
  s_add_u32 m0, s26, 31744
  buffer_load_dwordx4 v7, s[8:11], s44 offen sc1 lds
  s_waitcnt vmcnt(28)
  ds_read_b128 v[16:19], v8 offset:0
  ds_read_b128 v[20:23], v9 offset:0
  ds_read_b128 v[24:27], v10 offset:0
  ds_read_b128 v[28:31], v11 offset:0
  s_waitcnt lgkmcnt(3)
  v_mfma_f32_32x32x16_bf16 v[32:47], v[16:19], a[80:83], v[32:47]
  s_waitcnt lgkmcnt(2)
  v_mfma_f32_32x32x16_bf16 v[32:47], v[20:23], a[84:87], v[32:47]
  s_waitcnt lgkmcnt(1)
  v_mfma_f32_32x32x16_bf16 v[32:47], v[24:27], a[88:91], v[32:47]
  s_waitcnt lgkmcnt(0)
  v_mfma_f32_32x32x16_bf16 v[32:47], v[28:31], a[92:95], v[32:47]
  s_lshl_b32 s35, s22, 7
  s_add_u32 s35, s35, 7936
  s_add_u32 s31, s30, s35
  s_add_u32 s44, s31, 0
  s_add_u32 m0, s26, 0
  buffer_load_dwordx4 v6, s[8:11], s44 offen sc1 lds
  s_add_u32 s44, s31, 75776
  s_add_u32 m0, s26, 1024
  buffer_load_dwordx4 v7, s[8:11], s44 offen sc1 lds
  s_add_u32 s44, s31, 151552
  s_add_u32 m0, s26, 2048
  buffer_load_dwordx4 v6, s[8:11], s44 offen sc1 lds
  s_add_u32 s44, s31, 227328
  s_add_u32 m0, s26, 3072
  buffer_load_dwordx4 v7, s[8:11], s44 offen sc1 lds
  s_waitcnt vmcnt(28)
  ds_read_b128 v[16:19], v8 offset:4096
  ds_read_b128 v[20:23], v9 offset:4096
  ds_read_b128 v[24:27], v10 offset:4096
  ds_read_b128 v[28:31], v11 offset:4096
  s_waitcnt lgkmcnt(3)
  v_mfma_f32_32x32x16_bf16 v[32:47], v[16:19], a[96:99], v[32:47]
  s_waitcnt lgkmcnt(2)
  v_mfma_f32_32x32x16_bf16 v[32:47], v[20:23], a[100:103], v[32:47]
  s_waitcnt lgkmcnt(1)
  v_mfma_f32_32x32x16_bf16 v[32:47], v[24:27], a[104:107], v[32:47]
  s_waitcnt lgkmcnt(0)
  v_mfma_f32_32x32x16_bf16 v[32:47], v[28:31], a[108:111], v[32:47]
  s_lshl_b32 s35, s22, 7
  s_add_u32 s35, s35, 8448
  s_add_u32 s31, s30, s35
  s_add_u32 s44, s31, 0
  s_add_u32 m0, s26, 4096
  buffer_load_dwordx4 v6, s[8:11], s44 offen sc1 lds
  s_add_u32 s44, s31, 75776
  s_add_u32 m0, s26, 5120
  buffer_load_dwordx4 v7, s[8:11], s44 offen sc1 lds
  s_add_u32 s44, s31, 151552
  s_add_u32 m0, s26, 6144
  buffer_load_dwordx4 v6, s[8:11], s44 offen sc1 lds
  s_add_u32 s44, s31, 227328
  s_add_u32 m0, s26, 7168
  buffer_load_dwordx4 v7, s[8:11], s44 offen sc1 lds
  s_waitcnt vmcnt(28)
  ds_read_b128 v[16:19], v8 offset:8192
  ds_read_b128 v[20:23], v9 offset:8192
  ds_read_b128 v[24:27], v10 offset:8192
  ds_read_b128 v[28:31], v11 offset:8192
  s_waitcnt lgkmcnt(3)
  v_mfma_f32_32x32x16_bf16 v[32:47], v[16:19], a[112:115], v[32:47]
  s_waitcnt lgkmcnt(2)
  v_mfma_f32_32x32x16_bf16 v[32:47], v[20:23], a[116:119], v[32:47]
  s_waitcnt lgkmcnt(1)
  v_mfma_f32_32x32x16_bf16 v[32:47], v[24:27], a[120:123], v[32:47]
  s_waitcnt lgkmcnt(0)
  v_mfma_f32_32x32x16_bf16 v[32:47], v[28:31], a[124:127], v[32:47]
  s_lshl_b32 s35, s22, 7
  s_add_u32 s35, s35, 8960
  s_add_u32 s31, s30, s35
  s_add_u32 s44, s31, 0
  s_add_u32 m0, s26, 8192
  buffer_load_dwordx4 v6, s[8:11], s44 offen sc1 lds
  s_add_u32 s44, s31, 75776
  s_add_u32 m0, s26, 9216
  buffer_load_dwordx4 v7, s[8:11], s44 offen sc1 lds
  s_add_u32 s44, s31, 151552
  s_add_u32 m0, s26, 10240
  buffer_load_dwordx4 v6, s[8:11], s44 offen sc1 lds
  s_add_u32 s44, s31, 227328
  s_add_u32 m0, s26, 11264
  buffer_load_dwordx4 v7, s[8:11], s44 offen sc1 lds
  s_waitcnt vmcnt(28)
  ds_read_b128 v[16:19], v8 offset:12288
  ds_read_b128 v[20:23], v9 offset:12288
  ds_read_b128 v[24:27], v10 offset:12288
  ds_read_b128 v[28:31], v11 offset:12288
  s_waitcnt lgkmcnt(3)
  v_mfma_f32_32x32x16_bf16 v[32:47], v[16:19], a[128:131], v[32:47]
  s_waitcnt lgkmcnt(2)
  v_mfma_f32_32x32x16_bf16 v[32:47], v[20:23], a[132:135], v[32:47]
  s_waitcnt lgkmcnt(1)
  v_mfma_f32_32x32x16_bf16 v[32:47], v[24:27], a[136:139], v[32:47]
  s_waitcnt lgkmcnt(0)
  v_mfma_f32_32x32x16_bf16 v[32:47], v[28:31], a[140:143], v[32:47]
  s_waitcnt vmcnt(24)
  ds_read_b128 v[16:19], v8 offset:16384
  ds_read_b128 v[20:23], v9 offset:16384
  ds_read_b128 v[24:27], v10 offset:16384
  ds_read_b128 v[28:31], v11 offset:16384
  s_waitcnt lgkmcnt(3)
  v_mfma_f32_32x32x16_bf16 v[32:47], v[16:19], a[144:147], v[32:47]
  s_waitcnt lgkmcnt(2)
  v_mfma_f32_32x32x16_bf16 v[32:47], v[20:23], a[148:151], v[32:47]
  s_waitcnt lgkmcnt(1)
  v_mfma_f32_32x32x16_bf16 v[32:47], v[24:27], a[152:155], v[32:47]
  s_waitcnt lgkmcnt(0)
  v_mfma_f32_32x32x16_bf16 v[32:47], v[28:31], a[156:159], v[32:47]
  s_waitcnt vmcnt(20)
  ds_read_b128 v[16:19], v8 offset:20480
  ds_read_b128 v[20:23], v9 offset:20480
  ds_read_b128 v[24:27], v10 offset:20480
  ds_read_b128 v[28:31], v11 offset:20480
  s_waitcnt lgkmcnt(3)
  v_mfma_f32_32x32x16_bf16 v[32:47], v[16:19], a[160:163], v[32:47]
  s_waitcnt lgkmcnt(2)
  v_mfma_f32_32x32x16_bf16 v[32:47], v[20:23], a[164:167], v[32:47]
  s_waitcnt lgkmcnt(1)
  v_mfma_f32_32x32x16_bf16 v[32:47], v[24:27], a[168:171], v[32:47]
  s_waitcnt lgkmcnt(0)
  v_mfma_f32_32x32x16_bf16 v[32:47], v[28:31], a[172:175], v[32:47]
  s_waitcnt vmcnt(16)
  ds_read_b128 v[16:19], v8 offset:24576
  ds_read_b128 v[20:23], v9 offset:24576
  ds_read_b128 v[24:27], v10 offset:24576
  ds_read_b128 v[28:31], v11 offset:24576
  s_waitcnt lgkmcnt(3)
  v_mfma_f32_32x32x16_bf16 v[32:47], v[16:19], a[176:179], v[32:47]
  s_waitcnt lgkmcnt(2)
  v_mfma_f32_32x32x16_bf16 v[32:47], v[20:23], a[180:183], v[32:47]
  s_waitcnt lgkmcnt(1)
  v_mfma_f32_32x32x16_bf16 v[32:47], v[24:27], a[184:187], v[32:47]
  s_waitcnt lgkmcnt(0)
  v_mfma_f32_32x32x16_bf16 v[32:47], v[28:31], a[188:191], v[32:47]
  s_waitcnt vmcnt(12)
  ds_read_b128 v[16:19], v8 offset:28672
  ds_read_b128 v[20:23], v9 offset:28672
  ds_read_b128 v[24:27], v10 offset:28672
  ds_read_b128 v[28:31], v11 offset:28672
  s_waitcnt lgkmcnt(3)
  v_mfma_f32_32x32x16_bf16 v[32:47], v[16:19], a[192:195], v[32:47]
  s_waitcnt lgkmcnt(2)
  v_mfma_f32_32x32x16_bf16 v[32:47], v[20:23], a[196:199], v[32:47]
  s_waitcnt lgkmcnt(1)
  v_mfma_f32_32x32x16_bf16 v[32:47], v[24:27], a[200:203], v[32:47]
  s_waitcnt lgkmcnt(0)
  v_mfma_f32_32x32x16_bf16 v[32:47], v[28:31], a[204:207], v[32:47]
  s_waitcnt vmcnt(8)
  ds_read_b128 v[16:19], v8 offset:0
  ds_read_b128 v[20:23], v9 offset:0
  ds_read_b128 v[24:27], v10 offset:0
  ds_read_b128 v[28:31], v11 offset:0
  s_waitcnt lgkmcnt(3)
  v_mfma_f32_32x32x16_bf16 v[32:47], v[16:19], a[208:211], v[32:47]
  s_waitcnt lgkmcnt(2)
  v_mfma_f32_32x32x16_bf16 v[32:47], v[20:23], a[212:215], v[32:47]
  s_waitcnt lgkmcnt(1)
  v_mfma_f32_32x32x16_bf16 v[32:47], v[24:27], a[216:219], v[32:47]
  s_waitcnt lgkmcnt(0)
  v_mfma_f32_32x32x16_bf16 v[32:47], v[28:31], a[220:223], v[32:47]
  s_waitcnt vmcnt(4)
  ds_read_b128 v[16:19], v8 offset:4096
  ds_read_b128 v[20:23], v9 offset:4096
  ds_read_b128 v[24:27], v10 offset:4096
  ds_read_b128 v[28:31], v11 offset:4096
  s_waitcnt lgkmcnt(3)
  v_mfma_f32_32x32x16_bf16 v[32:47], v[16:19], a[224:227], v[32:47]
  s_waitcnt lgkmcnt(2)
  v_mfma_f32_32x32x16_bf16 v[32:47], v[20:23], a[228:231], v[32:47]
  s_waitcnt lgkmcnt(1)
  v_mfma_f32_32x32x16_bf16 v[32:47], v[24:27], a[232:235], v[32:47]
  s_waitcnt lgkmcnt(0)
  v_mfma_f32_32x32x16_bf16 v[32:47], v[28:31], a[236:239], v[32:47]
  s_waitcnt vmcnt(0)
  ds_read_b128 v[16:19], v8 offset:8192
  ds_read_b128 v[20:23], v9 offset:8192
  ds_read_b128 v[24:27], v10 offset:8192
  ds_read_b128 v[28:31], v11 offset:8192
  s_waitcnt lgkmcnt(3)
  v_mfma_f32_32x32x16_bf16 v[32:47], v[16:19], a[240:243], v[32:47]
  s_waitcnt lgkmcnt(2)
  v_mfma_f32_32x32x16_bf16 v[32:47], v[20:23], a[244:247], v[32:47]
  s_waitcnt lgkmcnt(1)
  v_mfma_f32_32x32x16_bf16 v[32:47], v[24:27], a[248:251], v[32:47]
  s_waitcnt lgkmcnt(0)
  v_mfma_f32_32x32x16_bf16 v[32:47], v[28:31], a[252:255], v[32:47]
  s_nop 15
  s_nop 3
  s_lshl_b32 s34, s22, 12
  v_lshlrev_b32 v70, 2, v0
  v_add_u32 v71, s34, v70
  v_add_u32 v71, 131072, v71
  ds_write_b32 v71, v32 offset:0
  ds_write_b32 v71, v33 offset:256
  ds_write_b32 v71, v34 offset:512
  ds_write_b32 v71, v35 offset:768
  ds_write_b32 v71, v36 offset:1024
  ds_write_b32 v71, v37 offset:1280
  ds_write_b32 v71, v38 offset:1536
  ds_write_b32 v71, v39 offset:1792
  ds_write_b32 v71, v40 offset:2048
  ds_write_b32 v71, v41 offset:2304
  ds_write_b32 v71, v42 offset:2560
  ds_write_b32 v71, v43 offset:2816
  ds_write_b32 v71, v44 offset:3072
  ds_write_b32 v71, v45 offset:3328
  ds_write_b32 v71, v46 offset:3584
  ds_write_b32 v71, v47 offset:3840
  s_waitcnt lgkmcnt(0)
  s_barrier
  s_lshl_b32 s34, s22, 10
  v_add_u32 v71, s34, v70
  v_add_u32 v71, 131072, v71
  ds_read_b32 v48, v71 offset:0
  ds_read_b32 v49, v71 offset:256
  ds_read_b32 v50, v71 offset:512
  ds_read_b32 v51, v71 offset:768
  ds_read_b32 v52, v71 offset:4096
  ds_read_b32 v53, v71 offset:4352
  ds_read_b32 v54, v71 offset:4608
  ds_read_b32 v55, v71 offset:4864
  ds_read_b32 v56, v71 offset:8192
  ds_read_b32 v57, v71 offset:8448
  ds_read_b32 v58, v71 offset:8704
  ds_read_b32 v59, v71 offset:8960
  ds_read_b32 v60, v71 offset:12288
  ds_read_b32 v61, v71 offset:12544
  ds_read_b32 v62, v71 offset:12800
  ds_read_b32 v63, v71 offset:13056
  s_waitcnt lgkmcnt(0)
  v_add_f32 v48, v48, v52
  v_add_f32 v56, v56, v60
  v_add_f32 v48, v48, v56
  v_add_f32 v49, v49, v53
  v_add_f32 v57, v57, v61
  v_add_f32 v49, v49, v57
  v_add_f32 v50, v50, v54
  v_add_f32 v58, v58, v62
  v_add_f32 v50, v50, v58
  v_add_f32 v51, v51, v55
  v_add_f32 v59, v59, v63
  v_add_f32 v51, v51, v59
  s_mov_b32 s12, s94
  s_and_b32 s13, s95, 0xffff
  s_mov_b32 s14, 2621440
  s_mov_b32 s15, 0x20000
  v_cvt_pk_bf16_f32 v74, v48, v49
  v_cvt_pk_bf16_f32 v75, v50, v51
  v_lshrrev_b32 v70, 5, v0
  v_and_b32 v71, 31, v0
  v_mul_u32_u24 v70, 5120, v70
  v_lshl_add_u32 v70, v71, 1, v70
  s_lshl_b32 s26, s24, 5
  s_lshl_b32 s27, s22, 3
  s_add_u32 s26, s26, s27
  s_mul_i32 s26, s26, 1280
  s_add_u32 s26, s26, s62
  buffer_store_short v74, v70, s[12:15], s26 offen
  buffer_store_short_d16_hi v74, v70, s[12:15], s26 offen offset:1280
  buffer_store_short v75, v70, s[12:15], s26 offen offset:2560
  buffer_store_short_d16_hi v75, v70, s[12:15], s26 offen offset:3840
  s_add_u32 s29, s29, 1
  s_cmp_lt_u32 s29, 16
  s_cbranch_scc0 L_jobdone
  s_waitcnt lgkmcnt(0)
  s_barrier
  s_branch JOP_tb
L_codeend:
  s_endpgm
.section .rodata,"a"
.p2align 6
.amdhsa_kernel main_kernel
  .amdhsa_next_free_vgpr 512
  .amdhsa_next_free_sgpr 102
  .amdhsa_accum_offset 256
  .amdhsa_group_segment_fixed_size 0
  .amdhsa_kernarg_size 120
  .amdhsa_user_sgpr_count 2
  .amdhsa_user_sgpr_kernarg_segment_ptr 1
  .amdhsa_system_sgpr_workgroup_id_x 1
  .amdhsa_float_denorm_mode_32 3
.end_amdhsa_kernel
.text
```
